```python
import torch

def _softmax(x, axis=-1):
    return torch.softmax(x, dim=axis)

def _gelu(x):
    return torch.nn.functional.gelu(x, approximate='tanh')

def _silu(x):
    return torch.nn.functional.silu(x)

def _sigmoid(x):
    return torch.sigmoid(x)

def _layernorm(x, axis=-1, eps=1e-05):
    m = x.mean(dim=axis, keepdim=True)
    v = x.var(dim=axis, keepdim=True, unbiased=False)
    return (x - m) / torch.sqrt(v + eps)

def _scatter_add(tgt, idx, src, axis=0):
    return tgt.clone().index_add_(axis, idx, src)

def _segment_sum(src, seg, n):
    out = torch.zeros((n,) + src.shape[1:], dtype=src.dtype)
    return out.index_add_(0, seg, src)

def _pad(x, pw):
    flat = tuple((v for pair in reversed(pw) for v in pair))
    return torch.nn.functional.pad(x, flat)
kernel_name = 'parallel_sum__memory_aug_recurrent_mem_tr__moe_arch_mod__prompt'

def setup_inputs():

    _w = lambda a: (lambda t: t.to(torch.bfloat16) if t.is_floating_point() else t)(torch.as_tensor(a))

    def _A_setup():
        B, S, Dm = (1, 2048, 448)
        H, Dh = (16, 256)
        M, seg = (8, 32)
        seg = min(seg, S)
        S = S // seg * seg
        return {'x': _w((lambda *s: torch.randn(*s, dtype=torch.bfloat16) * 0.05)(B, S, Dm)), 'mem0': _w((lambda *s: torch.randn(*s, dtype=torch.bfloat16) * 1.6)(B, M, Dm)), 'Wq': _w((lambda *s: torch.randn(*s, dtype=torch.bfloat16) * 0.8)(Dm, H, Dh) * Dm ** (-0.5)), 'Wk': _w((lambda *s: torch.randn(*s, dtype=torch.bfloat16) * 0.8)(Dm, H, Dh) * Dm ** (-0.5)), 'Wv': _w((lambda *s: torch.randn(*s, dtype=torch.bfloat16) * 1.6)(Dm, H, Dh) * Dm ** (-0.5)), 'Wo': _w((lambda *s: torch.randn(*s, dtype=torch.bfloat16) * 1.6)(H, Dh, Dm) * (H * Dh) ** (-0.5)), 'seg_len': seg}
    _A_in = _A_setup()

    def _B_setup():
        B, S, D, F, C = (1, 2048, 448, 1792, 8)
        return {'x': _w((lambda *s: torch.randn(*s, dtype=torch.bfloat16) * 0.05)(B, S, D)), 'w_r': _w((lambda *s: torch.randn(*s, dtype=torch.bfloat16) * 0.05)(D)), 'w_gate': _w((lambda *s: torch.randn(*s, dtype=torch.bfloat16) * 0.05)(D, F)), 'w_up': _w((lambda *s: torch.randn(*s, dtype=torch.bfloat16) * 0.05)(D, F)), 'w_down': _w((lambda *s: torch.randn(*s, dtype=torch.bfloat16) * 0.05)(F, D))}
    _B_in = _B_setup()
    return {'A_x': _A_in['x'], 'A_mem0': _A_in['mem0'], 'A_Wq': _A_in['Wq'], 'A_Wk': _A_in['Wk'], 'A_Wv': _A_in['Wv'], 'A_Wo': _A_in['Wo'], 'A_seg_len': _A_in['seg_len'], 'B_x': _B_in['x'], 'B_w_r': _B_in['w_r'], 'B_w_gate': _B_in['w_gate'], 'B_w_up': _B_in['w_up'], 'B_w_down': _B_in['w_down']}

def reference(A_x, A_mem0, A_Wq, A_Wk, A_Wv, A_Wo, A_seg_len, B_x, B_w_r, B_w_gate, B_w_up, B_w_down):

    def _A_ref(x, mem0, Wq, Wk, Wv, Wo, seg_len):
        B, S, Dm = x.shape
        H, Dh = (Wq.shape[1], Wq.shape[2])
        M = mem0.shape[1]
        scale = Dh ** (-0.5)
        n_seg = S // seg_len
        L = M + seg_len
        idx = torch.arange(L)
        mask = (idx[:, None] < M) | (idx[:, None] >= idx[None, :])
        mem = mem0
        outs = []
        for s in range(n_seg):
            xs = x[:, s * seg_len:(s + 1) * seg_len, :].clone()
            h = torch.concatenate([mem, xs], axis=1)
            q = torch.einsum('btd,dhe->bhte', h, Wq)
            k = torch.einsum('btd,dhe->bhte', h, Wk)
            v = torch.einsum('btd,dhe->bhte', h, Wv)
            scores = torch.einsum('bhqe,bhke->bhqk', q, k) * scale
            scores = torch.where(mask[None, None], scores, -1000000000.0)
            p = _softmax(scores, axis=-1)
            o = torch.einsum('bhqk,bhke->bhqe', p, v)
            o = torch.einsum('bhte,hed->btd', o, Wo)
            mem = o[:, :M, :].clone()
            outs.append(o[:, M:, :])
        return torch.concatenate(outs, axis=1)

    def _B_ref(x, w_r, w_gate, w_up, w_down):
        B, S, D = x.shape
        C = 8
        r = x @ w_r
        idx = torch.argsort(-r, axis=-1)[:, :C]
        idx_e = (lambda x, n, axis: torch.repeat_interleave(x, n, dim=axis))(idx.reshape(B, C, 1), D, axis=2)
        x_sel = (lambda x, i, axis: torch.take_along_dim(x, i, dim=axis))(x, idx_e, axis=1)
        g = _silu(x_sel @ w_gate)
        u = x_sel @ w_up
        y = g * u @ w_down
        r_sel = _sigmoid((lambda x, i, axis: torch.take_along_dim(x, i, dim=axis))(r, idx, axis=1))
        y = y * r_sel.reshape(B, C, 1)
        b_off = (torch.arange(B) * S).reshape(B, 1)
        flat_idx = (idx + b_off).reshape(B * C)
        zero = (x * 0.0).reshape(B * S, D)
        upd = _scatter_add(zero, flat_idx, y.reshape(B * C, D), axis=0)
        return x + upd.reshape(B, S, D)
    x = A_x
    xn = _layernorm(x, axis=-1)
    return x + _A_ref(xn, A_mem0, A_Wq, A_Wk, A_Wv, A_Wo, A_seg_len) + _B_ref(xn, B_w_r, B_w_gate, B_w_up, B_w_down)
```

```asm
; @launch kernel=prep_kernel grid=(256,1,1) block=(512,1,1) lds=157696
; @launch kernel=main_kernel grid=(256,1,1) block=(256,1,1) lds=163840
.amdgcn_target "amdgcn-amd-amdhsa--gfx950"
.text
.globl prep_kernel
.p2align 8
.type prep_kernel,@function
prep_kernel:
    s_cmp_ge_u32 s2, 256
    s_cbranch_scc1 P_exit
    s_load_dwordx2 s[4:5], s[0:1], 112
    s_mov_b32 s6, 268435456
    s_mov_b32 s7, 0x20000
    v_lshrrev_b32 v1, 6, v0
    v_and_b32 v2, 63, v0
    v_readfirstlane_b32 s16, v1
    s_nop 2
    s_cmp_eq_u32 s16, 7
    s_cbranch_scc1 P_ln
    s_and_b32 s19, s2, 15
    s_bfe_u32 s18, s2, 0x10005
    s_lshr_b32 s20, s2, 6
    s_bitcmp1_b32 s2, 4
    s_cbranch_scc1 P_gB0
    s_load_dwordx2 s[8:9], s[0:1], 16
    s_mov_b32 s10, 3670016
    s_mov_b32 s11, 0x20000
    s_load_dwordx2 s[12:13], s[0:1], 24
    s_mov_b32 s14, 3670016
    s_mov_b32 s15, 0x20000
    s_branch P_g1
P_gB0:
    s_load_dwordx2 s[8:9], s[0:1], 32
    s_mov_b32 s10, 3670016
    s_mov_b32 s11, 0x20000
    s_load_dwordx2 s[12:13], s[0:1], 40
    s_mov_b32 s14, 3670016
    s_mov_b32 s15, 0x20000
P_g1:
    v_and_b32 v3, 15, v2
    v_lshrrev_b32 v4, 4, v2
    v_lshlrev_b32 v5, 4, v2
    s_mul_i32 s21, s18, 7
    s_add_u32 s21, s21, s16
    v_lshrrev_b32 v18, 3, v2
    s_lshl_b32 s22, s21, 5
    v_add_u32 v18, s22, v18
    v_lshlrev_b32 v18, 13, v18
    s_lshl_b32 s22, s19, 9
    v_add_u32 v18, s22, v18
    v_and_b32 v19, 7, v2
    v_and_b32 v26, 1, v4
    v_xor_b32 v19, v19, v26
    v_xor_b32 v26, 0, v19
    v_lshl_add_u32 v6, v26, 4, v18
    v_xor_b32 v26, 2, v19
    v_lshl_add_u32 v7, v26, 4, v18
    v_add_u32 v7, 65536, v7
    v_xor_b32 v26, 4, v19
    v_lshl_add_u32 v8, v26, 4, v18
    v_add_u32 v8, 131072, v8
    v_xor_b32 v26, 6, v19
    v_lshl_add_u32 v9, v26, 4, v18
    v_add_u32 v9, 196608, v9
    v_lshrrev_b32 v18, 2, v3
    v_bfe_u32 v19, v3, 1, 1
    v_lshl_add_u32 v19, v18, 1, v19
    v_xor_b32 v19, v19, v4
    v_lshlrev_b32 v19, 4, v19
    v_lshl_add_u32 v19, v18, 10, v19
    v_and_b32 v18, 3, v3
    v_lshl_add_u32 v19, v18, 7, v19
    s_lshl_b32 s33, s16, 12
    v_add_u32 v12, s33, v19
    v_xor_b32 v13, 64, v12
    s_lshl_b32 s22, s18, 1
    s_add_u32 s22, s22, s20
    s_add_u32 s24, s22, 0
    s_and_b32 s24, s24, 3
    s_add_u32 s25, s22, 1
    s_and_b32 s25, s25, 3
    s_add_u32 s26, s22, 2
    s_and_b32 s26, s26, 3
    s_add_u32 s27, s22, 3
    s_and_b32 s27, s27, 3
    s_lshl_b32 s32, s16, 11
    s_add_u32 s32, s32, 28672
    s_bitcmp1_b32 s2, 4
    s_cbranch_scc1 P_gB
    s_mul_i32 s22, s20, 7
    s_add_u32 s22, s22, s16
    s_lshr_b32 s23, s22, 1
    s_lshl_b32 s23, s23, 5
    s_and_b32 s22, s22, 1
    s_lshl_b32 s22, s22, 3
    s_add_u32 s22, s22, s23
    v_bfe_u32 v18, v2, 4, 1
    v_lshlrev_b32 v18, 2, v18
    v_bfe_u32 v19, v2, 5, 1
    v_lshl_add_u32 v18, v19, 1, v18
    v_bfe_u32 v19, v2, 3, 1
    v_add3_u32 v18, v18, v19, s22
    v_lshlrev_b32 v18, 13, v18
    s_lshl_b32 s22, s19, 9
    v_add_u32 v18, s22, v18
    v_and_b32 v19, 7, v2
    v_xor_b32 v19, v19, v4
    v_lshl_add_u32 v10, v19, 4, v18
    v_xor_b32 v19, 4, v19
    v_lshl_add_u32 v11, v19, 4, v18
    v_add_u32 v11, 131072, v11
    v_lshrrev_b32 v18, 1, v3
    v_xor_b32 v18, v18, v4
    v_lshlrev_b32 v18, 4, v18
    v_lshl_add_u32 v18, v3, 7, v18
    v_add_u32 v16, 28672, v18
    v_xor_b32 v17, 64, v16
    s_waitcnt lgkmcnt(0)
    s_and_b32 s5, s5, 0xffff
    s_and_b32 s9, s9, 0xffff
    s_and_b32 s13, s13, 0xffff
    s_lshl_b32 s36, s24, 7
    s_mul_i32 s35, s24, 128
    s_add_u32 s34, s32, 0
    s_mov_b32 m0, s34
    s_nop 0
    buffer_load_dwordx4 v10, s[12:15], s35 offen lds
    s_add_u32 s34, s32, 1024
    s_mov_b32 m0, s34
    s_nop 0
    buffer_load_dwordx4 v11, s[12:15], s35 offen lds
    s_add_u32 s34, s33, 0
    s_mov_b32 m0, s34
    s_nop 0
    buffer_load_dwordx4 v6, s[8:11], s36 offen lds
    s_add_u32 s34, s33, 1024
    s_mov_b32 m0, s34
    s_nop 0
    buffer_load_dwordx4 v7, s[8:11], s36 offen lds
    s_add_u32 s34, s33, 2048
    s_mov_b32 m0, s34
    s_nop 0
    buffer_load_dwordx4 v8, s[8:11], s36 offen lds
    s_add_u32 s34, s33, 3072
    s_mov_b32 m0, s34
    s_nop 0
    buffer_load_dwordx4 v9, s[8:11], s36 offen lds
    s_lshl_b32 s36, s25, 7
    s_mul_i32 s35, s25, 128
    s_add_u32 s34, s32, 43008
    s_mov_b32 m0, s34
    s_nop 0
    buffer_load_dwordx4 v10, s[12:15], s35 offen lds
    s_add_u32 s34, s32, 44032
    s_mov_b32 m0, s34
    s_nop 0
    buffer_load_dwordx4 v11, s[12:15], s35 offen lds
    s_add_u32 s34, s33, 43008
    s_mov_b32 m0, s34
    s_nop 0
    buffer_load_dwordx4 v6, s[8:11], s36 offen lds
    s_add_u32 s34, s33, 44032
    s_mov_b32 m0, s34
    s_nop 0
    buffer_load_dwordx4 v7, s[8:11], s36 offen lds
    s_add_u32 s34, s33, 45056
    s_mov_b32 m0, s34
    s_nop 0
    buffer_load_dwordx4 v8, s[8:11], s36 offen lds
    s_add_u32 s34, s33, 46080
    s_mov_b32 m0, s34
    s_nop 0
    buffer_load_dwordx4 v9, s[8:11], s36 offen lds
    s_lshl_b32 s36, s26, 7
    s_mul_i32 s35, s26, 128
    s_add_u32 s34, s32, 86016
    s_mov_b32 m0, s34
    s_nop 0
    buffer_load_dwordx4 v10, s[12:15], s35 offen lds
    s_add_u32 s34, s32, 87040
    s_mov_b32 m0, s34
    s_nop 0
    buffer_load_dwordx4 v11, s[12:15], s35 offen lds
    s_add_u32 s34, s33, 86016
    s_mov_b32 m0, s34
    s_nop 0
    buffer_load_dwordx4 v6, s[8:11], s36 offen lds
    s_add_u32 s34, s33, 87040
    s_mov_b32 m0, s34
    s_nop 0
    buffer_load_dwordx4 v7, s[8:11], s36 offen lds
    s_add_u32 s34, s33, 88064
    s_mov_b32 m0, s34
    s_nop 0
    buffer_load_dwordx4 v8, s[8:11], s36 offen lds
    s_add_u32 s34, s33, 89088
    s_mov_b32 m0, s34
    s_nop 0
    buffer_load_dwordx4 v9, s[8:11], s36 offen lds
    s_lshl_b32 s36, s27, 7
    s_mul_i32 s35, s27, 128
    buffer_load_dwordx4 v[156:159], v10, s[12:15], s35 offen
    buffer_load_dwordx4 v[160:163], v11, s[12:15], s35 offen
    s_add_u32 s34, s33, 129024
    s_mov_b32 m0, s34
    s_nop 0
    buffer_load_dwordx4 v6, s[8:11], s36 offen lds
    s_add_u32 s34, s33, 130048
    s_mov_b32 m0, s34
    s_nop 0
    buffer_load_dwordx4 v7, s[8:11], s36 offen lds
    s_add_u32 s34, s33, 131072
    s_mov_b32 m0, s34
    s_nop 0
    buffer_load_dwordx4 v8, s[8:11], s36 offen lds
    s_add_u32 s34, s33, 132096
    s_mov_b32 m0, s34
    s_nop 0
    buffer_load_dwordx4 v9, s[8:11], s36 offen lds
    v_add_u32 v26, s32, v5
    s_waitcnt vmcnt(18) lgkmcnt(0)
    s_barrier
    v_add_u32 v20, 0, v12
    v_add_u32 v24, 0, v16
    v_add_u32 v21, 0, v13
    v_add_u32 v25, 0, v17
    ds_read_b128 v[84:87], v20 offset:0
    ds_read_b128 v[88:91], v20 offset:512
    ds_read_b128 v[92:95], v24 offset:0
    ds_read_b128 v[96:99], v24 offset:2048
    ds_read_b128 v[100:103], v24 offset:4096
    ds_read_b128 v[104:107], v24 offset:6144
    ds_read_b128 v[108:111], v24 offset:8192
    ds_read_b128 v[112:115], v24 offset:10240
    ds_read_b128 v[116:119], v24 offset:12288
    ds_read_b128 v[120:123], v21 offset:0
    ds_read_b128 v[124:127], v21 offset:512
    ds_read_b128 v[128:131], v25 offset:0
    ds_read_b128 v[132:135], v25 offset:2048
    ds_read_b128 v[136:139], v25 offset:4096
    ds_read_b128 v[140:143], v25 offset:6144
    ds_read_b128 v[144:147], v25 offset:8192
    ds_read_b128 v[148:151], v25 offset:10240
    ds_read_b128 v[152:155], v25 offset:12288
    s_waitcnt lgkmcnt(9)
    v_mfma_f32_16x16x32_bf16 v[28:31], v[84:87], v[92:95], 0
    v_mfma_f32_16x16x32_bf16 v[32:35], v[84:87], v[96:99], 0
    v_mfma_f32_16x16x32_bf16 v[36:39], v[84:87], v[100:103], 0
    v_mfma_f32_16x16x32_bf16 v[40:43], v[84:87], v[104:107], 0
    v_mfma_f32_16x16x32_bf16 v[44:47], v[84:87], v[108:111], 0
    v_mfma_f32_16x16x32_bf16 v[48:51], v[84:87], v[112:115], 0
    v_mfma_f32_16x16x32_bf16 v[52:55], v[84:87], v[116:119], 0
    v_mfma_f32_16x16x32_bf16 v[56:59], v[88:91], v[92:95], 0
    v_mfma_f32_16x16x32_bf16 v[60:63], v[88:91], v[96:99], 0
    v_mfma_f32_16x16x32_bf16 v[64:67], v[88:91], v[100:103], 0
    v_mfma_f32_16x16x32_bf16 v[68:71], v[88:91], v[104:107], 0
    v_mfma_f32_16x16x32_bf16 v[72:75], v[88:91], v[108:111], 0
    v_mfma_f32_16x16x32_bf16 v[76:79], v[88:91], v[112:115], 0
    v_mfma_f32_16x16x32_bf16 v[80:83], v[88:91], v[116:119], 0
    s_waitcnt vmcnt(12) lgkmcnt(0)
    s_barrier
    v_add_u32 v20, 43008, v12
    v_add_u32 v24, 43008, v16
    v_add_u32 v21, 43008, v13
    v_add_u32 v25, 43008, v17
    ds_read_b128 v[84:87], v20 offset:0
    ds_read_b128 v[88:91], v20 offset:512
    ds_read_b128 v[92:95], v24 offset:0
    ds_read_b128 v[96:99], v24 offset:2048
    ds_read_b128 v[100:103], v24 offset:4096
    ds_read_b128 v[104:107], v24 offset:6144
    ds_read_b128 v[108:111], v24 offset:8192
    ds_read_b128 v[112:115], v24 offset:10240
    ds_read_b128 v[116:119], v24 offset:12288
    s_waitcnt lgkmcnt(9)
    v_mfma_f32_16x16x32_bf16 v[28:31], v[120:123], v[128:131], v[28:31]
    v_mfma_f32_16x16x32_bf16 v[32:35], v[120:123], v[132:135], v[32:35]
    v_mfma_f32_16x16x32_bf16 v[36:39], v[120:123], v[136:139], v[36:39]
    v_mfma_f32_16x16x32_bf16 v[40:43], v[120:123], v[140:143], v[40:43]
    v_mfma_f32_16x16x32_bf16 v[44:47], v[120:123], v[144:147], v[44:47]
    v_mfma_f32_16x16x32_bf16 v[48:51], v[120:123], v[148:151], v[48:51]
    v_mfma_f32_16x16x32_bf16 v[52:55], v[120:123], v[152:155], v[52:55]
    v_mfma_f32_16x16x32_bf16 v[56:59], v[124:127], v[128:131], v[56:59]
    v_mfma_f32_16x16x32_bf16 v[60:63], v[124:127], v[132:135], v[60:63]
    v_mfma_f32_16x16x32_bf16 v[64:67], v[124:127], v[136:139], v[64:67]
    v_mfma_f32_16x16x32_bf16 v[68:71], v[124:127], v[140:143], v[68:71]
    v_mfma_f32_16x16x32_bf16 v[72:75], v[124:127], v[144:147], v[72:75]
    v_mfma_f32_16x16x32_bf16 v[76:79], v[124:127], v[148:151], v[76:79]
    v_mfma_f32_16x16x32_bf16 v[80:83], v[124:127], v[152:155], v[80:83]
    ds_read_b128 v[120:123], v21 offset:0
    ds_read_b128 v[124:127], v21 offset:512
    ds_read_b128 v[128:131], v25 offset:0
    ds_read_b128 v[132:135], v25 offset:2048
    ds_read_b128 v[136:139], v25 offset:4096
    ds_read_b128 v[140:143], v25 offset:6144
    ds_read_b128 v[144:147], v25 offset:8192
    ds_read_b128 v[148:151], v25 offset:10240
    ds_read_b128 v[152:155], v25 offset:12288
    s_waitcnt lgkmcnt(9)
    v_mfma_f32_16x16x32_bf16 v[28:31], v[84:87], v[92:95], v[28:31]
    v_mfma_f32_16x16x32_bf16 v[32:35], v[84:87], v[96:99], v[32:35]
    v_mfma_f32_16x16x32_bf16 v[36:39], v[84:87], v[100:103], v[36:39]
    v_mfma_f32_16x16x32_bf16 v[40:43], v[84:87], v[104:107], v[40:43]
    v_mfma_f32_16x16x32_bf16 v[44:47], v[84:87], v[108:111], v[44:47]
    v_mfma_f32_16x16x32_bf16 v[48:51], v[84:87], v[112:115], v[48:51]
    v_mfma_f32_16x16x32_bf16 v[52:55], v[84:87], v[116:119], v[52:55]
    v_mfma_f32_16x16x32_bf16 v[56:59], v[88:91], v[92:95], v[56:59]
    v_mfma_f32_16x16x32_bf16 v[60:63], v[88:91], v[96:99], v[60:63]
    v_mfma_f32_16x16x32_bf16 v[64:67], v[88:91], v[100:103], v[64:67]
    v_mfma_f32_16x16x32_bf16 v[68:71], v[88:91], v[104:107], v[68:71]
    v_mfma_f32_16x16x32_bf16 v[72:75], v[88:91], v[108:111], v[72:75]
    v_mfma_f32_16x16x32_bf16 v[76:79], v[88:91], v[112:115], v[76:79]
    v_mfma_f32_16x16x32_bf16 v[80:83], v[88:91], v[116:119], v[80:83]
    s_waitcnt vmcnt(4)
    ds_write_b128 v26, v[156:159] offset:0
    ds_write_b128 v26, v[160:163] offset:1024
    s_waitcnt lgkmcnt(0)
    s_barrier
    v_add_u32 v20, 86016, v12
    v_add_u32 v24, 86016, v16
    v_add_u32 v21, 86016, v13
    v_add_u32 v25, 86016, v17
    ds_read_b128 v[84:87], v20 offset:0
    ds_read_b128 v[88:91], v20 offset:512
    ds_read_b128 v[92:95], v24 offset:0
    ds_read_b128 v[96:99], v24 offset:2048
    ds_read_b128 v[100:103], v24 offset:4096
    ds_read_b128 v[104:107], v24 offset:6144
    ds_read_b128 v[108:111], v24 offset:8192
    ds_read_b128 v[112:115], v24 offset:10240
    ds_read_b128 v[116:119], v24 offset:12288
    s_waitcnt lgkmcnt(9)
    v_mfma_f32_16x16x32_bf16 v[28:31], v[120:123], v[128:131], v[28:31]
    v_mfma_f32_16x16x32_bf16 v[32:35], v[120:123], v[132:135], v[32:35]
    v_mfma_f32_16x16x32_bf16 v[36:39], v[120:123], v[136:139], v[36:39]
    v_mfma_f32_16x16x32_bf16 v[40:43], v[120:123], v[140:143], v[40:43]
    v_mfma_f32_16x16x32_bf16 v[44:47], v[120:123], v[144:147], v[44:47]
    v_mfma_f32_16x16x32_bf16 v[48:51], v[120:123], v[148:151], v[48:51]
    v_mfma_f32_16x16x32_bf16 v[52:55], v[120:123], v[152:155], v[52:55]
    v_mfma_f32_16x16x32_bf16 v[56:59], v[124:127], v[128:131], v[56:59]
    v_mfma_f32_16x16x32_bf16 v[60:63], v[124:127], v[132:135], v[60:63]
    v_mfma_f32_16x16x32_bf16 v[64:67], v[124:127], v[136:139], v[64:67]
    v_mfma_f32_16x16x32_bf16 v[68:71], v[124:127], v[140:143], v[68:71]
    v_mfma_f32_16x16x32_bf16 v[72:75], v[124:127], v[144:147], v[72:75]
    v_mfma_f32_16x16x32_bf16 v[76:79], v[124:127], v[148:151], v[76:79]
    v_mfma_f32_16x16x32_bf16 v[80:83], v[124:127], v[152:155], v[80:83]
    ds_read_b128 v[120:123], v21 offset:0
    ds_read_b128 v[124:127], v21 offset:512
    ds_read_b128 v[128:131], v25 offset:0
    ds_read_b128 v[132:135], v25 offset:2048
    ds_read_b128 v[136:139], v25 offset:4096
    ds_read_b128 v[140:143], v25 offset:6144
    ds_read_b128 v[144:147], v25 offset:8192
    ds_read_b128 v[148:151], v25 offset:10240
    ds_read_b128 v[152:155], v25 offset:12288
    s_waitcnt lgkmcnt(9)
    v_mfma_f32_16x16x32_bf16 v[28:31], v[84:87], v[92:95], v[28:31]
    v_mfma_f32_16x16x32_bf16 v[32:35], v[84:87], v[96:99], v[32:35]
    v_mfma_f32_16x16x32_bf16 v[36:39], v[84:87], v[100:103], v[36:39]
    v_mfma_f32_16x16x32_bf16 v[40:43], v[84:87], v[104:107], v[40:43]
    v_mfma_f32_16x16x32_bf16 v[44:47], v[84:87], v[108:111], v[44:47]
    v_mfma_f32_16x16x32_bf16 v[48:51], v[84:87], v[112:115], v[48:51]
    v_mfma_f32_16x16x32_bf16 v[52:55], v[84:87], v[116:119], v[52:55]
    v_mfma_f32_16x16x32_bf16 v[56:59], v[88:91], v[92:95], v[56:59]
    v_mfma_f32_16x16x32_bf16 v[60:63], v[88:91], v[96:99], v[60:63]
    v_mfma_f32_16x16x32_bf16 v[64:67], v[88:91], v[100:103], v[64:67]
    v_mfma_f32_16x16x32_bf16 v[68:71], v[88:91], v[104:107], v[68:71]
    v_mfma_f32_16x16x32_bf16 v[72:75], v[88:91], v[108:111], v[72:75]
    v_mfma_f32_16x16x32_bf16 v[76:79], v[88:91], v[112:115], v[76:79]
    v_mfma_f32_16x16x32_bf16 v[80:83], v[88:91], v[116:119], v[80:83]
    s_waitcnt vmcnt(0) lgkmcnt(0)
    s_barrier
    v_add_u32 v20, 129024, v12
    v_add_u32 v24, 0, v16
    v_add_u32 v21, 129024, v13
    v_add_u32 v25, 0, v17
    ds_read_b128 v[84:87], v20 offset:0
    ds_read_b128 v[88:91], v20 offset:512
    ds_read_b128 v[92:95], v24 offset:0
    ds_read_b128 v[96:99], v24 offset:2048
    ds_read_b128 v[100:103], v24 offset:4096
    ds_read_b128 v[104:107], v24 offset:6144
    ds_read_b128 v[108:111], v24 offset:8192
    ds_read_b128 v[112:115], v24 offset:10240
    ds_read_b128 v[116:119], v24 offset:12288
    s_waitcnt lgkmcnt(9)
    v_mfma_f32_16x16x32_bf16 v[28:31], v[120:123], v[128:131], v[28:31]
    v_mfma_f32_16x16x32_bf16 v[32:35], v[120:123], v[132:135], v[32:35]
    v_mfma_f32_16x16x32_bf16 v[36:39], v[120:123], v[136:139], v[36:39]
    v_mfma_f32_16x16x32_bf16 v[40:43], v[120:123], v[140:143], v[40:43]
    v_mfma_f32_16x16x32_bf16 v[44:47], v[120:123], v[144:147], v[44:47]
    v_mfma_f32_16x16x32_bf16 v[48:51], v[120:123], v[148:151], v[48:51]
    v_mfma_f32_16x16x32_bf16 v[52:55], v[120:123], v[152:155], v[52:55]
    v_mfma_f32_16x16x32_bf16 v[56:59], v[124:127], v[128:131], v[56:59]
    v_mfma_f32_16x16x32_bf16 v[60:63], v[124:127], v[132:135], v[60:63]
    v_mfma_f32_16x16x32_bf16 v[64:67], v[124:127], v[136:139], v[64:67]
    v_mfma_f32_16x16x32_bf16 v[68:71], v[124:127], v[140:143], v[68:71]
    v_mfma_f32_16x16x32_bf16 v[72:75], v[124:127], v[144:147], v[72:75]
    v_mfma_f32_16x16x32_bf16 v[76:79], v[124:127], v[148:151], v[76:79]
    v_mfma_f32_16x16x32_bf16 v[80:83], v[124:127], v[152:155], v[80:83]
    ds_read_b128 v[120:123], v21 offset:0
    ds_read_b128 v[124:127], v21 offset:512
    ds_read_b128 v[128:131], v25 offset:0
    ds_read_b128 v[132:135], v25 offset:2048
    ds_read_b128 v[136:139], v25 offset:4096
    ds_read_b128 v[140:143], v25 offset:6144
    ds_read_b128 v[144:147], v25 offset:8192
    ds_read_b128 v[148:151], v25 offset:10240
    ds_read_b128 v[152:155], v25 offset:12288
    s_waitcnt lgkmcnt(9)
    v_mfma_f32_16x16x32_bf16 v[28:31], v[84:87], v[92:95], v[28:31]
    v_mfma_f32_16x16x32_bf16 v[32:35], v[84:87], v[96:99], v[32:35]
    v_mfma_f32_16x16x32_bf16 v[36:39], v[84:87], v[100:103], v[36:39]
    v_mfma_f32_16x16x32_bf16 v[40:43], v[84:87], v[104:107], v[40:43]
    v_mfma_f32_16x16x32_bf16 v[44:47], v[84:87], v[108:111], v[44:47]
    v_mfma_f32_16x16x32_bf16 v[48:51], v[84:87], v[112:115], v[48:51]
    v_mfma_f32_16x16x32_bf16 v[52:55], v[84:87], v[116:119], v[52:55]
    v_mfma_f32_16x16x32_bf16 v[56:59], v[88:91], v[92:95], v[56:59]
    v_mfma_f32_16x16x32_bf16 v[60:63], v[88:91], v[96:99], v[60:63]
    v_mfma_f32_16x16x32_bf16 v[64:67], v[88:91], v[100:103], v[64:67]
    v_mfma_f32_16x16x32_bf16 v[68:71], v[88:91], v[104:107], v[68:71]
    v_mfma_f32_16x16x32_bf16 v[72:75], v[88:91], v[108:111], v[72:75]
    v_mfma_f32_16x16x32_bf16 v[76:79], v[88:91], v[112:115], v[76:79]
    v_mfma_f32_16x16x32_bf16 v[80:83], v[88:91], v[116:119], v[80:83]
    s_waitcnt lgkmcnt(0)
    v_mfma_f32_16x16x32_bf16 v[28:31], v[120:123], v[128:131], v[28:31]
    v_mfma_f32_16x16x32_bf16 v[32:35], v[120:123], v[132:135], v[32:35]
    v_mfma_f32_16x16x32_bf16 v[36:39], v[120:123], v[136:139], v[36:39]
    v_mfma_f32_16x16x32_bf16 v[40:43], v[120:123], v[140:143], v[40:43]
    v_mfma_f32_16x16x32_bf16 v[44:47], v[120:123], v[144:147], v[44:47]
    v_mfma_f32_16x16x32_bf16 v[48:51], v[120:123], v[148:151], v[48:51]
    v_mfma_f32_16x16x32_bf16 v[52:55], v[120:123], v[152:155], v[52:55]
    v_mfma_f32_16x16x32_bf16 v[56:59], v[124:127], v[128:131], v[56:59]
    v_mfma_f32_16x16x32_bf16 v[60:63], v[124:127], v[132:135], v[60:63]
    v_mfma_f32_16x16x32_bf16 v[64:67], v[124:127], v[136:139], v[64:67]
    v_mfma_f32_16x16x32_bf16 v[68:71], v[124:127], v[140:143], v[68:71]
    v_mfma_f32_16x16x32_bf16 v[72:75], v[124:127], v[144:147], v[72:75]
    v_mfma_f32_16x16x32_bf16 v[76:79], v[124:127], v[148:151], v[76:79]
    v_mfma_f32_16x16x32_bf16 v[80:83], v[124:127], v[152:155], v[80:83]
    s_mov_b32 s22, 0x3db8aa3b
    s_mov_b32 s23, 0
    s_branch P_gepi
P_gB:
    s_mov_b32 s22, 306783379
    v_mul_hi_u32 v18, v0, s22
    v_mul_u32_u24 v19, 14, v18
    v_sub_u32 v19, v0, v19
    v_bfe_u32 v26, v18, 2, 1
    v_bfe_u32 v27, v18, 3, 1
    v_and_b32 v18, 0x13, v18
    v_lshl_add_u32 v18, v26, 3, v18
    v_lshl_add_u32 v18, v27, 2, v18
    v_mul_u32_u24 v18, 896, v18
    v_lshl_add_u32 v18, v19, 4, v18
    s_mul_i32 s22, s19, 229376
    s_mul_i32 s23, s20, 224
    s_add_u32 s22, s22, s23
    v_add_u32 v10, s22, v18
    v_add_u32 v11, 28672, v10
    s_lshl_b32 s32, s16, 10
    s_add_u32 s32, s32, 28672
    v_bfe_u32 v18, v2, 2, 3
    v_bfe_u32 v19, v2, 5, 1
    v_lshl_add_u32 v18, v19, 4, v18
    v_mul_u32_u24 v18, 224, v18
    v_and_b32 v19, 3, v2
    v_lshl_add_u32 v18, v19, 3, v18
    v_add_u32 v16, 28672, v18
    v_add_u32 v17, 7168, v16
    s_waitcnt lgkmcnt(0)
    s_and_b32 s5, s5, 0xffff
    s_and_b32 s9, s9, 0xffff
    s_and_b32 s13, s13, 0xffff
    s_lshl_b32 s36, s24, 7
    s_mul_i32 s35, s24, 57344
    s_add_u32 s34, s32, 0
    s_mov_b32 m0, s34
    s_nop 0
    buffer_load_dwordx4 v10, s[12:15], s35 offen lds
    s_add_u32 s34, s32, 7168
    s_mov_b32 m0, s34
    s_nop 0
    buffer_load_dwordx4 v11, s[12:15], s35 offen lds
    s_add_u32 s34, s33, 0
    s_mov_b32 m0, s34
    s_nop 0
    buffer_load_dwordx4 v6, s[8:11], s36 offen lds
    s_add_u32 s34, s33, 1024
    s_mov_b32 m0, s34
    s_nop 0
    buffer_load_dwordx4 v7, s[8:11], s36 offen lds
    s_add_u32 s34, s33, 2048
    s_mov_b32 m0, s34
    s_nop 0
    buffer_load_dwordx4 v8, s[8:11], s36 offen lds
    s_add_u32 s34, s33, 3072
    s_mov_b32 m0, s34
    s_nop 0
    buffer_load_dwordx4 v9, s[8:11], s36 offen lds
    s_lshl_b32 s36, s25, 7
    s_mul_i32 s35, s25, 57344
    s_add_u32 s34, s32, 43008
    s_mov_b32 m0, s34
    s_nop 0
    buffer_load_dwordx4 v10, s[12:15], s35 offen lds
    s_add_u32 s34, s32, 50176
    s_mov_b32 m0, s34
    s_nop 0
    buffer_load_dwordx4 v11, s[12:15], s35 offen lds
    s_add_u32 s34, s33, 43008
    s_mov_b32 m0, s34
    s_nop 0
    buffer_load_dwordx4 v6, s[8:11], s36 offen lds
    s_add_u32 s34, s33, 44032
    s_mov_b32 m0, s34
    s_nop 0
    buffer_load_dwordx4 v7, s[8:11], s36 offen lds
    s_add_u32 s34, s33, 45056
    s_mov_b32 m0, s34
    s_nop 0
    buffer_load_dwordx4 v8, s[8:11], s36 offen lds
    s_add_u32 s34, s33, 46080
    s_mov_b32 m0, s34
    s_nop 0
    buffer_load_dwordx4 v9, s[8:11], s36 offen lds
    s_lshl_b32 s36, s26, 7
    s_mul_i32 s35, s26, 57344
    s_add_u32 s34, s32, 86016
    s_mov_b32 m0, s34
    s_nop 0
    buffer_load_dwordx4 v10, s[12:15], s35 offen lds
    s_add_u32 s34, s32, 93184
    s_mov_b32 m0, s34
    s_nop 0
    buffer_load_dwordx4 v11, s[12:15], s35 offen lds
    s_add_u32 s34, s33, 86016
    s_mov_b32 m0, s34
    s_nop 0
    buffer_load_dwordx4 v6, s[8:11], s36 offen lds
    s_add_u32 s34, s33, 87040
    s_mov_b32 m0, s34
    s_nop 0
    buffer_load_dwordx4 v7, s[8:11], s36 offen lds
    s_add_u32 s34, s33, 88064
    s_mov_b32 m0, s34
    s_nop 0
    buffer_load_dwordx4 v8, s[8:11], s36 offen lds
    s_add_u32 s34, s33, 89088
    s_mov_b32 m0, s34
    s_nop 0
    buffer_load_dwordx4 v9, s[8:11], s36 offen lds
    s_lshl_b32 s36, s27, 7
    s_mul_i32 s35, s27, 57344
    buffer_load_dwordx4 v[156:159], v10, s[12:15], s35 offen
    buffer_load_dwordx4 v[160:163], v11, s[12:15], s35 offen
    s_add_u32 s34, s33, 129024
    s_mov_b32 m0, s34
    s_nop 0
    buffer_load_dwordx4 v6, s[8:11], s36 offen lds
    s_add_u32 s34, s33, 130048
    s_mov_b32 m0, s34
    s_nop 0
    buffer_load_dwordx4 v7, s[8:11], s36 offen lds
    s_add_u32 s34, s33, 131072
    s_mov_b32 m0, s34
    s_nop 0
    buffer_load_dwordx4 v8, s[8:11], s36 offen lds
    s_add_u32 s34, s33, 132096
    s_mov_b32 m0, s34
    s_nop 0
    buffer_load_dwordx4 v9, s[8:11], s36 offen lds
    v_add_u32 v26, s32, v5
    s_waitcnt vmcnt(18) lgkmcnt(0)
    s_barrier
    v_add_u32 v20, 0, v12
    v_add_u32 v24, 0, v16
    v_add_u32 v21, 0, v13
    v_add_u32 v25, 0, v17
    ds_read_b128 v[84:87], v20 offset:0
    ds_read_b128 v[88:91], v20 offset:512
    ds_read_b64_tr_b16 v[92:93], v24 offset:0
    ds_read_b64_tr_b16 v[94:95], v24 offset:1792
    ds_read_b64_tr_b16 v[96:97], v24 offset:32
    ds_read_b64_tr_b16 v[98:99], v24 offset:1824
    ds_read_b64_tr_b16 v[100:101], v24 offset:64
    ds_read_b64_tr_b16 v[102:103], v24 offset:1856
    ds_read_b64_tr_b16 v[104:105], v24 offset:96
    ds_read_b64_tr_b16 v[106:107], v24 offset:1888
    ds_read_b64_tr_b16 v[108:109], v24 offset:128
    ds_read_b64_tr_b16 v[110:111], v24 offset:1920
    ds_read_b64_tr_b16 v[112:113], v24 offset:160
    ds_read_b64_tr_b16 v[114:115], v24 offset:1952
    ds_read_b64_tr_b16 v[116:117], v24 offset:192
    ds_read_b64_tr_b16 v[118:119], v24 offset:1984
    ds_read_b128 v[120:123], v21 offset:0
    ds_read_b128 v[124:127], v21 offset:512
    ds_read_b64_tr_b16 v[128:129], v25 offset:0
    ds_read_b64_tr_b16 v[130:131], v25 offset:1792
    ds_read_b64_tr_b16 v[132:133], v25 offset:32
    ds_read_b64_tr_b16 v[134:135], v25 offset:1824
    ds_read_b64_tr_b16 v[136:137], v25 offset:64
    ds_read_b64_tr_b16 v[138:139], v25 offset:1856
    ds_read_b64_tr_b16 v[140:141], v25 offset:96
    ds_read_b64_tr_b16 v[142:143], v25 offset:1888
    ds_read_b64_tr_b16 v[144:145], v25 offset:128
    ds_read_b64_tr_b16 v[146:147], v25 offset:1920
    ds_read_b64_tr_b16 v[148:149], v25 offset:160
    ds_read_b64_tr_b16 v[150:151], v25 offset:1952
    ds_read_b64_tr_b16 v[152:153], v25 offset:192
    ds_read_b64_tr_b16 v[154:155], v25 offset:1984
    s_waitcnt lgkmcnt(15)
    v_mfma_f32_16x16x32_bf16 v[28:31], v[84:87], v[92:95], 0
    v_mfma_f32_16x16x32_bf16 v[32:35], v[84:87], v[96:99], 0
    v_mfma_f32_16x16x32_bf16 v[36:39], v[84:87], v[100:103], 0
    v_mfma_f32_16x16x32_bf16 v[40:43], v[84:87], v[104:107], 0
    v_mfma_f32_16x16x32_bf16 v[44:47], v[84:87], v[108:111], 0
    v_mfma_f32_16x16x32_bf16 v[48:51], v[84:87], v[112:115], 0
    v_mfma_f32_16x16x32_bf16 v[52:55], v[84:87], v[116:119], 0
    v_mfma_f32_16x16x32_bf16 v[56:59], v[88:91], v[92:95], 0
    v_mfma_f32_16x16x32_bf16 v[60:63], v[88:91], v[96:99], 0
    v_mfma_f32_16x16x32_bf16 v[64:67], v[88:91], v[100:103], 0
    v_mfma_f32_16x16x32_bf16 v[68:71], v[88:91], v[104:107], 0
    v_mfma_f32_16x16x32_bf16 v[72:75], v[88:91], v[108:111], 0
    v_mfma_f32_16x16x32_bf16 v[76:79], v[88:91], v[112:115], 0
    v_mfma_f32_16x16x32_bf16 v[80:83], v[88:91], v[116:119], 0
    s_waitcnt vmcnt(12) lgkmcnt(0)
    s_barrier
    v_add_u32 v20, 43008, v12
    v_add_u32 v24, 43008, v16
    v_add_u32 v21, 43008, v13
    v_add_u32 v25, 43008, v17
    ds_read_b128 v[84:87], v20 offset:0
    ds_read_b128 v[88:91], v20 offset:512
    ds_read_b64_tr_b16 v[92:93], v24 offset:0
    ds_read_b64_tr_b16 v[94:95], v24 offset:1792
    ds_read_b64_tr_b16 v[96:97], v24 offset:32
    ds_read_b64_tr_b16 v[98:99], v24 offset:1824
    ds_read_b64_tr_b16 v[100:101], v24 offset:64
    ds_read_b64_tr_b16 v[102:103], v24 offset:1856
    ds_read_b64_tr_b16 v[104:105], v24 offset:96
    ds_read_b64_tr_b16 v[106:107], v24 offset:1888
    ds_read_b64_tr_b16 v[108:109], v24 offset:128
    ds_read_b64_tr_b16 v[110:111], v24 offset:1920
    ds_read_b64_tr_b16 v[112:113], v24 offset:160
    ds_read_b64_tr_b16 v[114:115], v24 offset:1952
    ds_read_b64_tr_b16 v[116:117], v24 offset:192
    ds_read_b64_tr_b16 v[118:119], v24 offset:1984
    s_waitcnt lgkmcnt(15)
    v_mfma_f32_16x16x32_bf16 v[28:31], v[120:123], v[128:131], v[28:31]
    v_mfma_f32_16x16x32_bf16 v[32:35], v[120:123], v[132:135], v[32:35]
    v_mfma_f32_16x16x32_bf16 v[36:39], v[120:123], v[136:139], v[36:39]
    v_mfma_f32_16x16x32_bf16 v[40:43], v[120:123], v[140:143], v[40:43]
    v_mfma_f32_16x16x32_bf16 v[44:47], v[120:123], v[144:147], v[44:47]
    v_mfma_f32_16x16x32_bf16 v[48:51], v[120:123], v[148:151], v[48:51]
    v_mfma_f32_16x16x32_bf16 v[52:55], v[120:123], v[152:155], v[52:55]
    v_mfma_f32_16x16x32_bf16 v[56:59], v[124:127], v[128:131], v[56:59]
    v_mfma_f32_16x16x32_bf16 v[60:63], v[124:127], v[132:135], v[60:63]
    v_mfma_f32_16x16x32_bf16 v[64:67], v[124:127], v[136:139], v[64:67]
    v_mfma_f32_16x16x32_bf16 v[68:71], v[124:127], v[140:143], v[68:71]
    v_mfma_f32_16x16x32_bf16 v[72:75], v[124:127], v[144:147], v[72:75]
    v_mfma_f32_16x16x32_bf16 v[76:79], v[124:127], v[148:151], v[76:79]
    v_mfma_f32_16x16x32_bf16 v[80:83], v[124:127], v[152:155], v[80:83]
    ds_read_b128 v[120:123], v21 offset:0
    ds_read_b128 v[124:127], v21 offset:512
    ds_read_b64_tr_b16 v[128:129], v25 offset:0
    ds_read_b64_tr_b16 v[130:131], v25 offset:1792
    ds_read_b64_tr_b16 v[132:133], v25 offset:32
    ds_read_b64_tr_b16 v[134:135], v25 offset:1824
    ds_read_b64_tr_b16 v[136:137], v25 offset:64
    ds_read_b64_tr_b16 v[138:139], v25 offset:1856
    ds_read_b64_tr_b16 v[140:141], v25 offset:96
    ds_read_b64_tr_b16 v[142:143], v25 offset:1888
    ds_read_b64_tr_b16 v[144:145], v25 offset:128
    ds_read_b64_tr_b16 v[146:147], v25 offset:1920
    ds_read_b64_tr_b16 v[148:149], v25 offset:160
    ds_read_b64_tr_b16 v[150:151], v25 offset:1952
    ds_read_b64_tr_b16 v[152:153], v25 offset:192
    ds_read_b64_tr_b16 v[154:155], v25 offset:1984
    s_waitcnt lgkmcnt(15)
    v_mfma_f32_16x16x32_bf16 v[28:31], v[84:87], v[92:95], v[28:31]
    v_mfma_f32_16x16x32_bf16 v[32:35], v[84:87], v[96:99], v[32:35]
    v_mfma_f32_16x16x32_bf16 v[36:39], v[84:87], v[100:103], v[36:39]
    v_mfma_f32_16x16x32_bf16 v[40:43], v[84:87], v[104:107], v[40:43]
    v_mfma_f32_16x16x32_bf16 v[44:47], v[84:87], v[108:111], v[44:47]
    v_mfma_f32_16x16x32_bf16 v[48:51], v[84:87], v[112:115], v[48:51]
    v_mfma_f32_16x16x32_bf16 v[52:55], v[84:87], v[116:119], v[52:55]
    v_mfma_f32_16x16x32_bf16 v[56:59], v[88:91], v[92:95], v[56:59]
    v_mfma_f32_16x16x32_bf16 v[60:63], v[88:91], v[96:99], v[60:63]
    v_mfma_f32_16x16x32_bf16 v[64:67], v[88:91], v[100:103], v[64:67]
    v_mfma_f32_16x16x32_bf16 v[68:71], v[88:91], v[104:107], v[68:71]
    v_mfma_f32_16x16x32_bf16 v[72:75], v[88:91], v[108:111], v[72:75]
    v_mfma_f32_16x16x32_bf16 v[76:79], v[88:91], v[112:115], v[76:79]
    v_mfma_f32_16x16x32_bf16 v[80:83], v[88:91], v[116:119], v[80:83]
    s_waitcnt vmcnt(4)
    ds_write_b128 v26, v[156:159] offset:0
    ds_write_b128 v26, v[160:163] offset:7168
    s_waitcnt lgkmcnt(0)
    s_barrier
    v_add_u32 v20, 86016, v12
    v_add_u32 v24, 86016, v16
    v_add_u32 v21, 86016, v13
    v_add_u32 v25, 86016, v17
    ds_read_b128 v[84:87], v20 offset:0
    ds_read_b128 v[88:91], v20 offset:512
    ds_read_b64_tr_b16 v[92:93], v24 offset:0
    ds_read_b64_tr_b16 v[94:95], v24 offset:1792
    ds_read_b64_tr_b16 v[96:97], v24 offset:32
    ds_read_b64_tr_b16 v[98:99], v24 offset:1824
    ds_read_b64_tr_b16 v[100:101], v24 offset:64
    ds_read_b64_tr_b16 v[102:103], v24 offset:1856
    ds_read_b64_tr_b16 v[104:105], v24 offset:96
    ds_read_b64_tr_b16 v[106:107], v24 offset:1888
    ds_read_b64_tr_b16 v[108:109], v24 offset:128
    ds_read_b64_tr_b16 v[110:111], v24 offset:1920
    ds_read_b64_tr_b16 v[112:113], v24 offset:160
    ds_read_b64_tr_b16 v[114:115], v24 offset:1952
    ds_read_b64_tr_b16 v[116:117], v24 offset:192
    ds_read_b64_tr_b16 v[118:119], v24 offset:1984
    s_waitcnt lgkmcnt(15)
    v_mfma_f32_16x16x32_bf16 v[28:31], v[120:123], v[128:131], v[28:31]
    v_mfma_f32_16x16x32_bf16 v[32:35], v[120:123], v[132:135], v[32:35]
    v_mfma_f32_16x16x32_bf16 v[36:39], v[120:123], v[136:139], v[36:39]
    v_mfma_f32_16x16x32_bf16 v[40:43], v[120:123], v[140:143], v[40:43]
    v_mfma_f32_16x16x32_bf16 v[44:47], v[120:123], v[144:147], v[44:47]
    v_mfma_f32_16x16x32_bf16 v[48:51], v[120:123], v[148:151], v[48:51]
    v_mfma_f32_16x16x32_bf16 v[52:55], v[120:123], v[152:155], v[52:55]
    v_mfma_f32_16x16x32_bf16 v[56:59], v[124:127], v[128:131], v[56:59]
    v_mfma_f32_16x16x32_bf16 v[60:63], v[124:127], v[132:135], v[60:63]
    v_mfma_f32_16x16x32_bf16 v[64:67], v[124:127], v[136:139], v[64:67]
    v_mfma_f32_16x16x32_bf16 v[68:71], v[124:127], v[140:143], v[68:71]
    v_mfma_f32_16x16x32_bf16 v[72:75], v[124:127], v[144:147], v[72:75]
    v_mfma_f32_16x16x32_bf16 v[76:79], v[124:127], v[148:151], v[76:79]
    v_mfma_f32_16x16x32_bf16 v[80:83], v[124:127], v[152:155], v[80:83]
    ds_read_b128 v[120:123], v21 offset:0
    ds_read_b128 v[124:127], v21 offset:512
    ds_read_b64_tr_b16 v[128:129], v25 offset:0
    ds_read_b64_tr_b16 v[130:131], v25 offset:1792
    ds_read_b64_tr_b16 v[132:133], v25 offset:32
    ds_read_b64_tr_b16 v[134:135], v25 offset:1824
    ds_read_b64_tr_b16 v[136:137], v25 offset:64
    ds_read_b64_tr_b16 v[138:139], v25 offset:1856
    ds_read_b64_tr_b16 v[140:141], v25 offset:96
    ds_read_b64_tr_b16 v[142:143], v25 offset:1888
    ds_read_b64_tr_b16 v[144:145], v25 offset:128
    ds_read_b64_tr_b16 v[146:147], v25 offset:1920
    ds_read_b64_tr_b16 v[148:149], v25 offset:160
    ds_read_b64_tr_b16 v[150:151], v25 offset:1952
    ds_read_b64_tr_b16 v[152:153], v25 offset:192
    ds_read_b64_tr_b16 v[154:155], v25 offset:1984
    s_waitcnt lgkmcnt(15)
    v_mfma_f32_16x16x32_bf16 v[28:31], v[84:87], v[92:95], v[28:31]
    v_mfma_f32_16x16x32_bf16 v[32:35], v[84:87], v[96:99], v[32:35]
    v_mfma_f32_16x16x32_bf16 v[36:39], v[84:87], v[100:103], v[36:39]
    v_mfma_f32_16x16x32_bf16 v[40:43], v[84:87], v[104:107], v[40:43]
    v_mfma_f32_16x16x32_bf16 v[44:47], v[84:87], v[108:111], v[44:47]
    v_mfma_f32_16x16x32_bf16 v[48:51], v[84:87], v[112:115], v[48:51]
    v_mfma_f32_16x16x32_bf16 v[52:55], v[84:87], v[116:119], v[52:55]
    v_mfma_f32_16x16x32_bf16 v[56:59], v[88:91], v[92:95], v[56:59]
    v_mfma_f32_16x16x32_bf16 v[60:63], v[88:91], v[96:99], v[60:63]
    v_mfma_f32_16x16x32_bf16 v[64:67], v[88:91], v[100:103], v[64:67]
    v_mfma_f32_16x16x32_bf16 v[68:71], v[88:91], v[104:107], v[68:71]
    v_mfma_f32_16x16x32_bf16 v[72:75], v[88:91], v[108:111], v[72:75]
    v_mfma_f32_16x16x32_bf16 v[76:79], v[88:91], v[112:115], v[76:79]
    v_mfma_f32_16x16x32_bf16 v[80:83], v[88:91], v[116:119], v[80:83]
    s_waitcnt vmcnt(0) lgkmcnt(0)
    s_barrier
    v_add_u32 v20, 129024, v12
    v_add_u32 v24, 0, v16
    v_add_u32 v21, 129024, v13
    v_add_u32 v25, 0, v17
    ds_read_b128 v[84:87], v20 offset:0
    ds_read_b128 v[88:91], v20 offset:512
    ds_read_b64_tr_b16 v[92:93], v24 offset:0
    ds_read_b64_tr_b16 v[94:95], v24 offset:1792
    ds_read_b64_tr_b16 v[96:97], v24 offset:32
    ds_read_b64_tr_b16 v[98:99], v24 offset:1824
    ds_read_b64_tr_b16 v[100:101], v24 offset:64
    ds_read_b64_tr_b16 v[102:103], v24 offset:1856
    ds_read_b64_tr_b16 v[104:105], v24 offset:96
    ds_read_b64_tr_b16 v[106:107], v24 offset:1888
    ds_read_b64_tr_b16 v[108:109], v24 offset:128
    ds_read_b64_tr_b16 v[110:111], v24 offset:1920
    ds_read_b64_tr_b16 v[112:113], v24 offset:160
    ds_read_b64_tr_b16 v[114:115], v24 offset:1952
    ds_read_b64_tr_b16 v[116:117], v24 offset:192
    ds_read_b64_tr_b16 v[118:119], v24 offset:1984
    s_waitcnt lgkmcnt(15)
    v_mfma_f32_16x16x32_bf16 v[28:31], v[120:123], v[128:131], v[28:31]
    v_mfma_f32_16x16x32_bf16 v[32:35], v[120:123], v[132:135], v[32:35]
    v_mfma_f32_16x16x32_bf16 v[36:39], v[120:123], v[136:139], v[36:39]
    v_mfma_f32_16x16x32_bf16 v[40:43], v[120:123], v[140:143], v[40:43]
    v_mfma_f32_16x16x32_bf16 v[44:47], v[120:123], v[144:147], v[44:47]
    v_mfma_f32_16x16x32_bf16 v[48:51], v[120:123], v[148:151], v[48:51]
    v_mfma_f32_16x16x32_bf16 v[52:55], v[120:123], v[152:155], v[52:55]
    v_mfma_f32_16x16x32_bf16 v[56:59], v[124:127], v[128:131], v[56:59]
    v_mfma_f32_16x16x32_bf16 v[60:63], v[124:127], v[132:135], v[60:63]
    v_mfma_f32_16x16x32_bf16 v[64:67], v[124:127], v[136:139], v[64:67]
    v_mfma_f32_16x16x32_bf16 v[68:71], v[124:127], v[140:143], v[68:71]
    v_mfma_f32_16x16x32_bf16 v[72:75], v[124:127], v[144:147], v[72:75]
    v_mfma_f32_16x16x32_bf16 v[76:79], v[124:127], v[148:151], v[76:79]
    v_mfma_f32_16x16x32_bf16 v[80:83], v[124:127], v[152:155], v[80:83]
    ds_read_b128 v[120:123], v21 offset:0
    ds_read_b128 v[124:127], v21 offset:512
    ds_read_b64_tr_b16 v[128:129], v25 offset:0
    ds_read_b64_tr_b16 v[130:131], v25 offset:1792
    ds_read_b64_tr_b16 v[132:133], v25 offset:32
    ds_read_b64_tr_b16 v[134:135], v25 offset:1824
    ds_read_b64_tr_b16 v[136:137], v25 offset:64
    ds_read_b64_tr_b16 v[138:139], v25 offset:1856
    ds_read_b64_tr_b16 v[140:141], v25 offset:96
    ds_read_b64_tr_b16 v[142:143], v25 offset:1888
    ds_read_b64_tr_b16 v[144:145], v25 offset:128
    ds_read_b64_tr_b16 v[146:147], v25 offset:1920
    ds_read_b64_tr_b16 v[148:149], v25 offset:160
    ds_read_b64_tr_b16 v[150:151], v25 offset:1952
    ds_read_b64_tr_b16 v[152:153], v25 offset:192
    ds_read_b64_tr_b16 v[154:155], v25 offset:1984
    s_waitcnt lgkmcnt(15)
    v_mfma_f32_16x16x32_bf16 v[28:31], v[84:87], v[92:95], v[28:31]
    v_mfma_f32_16x16x32_bf16 v[32:35], v[84:87], v[96:99], v[32:35]
    v_mfma_f32_16x16x32_bf16 v[36:39], v[84:87], v[100:103], v[36:39]
    v_mfma_f32_16x16x32_bf16 v[40:43], v[84:87], v[104:107], v[40:43]
    v_mfma_f32_16x16x32_bf16 v[44:47], v[84:87], v[108:111], v[44:47]
    v_mfma_f32_16x16x32_bf16 v[48:51], v[84:87], v[112:115], v[48:51]
    v_mfma_f32_16x16x32_bf16 v[52:55], v[84:87], v[116:119], v[52:55]
    v_mfma_f32_16x16x32_bf16 v[56:59], v[88:91], v[92:95], v[56:59]
    v_mfma_f32_16x16x32_bf16 v[60:63], v[88:91], v[96:99], v[60:63]
    v_mfma_f32_16x16x32_bf16 v[64:67], v[88:91], v[100:103], v[64:67]
    v_mfma_f32_16x16x32_bf16 v[68:71], v[88:91], v[104:107], v[68:71]
    v_mfma_f32_16x16x32_bf16 v[72:75], v[88:91], v[108:111], v[72:75]
    v_mfma_f32_16x16x32_bf16 v[76:79], v[88:91], v[112:115], v[76:79]
    v_mfma_f32_16x16x32_bf16 v[80:83], v[88:91], v[116:119], v[80:83]
    s_waitcnt lgkmcnt(0)
    v_mfma_f32_16x16x32_bf16 v[28:31], v[120:123], v[128:131], v[28:31]
    v_mfma_f32_16x16x32_bf16 v[32:35], v[120:123], v[132:135], v[32:35]
    v_mfma_f32_16x16x32_bf16 v[36:39], v[120:123], v[136:139], v[36:39]
    v_mfma_f32_16x16x32_bf16 v[40:43], v[120:123], v[140:143], v[40:43]
    v_mfma_f32_16x16x32_bf16 v[44:47], v[120:123], v[144:147], v[44:47]
    v_mfma_f32_16x16x32_bf16 v[48:51], v[120:123], v[148:151], v[48:51]
    v_mfma_f32_16x16x32_bf16 v[52:55], v[120:123], v[152:155], v[52:55]
    v_mfma_f32_16x16x32_bf16 v[56:59], v[124:127], v[128:131], v[56:59]
    v_mfma_f32_16x16x32_bf16 v[60:63], v[124:127], v[132:135], v[60:63]
    v_mfma_f32_16x16x32_bf16 v[64:67], v[124:127], v[136:139], v[64:67]
    v_mfma_f32_16x16x32_bf16 v[68:71], v[124:127], v[140:143], v[68:71]
    v_mfma_f32_16x16x32_bf16 v[72:75], v[124:127], v[144:147], v[72:75]
    v_mfma_f32_16x16x32_bf16 v[76:79], v[124:127], v[148:151], v[76:79]
    v_mfma_f32_16x16x32_bf16 v[80:83], v[124:127], v[152:155], v[80:83]
    s_mov_b32 s22, 1.0
    s_mov_b32 s23, 6422528
P_gepi:
    s_mul_i32 s24, s19, 28
    s_mul_i32 s25, s20, 7
    s_add_u32 s24, s24, s25
    s_mul_i32 s24, s24, 14
    s_add_u32 s24, s24, s21
    s_lshl_b32 s24, s24, 10
    s_add_u32 s24, s24, s23
    s_mov_b32 s23, s22
    v_pk_mul_f32 v[28:29], v[28:29], s[22:23]
    v_pk_mul_f32 v[30:31], v[30:31], s[22:23]
    v_cvt_pk_bf16_f32 v84, v28, v29
    v_cvt_pk_bf16_f32 v85, v30, v31
    v_pk_mul_f32 v[56:57], v[56:57], s[22:23]
    v_pk_mul_f32 v[58:59], v[58:59], s[22:23]
    v_cvt_pk_bf16_f32 v86, v56, v57
    v_cvt_pk_bf16_f32 v87, v58, v59
    buffer_store_dwordx4 v[84:87], v5, s[4:7], s24 offen sc1
    s_add_u32 s24, s24, 14336
    v_pk_mul_f32 v[32:33], v[32:33], s[22:23]
    v_pk_mul_f32 v[34:35], v[34:35], s[22:23]
    v_cvt_pk_bf16_f32 v88, v32, v33
    v_cvt_pk_bf16_f32 v89, v34, v35
    v_pk_mul_f32 v[60:61], v[60:61], s[22:23]
    v_pk_mul_f32 v[62:63], v[62:63], s[22:23]
    v_cvt_pk_bf16_f32 v90, v60, v61
    v_cvt_pk_bf16_f32 v91, v62, v63
    buffer_store_dwordx4 v[88:91], v5, s[4:7], s24 offen sc1
    s_add_u32 s24, s24, 14336
    v_pk_mul_f32 v[36:37], v[36:37], s[22:23]
    v_pk_mul_f32 v[38:39], v[38:39], s[22:23]
    v_cvt_pk_bf16_f32 v92, v36, v37
    v_cvt_pk_bf16_f32 v93, v38, v39
    v_pk_mul_f32 v[64:65], v[64:65], s[22:23]
    v_pk_mul_f32 v[66:67], v[66:67], s[22:23]
    v_cvt_pk_bf16_f32 v94, v64, v65
    v_cvt_pk_bf16_f32 v95, v66, v67
    buffer_store_dwordx4 v[92:95], v5, s[4:7], s24 offen sc1
    s_add_u32 s24, s24, 14336
    v_pk_mul_f32 v[40:41], v[40:41], s[22:23]
    v_pk_mul_f32 v[42:43], v[42:43], s[22:23]
    v_cvt_pk_bf16_f32 v96, v40, v41
    v_cvt_pk_bf16_f32 v97, v42, v43
    v_pk_mul_f32 v[68:69], v[68:69], s[22:23]
    v_pk_mul_f32 v[70:71], v[70:71], s[22:23]
    v_cvt_pk_bf16_f32 v98, v68, v69
    v_cvt_pk_bf16_f32 v99, v70, v71
    buffer_store_dwordx4 v[96:99], v5, s[4:7], s24 offen sc1
    s_add_u32 s24, s24, 14336
    v_pk_mul_f32 v[44:45], v[44:45], s[22:23]
    v_pk_mul_f32 v[46:47], v[46:47], s[22:23]
    v_cvt_pk_bf16_f32 v100, v44, v45
    v_cvt_pk_bf16_f32 v101, v46, v47
    v_pk_mul_f32 v[72:73], v[72:73], s[22:23]
    v_pk_mul_f32 v[74:75], v[74:75], s[22:23]
    v_cvt_pk_bf16_f32 v102, v72, v73
    v_cvt_pk_bf16_f32 v103, v74, v75
    buffer_store_dwordx4 v[100:103], v5, s[4:7], s24 offen sc1
    s_add_u32 s24, s24, 14336
    v_pk_mul_f32 v[48:49], v[48:49], s[22:23]
    v_pk_mul_f32 v[50:51], v[50:51], s[22:23]
    v_cvt_pk_bf16_f32 v104, v48, v49
    v_cvt_pk_bf16_f32 v105, v50, v51
    v_pk_mul_f32 v[76:77], v[76:77], s[22:23]
    v_pk_mul_f32 v[78:79], v[78:79], s[22:23]
    v_cvt_pk_bf16_f32 v106, v76, v77
    v_cvt_pk_bf16_f32 v107, v78, v79
    buffer_store_dwordx4 v[104:107], v5, s[4:7], s24 offen sc1
    s_add_u32 s24, s24, 14336
    v_pk_mul_f32 v[52:53], v[52:53], s[22:23]
    v_pk_mul_f32 v[54:55], v[54:55], s[22:23]
    v_cvt_pk_bf16_f32 v108, v52, v53
    v_cvt_pk_bf16_f32 v109, v54, v55
    v_pk_mul_f32 v[80:81], v[80:81], s[22:23]
    v_pk_mul_f32 v[82:83], v[82:83], s[22:23]
    v_cvt_pk_bf16_f32 v110, v80, v81
    v_cvt_pk_bf16_f32 v111, v82, v83
    buffer_store_dwordx4 v[108:111], v5, s[4:7], s24 offen sc1
    s_add_u32 s24, s24, 14336
    s_endpgm
P_ln:
    s_load_dwordx2 s[8:9], s[0:1], 0
    s_mov_b32 s10, 1835008
    s_mov_b32 s11, 0x20000
    s_load_dwordx2 s[12:13], s[0:1], 64
    s_mov_b32 s14, 896
    s_mov_b32 s15, 0x20000
    s_load_dwordx2 s[28:29], s[0:1], 8
    s_mov_b32 s30, 7168
    s_mov_b32 s31, 0x20000
    s_mov_b32 s17, s2
    v_lshrrev_b32 v3, 3, v2
    s_lshl_b32 s18, s17, 3
    v_add_u32 v3, s18, v3
    v_and_b32 v4, 7, v2
    v_mul_u32_u24 v5, 896, v3
    v_lshl_add_u32 v5, v4, 4, v5
    v_lshlrev_b32 v6, 4, v4
    s_waitcnt lgkmcnt(0)
    s_and_b32 s5, s5, 0xffff
    s_and_b32 s9, s9, 0xffff
    s_and_b32 s13, s13, 0xffff
    buffer_load_dwordx4 v[16:19], v5, s[8:11], 0 offen offset:0
    buffer_load_dwordx4 v[20:23], v5, s[8:11], 0 offen offset:128
    buffer_load_dwordx4 v[24:27], v5, s[8:11], 0 offen offset:256
    buffer_load_dwordx4 v[28:31], v5, s[8:11], 0 offen offset:384
    buffer_load_dwordx4 v[32:35], v5, s[8:11], 0 offen offset:512
    buffer_load_dwordx4 v[36:39], v5, s[8:11], 0 offen offset:640
    buffer_load_dwordx4 v[40:43], v5, s[8:11], 0 offen offset:768
    buffer_load_dwordx4 v[44:47], v6, s[12:15], 0 offen offset:0
    buffer_load_dwordx4 v[48:51], v6, s[12:15], 0 offen offset:128
    buffer_load_dwordx4 v[52:55], v6, s[12:15], 0 offen offset:256
    buffer_load_dwordx4 v[56:59], v6, s[12:15], 0 offen offset:384
    buffer_load_dwordx4 v[60:63], v6, s[12:15], 0 offen offset:512
    buffer_load_dwordx4 v[64:67], v6, s[12:15], 0 offen offset:640
    buffer_load_dwordx4 v[68:71], v6, s[12:15], 0 offen offset:768
    v_lshrrev_b32 v7, 4, v3
    v_mul_u32_u24 v7, 14336, v7
    v_lshrrev_b32 v8, 2, v4
    v_lshl_add_u32 v7, v8, 10, v7
    v_and_b32 v8, 15, v3
    v_lshl_add_u32 v9, v8, 4, v7
    v_and_b32 v8, 3, v4
    v_lshl_add_u32 v9, v8, 8, v9
    v_bfe_u32 v8, v3, 1, 2
    v_lshl_add_u32 v10, v8, 6, v7
    v_bfe_u32 v8, v3, 3, 1
    v_lshl_add_u32 v10, v8, 5, v10
    v_and_b32 v8, 1, v3
    v_lshl_add_u32 v10, v8, 4, v10
    v_bfe_u32 v8, v4, 1, 1
    v_lshl_add_u32 v10, v8, 9, v10
    v_and_b32 v8, 1, v4
    v_lshl_add_u32 v10, v8, 3, v10
    s_mov_b32 s20, 0xffff0000
    s_and_b32 s29, s29, 0xffff
    v_bfe_u32 v12, v2, 2, 3
    v_mul_u32_u24 v12, 896, v12
    v_and_b32 v13, 3, v2
    v_lshl_add_u32 v12, v13, 3, v12
    v_lshrrev_b32 v13, 5, v2
    v_lshl_add_u32 v12, v13, 2, v12
    s_lshl_b32 s21, s2, 5
    buffer_load_dword v160, v12, s[28:31], s21 offen
    s_barrier
    s_mov_b32 s32, s4
    s_mov_b32 s33, s5
    s_mov_b32 s34, 64414720
    s_mov_b32 s35, 0x20000
    s_mov_b32 s36, s4
    s_mov_b32 s37, s5
    s_mov_b32 s38, 67710976
    s_mov_b32 s39, 0x20000
    v_lshlrev_b32 v11, 4, v2
    s_mul_i32 s21, s2, 6144
    s_add_u32 s21, s21, 62856192
    v_mov_b32 v164, -1
    v_mov_b32 v165, -1
    v_mov_b32 v166, -1
    v_mov_b32 v167, -1
    v_mov_b32 v168, 0
    v_mov_b32 v169, 0
    v_mov_b32 v170, 0
    v_mov_b32 v171, 0
    buffer_store_dwordx4 v[164:167], v11, s[32:35], s21 offen offset:0
    buffer_store_dwordx4 v[164:167], v11, s[32:35], s21 offen offset:1024
    buffer_store_dwordx4 v[164:167], v11, s[32:35], s21 offen offset:2048
    buffer_store_dwordx4 v[164:167], v11, s[32:35], s21 offen offset:3072
    s_add_u32 s21, s21, 4096
    buffer_store_dwordx4 v[164:167], v11, s[32:35], s21 offen offset:0
    buffer_store_dwordx4 v[164:167], v11, s[32:35], s21 offen offset:1024
    s_mov_b32 s34, 62849024
    s_mul_i32 s21, s2, 3072
    s_add_u32 s21, s21, 62160896
    buffer_store_dwordx4 v[164:167], v11, s[32:35], s21 offen offset:0
    buffer_store_dwordx4 v[164:167], v11, s[32:35], s21 offen offset:1024
    buffer_store_dwordx4 v[164:167], v11, s[32:35], s21 offen offset:2048
    s_lshl_b32 s21, s2, 10
    s_add_u32 s21, s21, 67678208
    buffer_store_dwordx4 v[168:171], v11, s[36:39], s21 offen
    s_waitcnt vmcnt(18)
    v_lshlrev_b32 v72, 16, v16
    v_and_b32 v73, s20, v16
    v_lshlrev_b32 v74, 16, v17
    v_and_b32 v75, s20, v17
    v_lshlrev_b32 v76, 16, v18
    v_and_b32 v77, s20, v18
    v_lshlrev_b32 v78, 16, v19
    v_and_b32 v79, s20, v19
    v_lshlrev_b32 v80, 16, v20
    v_and_b32 v81, s20, v20
    v_lshlrev_b32 v82, 16, v21
    v_and_b32 v83, s20, v21
    v_lshlrev_b32 v84, 16, v22
    v_and_b32 v85, s20, v22
    v_lshlrev_b32 v86, 16, v23
    v_and_b32 v87, s20, v23
    v_lshlrev_b32 v88, 16, v24
    v_and_b32 v89, s20, v24
    v_lshlrev_b32 v90, 16, v25
    v_and_b32 v91, s20, v25
    v_lshlrev_b32 v92, 16, v26
    v_and_b32 v93, s20, v26
    v_lshlrev_b32 v94, 16, v27
    v_and_b32 v95, s20, v27
    v_lshlrev_b32 v96, 16, v28
    v_and_b32 v97, s20, v28
    v_lshlrev_b32 v98, 16, v29
    v_and_b32 v99, s20, v29
    v_lshlrev_b32 v100, 16, v30
    v_and_b32 v101, s20, v30
    v_lshlrev_b32 v102, 16, v31
    v_and_b32 v103, s20, v31
    v_lshlrev_b32 v104, 16, v32
    v_and_b32 v105, s20, v32
    v_lshlrev_b32 v106, 16, v33
    v_and_b32 v107, s20, v33
    v_lshlrev_b32 v108, 16, v34
    v_and_b32 v109, s20, v34
    v_lshlrev_b32 v110, 16, v35
    v_and_b32 v111, s20, v35
    v_lshlrev_b32 v112, 16, v36
    v_and_b32 v113, s20, v36
    v_lshlrev_b32 v114, 16, v37
    v_and_b32 v115, s20, v37
    v_lshlrev_b32 v116, 16, v38
    v_and_b32 v117, s20, v38
    v_lshlrev_b32 v118, 16, v39
    v_and_b32 v119, s20, v39
    v_lshlrev_b32 v120, 16, v40
    v_and_b32 v121, s20, v40
    v_lshlrev_b32 v122, 16, v41
    v_and_b32 v123, s20, v41
    v_lshlrev_b32 v124, 16, v42
    v_and_b32 v125, s20, v42
    v_lshlrev_b32 v126, 16, v43
    v_and_b32 v127, s20, v43
    v_pk_add_f32 v[12:13], v[72:73], v[74:75]
    v_pk_add_f32 v[12:13], v[12:13], v[76:77]
    v_pk_add_f32 v[12:13], v[12:13], v[78:79]
    v_pk_add_f32 v[12:13], v[12:13], v[80:81]
    v_pk_add_f32 v[12:13], v[12:13], v[82:83]
    v_pk_add_f32 v[12:13], v[12:13], v[84:85]
    v_pk_add_f32 v[12:13], v[12:13], v[86:87]
    v_pk_add_f32 v[12:13], v[12:13], v[88:89]
    v_pk_add_f32 v[12:13], v[12:13], v[90:91]
    v_pk_add_f32 v[12:13], v[12:13], v[92:93]
    v_pk_add_f32 v[12:13], v[12:13], v[94:95]
    v_pk_add_f32 v[12:13], v[12:13], v[96:97]
    v_pk_add_f32 v[12:13], v[12:13], v[98:99]
    v_pk_add_f32 v[12:13], v[12:13], v[100:101]
    v_pk_add_f32 v[12:13], v[12:13], v[102:103]
    v_pk_add_f32 v[12:13], v[12:13], v[104:105]
    v_pk_add_f32 v[12:13], v[12:13], v[106:107]
    v_pk_add_f32 v[12:13], v[12:13], v[108:109]
    v_pk_add_f32 v[12:13], v[12:13], v[110:111]
    v_pk_add_f32 v[12:13], v[12:13], v[112:113]
    v_pk_add_f32 v[12:13], v[12:13], v[114:115]
    v_pk_add_f32 v[12:13], v[12:13], v[116:117]
    v_pk_add_f32 v[12:13], v[12:13], v[118:119]
    v_pk_add_f32 v[12:13], v[12:13], v[120:121]
    v_pk_add_f32 v[12:13], v[12:13], v[122:123]
    v_pk_add_f32 v[12:13], v[12:13], v[124:125]
    v_pk_add_f32 v[12:13], v[12:13], v[126:127]
    v_add_f32 v12, v12, v13
    s_barrier
    s_nop 1
    v_add_f32_dpp v12, v12, v12 quad_perm:[1,0,3,2] row_mask:0xf bank_mask:0xf
    s_nop 1
    v_add_f32_dpp v12, v12, v12 quad_perm:[2,3,0,1] row_mask:0xf bank_mask:0xf
    s_nop 1
    v_add_f32_dpp v12, v12, v12 row_half_mirror row_mask:0xf bank_mask:0xf
    s_mov_b32 s21, 0x3b124925
    v_mul_f32 v12, s21, v12
    v_mov_b32 v14, 0
    v_mov_b32 v15, 0
    v_pk_add_f32 v[16:17], v[72:73], v[12:13] op_sel_hi:[1,0] neg_lo:[0,1] neg_hi:[0,1]
    v_pk_fma_f32 v[14:15], v[16:17], v[16:17], v[14:15]
    v_pk_add_f32 v[16:17], v[74:75], v[12:13] op_sel_hi:[1,0] neg_lo:[0,1] neg_hi:[0,1]
    v_pk_fma_f32 v[14:15], v[16:17], v[16:17], v[14:15]
    v_pk_add_f32 v[16:17], v[76:77], v[12:13] op_sel_hi:[1,0] neg_lo:[0,1] neg_hi:[0,1]
    v_pk_fma_f32 v[14:15], v[16:17], v[16:17], v[14:15]
    v_pk_add_f32 v[16:17], v[78:79], v[12:13] op_sel_hi:[1,0] neg_lo:[0,1] neg_hi:[0,1]
    v_pk_fma_f32 v[14:15], v[16:17], v[16:17], v[14:15]
    v_pk_add_f32 v[16:17], v[80:81], v[12:13] op_sel_hi:[1,0] neg_lo:[0,1] neg_hi:[0,1]
    v_pk_fma_f32 v[14:15], v[16:17], v[16:17], v[14:15]
    v_pk_add_f32 v[16:17], v[82:83], v[12:13] op_sel_hi:[1,0] neg_lo:[0,1] neg_hi:[0,1]
    v_pk_fma_f32 v[14:15], v[16:17], v[16:17], v[14:15]
    v_pk_add_f32 v[16:17], v[84:85], v[12:13] op_sel_hi:[1,0] neg_lo:[0,1] neg_hi:[0,1]
    v_pk_fma_f32 v[14:15], v[16:17], v[16:17], v[14:15]
    v_pk_add_f32 v[16:17], v[86:87], v[12:13] op_sel_hi:[1,0] neg_lo:[0,1] neg_hi:[0,1]
    v_pk_fma_f32 v[14:15], v[16:17], v[16:17], v[14:15]
    v_pk_add_f32 v[16:17], v[88:89], v[12:13] op_sel_hi:[1,0] neg_lo:[0,1] neg_hi:[0,1]
    v_pk_fma_f32 v[14:15], v[16:17], v[16:17], v[14:15]
    v_pk_add_f32 v[16:17], v[90:91], v[12:13] op_sel_hi:[1,0] neg_lo:[0,1] neg_hi:[0,1]
    v_pk_fma_f32 v[14:15], v[16:17], v[16:17], v[14:15]
    v_pk_add_f32 v[16:17], v[92:93], v[12:13] op_sel_hi:[1,0] neg_lo:[0,1] neg_hi:[0,1]
    v_pk_fma_f32 v[14:15], v[16:17], v[16:17], v[14:15]
    v_pk_add_f32 v[16:17], v[94:95], v[12:13] op_sel_hi:[1,0] neg_lo:[0,1] neg_hi:[0,1]
    v_pk_fma_f32 v[14:15], v[16:17], v[16:17], v[14:15]
    v_pk_add_f32 v[16:17], v[96:97], v[12:13] op_sel_hi:[1,0] neg_lo:[0,1] neg_hi:[0,1]
    v_pk_fma_f32 v[14:15], v[16:17], v[16:17], v[14:15]
    v_pk_add_f32 v[16:17], v[98:99], v[12:13] op_sel_hi:[1,0] neg_lo:[0,1] neg_hi:[0,1]
    v_pk_fma_f32 v[14:15], v[16:17], v[16:17], v[14:15]
    v_pk_add_f32 v[16:17], v[100:101], v[12:13] op_sel_hi:[1,0] neg_lo:[0,1] neg_hi:[0,1]
    v_pk_fma_f32 v[14:15], v[16:17], v[16:17], v[14:15]
    v_pk_add_f32 v[16:17], v[102:103], v[12:13] op_sel_hi:[1,0] neg_lo:[0,1] neg_hi:[0,1]
    v_pk_fma_f32 v[14:15], v[16:17], v[16:17], v[14:15]
    v_pk_add_f32 v[16:17], v[104:105], v[12:13] op_sel_hi:[1,0] neg_lo:[0,1] neg_hi:[0,1]
    v_pk_fma_f32 v[14:15], v[16:17], v[16:17], v[14:15]
    v_pk_add_f32 v[16:17], v[106:107], v[12:13] op_sel_hi:[1,0] neg_lo:[0,1] neg_hi:[0,1]
    v_pk_fma_f32 v[14:15], v[16:17], v[16:17], v[14:15]
    v_pk_add_f32 v[16:17], v[108:109], v[12:13] op_sel_hi:[1,0] neg_lo:[0,1] neg_hi:[0,1]
    v_pk_fma_f32 v[14:15], v[16:17], v[16:17], v[14:15]
    v_pk_add_f32 v[16:17], v[110:111], v[12:13] op_sel_hi:[1,0] neg_lo:[0,1] neg_hi:[0,1]
    v_pk_fma_f32 v[14:15], v[16:17], v[16:17], v[14:15]
    v_pk_add_f32 v[16:17], v[112:113], v[12:13] op_sel_hi:[1,0] neg_lo:[0,1] neg_hi:[0,1]
    v_pk_fma_f32 v[14:15], v[16:17], v[16:17], v[14:15]
    v_pk_add_f32 v[16:17], v[114:115], v[12:13] op_sel_hi:[1,0] neg_lo:[0,1] neg_hi:[0,1]
    v_pk_fma_f32 v[14:15], v[16:17], v[16:17], v[14:15]
    v_pk_add_f32 v[16:17], v[116:117], v[12:13] op_sel_hi:[1,0] neg_lo:[0,1] neg_hi:[0,1]
    v_pk_fma_f32 v[14:15], v[16:17], v[16:17], v[14:15]
    v_pk_add_f32 v[16:17], v[118:119], v[12:13] op_sel_hi:[1,0] neg_lo:[0,1] neg_hi:[0,1]
    v_pk_fma_f32 v[14:15], v[16:17], v[16:17], v[14:15]
    v_pk_add_f32 v[16:17], v[120:121], v[12:13] op_sel_hi:[1,0] neg_lo:[0,1] neg_hi:[0,1]
    v_pk_fma_f32 v[14:15], v[16:17], v[16:17], v[14:15]
    v_pk_add_f32 v[16:17], v[122:123], v[12:13] op_sel_hi:[1,0] neg_lo:[0,1] neg_hi:[0,1]
    v_pk_fma_f32 v[14:15], v[16:17], v[16:17], v[14:15]
    v_pk_add_f32 v[16:17], v[124:125], v[12:13] op_sel_hi:[1,0] neg_lo:[0,1] neg_hi:[0,1]
    v_pk_fma_f32 v[14:15], v[16:17], v[16:17], v[14:15]
    v_pk_add_f32 v[16:17], v[126:127], v[12:13] op_sel_hi:[1,0] neg_lo:[0,1] neg_hi:[0,1]
    v_pk_fma_f32 v[14:15], v[16:17], v[16:17], v[14:15]
    v_add_f32 v14, v14, v15
    s_nop 1
    v_add_f32_dpp v14, v14, v14 quad_perm:[1,0,3,2] row_mask:0xf bank_mask:0xf
    s_nop 1
    v_add_f32_dpp v14, v14, v14 quad_perm:[2,3,0,1] row_mask:0xf bank_mask:0xf
    s_nop 1
    v_add_f32_dpp v14, v14, v14 row_half_mirror row_mask:0xf bank_mask:0xf
    v_mul_f32 v14, s21, v14
    v_cvt_pk_bf16_f32 v14, v14, v14
    v_and_b32 v14, s20, v14
    v_add_f32 v14, 0x3727c5ac, v14
    v_cvt_pk_bf16_f32 v14, v14, v14
    v_and_b32 v14, s20, v14
    v_sqrt_f32 v14, v14
    s_nop 0
    v_cvt_pk_bf16_f32 v14, v14, v14
    v_and_b32 v14, s20, v14
    v_rcp_f32 v15, v14
    v_cvt_pk_bf16_f32 v12, v12, v12
    v_and_b32 v12, s20, v12
    s_waitcnt vmcnt(10)
    v_mov_b32 v128, 0
    v_mov_b32 v129, 0
    v_pk_add_f32 v[72:73], v[72:73], v[12:13] op_sel_hi:[1,0] neg_lo:[0,1] neg_hi:[0,1]
    v_cvt_pk_bf16_f32 v130, v72, v73
    v_lshlrev_b32 v72, 16, v130
    v_and_b32 v73, s20, v130
    v_pk_mul_f32 v[130:131], v[72:73], v[14:15] op_sel:[0,1] op_sel_hi:[1,1]
    v_pk_fma_f32 v[72:73], v[130:131], v[14:15], v[72:73] op_sel_hi:[1,0,1] neg_lo:[1,0,0] neg_hi:[1,0,0]
    v_pk_fma_f32 v[130:131], v[72:73], v[14:15], v[130:131] op_sel:[0,1,0] op_sel_hi:[1,1,1]
    v_cvt_pk_bf16_f32 v16, v130, v131
    v_mov_b32 v132, v16
    v_dot2_f32_bf16 v128, v16, v44, v128
    v_pk_add_f32 v[74:75], v[74:75], v[12:13] op_sel_hi:[1,0] neg_lo:[0,1] neg_hi:[0,1]
    v_cvt_pk_bf16_f32 v130, v74, v75
    v_lshlrev_b32 v74, 16, v130
    v_and_b32 v75, s20, v130
    v_pk_mul_f32 v[130:131], v[74:75], v[14:15] op_sel:[0,1] op_sel_hi:[1,1]
    v_pk_fma_f32 v[74:75], v[130:131], v[14:15], v[74:75] op_sel_hi:[1,0,1] neg_lo:[1,0,0] neg_hi:[1,0,0]
    v_pk_fma_f32 v[130:131], v[74:75], v[14:15], v[130:131] op_sel:[0,1,0] op_sel_hi:[1,1,1]
    v_cvt_pk_bf16_f32 v17, v130, v131
    v_mov_b32 v134, v17
    v_dot2_f32_bf16 v129, v17, v45, v129
    v_pk_add_f32 v[76:77], v[76:77], v[12:13] op_sel_hi:[1,0] neg_lo:[0,1] neg_hi:[0,1]
    v_cvt_pk_bf16_f32 v130, v76, v77
    v_lshlrev_b32 v76, 16, v130
    v_and_b32 v77, s20, v130
    v_pk_mul_f32 v[130:131], v[76:77], v[14:15] op_sel:[0,1] op_sel_hi:[1,1]
    v_pk_fma_f32 v[76:77], v[130:131], v[14:15], v[76:77] op_sel_hi:[1,0,1] neg_lo:[1,0,0] neg_hi:[1,0,0]
    v_pk_fma_f32 v[130:131], v[76:77], v[14:15], v[130:131] op_sel:[0,1,0] op_sel_hi:[1,1,1]
    v_cvt_pk_bf16_f32 v18, v130, v131
    v_mov_b32 v133, v18
    v_dot2_f32_bf16 v128, v18, v46, v128
    v_pk_add_f32 v[78:79], v[78:79], v[12:13] op_sel_hi:[1,0] neg_lo:[0,1] neg_hi:[0,1]
    v_cvt_pk_bf16_f32 v130, v78, v79
    v_lshlrev_b32 v78, 16, v130
    v_and_b32 v79, s20, v130
    v_pk_mul_f32 v[130:131], v[78:79], v[14:15] op_sel:[0,1] op_sel_hi:[1,1]
    v_pk_fma_f32 v[78:79], v[130:131], v[14:15], v[78:79] op_sel_hi:[1,0,1] neg_lo:[1,0,0] neg_hi:[1,0,0]
    v_pk_fma_f32 v[130:131], v[78:79], v[14:15], v[130:131] op_sel:[0,1,0] op_sel_hi:[1,1,1]
    v_cvt_pk_bf16_f32 v19, v130, v131
    v_mov_b32 v135, v19
    v_dot2_f32_bf16 v129, v19, v47, v129
    s_barrier
    v_pk_add_f32 v[80:81], v[80:81], v[12:13] op_sel_hi:[1,0] neg_lo:[0,1] neg_hi:[0,1]
    v_cvt_pk_bf16_f32 v130, v80, v81
    v_lshlrev_b32 v80, 16, v130
    v_and_b32 v81, s20, v130
    v_pk_mul_f32 v[130:131], v[80:81], v[14:15] op_sel:[0,1] op_sel_hi:[1,1]
    v_pk_fma_f32 v[80:81], v[130:131], v[14:15], v[80:81] op_sel_hi:[1,0,1] neg_lo:[1,0,0] neg_hi:[1,0,0]
    v_pk_fma_f32 v[130:131], v[80:81], v[14:15], v[130:131] op_sel:[0,1,0] op_sel_hi:[1,1,1]
    v_cvt_pk_bf16_f32 v20, v130, v131
    v_mov_b32 v136, v20
    v_dot2_f32_bf16 v128, v20, v48, v128
    v_pk_add_f32 v[82:83], v[82:83], v[12:13] op_sel_hi:[1,0] neg_lo:[0,1] neg_hi:[0,1]
    v_cvt_pk_bf16_f32 v130, v82, v83
    v_lshlrev_b32 v82, 16, v130
    v_and_b32 v83, s20, v130
    v_pk_mul_f32 v[130:131], v[82:83], v[14:15] op_sel:[0,1] op_sel_hi:[1,1]
    v_pk_fma_f32 v[82:83], v[130:131], v[14:15], v[82:83] op_sel_hi:[1,0,1] neg_lo:[1,0,0] neg_hi:[1,0,0]
    v_pk_fma_f32 v[130:131], v[82:83], v[14:15], v[130:131] op_sel:[0,1,0] op_sel_hi:[1,1,1]
    v_cvt_pk_bf16_f32 v21, v130, v131
    v_mov_b32 v138, v21
    v_dot2_f32_bf16 v129, v21, v49, v129
    v_pk_add_f32 v[84:85], v[84:85], v[12:13] op_sel_hi:[1,0] neg_lo:[0,1] neg_hi:[0,1]
    v_cvt_pk_bf16_f32 v130, v84, v85
    v_lshlrev_b32 v84, 16, v130
    v_and_b32 v85, s20, v130
    v_pk_mul_f32 v[130:131], v[84:85], v[14:15] op_sel:[0,1] op_sel_hi:[1,1]
    v_pk_fma_f32 v[84:85], v[130:131], v[14:15], v[84:85] op_sel_hi:[1,0,1] neg_lo:[1,0,0] neg_hi:[1,0,0]
    v_pk_fma_f32 v[130:131], v[84:85], v[14:15], v[130:131] op_sel:[0,1,0] op_sel_hi:[1,1,1]
    v_cvt_pk_bf16_f32 v22, v130, v131
    v_mov_b32 v137, v22
    v_dot2_f32_bf16 v128, v22, v50, v128
    v_pk_add_f32 v[86:87], v[86:87], v[12:13] op_sel_hi:[1,0] neg_lo:[0,1] neg_hi:[0,1]
    v_cvt_pk_bf16_f32 v130, v86, v87
    v_lshlrev_b32 v86, 16, v130
    v_and_b32 v87, s20, v130
    v_pk_mul_f32 v[130:131], v[86:87], v[14:15] op_sel:[0,1] op_sel_hi:[1,1]
    v_pk_fma_f32 v[86:87], v[130:131], v[14:15], v[86:87] op_sel_hi:[1,0,1] neg_lo:[1,0,0] neg_hi:[1,0,0]
    v_pk_fma_f32 v[130:131], v[86:87], v[14:15], v[130:131] op_sel:[0,1,0] op_sel_hi:[1,1,1]
    v_cvt_pk_bf16_f32 v23, v130, v131
    v_mov_b32 v139, v23
    v_dot2_f32_bf16 v129, v23, v51, v129
    v_pk_add_f32 v[88:89], v[88:89], v[12:13] op_sel_hi:[1,0] neg_lo:[0,1] neg_hi:[0,1]
    v_cvt_pk_bf16_f32 v130, v88, v89
    v_lshlrev_b32 v88, 16, v130
    v_and_b32 v89, s20, v130
    v_pk_mul_f32 v[130:131], v[88:89], v[14:15] op_sel:[0,1] op_sel_hi:[1,1]
    v_pk_fma_f32 v[88:89], v[130:131], v[14:15], v[88:89] op_sel_hi:[1,0,1] neg_lo:[1,0,0] neg_hi:[1,0,0]
    v_pk_fma_f32 v[130:131], v[88:89], v[14:15], v[130:131] op_sel:[0,1,0] op_sel_hi:[1,1,1]
    v_cvt_pk_bf16_f32 v24, v130, v131
    v_mov_b32 v140, v24
    v_dot2_f32_bf16 v128, v24, v52, v128
    v_pk_add_f32 v[90:91], v[90:91], v[12:13] op_sel_hi:[1,0] neg_lo:[0,1] neg_hi:[0,1]
    v_cvt_pk_bf16_f32 v130, v90, v91
    v_lshlrev_b32 v90, 16, v130
    v_and_b32 v91, s20, v130
    v_pk_mul_f32 v[130:131], v[90:91], v[14:15] op_sel:[0,1] op_sel_hi:[1,1]
    v_pk_fma_f32 v[90:91], v[130:131], v[14:15], v[90:91] op_sel_hi:[1,0,1] neg_lo:[1,0,0] neg_hi:[1,0,0]
    v_pk_fma_f32 v[130:131], v[90:91], v[14:15], v[130:131] op_sel:[0,1,0] op_sel_hi:[1,1,1]
    v_cvt_pk_bf16_f32 v25, v130, v131
    v_mov_b32 v142, v25
    v_dot2_f32_bf16 v129, v25, v53, v129
    v_pk_add_f32 v[92:93], v[92:93], v[12:13] op_sel_hi:[1,0] neg_lo:[0,1] neg_hi:[0,1]
    v_cvt_pk_bf16_f32 v130, v92, v93
    v_lshlrev_b32 v92, 16, v130
    v_and_b32 v93, s20, v130
    v_pk_mul_f32 v[130:131], v[92:93], v[14:15] op_sel:[0,1] op_sel_hi:[1,1]
    v_pk_fma_f32 v[92:93], v[130:131], v[14:15], v[92:93] op_sel_hi:[1,0,1] neg_lo:[1,0,0] neg_hi:[1,0,0]
    v_pk_fma_f32 v[130:131], v[92:93], v[14:15], v[130:131] op_sel:[0,1,0] op_sel_hi:[1,1,1]
    v_cvt_pk_bf16_f32 v26, v130, v131
    v_mov_b32 v141, v26
    v_dot2_f32_bf16 v128, v26, v54, v128
    v_pk_add_f32 v[94:95], v[94:95], v[12:13] op_sel_hi:[1,0] neg_lo:[0,1] neg_hi:[0,1]
    v_cvt_pk_bf16_f32 v130, v94, v95
    v_lshlrev_b32 v94, 16, v130
    v_and_b32 v95, s20, v130
    v_pk_mul_f32 v[130:131], v[94:95], v[14:15] op_sel:[0,1] op_sel_hi:[1,1]
    v_pk_fma_f32 v[94:95], v[130:131], v[14:15], v[94:95] op_sel_hi:[1,0,1] neg_lo:[1,0,0] neg_hi:[1,0,0]
    v_pk_fma_f32 v[130:131], v[94:95], v[14:15], v[130:131] op_sel:[0,1,0] op_sel_hi:[1,1,1]
    v_cvt_pk_bf16_f32 v27, v130, v131
    v_mov_b32 v143, v27
    v_dot2_f32_bf16 v129, v27, v55, v129
    v_pk_add_f32 v[96:97], v[96:97], v[12:13] op_sel_hi:[1,0] neg_lo:[0,1] neg_hi:[0,1]
    v_cvt_pk_bf16_f32 v130, v96, v97
    v_lshlrev_b32 v96, 16, v130
    v_and_b32 v97, s20, v130
    v_pk_mul_f32 v[130:131], v[96:97], v[14:15] op_sel:[0,1] op_sel_hi:[1,1]
    v_pk_fma_f32 v[96:97], v[130:131], v[14:15], v[96:97] op_sel_hi:[1,0,1] neg_lo:[1,0,0] neg_hi:[1,0,0]
    v_pk_fma_f32 v[130:131], v[96:97], v[14:15], v[130:131] op_sel:[0,1,0] op_sel_hi:[1,1,1]
    v_cvt_pk_bf16_f32 v28, v130, v131
    v_mov_b32 v144, v28
    v_dot2_f32_bf16 v128, v28, v56, v128
    v_pk_add_f32 v[98:99], v[98:99], v[12:13] op_sel_hi:[1,0] neg_lo:[0,1] neg_hi:[0,1]
    v_cvt_pk_bf16_f32 v130, v98, v99
    v_lshlrev_b32 v98, 16, v130
    v_and_b32 v99, s20, v130
    v_pk_mul_f32 v[130:131], v[98:99], v[14:15] op_sel:[0,1] op_sel_hi:[1,1]
    v_pk_fma_f32 v[98:99], v[130:131], v[14:15], v[98:99] op_sel_hi:[1,0,1] neg_lo:[1,0,0] neg_hi:[1,0,0]
    v_pk_fma_f32 v[130:131], v[98:99], v[14:15], v[130:131] op_sel:[0,1,0] op_sel_hi:[1,1,1]
    v_cvt_pk_bf16_f32 v29, v130, v131
    v_mov_b32 v146, v29
    v_dot2_f32_bf16 v129, v29, v57, v129
    v_pk_add_f32 v[100:101], v[100:101], v[12:13] op_sel_hi:[1,0] neg_lo:[0,1] neg_hi:[0,1]
    v_cvt_pk_bf16_f32 v130, v100, v101
    v_lshlrev_b32 v100, 16, v130
    v_and_b32 v101, s20, v130
    v_pk_mul_f32 v[130:131], v[100:101], v[14:15] op_sel:[0,1] op_sel_hi:[1,1]
    v_pk_fma_f32 v[100:101], v[130:131], v[14:15], v[100:101] op_sel_hi:[1,0,1] neg_lo:[1,0,0] neg_hi:[1,0,0]
    v_pk_fma_f32 v[130:131], v[100:101], v[14:15], v[130:131] op_sel:[0,1,0] op_sel_hi:[1,1,1]
    v_cvt_pk_bf16_f32 v30, v130, v131
    v_mov_b32 v145, v30
    v_dot2_f32_bf16 v128, v30, v58, v128
    v_pk_add_f32 v[102:103], v[102:103], v[12:13] op_sel_hi:[1,0] neg_lo:[0,1] neg_hi:[0,1]
    v_cvt_pk_bf16_f32 v130, v102, v103
    v_lshlrev_b32 v102, 16, v130
    v_and_b32 v103, s20, v130
    v_pk_mul_f32 v[130:131], v[102:103], v[14:15] op_sel:[0,1] op_sel_hi:[1,1]
    v_pk_fma_f32 v[102:103], v[130:131], v[14:15], v[102:103] op_sel_hi:[1,0,1] neg_lo:[1,0,0] neg_hi:[1,0,0]
    v_pk_fma_f32 v[130:131], v[102:103], v[14:15], v[130:131] op_sel:[0,1,0] op_sel_hi:[1,1,1]
    v_cvt_pk_bf16_f32 v31, v130, v131
    v_mov_b32 v147, v31
    v_dot2_f32_bf16 v129, v31, v59, v129
    s_barrier
    v_pk_add_f32 v[104:105], v[104:105], v[12:13] op_sel_hi:[1,0] neg_lo:[0,1] neg_hi:[0,1]
    v_cvt_pk_bf16_f32 v130, v104, v105
    v_lshlrev_b32 v104, 16, v130
    v_and_b32 v105, s20, v130
    v_pk_mul_f32 v[130:131], v[104:105], v[14:15] op_sel:[0,1] op_sel_hi:[1,1]
    v_pk_fma_f32 v[104:105], v[130:131], v[14:15], v[104:105] op_sel_hi:[1,0,1] neg_lo:[1,0,0] neg_hi:[1,0,0]
    v_pk_fma_f32 v[130:131], v[104:105], v[14:15], v[130:131] op_sel:[0,1,0] op_sel_hi:[1,1,1]
    v_cvt_pk_bf16_f32 v32, v130, v131
    v_mov_b32 v148, v32
    v_dot2_f32_bf16 v128, v32, v60, v128
    v_pk_add_f32 v[106:107], v[106:107], v[12:13] op_sel_hi:[1,0] neg_lo:[0,1] neg_hi:[0,1]
    v_cvt_pk_bf16_f32 v130, v106, v107
    v_lshlrev_b32 v106, 16, v130
    v_and_b32 v107, s20, v130
    v_pk_mul_f32 v[130:131], v[106:107], v[14:15] op_sel:[0,1] op_sel_hi:[1,1]
    v_pk_fma_f32 v[106:107], v[130:131], v[14:15], v[106:107] op_sel_hi:[1,0,1] neg_lo:[1,0,0] neg_hi:[1,0,0]
    v_pk_fma_f32 v[130:131], v[106:107], v[14:15], v[130:131] op_sel:[0,1,0] op_sel_hi:[1,1,1]
    v_cvt_pk_bf16_f32 v33, v130, v131
    v_mov_b32 v150, v33
    v_dot2_f32_bf16 v129, v33, v61, v129
    v_pk_add_f32 v[108:109], v[108:109], v[12:13] op_sel_hi:[1,0] neg_lo:[0,1] neg_hi:[0,1]
    v_cvt_pk_bf16_f32 v130, v108, v109
    v_lshlrev_b32 v108, 16, v130
    v_and_b32 v109, s20, v130
    v_pk_mul_f32 v[130:131], v[108:109], v[14:15] op_sel:[0,1] op_sel_hi:[1,1]
    v_pk_fma_f32 v[108:109], v[130:131], v[14:15], v[108:109] op_sel_hi:[1,0,1] neg_lo:[1,0,0] neg_hi:[1,0,0]
    v_pk_fma_f32 v[130:131], v[108:109], v[14:15], v[130:131] op_sel:[0,1,0] op_sel_hi:[1,1,1]
    v_cvt_pk_bf16_f32 v34, v130, v131
    v_mov_b32 v149, v34
    v_dot2_f32_bf16 v128, v34, v62, v128
    v_pk_add_f32 v[110:111], v[110:111], v[12:13] op_sel_hi:[1,0] neg_lo:[0,1] neg_hi:[0,1]
    v_cvt_pk_bf16_f32 v130, v110, v111
    v_lshlrev_b32 v110, 16, v130
    v_and_b32 v111, s20, v130
    v_pk_mul_f32 v[130:131], v[110:111], v[14:15] op_sel:[0,1] op_sel_hi:[1,1]
    v_pk_fma_f32 v[110:111], v[130:131], v[14:15], v[110:111] op_sel_hi:[1,0,1] neg_lo:[1,0,0] neg_hi:[1,0,0]
    v_pk_fma_f32 v[130:131], v[110:111], v[14:15], v[130:131] op_sel:[0,1,0] op_sel_hi:[1,1,1]
    v_cvt_pk_bf16_f32 v35, v130, v131
    v_mov_b32 v151, v35
    v_dot2_f32_bf16 v129, v35, v63, v129
    v_pk_add_f32 v[112:113], v[112:113], v[12:13] op_sel_hi:[1,0] neg_lo:[0,1] neg_hi:[0,1]
    v_cvt_pk_bf16_f32 v130, v112, v113
    v_lshlrev_b32 v112, 16, v130
    v_and_b32 v113, s20, v130
    v_pk_mul_f32 v[130:131], v[112:113], v[14:15] op_sel:[0,1] op_sel_hi:[1,1]
    v_pk_fma_f32 v[112:113], v[130:131], v[14:15], v[112:113] op_sel_hi:[1,0,1] neg_lo:[1,0,0] neg_hi:[1,0,0]
    v_pk_fma_f32 v[130:131], v[112:113], v[14:15], v[130:131] op_sel:[0,1,0] op_sel_hi:[1,1,1]
    v_cvt_pk_bf16_f32 v36, v130, v131
    v_mov_b32 v152, v36
    v_dot2_f32_bf16 v128, v36, v64, v128
    v_pk_add_f32 v[114:115], v[114:115], v[12:13] op_sel_hi:[1,0] neg_lo:[0,1] neg_hi:[0,1]
    v_cvt_pk_bf16_f32 v130, v114, v115
    v_lshlrev_b32 v114, 16, v130
    v_and_b32 v115, s20, v130
    v_pk_mul_f32 v[130:131], v[114:115], v[14:15] op_sel:[0,1] op_sel_hi:[1,1]
    v_pk_fma_f32 v[114:115], v[130:131], v[14:15], v[114:115] op_sel_hi:[1,0,1] neg_lo:[1,0,0] neg_hi:[1,0,0]
    v_pk_fma_f32 v[130:131], v[114:115], v[14:15], v[130:131] op_sel:[0,1,0] op_sel_hi:[1,1,1]
    v_cvt_pk_bf16_f32 v37, v130, v131
    v_mov_b32 v154, v37
    v_dot2_f32_bf16 v129, v37, v65, v129
    v_pk_add_f32 v[116:117], v[116:117], v[12:13] op_sel_hi:[1,0] neg_lo:[0,1] neg_hi:[0,1]
    v_cvt_pk_bf16_f32 v130, v116, v117
    v_lshlrev_b32 v116, 16, v130
    v_and_b32 v117, s20, v130
    v_pk_mul_f32 v[130:131], v[116:117], v[14:15] op_sel:[0,1] op_sel_hi:[1,1]
    v_pk_fma_f32 v[116:117], v[130:131], v[14:15], v[116:117] op_sel_hi:[1,0,1] neg_lo:[1,0,0] neg_hi:[1,0,0]
    v_pk_fma_f32 v[130:131], v[116:117], v[14:15], v[130:131] op_sel:[0,1,0] op_sel_hi:[1,1,1]
    v_cvt_pk_bf16_f32 v38, v130, v131
    v_mov_b32 v153, v38
    v_dot2_f32_bf16 v128, v38, v66, v128
    v_pk_add_f32 v[118:119], v[118:119], v[12:13] op_sel_hi:[1,0] neg_lo:[0,1] neg_hi:[0,1]
    v_cvt_pk_bf16_f32 v130, v118, v119
    v_lshlrev_b32 v118, 16, v130
    v_and_b32 v119, s20, v130
    v_pk_mul_f32 v[130:131], v[118:119], v[14:15] op_sel:[0,1] op_sel_hi:[1,1]
    v_pk_fma_f32 v[118:119], v[130:131], v[14:15], v[118:119] op_sel_hi:[1,0,1] neg_lo:[1,0,0] neg_hi:[1,0,0]
    v_pk_fma_f32 v[130:131], v[118:119], v[14:15], v[130:131] op_sel:[0,1,0] op_sel_hi:[1,1,1]
    v_cvt_pk_bf16_f32 v39, v130, v131
    v_mov_b32 v155, v39
    v_dot2_f32_bf16 v129, v39, v67, v129
    v_pk_add_f32 v[120:121], v[120:121], v[12:13] op_sel_hi:[1,0] neg_lo:[0,1] neg_hi:[0,1]
    v_cvt_pk_bf16_f32 v130, v120, v121
    v_lshlrev_b32 v120, 16, v130
    v_and_b32 v121, s20, v130
    v_pk_mul_f32 v[130:131], v[120:121], v[14:15] op_sel:[0,1] op_sel_hi:[1,1]
    v_pk_fma_f32 v[120:121], v[130:131], v[14:15], v[120:121] op_sel_hi:[1,0,1] neg_lo:[1,0,0] neg_hi:[1,0,0]
    v_pk_fma_f32 v[130:131], v[120:121], v[14:15], v[130:131] op_sel:[0,1,0] op_sel_hi:[1,1,1]
    v_cvt_pk_bf16_f32 v40, v130, v131
    v_mov_b32 v156, v40
    v_dot2_f32_bf16 v128, v40, v68, v128
    v_pk_add_f32 v[122:123], v[122:123], v[12:13] op_sel_hi:[1,0] neg_lo:[0,1] neg_hi:[0,1]
    v_cvt_pk_bf16_f32 v130, v122, v123
    v_lshlrev_b32 v122, 16, v130
    v_and_b32 v123, s20, v130
    v_pk_mul_f32 v[130:131], v[122:123], v[14:15] op_sel:[0,1] op_sel_hi:[1,1]
    v_pk_fma_f32 v[122:123], v[130:131], v[14:15], v[122:123] op_sel_hi:[1,0,1] neg_lo:[1,0,0] neg_hi:[1,0,0]
    v_pk_fma_f32 v[130:131], v[122:123], v[14:15], v[130:131] op_sel:[0,1,0] op_sel_hi:[1,1,1]
    v_cvt_pk_bf16_f32 v41, v130, v131
    v_mov_b32 v158, v41
    v_dot2_f32_bf16 v129, v41, v69, v129
    v_pk_add_f32 v[124:125], v[124:125], v[12:13] op_sel_hi:[1,0] neg_lo:[0,1] neg_hi:[0,1]
    v_cvt_pk_bf16_f32 v130, v124, v125
    v_lshlrev_b32 v124, 16, v130
    v_and_b32 v125, s20, v130
    v_pk_mul_f32 v[130:131], v[124:125], v[14:15] op_sel:[0,1] op_sel_hi:[1,1]
    v_pk_fma_f32 v[124:125], v[130:131], v[14:15], v[124:125] op_sel_hi:[1,0,1] neg_lo:[1,0,0] neg_hi:[1,0,0]
    v_pk_fma_f32 v[130:131], v[124:125], v[14:15], v[130:131] op_sel:[0,1,0] op_sel_hi:[1,1,1]
    v_cvt_pk_bf16_f32 v42, v130, v131
    v_mov_b32 v157, v42
    v_dot2_f32_bf16 v128, v42, v70, v128
    v_pk_add_f32 v[126:127], v[126:127], v[12:13] op_sel_hi:[1,0] neg_lo:[0,1] neg_hi:[0,1]
    v_cvt_pk_bf16_f32 v130, v126, v127
    v_lshlrev_b32 v126, 16, v130
    v_and_b32 v127, s20, v130
    v_pk_mul_f32 v[130:131], v[126:127], v[14:15] op_sel:[0,1] op_sel_hi:[1,1]
    v_pk_fma_f32 v[126:127], v[130:131], v[14:15], v[126:127] op_sel_hi:[1,0,1] neg_lo:[1,0,0] neg_hi:[1,0,0]
    v_pk_fma_f32 v[130:131], v[126:127], v[14:15], v[130:131] op_sel:[0,1,0] op_sel_hi:[1,1,1]
    v_cvt_pk_bf16_f32 v43, v130, v131
    v_mov_b32 v159, v43
    v_dot2_f32_bf16 v129, v43, v71, v129
    s_mov_b32 s23, 12845056
    s_mov_b32 s24, 14680064
    buffer_store_dwordx4 v[16:19], v9, s[4:7], s23 offen offset:0
    buffer_store_dwordx2 v[132:133], v10, s[4:7], s24 offen offset:0
    buffer_store_dwordx2 v[134:135], v10, s[4:7], s24 offen offset:256
    buffer_store_dwordx4 v[20:23], v9, s[4:7], s23 offen offset:2048
    buffer_store_dwordx2 v[136:137], v10, s[4:7], s24 offen offset:2048
    buffer_store_dwordx2 v[138:139], v10, s[4:7], s24 offen offset:2304
    s_add_u32 s23, s23, 4096
    s_add_u32 s24, s24, 4096
    buffer_store_dwordx4 v[24:27], v9, s[4:7], s23 offen offset:0
    buffer_store_dwordx2 v[140:141], v10, s[4:7], s24 offen offset:0
    buffer_store_dwordx2 v[142:143], v10, s[4:7], s24 offen offset:256
    buffer_store_dwordx4 v[28:31], v9, s[4:7], s23 offen offset:2048
    buffer_store_dwordx2 v[144:145], v10, s[4:7], s24 offen offset:2048
    buffer_store_dwordx2 v[146:147], v10, s[4:7], s24 offen offset:2304
    s_add_u32 s23, s23, 4096
    s_add_u32 s24, s24, 4096
    buffer_store_dwordx4 v[32:35], v9, s[4:7], s23 offen offset:0
    buffer_store_dwordx2 v[148:149], v10, s[4:7], s24 offen offset:0
    buffer_store_dwordx2 v[150:151], v10, s[4:7], s24 offen offset:256
    buffer_store_dwordx4 v[36:39], v9, s[4:7], s23 offen offset:2048
    buffer_store_dwordx2 v[152:153], v10, s[4:7], s24 offen offset:2048
    buffer_store_dwordx2 v[154:155], v10, s[4:7], s24 offen offset:2304
    s_add_u32 s23, s23, 4096
    s_add_u32 s24, s24, 4096
    buffer_store_dwordx4 v[40:43], v9, s[4:7], s23 offen offset:0
    buffer_store_dwordx2 v[156:157], v10, s[4:7], s24 offen offset:0
    buffer_store_dwordx2 v[158:159], v10, s[4:7], s24 offen offset:256
    s_nop 1
    v_add_f32 v128, v128, v129
    s_nop 1
    v_add_f32_dpp v128, v128, v128 quad_perm:[1,0,3,2] row_mask:0xf bank_mask:0xf
    s_nop 1
    v_add_f32_dpp v128, v128, v128 quad_perm:[2,3,0,1] row_mask:0xf bank_mask:0xf
    s_nop 1
    v_add_f32_dpp v128, v128, v128 row_half_mirror row_mask:0xf bank_mask:0xf
    v_cvt_pk_bf16_f32 v128, v128, v128
    v_and_b32 v128, s20, v128
    v_lshlrev_b32 v3, 2, v3
    s_mov_b32 s22, 67567616
    buffer_store_dword v128, v3, s[4:7], s22 offen
    s_cmp_ge_u32 s2, 28
    s_cbranch_scc1 P_exit
    v_min_u32 v160, -2, v160
    v_lshlrev_b32 v11, 2, v2
    s_lshl_b32 s21, s2, 8
    s_add_u32 s22, s21, 62849024
    s_add_u32 s21, s21, 64414720
    buffer_store_dword v160, v11, s[4:7], s22 offen
    s_add_u32 s22, s22, 7168
    buffer_store_dword v160, v11, s[4:7], s21 offen
P_exit:
    s_endpgm
.section .rodata,"a"
.p2align 6
.amdhsa_kernel prep_kernel
  .amdhsa_next_free_vgpr 192
  .amdhsa_next_free_sgpr 96
  .amdhsa_accum_offset 192
  .amdhsa_group_segment_fixed_size 0
  .amdhsa_kernarg_size 120
  .amdhsa_user_sgpr_count 2
  .amdhsa_user_sgpr_kernarg_segment_ptr 1
  .amdhsa_system_sgpr_workgroup_id_x 1
.end_amdhsa_kernel
.text
.globl main_kernel
.p2align 8
.type main_kernel,@function
main_kernel:
    s_cmp_ge_u32 s2, 256
    s_cbranch_scc1 L_exit
    s_load_dwordx2 s[4:5], s[0:1], 112
    s_load_dwordx2 s[8:9], s[0:1], 104
    s_getreg_b32 s3, hwreg(HW_REG_XCC_ID, 0, 4)
    v_lshrrev_b32 v1, 6, v0
    s_nop 0
    v_readfirstlane_b32 s13, v1
    s_mov_b32 s6, 268435456
    s_mov_b32 s7, 0x20000
    s_mov_b32 s10, 256
    s_mov_b32 s11, 0x20000
    s_waitcnt lgkmcnt(0)
    s_and_b32 s5, s5, 0xffff
    s_and_b32 s9, s9, 0xffff
    s_mov_b32 s12, 255
    s_and_b32 s40, s2, 7
    s_cmp_lg_u32 s40, 0
    s_cbranch_scc1 L_dispatch
    s_lshr_b32 s12, s2, 3
    s_cmp_lg_u32 s13, 0
    s_cbranch_scc1 L_dispatch
    s_lshl_b32 s40, s3, 2
    s_mov_b64 exec, 1
    v_mov_b32 v2, 1
    buffer_atomic_add v2, off, s[8:11], s40 offset:32
    s_mov_b64 exec, -1
L_dispatch:
    s_cmp_lt_u32 s12, 16
    s_cbranch_scc1 L_roleA
    s_cmp_lt_u32 s12, 30
    s_cbranch_scc1 L_roleB
    s_cmp_lt_u32 s12, 32
    s_cbranch_scc1 L_roleP
L_worker:
    v_and_b32 v1, 63, v0
    v_lshlrev_b32 v2, 4, v1
    s_mov_b32 s23, 400000
    s_mov_b32 s14, 255
    s_add_u32 s42, s2, 7
    s_and_b32 s42, s42, 7
    s_lshl_b32 s42, s42, 5
    s_lshr_b32 s41, s2, 3
    s_add_u32 s42, s42, s41
    s_mul_hi_u32 s60, s42, 306783379
    s_mul_i32 s41, s60, 14
    s_sub_u32 s61, s42, s41
    s_mov_b32 s64, s61
    s_cmp_lt_u32 s61, 4
    s_cbranch_scc1 T_Uq
    s_sub_u32 s61, s61, 4
    s_cmp_lg_u32 s61, 0
    s_cbranch_scc1 W_g
    s_mov_b32 s61, 1
    s_branch T_Uh
W_g:
    s_branch T_U
W_next:
    s_cmp_lg_u32 s13, 0
    s_cbranch_scc1 W_bc
    s_mov_b64 exec, 1
    v_mov_b32 v3, 1
    buffer_atomic_add v3, off, s[8:11], 0 offset:192 sc0
    v_mov_b32 v4, 163832
    s_waitcnt vmcnt(0)
    ds_write_b32 v4, v3
    s_waitcnt lgkmcnt(0)
    s_mov_b64 exec, -1
W_bc:
    s_barrier
    v_mov_b32 v4, 163832
    ds_read_b32 v3, v4
    s_waitcnt lgkmcnt(0)
    v_readfirstlane_b32 s42, v3
    s_nop 3
    s_cmp_ge_u32 s42, 1848
    s_cbranch_scc1 L_exit
W_q1:
    s_sub_u32 s65, s42, 0
    s_cmp_lt_u32 s42, 28
    s_cbranch_scc1 T_M1
    s_sub_u32 s65, s42, 28
    s_cmp_lt_u32 s42, 56
    s_cbranch_scc1 T_M2
    s_cmp_lt_u32 s42, 136
    s_cbranch_scc0 W_q2
    s_sub_u32 s43, s42, 56
    s_and_b32 s60, s43, 15
    s_lshr_b32 s61, s43, 4
    s_cmp_lt_u32 s42, 104
    s_cbranch_scc1 T_P
    s_sub_u32 s42, s42, 88
    s_mov_b32 s41, -1
    s_branch W_q4
W_q2:
    s_cmp_lt_u32 s42, 1792
    s_cbranch_scc0 W_q3
    s_cmp_lt_u32 s42, 856
    s_cbranch_scc0 W_q6
    s_add_u32 s43, s42, 96
    s_cmp_lt_u32 s42, 136
    s_cselect_b32 s42, s43, s42
    s_cbranch_scc1 W_q6
    s_sub_u32 s42, s42, 136
    s_mul_hi_u32 s41, s42, 35791395
    s_mul_i32 s43, s41, 120
    s_sub_u32 s42, s42, s43
    s_mov_b32 s60, s42
    s_add_u32 s61, s41, 10
    s_cmp_lt_u32 s42, 16
    s_cbranch_scc1 T_U
    s_sub_u32 s42, s42, 16
    s_add_u32 s41, s41, 0
    s_branch W_q7
W_q6:
    s_sub_u32 s42, s42, 232
    s_mul_hi_u32 s41, s42, 41297763
    s_mul_i32 s43, s41, 104
    s_sub_u32 s42, s42, s43
W_q7:
    s_cmp_lt_u32 s42, 16
    s_cbranch_scc0 W_q4
    s_mov_b32 s60, s42
    s_add_u32 s61, s41, 3
    s_cmp_lt_u32 s61, 16
    s_cbranch_scc1 T_P
    s_barrier
    s_branch W_next
W_q4:
    s_cmp_lt_u32 s42, 48
    s_cbranch_scc0 W_q5
    s_sub_u32 s42, s42, 16
    s_and_b32 s60, s42, 7
    s_lshr_b32 s64, s42, 3
    s_add_u32 s61, s41, 1
    s_cmp_lt_u32 s61, 15
    s_cbranch_scc1 T_W
    s_barrier
    s_branch W_next
W_q5:
    s_sub_u32 s42, s42, 48
    s_mul_i32 s41, s41, 56
    s_add_u32 s42, s42, s41
    s_branch W_v
W_q3:
    s_sub_u32 s42, s42, 952
W_v:
    s_mul_hi_u32 s62, s42, 306783379
    s_mul_i32 s41, s62, 14
    s_sub_u32 s42, s42, s41
    s_cmp_ge_u32 s42, 7
    s_cselect_b32 s63, 1, 0
    s_mul_i32 s41, s63, 7
    s_sub_u32 s64, s42, s41
    s_branch T_V
T_U:
    s_min_u32 s59, s61, 13
    s_mul_i32 s41, s13, 28672
    s_mul_i32 s40, s61, 114688
    s_add_u32 s40, s40, s41
    s_add_u32 s40, s40, 12845056
    s_mul_i32 s42, s60, 401408
    s_mul_i32 s43, s13, 100352
    s_add_u32 s42, s42, s43
    s_add_u32 s42, s42, 6422528
    s_add_u32 s76, s59, 0
    s_sub_u32 s43, s76, 14
    s_cmp_ge_u32 s76, 14
    s_cselect_b32 s76, s43, s76
    s_lshl_b32 s76, s76, 10
    s_add_u32 s77, s59, 1
    s_sub_u32 s43, s77, 14
    s_cmp_ge_u32 s77, 14
    s_cselect_b32 s77, s43, s77
    s_lshl_b32 s77, s77, 10
    s_add_u32 s78, s59, 2
    s_sub_u32 s43, s78, 14
    s_cmp_ge_u32 s78, 14
    s_cselect_b32 s78, s43, s78
    s_lshl_b32 s78, s78, 10
    s_add_u32 s79, s59, 3
    s_sub_u32 s43, s79, 14
    s_cmp_ge_u32 s79, 14
    s_cselect_b32 s79, s43, s79
    s_lshl_b32 s79, s79, 10
    s_add_u32 s80, s59, 4
    s_sub_u32 s43, s80, 14
    s_cmp_ge_u32 s80, 14
    s_cselect_b32 s80, s43, s80
    s_lshl_b32 s80, s80, 10
    s_add_u32 s81, s59, 5
    s_sub_u32 s43, s81, 14
    s_cmp_ge_u32 s81, 14
    s_cselect_b32 s81, s43, s81
    s_lshl_b32 s81, s81, 10
    s_add_u32 s82, s59, 6
    s_sub_u32 s43, s82, 14
    s_cmp_ge_u32 s82, 14
    s_cselect_b32 s82, s43, s82
    s_lshl_b32 s82, s82, 10
    s_add_u32 s83, s59, 7
    s_sub_u32 s43, s83, 14
    s_cmp_ge_u32 s83, 14
    s_cselect_b32 s83, s43, s83
    s_lshl_b32 s83, s83, 10
    s_add_u32 s84, s59, 8
    s_sub_u32 s43, s84, 14
    s_cmp_ge_u32 s84, 14
    s_cselect_b32 s84, s43, s84
    s_lshl_b32 s84, s84, 10
    s_add_u32 s85, s59, 9
    s_sub_u32 s43, s85, 14
    s_cmp_ge_u32 s85, 14
    s_cselect_b32 s85, s43, s85
    s_lshl_b32 s85, s85, 10
    s_add_u32 s86, s59, 10
    s_sub_u32 s43, s86, 14
    s_cmp_ge_u32 s86, 14
    s_cselect_b32 s86, s43, s86
    s_lshl_b32 s86, s86, 10
    s_add_u32 s87, s59, 11
    s_sub_u32 s43, s87, 14
    s_cmp_ge_u32 s87, 14
    s_cselect_b32 s87, s43, s87
    s_lshl_b32 s87, s87, 10
    s_add_u32 s88, s59, 12
    s_sub_u32 s43, s88, 14
    s_cmp_ge_u32 s88, 14
    s_cselect_b32 s88, s43, s88
    s_lshl_b32 s88, s88, 10
    s_add_u32 s89, s59, 13
    s_sub_u32 s43, s89, 14
    s_cmp_ge_u32 s89, 14
    s_cselect_b32 s89, s43, s89
    s_lshl_b32 s89, s89, 10
    v_add_u32 v8, 0, v2
    v_add_u32 v9, 14336, v2
    v_add_u32 v10, 28672, v2
    v_add_u32 v11, 43008, v2
    v_add_u32 v12, 57344, v2
    v_add_u32 v13, 71680, v2
    v_add_u32 v14, 86016, v2
    v_add_u32 v17, 14336, v2
    s_barrier
    s_add_u32 s43, s41, s76
    s_mov_b32 m0, s43
    s_add_u32 s44, s40, s76
    buffer_load_dwordx4 v2, s[4:7], s44 offen lds
    s_add_u32 s43, s41, s76
    s_add_u32 s43, s43, 14336
    s_mov_b32 m0, s43
    s_add_u32 s44, s40, s76
    buffer_load_dwordx4 v17, s[4:7], s44 offen lds
    s_add_u32 s45, s42, s76
    buffer_load_dwordx4 a[0:3], v8, s[4:7], s45 offen
    buffer_load_dwordx4 a[4:7], v9, s[4:7], s45 offen
    buffer_load_dwordx4 a[8:11], v10, s[4:7], s45 offen
    buffer_load_dwordx4 a[12:15], v11, s[4:7], s45 offen
    buffer_load_dwordx4 a[16:19], v12, s[4:7], s45 offen
    buffer_load_dwordx4 a[20:23], v13, s[4:7], s45 offen
    buffer_load_dwordx4 a[24:27], v14, s[4:7], s45 offen
    s_add_u32 s43, s41, s77
    s_mov_b32 m0, s43
    s_add_u32 s44, s40, s77
    buffer_load_dwordx4 v2, s[4:7], s44 offen lds
    s_add_u32 s43, s41, s77
    s_add_u32 s43, s43, 14336
    s_mov_b32 m0, s43
    s_add_u32 s44, s40, s77
    buffer_load_dwordx4 v17, s[4:7], s44 offen lds
    s_add_u32 s45, s42, s77
    buffer_load_dwordx4 a[28:31], v8, s[4:7], s45 offen
    buffer_load_dwordx4 a[32:35], v9, s[4:7], s45 offen
    buffer_load_dwordx4 a[36:39], v10, s[4:7], s45 offen
    buffer_load_dwordx4 a[40:43], v11, s[4:7], s45 offen
    buffer_load_dwordx4 a[44:47], v12, s[4:7], s45 offen
    buffer_load_dwordx4 a[48:51], v13, s[4:7], s45 offen
    buffer_load_dwordx4 a[52:55], v14, s[4:7], s45 offen
    s_add_u32 s43, s41, s78
    s_mov_b32 m0, s43
    s_add_u32 s44, s40, s78
    buffer_load_dwordx4 v2, s[4:7], s44 offen lds
    s_add_u32 s43, s41, s78
    s_add_u32 s43, s43, 14336
    s_mov_b32 m0, s43
    s_add_u32 s44, s40, s78
    buffer_load_dwordx4 v17, s[4:7], s44 offen lds
    s_add_u32 s43, s41, s79
    s_mov_b32 m0, s43
    s_add_u32 s44, s40, s79
    buffer_load_dwordx4 v2, s[4:7], s44 offen lds
    s_add_u32 s43, s41, s79
    s_add_u32 s43, s43, 14336
    s_mov_b32 m0, s43
    s_add_u32 s44, s40, s79
    buffer_load_dwordx4 v17, s[4:7], s44 offen lds
    v_add_u32 v15, s76, v2
    v_add_u32 v16, 57344, v15
    s_waitcnt vmcnt(20)
    s_barrier
    ds_read_b128 a[84:87], v15 offset:0
    ds_read_b128 a[88:91], v15 offset:14336
    ds_read_b128 a[92:95], v15 offset:28672
    ds_read_b128 a[96:99], v15 offset:43008
    ds_read_b128 a[100:103], v16 offset:0
    ds_read_b128 a[104:107], v16 offset:14336
    ds_read_b128 a[108:111], v16 offset:28672
    ds_read_b128 a[112:115], v16 offset:43008
    v_add_u32 v15, s77, v2
    v_add_u32 v16, 57344, v15
    s_waitcnt vmcnt(11) lgkmcnt(0)
    s_barrier
    v_mfma_f32_16x16x32_bf16 v[32:35], a[84:87], a[0:3], 0
    v_mfma_f32_16x16x32_bf16 v[64:67], a[84:87], a[4:7], 0
    ds_read_b128 a[116:119], v15 offset:0
    v_mfma_f32_16x16x32_bf16 v[96:99], a[84:87], a[8:11], 0
    v_mfma_f32_16x16x32_bf16 v[128:131], a[84:87], a[12:15], 0
    s_add_u32 s43, s41, s80
    s_mov_b32 m0, s43
    s_add_u32 s44, s40, s80
    buffer_load_dwordx4 v2, s[4:7], s44 offen lds
    v_mfma_f32_16x16x32_bf16 v[160:163], a[84:87], a[16:19], 0
    v_mfma_f32_16x16x32_bf16 v[192:195], a[84:87], a[20:23], 0
    v_mfma_f32_16x16x32_bf16 v[224:227], a[84:87], a[24:27], 0
    v_mfma_f32_16x16x32_bf16 v[36:39], a[88:91], a[0:3], 0
    v_mfma_f32_16x16x32_bf16 v[68:71], a[88:91], a[4:7], 0
    ds_read_b128 a[120:123], v15 offset:14336
    v_mfma_f32_16x16x32_bf16 v[100:103], a[88:91], a[8:11], 0
    v_mfma_f32_16x16x32_bf16 v[132:135], a[88:91], a[12:15], 0
    s_add_u32 s43, s41, s80
    s_add_u32 s43, s43, 14336
    s_mov_b32 m0, s43
    s_add_u32 s44, s40, s80
    buffer_load_dwordx4 v17, s[4:7], s44 offen lds
    v_mfma_f32_16x16x32_bf16 v[164:167], a[88:91], a[16:19], 0
    v_mfma_f32_16x16x32_bf16 v[196:199], a[88:91], a[20:23], 0
    s_add_u32 s45, s42, s78
    buffer_load_dwordx4 a[56:59], v8, s[4:7], s45 offen
    v_mfma_f32_16x16x32_bf16 v[228:231], a[88:91], a[24:27], 0
    v_mfma_f32_16x16x32_bf16 v[40:43], a[92:95], a[0:3], 0
    v_mfma_f32_16x16x32_bf16 v[72:75], a[92:95], a[4:7], 0
    ds_read_b128 a[124:127], v15 offset:28672
    v_mfma_f32_16x16x32_bf16 v[104:107], a[92:95], a[8:11], 0
    v_mfma_f32_16x16x32_bf16 v[136:139], a[92:95], a[12:15], 0
    v_mfma_f32_16x16x32_bf16 v[168:171], a[92:95], a[16:19], 0
    v_mfma_f32_16x16x32_bf16 v[200:203], a[92:95], a[20:23], 0
    buffer_load_dwordx4 a[60:63], v9, s[4:7], s45 offen
    v_mfma_f32_16x16x32_bf16 v[232:235], a[92:95], a[24:27], 0
    v_mfma_f32_16x16x32_bf16 v[44:47], a[96:99], a[0:3], 0
    v_mfma_f32_16x16x32_bf16 v[76:79], a[96:99], a[4:7], 0
    ds_read_b128 a[128:131], v15 offset:43008
    v_mfma_f32_16x16x32_bf16 v[108:111], a[96:99], a[8:11], 0
    v_mfma_f32_16x16x32_bf16 v[140:143], a[96:99], a[12:15], 0
    v_mfma_f32_16x16x32_bf16 v[172:175], a[96:99], a[16:19], 0
    v_mfma_f32_16x16x32_bf16 v[204:207], a[96:99], a[20:23], 0
    buffer_load_dwordx4 a[64:67], v10, s[4:7], s45 offen
    v_mfma_f32_16x16x32_bf16 v[236:239], a[96:99], a[24:27], 0
    v_mfma_f32_16x16x32_bf16 v[48:51], a[100:103], a[0:3], 0
    v_mfma_f32_16x16x32_bf16 v[80:83], a[100:103], a[4:7], 0
    ds_read_b128 a[132:135], v16 offset:0
    v_mfma_f32_16x16x32_bf16 v[112:115], a[100:103], a[8:11], 0
    v_mfma_f32_16x16x32_bf16 v[144:147], a[100:103], a[12:15], 0
    v_mfma_f32_16x16x32_bf16 v[176:179], a[100:103], a[16:19], 0
    v_mfma_f32_16x16x32_bf16 v[208:211], a[100:103], a[20:23], 0
    buffer_load_dwordx4 a[68:71], v11, s[4:7], s45 offen
    v_mfma_f32_16x16x32_bf16 v[240:243], a[100:103], a[24:27], 0
    v_mfma_f32_16x16x32_bf16 v[52:55], a[104:107], a[0:3], 0
    v_mfma_f32_16x16x32_bf16 v[84:87], a[104:107], a[4:7], 0
    ds_read_b128 a[136:139], v16 offset:14336
    v_mfma_f32_16x16x32_bf16 v[116:119], a[104:107], a[8:11], 0
    v_mfma_f32_16x16x32_bf16 v[148:151], a[104:107], a[12:15], 0
    v_mfma_f32_16x16x32_bf16 v[180:183], a[104:107], a[16:19], 0
    v_mfma_f32_16x16x32_bf16 v[212:215], a[104:107], a[20:23], 0
    buffer_load_dwordx4 a[72:75], v12, s[4:7], s45 offen
    v_mfma_f32_16x16x32_bf16 v[244:247], a[104:107], a[24:27], 0
    v_mfma_f32_16x16x32_bf16 v[56:59], a[108:111], a[0:3], 0
    v_mfma_f32_16x16x32_bf16 v[88:91], a[108:111], a[4:7], 0
    ds_read_b128 a[140:143], v16 offset:28672
    v_mfma_f32_16x16x32_bf16 v[120:123], a[108:111], a[8:11], 0
    v_mfma_f32_16x16x32_bf16 v[152:155], a[108:111], a[12:15], 0
    v_mfma_f32_16x16x32_bf16 v[184:187], a[108:111], a[16:19], 0
    v_mfma_f32_16x16x32_bf16 v[216:219], a[108:111], a[20:23], 0
    buffer_load_dwordx4 a[76:79], v13, s[4:7], s45 offen
    v_mfma_f32_16x16x32_bf16 v[248:251], a[108:111], a[24:27], 0
    v_mfma_f32_16x16x32_bf16 v[60:63], a[112:115], a[0:3], 0
    v_mfma_f32_16x16x32_bf16 v[92:95], a[112:115], a[4:7], 0
    ds_read_b128 a[144:147], v16 offset:43008
    v_mfma_f32_16x16x32_bf16 v[124:127], a[112:115], a[8:11], 0
    v_mfma_f32_16x16x32_bf16 v[156:159], a[112:115], a[12:15], 0
    v_mfma_f32_16x16x32_bf16 v[188:191], a[112:115], a[16:19], 0
    v_mfma_f32_16x16x32_bf16 v[220:223], a[112:115], a[20:23], 0
    buffer_load_dwordx4 a[80:83], v14, s[4:7], s45 offen
    v_mfma_f32_16x16x32_bf16 v[252:255], a[112:115], a[24:27], 0
    v_add_u32 v15, s78, v2
    v_add_u32 v16, 57344, v15
    s_waitcnt vmcnt(11) lgkmcnt(0)
    s_barrier
    v_mfma_f32_16x16x32_bf16 v[32:35], a[116:119], a[28:31], v[32:35]
    v_mfma_f32_16x16x32_bf16 v[64:67], a[116:119], a[32:35], v[64:67]
    ds_read_b128 a[84:87], v15 offset:0
    v_mfma_f32_16x16x32_bf16 v[96:99], a[116:119], a[36:39], v[96:99]
    v_mfma_f32_16x16x32_bf16 v[128:131], a[116:119], a[40:43], v[128:131]
    s_add_u32 s43, s41, s81
    s_mov_b32 m0, s43
    s_add_u32 s44, s40, s81
    buffer_load_dwordx4 v2, s[4:7], s44 offen lds
    v_mfma_f32_16x16x32_bf16 v[160:163], a[116:119], a[44:47], v[160:163]
    v_mfma_f32_16x16x32_bf16 v[192:195], a[116:119], a[48:51], v[192:195]
    v_mfma_f32_16x16x32_bf16 v[224:227], a[116:119], a[52:55], v[224:227]
    v_mfma_f32_16x16x32_bf16 v[36:39], a[120:123], a[28:31], v[36:39]
    v_mfma_f32_16x16x32_bf16 v[68:71], a[120:123], a[32:35], v[68:71]
    ds_read_b128 a[88:91], v15 offset:14336
    v_mfma_f32_16x16x32_bf16 v[100:103], a[120:123], a[36:39], v[100:103]
    v_mfma_f32_16x16x32_bf16 v[132:135], a[120:123], a[40:43], v[132:135]
    s_add_u32 s43, s41, s81
    s_add_u32 s43, s43, 14336
    s_mov_b32 m0, s43
    s_add_u32 s44, s40, s81
    buffer_load_dwordx4 v17, s[4:7], s44 offen lds
    v_mfma_f32_16x16x32_bf16 v[164:167], a[120:123], a[44:47], v[164:167]
    v_mfma_f32_16x16x32_bf16 v[196:199], a[120:123], a[48:51], v[196:199]
    s_add_u32 s45, s42, s79
    buffer_load_dwordx4 a[0:3], v8, s[4:7], s45 offen
    v_mfma_f32_16x16x32_bf16 v[228:231], a[120:123], a[52:55], v[228:231]
    v_mfma_f32_16x16x32_bf16 v[40:43], a[124:127], a[28:31], v[40:43]
    v_mfma_f32_16x16x32_bf16 v[72:75], a[124:127], a[32:35], v[72:75]
    ds_read_b128 a[92:95], v15 offset:28672
    v_mfma_f32_16x16x32_bf16 v[104:107], a[124:127], a[36:39], v[104:107]
    v_mfma_f32_16x16x32_bf16 v[136:139], a[124:127], a[40:43], v[136:139]
    v_mfma_f32_16x16x32_bf16 v[168:171], a[124:127], a[44:47], v[168:171]
    v_mfma_f32_16x16x32_bf16 v[200:203], a[124:127], a[48:51], v[200:203]
    buffer_load_dwordx4 a[4:7], v9, s[4:7], s45 offen
    v_mfma_f32_16x16x32_bf16 v[232:235], a[124:127], a[52:55], v[232:235]
    v_mfma_f32_16x16x32_bf16 v[44:47], a[128:131], a[28:31], v[44:47]
    v_mfma_f32_16x16x32_bf16 v[76:79], a[128:131], a[32:35], v[76:79]
    ds_read_b128 a[96:99], v15 offset:43008
    v_mfma_f32_16x16x32_bf16 v[108:111], a[128:131], a[36:39], v[108:111]
    v_mfma_f32_16x16x32_bf16 v[140:143], a[128:131], a[40:43], v[140:143]
    v_mfma_f32_16x16x32_bf16 v[172:175], a[128:131], a[44:47], v[172:175]
    v_mfma_f32_16x16x32_bf16 v[204:207], a[128:131], a[48:51], v[204:207]
    buffer_load_dwordx4 a[8:11], v10, s[4:7], s45 offen
    v_mfma_f32_16x16x32_bf16 v[236:239], a[128:131], a[52:55], v[236:239]
    v_mfma_f32_16x16x32_bf16 v[48:51], a[132:135], a[28:31], v[48:51]
    v_mfma_f32_16x16x32_bf16 v[80:83], a[132:135], a[32:35], v[80:83]
    ds_read_b128 a[100:103], v16 offset:0
    v_mfma_f32_16x16x32_bf16 v[112:115], a[132:135], a[36:39], v[112:115]
    v_mfma_f32_16x16x32_bf16 v[144:147], a[132:135], a[40:43], v[144:147]
    v_mfma_f32_16x16x32_bf16 v[176:179], a[132:135], a[44:47], v[176:179]
    v_mfma_f32_16x16x32_bf16 v[208:211], a[132:135], a[48:51], v[208:211]
    buffer_load_dwordx4 a[12:15], v11, s[4:7], s45 offen
    v_mfma_f32_16x16x32_bf16 v[240:243], a[132:135], a[52:55], v[240:243]
    v_mfma_f32_16x16x32_bf16 v[52:55], a[136:139], a[28:31], v[52:55]
    v_mfma_f32_16x16x32_bf16 v[84:87], a[136:139], a[32:35], v[84:87]
    ds_read_b128 a[104:107], v16 offset:14336
    v_mfma_f32_16x16x32_bf16 v[116:119], a[136:139], a[36:39], v[116:119]
    v_mfma_f32_16x16x32_bf16 v[148:151], a[136:139], a[40:43], v[148:151]
    v_mfma_f32_16x16x32_bf16 v[180:183], a[136:139], a[44:47], v[180:183]
    v_mfma_f32_16x16x32_bf16 v[212:215], a[136:139], a[48:51], v[212:215]
    buffer_load_dwordx4 a[16:19], v12, s[4:7], s45 offen
    v_mfma_f32_16x16x32_bf16 v[244:247], a[136:139], a[52:55], v[244:247]
    v_mfma_f32_16x16x32_bf16 v[56:59], a[140:143], a[28:31], v[56:59]
    v_mfma_f32_16x16x32_bf16 v[88:91], a[140:143], a[32:35], v[88:91]
    ds_read_b128 a[108:111], v16 offset:28672
    v_mfma_f32_16x16x32_bf16 v[120:123], a[140:143], a[36:39], v[120:123]
    v_mfma_f32_16x16x32_bf16 v[152:155], a[140:143], a[40:43], v[152:155]
    v_mfma_f32_16x16x32_bf16 v[184:187], a[140:143], a[44:47], v[184:187]
    v_mfma_f32_16x16x32_bf16 v[216:219], a[140:143], a[48:51], v[216:219]
    buffer_load_dwordx4 a[20:23], v13, s[4:7], s45 offen
    v_mfma_f32_16x16x32_bf16 v[248:251], a[140:143], a[52:55], v[248:251]
    v_mfma_f32_16x16x32_bf16 v[60:63], a[144:147], a[28:31], v[60:63]
    v_mfma_f32_16x16x32_bf16 v[92:95], a[144:147], a[32:35], v[92:95]
    ds_read_b128 a[112:115], v16 offset:43008
    v_mfma_f32_16x16x32_bf16 v[124:127], a[144:147], a[36:39], v[124:127]
    v_mfma_f32_16x16x32_bf16 v[156:159], a[144:147], a[40:43], v[156:159]
    v_mfma_f32_16x16x32_bf16 v[188:191], a[144:147], a[44:47], v[188:191]
    v_mfma_f32_16x16x32_bf16 v[220:223], a[144:147], a[48:51], v[220:223]
    buffer_load_dwordx4 a[24:27], v14, s[4:7], s45 offen
    v_mfma_f32_16x16x32_bf16 v[252:255], a[144:147], a[52:55], v[252:255]
    v_add_u32 v15, s79, v2
    v_add_u32 v16, 57344, v15
    s_waitcnt vmcnt(9) lgkmcnt(0)
    s_barrier
    v_mfma_f32_16x16x32_bf16 v[32:35], a[84:87], a[56:59], v[32:35]
    v_mfma_f32_16x16x32_bf16 v[64:67], a[84:87], a[60:63], v[64:67]
    ds_read_b128 a[116:119], v15 offset:0
    v_mfma_f32_16x16x32_bf16 v[96:99], a[84:87], a[64:67], v[96:99]
    v_mfma_f32_16x16x32_bf16 v[128:131], a[84:87], a[68:71], v[128:131]
    s_add_u32 s43, s41, s82
    s_mov_b32 m0, s43
    s_add_u32 s44, s40, s82
    buffer_load_dwordx4 v2, s[4:7], s44 offen lds
    v_mfma_f32_16x16x32_bf16 v[160:163], a[84:87], a[72:75], v[160:163]
    v_mfma_f32_16x16x32_bf16 v[192:195], a[84:87], a[76:79], v[192:195]
    v_mfma_f32_16x16x32_bf16 v[224:227], a[84:87], a[80:83], v[224:227]
    v_mfma_f32_16x16x32_bf16 v[36:39], a[88:91], a[56:59], v[36:39]
    v_mfma_f32_16x16x32_bf16 v[68:71], a[88:91], a[60:63], v[68:71]
    ds_read_b128 a[120:123], v15 offset:14336
    v_mfma_f32_16x16x32_bf16 v[100:103], a[88:91], a[64:67], v[100:103]
    v_mfma_f32_16x16x32_bf16 v[132:135], a[88:91], a[68:71], v[132:135]
    s_add_u32 s43, s41, s82
    s_add_u32 s43, s43, 14336
    s_mov_b32 m0, s43
    s_add_u32 s44, s40, s82
    buffer_load_dwordx4 v17, s[4:7], s44 offen lds
    v_mfma_f32_16x16x32_bf16 v[164:167], a[88:91], a[72:75], v[164:167]
    v_mfma_f32_16x16x32_bf16 v[196:199], a[88:91], a[76:79], v[196:199]
    s_add_u32 s45, s42, s80
    buffer_load_dwordx4 a[28:31], v8, s[4:7], s45 offen
    v_mfma_f32_16x16x32_bf16 v[228:231], a[88:91], a[80:83], v[228:231]
    v_mfma_f32_16x16x32_bf16 v[40:43], a[92:95], a[56:59], v[40:43]
    v_mfma_f32_16x16x32_bf16 v[72:75], a[92:95], a[60:63], v[72:75]
    ds_read_b128 a[124:127], v15 offset:28672
    v_mfma_f32_16x16x32_bf16 v[104:107], a[92:95], a[64:67], v[104:107]
    v_mfma_f32_16x16x32_bf16 v[136:139], a[92:95], a[68:71], v[136:139]
    v_mfma_f32_16x16x32_bf16 v[168:171], a[92:95], a[72:75], v[168:171]
    v_mfma_f32_16x16x32_bf16 v[200:203], a[92:95], a[76:79], v[200:203]
    buffer_load_dwordx4 a[32:35], v9, s[4:7], s45 offen
    v_mfma_f32_16x16x32_bf16 v[232:235], a[92:95], a[80:83], v[232:235]
    v_mfma_f32_16x16x32_bf16 v[44:47], a[96:99], a[56:59], v[44:47]
    v_mfma_f32_16x16x32_bf16 v[76:79], a[96:99], a[60:63], v[76:79]
    ds_read_b128 a[128:131], v15 offset:43008
    v_mfma_f32_16x16x32_bf16 v[108:111], a[96:99], a[64:67], v[108:111]
    v_mfma_f32_16x16x32_bf16 v[140:143], a[96:99], a[68:71], v[140:143]
    v_mfma_f32_16x16x32_bf16 v[172:175], a[96:99], a[72:75], v[172:175]
    v_mfma_f32_16x16x32_bf16 v[204:207], a[96:99], a[76:79], v[204:207]
    buffer_load_dwordx4 a[36:39], v10, s[4:7], s45 offen
    v_mfma_f32_16x16x32_bf16 v[236:239], a[96:99], a[80:83], v[236:239]
    v_mfma_f32_16x16x32_bf16 v[48:51], a[100:103], a[56:59], v[48:51]
    v_mfma_f32_16x16x32_bf16 v[80:83], a[100:103], a[60:63], v[80:83]
    ds_read_b128 a[132:135], v16 offset:0
    v_mfma_f32_16x16x32_bf16 v[112:115], a[100:103], a[64:67], v[112:115]
    v_mfma_f32_16x16x32_bf16 v[144:147], a[100:103], a[68:71], v[144:147]
    v_mfma_f32_16x16x32_bf16 v[176:179], a[100:103], a[72:75], v[176:179]
    v_mfma_f32_16x16x32_bf16 v[208:211], a[100:103], a[76:79], v[208:211]
    buffer_load_dwordx4 a[40:43], v11, s[4:7], s45 offen
    v_mfma_f32_16x16x32_bf16 v[240:243], a[100:103], a[80:83], v[240:243]
    v_mfma_f32_16x16x32_bf16 v[52:55], a[104:107], a[56:59], v[52:55]
    v_mfma_f32_16x16x32_bf16 v[84:87], a[104:107], a[60:63], v[84:87]
    ds_read_b128 a[136:139], v16 offset:14336
    v_mfma_f32_16x16x32_bf16 v[116:119], a[104:107], a[64:67], v[116:119]
    v_mfma_f32_16x16x32_bf16 v[148:151], a[104:107], a[68:71], v[148:151]
    v_mfma_f32_16x16x32_bf16 v[180:183], a[104:107], a[72:75], v[180:183]
    v_mfma_f32_16x16x32_bf16 v[212:215], a[104:107], a[76:79], v[212:215]
    buffer_load_dwordx4 a[44:47], v12, s[4:7], s45 offen
    v_mfma_f32_16x16x32_bf16 v[244:247], a[104:107], a[80:83], v[244:247]
    v_mfma_f32_16x16x32_bf16 v[56:59], a[108:111], a[56:59], v[56:59]
    v_mfma_f32_16x16x32_bf16 v[88:91], a[108:111], a[60:63], v[88:91]
    ds_read_b128 a[140:143], v16 offset:28672
    v_mfma_f32_16x16x32_bf16 v[120:123], a[108:111], a[64:67], v[120:123]
    v_mfma_f32_16x16x32_bf16 v[152:155], a[108:111], a[68:71], v[152:155]
    v_mfma_f32_16x16x32_bf16 v[184:187], a[108:111], a[72:75], v[184:187]
    v_mfma_f32_16x16x32_bf16 v[216:219], a[108:111], a[76:79], v[216:219]
    buffer_load_dwordx4 a[48:51], v13, s[4:7], s45 offen
    v_mfma_f32_16x16x32_bf16 v[248:251], a[108:111], a[80:83], v[248:251]
    v_mfma_f32_16x16x32_bf16 v[60:63], a[112:115], a[56:59], v[60:63]
    v_mfma_f32_16x16x32_bf16 v[92:95], a[112:115], a[60:63], v[92:95]
    ds_read_b128 a[144:147], v16 offset:43008
    v_mfma_f32_16x16x32_bf16 v[124:127], a[112:115], a[64:67], v[124:127]
    v_mfma_f32_16x16x32_bf16 v[156:159], a[112:115], a[68:71], v[156:159]
    v_mfma_f32_16x16x32_bf16 v[188:191], a[112:115], a[72:75], v[188:191]
    v_mfma_f32_16x16x32_bf16 v[220:223], a[112:115], a[76:79], v[220:223]
    buffer_load_dwordx4 a[52:55], v14, s[4:7], s45 offen
    v_mfma_f32_16x16x32_bf16 v[252:255], a[112:115], a[80:83], v[252:255]
    v_add_u32 v15, s80, v2
    v_add_u32 v16, 57344, v15
    s_waitcnt vmcnt(9) lgkmcnt(0)
    s_barrier
    v_mfma_f32_16x16x32_bf16 v[32:35], a[116:119], a[0:3], v[32:35]
    v_mfma_f32_16x16x32_bf16 v[64:67], a[116:119], a[4:7], v[64:67]
    ds_read_b128 a[84:87], v15 offset:0
    v_mfma_f32_16x16x32_bf16 v[96:99], a[116:119], a[8:11], v[96:99]
    v_mfma_f32_16x16x32_bf16 v[128:131], a[116:119], a[12:15], v[128:131]
    s_add_u32 s43, s41, s83
    s_mov_b32 m0, s43
    s_add_u32 s44, s40, s83
    buffer_load_dwordx4 v2, s[4:7], s44 offen lds
    v_mfma_f32_16x16x32_bf16 v[160:163], a[116:119], a[16:19], v[160:163]
    v_mfma_f32_16x16x32_bf16 v[192:195], a[116:119], a[20:23], v[192:195]
    v_mfma_f32_16x16x32_bf16 v[224:227], a[116:119], a[24:27], v[224:227]
    v_mfma_f32_16x16x32_bf16 v[36:39], a[120:123], a[0:3], v[36:39]
    v_mfma_f32_16x16x32_bf16 v[68:71], a[120:123], a[4:7], v[68:71]
    ds_read_b128 a[88:91], v15 offset:14336
    v_mfma_f32_16x16x32_bf16 v[100:103], a[120:123], a[8:11], v[100:103]
    v_mfma_f32_16x16x32_bf16 v[132:135], a[120:123], a[12:15], v[132:135]
    s_add_u32 s43, s41, s83
    s_add_u32 s43, s43, 14336
    s_mov_b32 m0, s43
    s_add_u32 s44, s40, s83
    buffer_load_dwordx4 v17, s[4:7], s44 offen lds
    v_mfma_f32_16x16x32_bf16 v[164:167], a[120:123], a[16:19], v[164:167]
    v_mfma_f32_16x16x32_bf16 v[196:199], a[120:123], a[20:23], v[196:199]
    s_add_u32 s45, s42, s81
    buffer_load_dwordx4 a[56:59], v8, s[4:7], s45 offen
    v_mfma_f32_16x16x32_bf16 v[228:231], a[120:123], a[24:27], v[228:231]
    v_mfma_f32_16x16x32_bf16 v[40:43], a[124:127], a[0:3], v[40:43]
    v_mfma_f32_16x16x32_bf16 v[72:75], a[124:127], a[4:7], v[72:75]
    ds_read_b128 a[92:95], v15 offset:28672
    v_mfma_f32_16x16x32_bf16 v[104:107], a[124:127], a[8:11], v[104:107]
    v_mfma_f32_16x16x32_bf16 v[136:139], a[124:127], a[12:15], v[136:139]
    v_mfma_f32_16x16x32_bf16 v[168:171], a[124:127], a[16:19], v[168:171]
    v_mfma_f32_16x16x32_bf16 v[200:203], a[124:127], a[20:23], v[200:203]
    buffer_load_dwordx4 a[60:63], v9, s[4:7], s45 offen
    v_mfma_f32_16x16x32_bf16 v[232:235], a[124:127], a[24:27], v[232:235]
    v_mfma_f32_16x16x32_bf16 v[44:47], a[128:131], a[0:3], v[44:47]
    v_mfma_f32_16x16x32_bf16 v[76:79], a[128:131], a[4:7], v[76:79]
    ds_read_b128 a[96:99], v15 offset:43008
    v_mfma_f32_16x16x32_bf16 v[108:111], a[128:131], a[8:11], v[108:111]
    v_mfma_f32_16x16x32_bf16 v[140:143], a[128:131], a[12:15], v[140:143]
    v_mfma_f32_16x16x32_bf16 v[172:175], a[128:131], a[16:19], v[172:175]
    v_mfma_f32_16x16x32_bf16 v[204:207], a[128:131], a[20:23], v[204:207]
    buffer_load_dwordx4 a[64:67], v10, s[4:7], s45 offen
    v_mfma_f32_16x16x32_bf16 v[236:239], a[128:131], a[24:27], v[236:239]
    v_mfma_f32_16x16x32_bf16 v[48:51], a[132:135], a[0:3], v[48:51]
    v_mfma_f32_16x16x32_bf16 v[80:83], a[132:135], a[4:7], v[80:83]
    ds_read_b128 a[100:103], v16 offset:0
    v_mfma_f32_16x16x32_bf16 v[112:115], a[132:135], a[8:11], v[112:115]
    v_mfma_f32_16x16x32_bf16 v[144:147], a[132:135], a[12:15], v[144:147]
    v_mfma_f32_16x16x32_bf16 v[176:179], a[132:135], a[16:19], v[176:179]
    v_mfma_f32_16x16x32_bf16 v[208:211], a[132:135], a[20:23], v[208:211]
    buffer_load_dwordx4 a[68:71], v11, s[4:7], s45 offen
    v_mfma_f32_16x16x32_bf16 v[240:243], a[132:135], a[24:27], v[240:243]
    v_mfma_f32_16x16x32_bf16 v[52:55], a[136:139], a[0:3], v[52:55]
    v_mfma_f32_16x16x32_bf16 v[84:87], a[136:139], a[4:7], v[84:87]
    ds_read_b128 a[104:107], v16 offset:14336
    v_mfma_f32_16x16x32_bf16 v[116:119], a[136:139], a[8:11], v[116:119]
    v_mfma_f32_16x16x32_bf16 v[148:151], a[136:139], a[12:15], v[148:151]
    v_mfma_f32_16x16x32_bf16 v[180:183], a[136:139], a[16:19], v[180:183]
    v_mfma_f32_16x16x32_bf16 v[212:215], a[136:139], a[20:23], v[212:215]
    buffer_load_dwordx4 a[72:75], v12, s[4:7], s45 offen
    v_mfma_f32_16x16x32_bf16 v[244:247], a[136:139], a[24:27], v[244:247]
    v_mfma_f32_16x16x32_bf16 v[56:59], a[140:143], a[0:3], v[56:59]
    v_mfma_f32_16x16x32_bf16 v[88:91], a[140:143], a[4:7], v[88:91]
    ds_read_b128 a[108:111], v16 offset:28672
    v_mfma_f32_16x16x32_bf16 v[120:123], a[140:143], a[8:11], v[120:123]
    v_mfma_f32_16x16x32_bf16 v[152:155], a[140:143], a[12:15], v[152:155]
    v_mfma_f32_16x16x32_bf16 v[184:187], a[140:143], a[16:19], v[184:187]
    v_mfma_f32_16x16x32_bf16 v[216:219], a[140:143], a[20:23], v[216:219]
    buffer_load_dwordx4 a[76:79], v13, s[4:7], s45 offen
    v_mfma_f32_16x16x32_bf16 v[248:251], a[140:143], a[24:27], v[248:251]
    v_mfma_f32_16x16x32_bf16 v[60:63], a[144:147], a[0:3], v[60:63]
    v_mfma_f32_16x16x32_bf16 v[92:95], a[144:147], a[4:7], v[92:95]
    ds_read_b128 a[112:115], v16 offset:43008
    v_mfma_f32_16x16x32_bf16 v[124:127], a[144:147], a[8:11], v[124:127]
    v_mfma_f32_16x16x32_bf16 v[156:159], a[144:147], a[12:15], v[156:159]
    v_mfma_f32_16x16x32_bf16 v[188:191], a[144:147], a[16:19], v[188:191]
    v_mfma_f32_16x16x32_bf16 v[220:223], a[144:147], a[20:23], v[220:223]
    buffer_load_dwordx4 a[80:83], v14, s[4:7], s45 offen
    v_mfma_f32_16x16x32_bf16 v[252:255], a[144:147], a[24:27], v[252:255]
    v_add_u32 v15, s81, v2
    v_add_u32 v16, 57344, v15
    s_waitcnt vmcnt(9) lgkmcnt(0)
    s_barrier
    v_mfma_f32_16x16x32_bf16 v[32:35], a[84:87], a[28:31], v[32:35]
    v_mfma_f32_16x16x32_bf16 v[64:67], a[84:87], a[32:35], v[64:67]
    ds_read_b128 a[116:119], v15 offset:0
    v_mfma_f32_16x16x32_bf16 v[96:99], a[84:87], a[36:39], v[96:99]
    v_mfma_f32_16x16x32_bf16 v[128:131], a[84:87], a[40:43], v[128:131]
    s_add_u32 s43, s41, s84
    s_mov_b32 m0, s43
    s_add_u32 s44, s40, s84
    buffer_load_dwordx4 v2, s[4:7], s44 offen lds
    v_mfma_f32_16x16x32_bf16 v[160:163], a[84:87], a[44:47], v[160:163]
    v_mfma_f32_16x16x32_bf16 v[192:195], a[84:87], a[48:51], v[192:195]
    v_mfma_f32_16x16x32_bf16 v[224:227], a[84:87], a[52:55], v[224:227]
    v_mfma_f32_16x16x32_bf16 v[36:39], a[88:91], a[28:31], v[36:39]
    v_mfma_f32_16x16x32_bf16 v[68:71], a[88:91], a[32:35], v[68:71]
    ds_read_b128 a[120:123], v15 offset:14336
    v_mfma_f32_16x16x32_bf16 v[100:103], a[88:91], a[36:39], v[100:103]
    v_mfma_f32_16x16x32_bf16 v[132:135], a[88:91], a[40:43], v[132:135]
    s_add_u32 s43, s41, s84
    s_add_u32 s43, s43, 14336
    s_mov_b32 m0, s43
    s_add_u32 s44, s40, s84
    buffer_load_dwordx4 v17, s[4:7], s44 offen lds
    v_mfma_f32_16x16x32_bf16 v[164:167], a[88:91], a[44:47], v[164:167]
    v_mfma_f32_16x16x32_bf16 v[196:199], a[88:91], a[48:51], v[196:199]
    s_add_u32 s45, s42, s82
    buffer_load_dwordx4 a[0:3], v8, s[4:7], s45 offen
    v_mfma_f32_16x16x32_bf16 v[228:231], a[88:91], a[52:55], v[228:231]
    v_mfma_f32_16x16x32_bf16 v[40:43], a[92:95], a[28:31], v[40:43]
    v_mfma_f32_16x16x32_bf16 v[72:75], a[92:95], a[32:35], v[72:75]
    ds_read_b128 a[124:127], v15 offset:28672
    v_mfma_f32_16x16x32_bf16 v[104:107], a[92:95], a[36:39], v[104:107]
    v_mfma_f32_16x16x32_bf16 v[136:139], a[92:95], a[40:43], v[136:139]
    v_mfma_f32_16x16x32_bf16 v[168:171], a[92:95], a[44:47], v[168:171]
    v_mfma_f32_16x16x32_bf16 v[200:203], a[92:95], a[48:51], v[200:203]
    buffer_load_dwordx4 a[4:7], v9, s[4:7], s45 offen
    v_mfma_f32_16x16x32_bf16 v[232:235], a[92:95], a[52:55], v[232:235]
    v_mfma_f32_16x16x32_bf16 v[44:47], a[96:99], a[28:31], v[44:47]
    v_mfma_f32_16x16x32_bf16 v[76:79], a[96:99], a[32:35], v[76:79]
    ds_read_b128 a[128:131], v15 offset:43008
    v_mfma_f32_16x16x32_bf16 v[108:111], a[96:99], a[36:39], v[108:111]
    v_mfma_f32_16x16x32_bf16 v[140:143], a[96:99], a[40:43], v[140:143]
    v_mfma_f32_16x16x32_bf16 v[172:175], a[96:99], a[44:47], v[172:175]
    v_mfma_f32_16x16x32_bf16 v[204:207], a[96:99], a[48:51], v[204:207]
    buffer_load_dwordx4 a[8:11], v10, s[4:7], s45 offen
    v_mfma_f32_16x16x32_bf16 v[236:239], a[96:99], a[52:55], v[236:239]
    v_mfma_f32_16x16x32_bf16 v[48:51], a[100:103], a[28:31], v[48:51]
    v_mfma_f32_16x16x32_bf16 v[80:83], a[100:103], a[32:35], v[80:83]
    ds_read_b128 a[132:135], v16 offset:0
    v_mfma_f32_16x16x32_bf16 v[112:115], a[100:103], a[36:39], v[112:115]
    v_mfma_f32_16x16x32_bf16 v[144:147], a[100:103], a[40:43], v[144:147]
    v_mfma_f32_16x16x32_bf16 v[176:179], a[100:103], a[44:47], v[176:179]
    v_mfma_f32_16x16x32_bf16 v[208:211], a[100:103], a[48:51], v[208:211]
    buffer_load_dwordx4 a[12:15], v11, s[4:7], s45 offen
    v_mfma_f32_16x16x32_bf16 v[240:243], a[100:103], a[52:55], v[240:243]
    v_mfma_f32_16x16x32_bf16 v[52:55], a[104:107], a[28:31], v[52:55]
    v_mfma_f32_16x16x32_bf16 v[84:87], a[104:107], a[32:35], v[84:87]
    ds_read_b128 a[136:139], v16 offset:14336
    v_mfma_f32_16x16x32_bf16 v[116:119], a[104:107], a[36:39], v[116:119]
    v_mfma_f32_16x16x32_bf16 v[148:151], a[104:107], a[40:43], v[148:151]
    v_mfma_f32_16x16x32_bf16 v[180:183], a[104:107], a[44:47], v[180:183]
    v_mfma_f32_16x16x32_bf16 v[212:215], a[104:107], a[48:51], v[212:215]
    buffer_load_dwordx4 a[16:19], v12, s[4:7], s45 offen
    v_mfma_f32_16x16x32_bf16 v[244:247], a[104:107], a[52:55], v[244:247]
    v_mfma_f32_16x16x32_bf16 v[56:59], a[108:111], a[28:31], v[56:59]
    v_mfma_f32_16x16x32_bf16 v[88:91], a[108:111], a[32:35], v[88:91]
    ds_read_b128 a[140:143], v16 offset:28672
    v_mfma_f32_16x16x32_bf16 v[120:123], a[108:111], a[36:39], v[120:123]
    v_mfma_f32_16x16x32_bf16 v[152:155], a[108:111], a[40:43], v[152:155]
    v_mfma_f32_16x16x32_bf16 v[184:187], a[108:111], a[44:47], v[184:187]
    v_mfma_f32_16x16x32_bf16 v[216:219], a[108:111], a[48:51], v[216:219]
    buffer_load_dwordx4 a[20:23], v13, s[4:7], s45 offen
    v_mfma_f32_16x16x32_bf16 v[248:251], a[108:111], a[52:55], v[248:251]
    v_mfma_f32_16x16x32_bf16 v[60:63], a[112:115], a[28:31], v[60:63]
    v_mfma_f32_16x16x32_bf16 v[92:95], a[112:115], a[32:35], v[92:95]
    ds_read_b128 a[144:147], v16 offset:43008
    v_mfma_f32_16x16x32_bf16 v[124:127], a[112:115], a[36:39], v[124:127]
    v_mfma_f32_16x16x32_bf16 v[156:159], a[112:115], a[40:43], v[156:159]
    v_mfma_f32_16x16x32_bf16 v[188:191], a[112:115], a[44:47], v[188:191]
    v_mfma_f32_16x16x32_bf16 v[220:223], a[112:115], a[48:51], v[220:223]
    buffer_load_dwordx4 a[24:27], v14, s[4:7], s45 offen
    v_mfma_f32_16x16x32_bf16 v[252:255], a[112:115], a[52:55], v[252:255]
    v_add_u32 v15, s82, v2
    v_add_u32 v16, 57344, v15
    s_waitcnt vmcnt(9) lgkmcnt(0)
    s_barrier
    v_mfma_f32_16x16x32_bf16 v[32:35], a[116:119], a[56:59], v[32:35]
    v_mfma_f32_16x16x32_bf16 v[64:67], a[116:119], a[60:63], v[64:67]
    ds_read_b128 a[84:87], v15 offset:0
    v_mfma_f32_16x16x32_bf16 v[96:99], a[116:119], a[64:67], v[96:99]
    v_mfma_f32_16x16x32_bf16 v[128:131], a[116:119], a[68:71], v[128:131]
    s_add_u32 s43, s41, s85
    s_mov_b32 m0, s43
    s_add_u32 s44, s40, s85
    buffer_load_dwordx4 v2, s[4:7], s44 offen lds
    v_mfma_f32_16x16x32_bf16 v[160:163], a[116:119], a[72:75], v[160:163]
    v_mfma_f32_16x16x32_bf16 v[192:195], a[116:119], a[76:79], v[192:195]
    v_mfma_f32_16x16x32_bf16 v[224:227], a[116:119], a[80:83], v[224:227]
    v_mfma_f32_16x16x32_bf16 v[36:39], a[120:123], a[56:59], v[36:39]
    v_mfma_f32_16x16x32_bf16 v[68:71], a[120:123], a[60:63], v[68:71]
    ds_read_b128 a[88:91], v15 offset:14336
    v_mfma_f32_16x16x32_bf16 v[100:103], a[120:123], a[64:67], v[100:103]
    v_mfma_f32_16x16x32_bf16 v[132:135], a[120:123], a[68:71], v[132:135]
    s_add_u32 s43, s41, s85
    s_add_u32 s43, s43, 14336
    s_mov_b32 m0, s43
    s_add_u32 s44, s40, s85
    buffer_load_dwordx4 v17, s[4:7], s44 offen lds
    v_mfma_f32_16x16x32_bf16 v[164:167], a[120:123], a[72:75], v[164:167]
    v_mfma_f32_16x16x32_bf16 v[196:199], a[120:123], a[76:79], v[196:199]
    s_add_u32 s45, s42, s83
    buffer_load_dwordx4 a[28:31], v8, s[4:7], s45 offen
    v_mfma_f32_16x16x32_bf16 v[228:231], a[120:123], a[80:83], v[228:231]
    v_mfma_f32_16x16x32_bf16 v[40:43], a[124:127], a[56:59], v[40:43]
    v_mfma_f32_16x16x32_bf16 v[72:75], a[124:127], a[60:63], v[72:75]
    ds_read_b128 a[92:95], v15 offset:28672
    v_mfma_f32_16x16x32_bf16 v[104:107], a[124:127], a[64:67], v[104:107]
    v_mfma_f32_16x16x32_bf16 v[136:139], a[124:127], a[68:71], v[136:139]
    v_mfma_f32_16x16x32_bf16 v[168:171], a[124:127], a[72:75], v[168:171]
    v_mfma_f32_16x16x32_bf16 v[200:203], a[124:127], a[76:79], v[200:203]
    buffer_load_dwordx4 a[32:35], v9, s[4:7], s45 offen
    v_mfma_f32_16x16x32_bf16 v[232:235], a[124:127], a[80:83], v[232:235]
    v_mfma_f32_16x16x32_bf16 v[44:47], a[128:131], a[56:59], v[44:47]
    v_mfma_f32_16x16x32_bf16 v[76:79], a[128:131], a[60:63], v[76:79]
    ds_read_b128 a[96:99], v15 offset:43008
    v_mfma_f32_16x16x32_bf16 v[108:111], a[128:131], a[64:67], v[108:111]
    v_mfma_f32_16x16x32_bf16 v[140:143], a[128:131], a[68:71], v[140:143]
    v_mfma_f32_16x16x32_bf16 v[172:175], a[128:131], a[72:75], v[172:175]
    v_mfma_f32_16x16x32_bf16 v[204:207], a[128:131], a[76:79], v[204:207]
    buffer_load_dwordx4 a[36:39], v10, s[4:7], s45 offen
    v_mfma_f32_16x16x32_bf16 v[236:239], a[128:131], a[80:83], v[236:239]
    v_mfma_f32_16x16x32_bf16 v[48:51], a[132:135], a[56:59], v[48:51]
    v_mfma_f32_16x16x32_bf16 v[80:83], a[132:135], a[60:63], v[80:83]
    ds_read_b128 a[100:103], v16 offset:0
    v_mfma_f32_16x16x32_bf16 v[112:115], a[132:135], a[64:67], v[112:115]
    v_mfma_f32_16x16x32_bf16 v[144:147], a[132:135], a[68:71], v[144:147]
    v_mfma_f32_16x16x32_bf16 v[176:179], a[132:135], a[72:75], v[176:179]
    v_mfma_f32_16x16x32_bf16 v[208:211], a[132:135], a[76:79], v[208:211]
    buffer_load_dwordx4 a[40:43], v11, s[4:7], s45 offen
    v_mfma_f32_16x16x32_bf16 v[240:243], a[132:135], a[80:83], v[240:243]
    v_mfma_f32_16x16x32_bf16 v[52:55], a[136:139], a[56:59], v[52:55]
    v_mfma_f32_16x16x32_bf16 v[84:87], a[136:139], a[60:63], v[84:87]
    ds_read_b128 a[104:107], v16 offset:14336
    v_mfma_f32_16x16x32_bf16 v[116:119], a[136:139], a[64:67], v[116:119]
    v_mfma_f32_16x16x32_bf16 v[148:151], a[136:139], a[68:71], v[148:151]
    v_mfma_f32_16x16x32_bf16 v[180:183], a[136:139], a[72:75], v[180:183]
    v_mfma_f32_16x16x32_bf16 v[212:215], a[136:139], a[76:79], v[212:215]
    buffer_load_dwordx4 a[44:47], v12, s[4:7], s45 offen
    v_mfma_f32_16x16x32_bf16 v[244:247], a[136:139], a[80:83], v[244:247]
    v_mfma_f32_16x16x32_bf16 v[56:59], a[140:143], a[56:59], v[56:59]
    v_mfma_f32_16x16x32_bf16 v[88:91], a[140:143], a[60:63], v[88:91]
    ds_read_b128 a[108:111], v16 offset:28672
    v_mfma_f32_16x16x32_bf16 v[120:123], a[140:143], a[64:67], v[120:123]
    v_mfma_f32_16x16x32_bf16 v[152:155], a[140:143], a[68:71], v[152:155]
    v_mfma_f32_16x16x32_bf16 v[184:187], a[140:143], a[72:75], v[184:187]
    v_mfma_f32_16x16x32_bf16 v[216:219], a[140:143], a[76:79], v[216:219]
    buffer_load_dwordx4 a[48:51], v13, s[4:7], s45 offen
    v_mfma_f32_16x16x32_bf16 v[248:251], a[140:143], a[80:83], v[248:251]
    v_mfma_f32_16x16x32_bf16 v[60:63], a[144:147], a[56:59], v[60:63]
    v_mfma_f32_16x16x32_bf16 v[92:95], a[144:147], a[60:63], v[92:95]
    ds_read_b128 a[112:115], v16 offset:43008
    v_mfma_f32_16x16x32_bf16 v[124:127], a[144:147], a[64:67], v[124:127]
    v_mfma_f32_16x16x32_bf16 v[156:159], a[144:147], a[68:71], v[156:159]
    v_mfma_f32_16x16x32_bf16 v[188:191], a[144:147], a[72:75], v[188:191]
    v_mfma_f32_16x16x32_bf16 v[220:223], a[144:147], a[76:79], v[220:223]
    buffer_load_dwordx4 a[52:55], v14, s[4:7], s45 offen
    v_mfma_f32_16x16x32_bf16 v[252:255], a[144:147], a[80:83], v[252:255]
    v_add_u32 v15, s83, v2
    v_add_u32 v16, 57344, v15
    s_waitcnt vmcnt(9) lgkmcnt(0)
    s_barrier
    v_mfma_f32_16x16x32_bf16 v[32:35], a[84:87], a[0:3], v[32:35]
    v_mfma_f32_16x16x32_bf16 v[64:67], a[84:87], a[4:7], v[64:67]
    ds_read_b128 a[116:119], v15 offset:0
    v_mfma_f32_16x16x32_bf16 v[96:99], a[84:87], a[8:11], v[96:99]
    v_mfma_f32_16x16x32_bf16 v[128:131], a[84:87], a[12:15], v[128:131]
    s_add_u32 s43, s41, s86
    s_mov_b32 m0, s43
    s_add_u32 s44, s40, s86
    buffer_load_dwordx4 v2, s[4:7], s44 offen lds
    v_mfma_f32_16x16x32_bf16 v[160:163], a[84:87], a[16:19], v[160:163]
    v_mfma_f32_16x16x32_bf16 v[192:195], a[84:87], a[20:23], v[192:195]
    v_mfma_f32_16x16x32_bf16 v[224:227], a[84:87], a[24:27], v[224:227]
    v_mfma_f32_16x16x32_bf16 v[36:39], a[88:91], a[0:3], v[36:39]
    v_mfma_f32_16x16x32_bf16 v[68:71], a[88:91], a[4:7], v[68:71]
    ds_read_b128 a[120:123], v15 offset:14336
    v_mfma_f32_16x16x32_bf16 v[100:103], a[88:91], a[8:11], v[100:103]
    v_mfma_f32_16x16x32_bf16 v[132:135], a[88:91], a[12:15], v[132:135]
    s_add_u32 s43, s41, s86
    s_add_u32 s43, s43, 14336
    s_mov_b32 m0, s43
    s_add_u32 s44, s40, s86
    buffer_load_dwordx4 v17, s[4:7], s44 offen lds
    v_mfma_f32_16x16x32_bf16 v[164:167], a[88:91], a[16:19], v[164:167]
    v_mfma_f32_16x16x32_bf16 v[196:199], a[88:91], a[20:23], v[196:199]
    s_add_u32 s45, s42, s84
    buffer_load_dwordx4 a[56:59], v8, s[4:7], s45 offen
    v_mfma_f32_16x16x32_bf16 v[228:231], a[88:91], a[24:27], v[228:231]
    v_mfma_f32_16x16x32_bf16 v[40:43], a[92:95], a[0:3], v[40:43]
    v_mfma_f32_16x16x32_bf16 v[72:75], a[92:95], a[4:7], v[72:75]
    ds_read_b128 a[124:127], v15 offset:28672
    v_mfma_f32_16x16x32_bf16 v[104:107], a[92:95], a[8:11], v[104:107]
    v_mfma_f32_16x16x32_bf16 v[136:139], a[92:95], a[12:15], v[136:139]
    v_mfma_f32_16x16x32_bf16 v[168:171], a[92:95], a[16:19], v[168:171]
    v_mfma_f32_16x16x32_bf16 v[200:203], a[92:95], a[20:23], v[200:203]
    buffer_load_dwordx4 a[60:63], v9, s[4:7], s45 offen
    v_mfma_f32_16x16x32_bf16 v[232:235], a[92:95], a[24:27], v[232:235]
    v_mfma_f32_16x16x32_bf16 v[44:47], a[96:99], a[0:3], v[44:47]
    v_mfma_f32_16x16x32_bf16 v[76:79], a[96:99], a[4:7], v[76:79]
    ds_read_b128 a[128:131], v15 offset:43008
    v_mfma_f32_16x16x32_bf16 v[108:111], a[96:99], a[8:11], v[108:111]
    v_mfma_f32_16x16x32_bf16 v[140:143], a[96:99], a[12:15], v[140:143]
    v_mfma_f32_16x16x32_bf16 v[172:175], a[96:99], a[16:19], v[172:175]
    v_mfma_f32_16x16x32_bf16 v[204:207], a[96:99], a[20:23], v[204:207]
    buffer_load_dwordx4 a[64:67], v10, s[4:7], s45 offen
    v_mfma_f32_16x16x32_bf16 v[236:239], a[96:99], a[24:27], v[236:239]
    v_mfma_f32_16x16x32_bf16 v[48:51], a[100:103], a[0:3], v[48:51]
    v_mfma_f32_16x16x32_bf16 v[80:83], a[100:103], a[4:7], v[80:83]
    ds_read_b128 a[132:135], v16 offset:0
    v_mfma_f32_16x16x32_bf16 v[112:115], a[100:103], a[8:11], v[112:115]
    v_mfma_f32_16x16x32_bf16 v[144:147], a[100:103], a[12:15], v[144:147]
    v_mfma_f32_16x16x32_bf16 v[176:179], a[100:103], a[16:19], v[176:179]
    v_mfma_f32_16x16x32_bf16 v[208:211], a[100:103], a[20:23], v[208:211]
    buffer_load_dwordx4 a[68:71], v11, s[4:7], s45 offen
    v_mfma_f32_16x16x32_bf16 v[240:243], a[100:103], a[24:27], v[240:243]
    v_mfma_f32_16x16x32_bf16 v[52:55], a[104:107], a[0:3], v[52:55]
    v_mfma_f32_16x16x32_bf16 v[84:87], a[104:107], a[4:7], v[84:87]
    ds_read_b128 a[136:139], v16 offset:14336
    v_mfma_f32_16x16x32_bf16 v[116:119], a[104:107], a[8:11], v[116:119]
    v_mfma_f32_16x16x32_bf16 v[148:151], a[104:107], a[12:15], v[148:151]
    v_mfma_f32_16x16x32_bf16 v[180:183], a[104:107], a[16:19], v[180:183]
    v_mfma_f32_16x16x32_bf16 v[212:215], a[104:107], a[20:23], v[212:215]
    buffer_load_dwordx4 a[72:75], v12, s[4:7], s45 offen
    v_mfma_f32_16x16x32_bf16 v[244:247], a[104:107], a[24:27], v[244:247]
    v_mfma_f32_16x16x32_bf16 v[56:59], a[108:111], a[0:3], v[56:59]
    v_mfma_f32_16x16x32_bf16 v[88:91], a[108:111], a[4:7], v[88:91]
    ds_read_b128 a[140:143], v16 offset:28672
    v_mfma_f32_16x16x32_bf16 v[120:123], a[108:111], a[8:11], v[120:123]
    v_mfma_f32_16x16x32_bf16 v[152:155], a[108:111], a[12:15], v[152:155]
    v_mfma_f32_16x16x32_bf16 v[184:187], a[108:111], a[16:19], v[184:187]
    v_mfma_f32_16x16x32_bf16 v[216:219], a[108:111], a[20:23], v[216:219]
    buffer_load_dwordx4 a[76:79], v13, s[4:7], s45 offen
    v_mfma_f32_16x16x32_bf16 v[248:251], a[108:111], a[24:27], v[248:251]
    v_mfma_f32_16x16x32_bf16 v[60:63], a[112:115], a[0:3], v[60:63]
    v_mfma_f32_16x16x32_bf16 v[92:95], a[112:115], a[4:7], v[92:95]
    ds_read_b128 a[144:147], v16 offset:43008
    v_mfma_f32_16x16x32_bf16 v[124:127], a[112:115], a[8:11], v[124:127]
    v_mfma_f32_16x16x32_bf16 v[156:159], a[112:115], a[12:15], v[156:159]
    v_mfma_f32_16x16x32_bf16 v[188:191], a[112:115], a[16:19], v[188:191]
    v_mfma_f32_16x16x32_bf16 v[220:223], a[112:115], a[20:23], v[220:223]
    buffer_load_dwordx4 a[80:83], v14, s[4:7], s45 offen
    v_mfma_f32_16x16x32_bf16 v[252:255], a[112:115], a[24:27], v[252:255]
    v_add_u32 v15, s84, v2
    v_add_u32 v16, 57344, v15
    s_waitcnt vmcnt(9) lgkmcnt(0)
    s_barrier
    v_mfma_f32_16x16x32_bf16 v[32:35], a[116:119], a[28:31], v[32:35]
    v_mfma_f32_16x16x32_bf16 v[64:67], a[116:119], a[32:35], v[64:67]
    ds_read_b128 a[84:87], v15 offset:0
    v_mfma_f32_16x16x32_bf16 v[96:99], a[116:119], a[36:39], v[96:99]
    v_mfma_f32_16x16x32_bf16 v[128:131], a[116:119], a[40:43], v[128:131]
    s_add_u32 s43, s41, s87
    s_mov_b32 m0, s43
    s_add_u32 s44, s40, s87
    buffer_load_dwordx4 v2, s[4:7], s44 offen lds
    v_mfma_f32_16x16x32_bf16 v[160:163], a[116:119], a[44:47], v[160:163]
    v_mfma_f32_16x16x32_bf16 v[192:195], a[116:119], a[48:51], v[192:195]
    v_mfma_f32_16x16x32_bf16 v[224:227], a[116:119], a[52:55], v[224:227]
    v_mfma_f32_16x16x32_bf16 v[36:39], a[120:123], a[28:31], v[36:39]
    v_mfma_f32_16x16x32_bf16 v[68:71], a[120:123], a[32:35], v[68:71]
    ds_read_b128 a[88:91], v15 offset:14336
    v_mfma_f32_16x16x32_bf16 v[100:103], a[120:123], a[36:39], v[100:103]
    v_mfma_f32_16x16x32_bf16 v[132:135], a[120:123], a[40:43], v[132:135]
    s_add_u32 s43, s41, s87
    s_add_u32 s43, s43, 14336
    s_mov_b32 m0, s43
    s_add_u32 s44, s40, s87
    buffer_load_dwordx4 v17, s[4:7], s44 offen lds
    v_mfma_f32_16x16x32_bf16 v[164:167], a[120:123], a[44:47], v[164:167]
    v_mfma_f32_16x16x32_bf16 v[196:199], a[120:123], a[48:51], v[196:199]
    s_add_u32 s45, s42, s85
    buffer_load_dwordx4 a[0:3], v8, s[4:7], s45 offen
    v_mfma_f32_16x16x32_bf16 v[228:231], a[120:123], a[52:55], v[228:231]
    v_mfma_f32_16x16x32_bf16 v[40:43], a[124:127], a[28:31], v[40:43]
    v_mfma_f32_16x16x32_bf16 v[72:75], a[124:127], a[32:35], v[72:75]
    ds_read_b128 a[92:95], v15 offset:28672
    v_mfma_f32_16x16x32_bf16 v[104:107], a[124:127], a[36:39], v[104:107]
    v_mfma_f32_16x16x32_bf16 v[136:139], a[124:127], a[40:43], v[136:139]
    v_mfma_f32_16x16x32_bf16 v[168:171], a[124:127], a[44:47], v[168:171]
    v_mfma_f32_16x16x32_bf16 v[200:203], a[124:127], a[48:51], v[200:203]
    buffer_load_dwordx4 a[4:7], v9, s[4:7], s45 offen
    v_mfma_f32_16x16x32_bf16 v[232:235], a[124:127], a[52:55], v[232:235]
    v_mfma_f32_16x16x32_bf16 v[44:47], a[128:131], a[28:31], v[44:47]
    v_mfma_f32_16x16x32_bf16 v[76:79], a[128:131], a[32:35], v[76:79]
    ds_read_b128 a[96:99], v15 offset:43008
    v_mfma_f32_16x16x32_bf16 v[108:111], a[128:131], a[36:39], v[108:111]
    v_mfma_f32_16x16x32_bf16 v[140:143], a[128:131], a[40:43], v[140:143]
    v_mfma_f32_16x16x32_bf16 v[172:175], a[128:131], a[44:47], v[172:175]
    v_mfma_f32_16x16x32_bf16 v[204:207], a[128:131], a[48:51], v[204:207]
    buffer_load_dwordx4 a[8:11], v10, s[4:7], s45 offen
    v_mfma_f32_16x16x32_bf16 v[236:239], a[128:131], a[52:55], v[236:239]
    v_mfma_f32_16x16x32_bf16 v[48:51], a[132:135], a[28:31], v[48:51]
    v_mfma_f32_16x16x32_bf16 v[80:83], a[132:135], a[32:35], v[80:83]
    ds_read_b128 a[100:103], v16 offset:0
    v_mfma_f32_16x16x32_bf16 v[112:115], a[132:135], a[36:39], v[112:115]
    v_mfma_f32_16x16x32_bf16 v[144:147], a[132:135], a[40:43], v[144:147]
    v_mfma_f32_16x16x32_bf16 v[176:179], a[132:135], a[44:47], v[176:179]
    v_mfma_f32_16x16x32_bf16 v[208:211], a[132:135], a[48:51], v[208:211]
    buffer_load_dwordx4 a[12:15], v11, s[4:7], s45 offen
    v_mfma_f32_16x16x32_bf16 v[240:243], a[132:135], a[52:55], v[240:243]
    v_mfma_f32_16x16x32_bf16 v[52:55], a[136:139], a[28:31], v[52:55]
    v_mfma_f32_16x16x32_bf16 v[84:87], a[136:139], a[32:35], v[84:87]
    ds_read_b128 a[104:107], v16 offset:14336
    v_mfma_f32_16x16x32_bf16 v[116:119], a[136:139], a[36:39], v[116:119]
    v_mfma_f32_16x16x32_bf16 v[148:151], a[136:139], a[40:43], v[148:151]
    v_mfma_f32_16x16x32_bf16 v[180:183], a[136:139], a[44:47], v[180:183]
    v_mfma_f32_16x16x32_bf16 v[212:215], a[136:139], a[48:51], v[212:215]
    buffer_load_dwordx4 a[16:19], v12, s[4:7], s45 offen
    v_mfma_f32_16x16x32_bf16 v[244:247], a[136:139], a[52:55], v[244:247]
    v_mfma_f32_16x16x32_bf16 v[56:59], a[140:143], a[28:31], v[56:59]
    v_mfma_f32_16x16x32_bf16 v[88:91], a[140:143], a[32:35], v[88:91]
    ds_read_b128 a[108:111], v16 offset:28672
    v_mfma_f32_16x16x32_bf16 v[120:123], a[140:143], a[36:39], v[120:123]
    v_mfma_f32_16x16x32_bf16 v[152:155], a[140:143], a[40:43], v[152:155]
    v_mfma_f32_16x16x32_bf16 v[184:187], a[140:143], a[44:47], v[184:187]
    v_mfma_f32_16x16x32_bf16 v[216:219], a[140:143], a[48:51], v[216:219]
    buffer_load_dwordx4 a[20:23], v13, s[4:7], s45 offen
    v_mfma_f32_16x16x32_bf16 v[248:251], a[140:143], a[52:55], v[248:251]
    v_mfma_f32_16x16x32_bf16 v[60:63], a[144:147], a[28:31], v[60:63]
    v_mfma_f32_16x16x32_bf16 v[92:95], a[144:147], a[32:35], v[92:95]
    ds_read_b128 a[112:115], v16 offset:43008
    v_mfma_f32_16x16x32_bf16 v[124:127], a[144:147], a[36:39], v[124:127]
    v_mfma_f32_16x16x32_bf16 v[156:159], a[144:147], a[40:43], v[156:159]
    v_mfma_f32_16x16x32_bf16 v[188:191], a[144:147], a[44:47], v[188:191]
    v_mfma_f32_16x16x32_bf16 v[220:223], a[144:147], a[48:51], v[220:223]
    buffer_load_dwordx4 a[24:27], v14, s[4:7], s45 offen
    v_mfma_f32_16x16x32_bf16 v[252:255], a[144:147], a[52:55], v[252:255]
    v_add_u32 v15, s85, v2
    v_add_u32 v16, 57344, v15
    s_waitcnt vmcnt(9) lgkmcnt(0)
    s_barrier
    v_mfma_f32_16x16x32_bf16 v[32:35], a[84:87], a[56:59], v[32:35]
    v_mfma_f32_16x16x32_bf16 v[64:67], a[84:87], a[60:63], v[64:67]
    ds_read_b128 a[116:119], v15 offset:0
    v_mfma_f32_16x16x32_bf16 v[96:99], a[84:87], a[64:67], v[96:99]
    v_mfma_f32_16x16x32_bf16 v[128:131], a[84:87], a[68:71], v[128:131]
    s_add_u32 s43, s41, s88
    s_mov_b32 m0, s43
    s_add_u32 s44, s40, s88
    buffer_load_dwordx4 v2, s[4:7], s44 offen lds
    v_mfma_f32_16x16x32_bf16 v[160:163], a[84:87], a[72:75], v[160:163]
    v_mfma_f32_16x16x32_bf16 v[192:195], a[84:87], a[76:79], v[192:195]
    v_mfma_f32_16x16x32_bf16 v[224:227], a[84:87], a[80:83], v[224:227]
    v_mfma_f32_16x16x32_bf16 v[36:39], a[88:91], a[56:59], v[36:39]
    v_mfma_f32_16x16x32_bf16 v[68:71], a[88:91], a[60:63], v[68:71]
    ds_read_b128 a[120:123], v15 offset:14336
    v_mfma_f32_16x16x32_bf16 v[100:103], a[88:91], a[64:67], v[100:103]
    v_mfma_f32_16x16x32_bf16 v[132:135], a[88:91], a[68:71], v[132:135]
    s_add_u32 s43, s41, s88
    s_add_u32 s43, s43, 14336
    s_mov_b32 m0, s43
    s_add_u32 s44, s40, s88
    buffer_load_dwordx4 v17, s[4:7], s44 offen lds
    v_mfma_f32_16x16x32_bf16 v[164:167], a[88:91], a[72:75], v[164:167]
    v_mfma_f32_16x16x32_bf16 v[196:199], a[88:91], a[76:79], v[196:199]
    s_add_u32 s45, s42, s86
    buffer_load_dwordx4 a[28:31], v8, s[4:7], s45 offen
    v_mfma_f32_16x16x32_bf16 v[228:231], a[88:91], a[80:83], v[228:231]
    v_mfma_f32_16x16x32_bf16 v[40:43], a[92:95], a[56:59], v[40:43]
    v_mfma_f32_16x16x32_bf16 v[72:75], a[92:95], a[60:63], v[72:75]
    ds_read_b128 a[124:127], v15 offset:28672
    v_mfma_f32_16x16x32_bf16 v[104:107], a[92:95], a[64:67], v[104:107]
    v_mfma_f32_16x16x32_bf16 v[136:139], a[92:95], a[68:71], v[136:139]
    v_mfma_f32_16x16x32_bf16 v[168:171], a[92:95], a[72:75], v[168:171]
    v_mfma_f32_16x16x32_bf16 v[200:203], a[92:95], a[76:79], v[200:203]
    buffer_load_dwordx4 a[32:35], v9, s[4:7], s45 offen
    v_mfma_f32_16x16x32_bf16 v[232:235], a[92:95], a[80:83], v[232:235]
    v_mfma_f32_16x16x32_bf16 v[44:47], a[96:99], a[56:59], v[44:47]
    v_mfma_f32_16x16x32_bf16 v[76:79], a[96:99], a[60:63], v[76:79]
    ds_read_b128 a[128:131], v15 offset:43008
    v_mfma_f32_16x16x32_bf16 v[108:111], a[96:99], a[64:67], v[108:111]
    v_mfma_f32_16x16x32_bf16 v[140:143], a[96:99], a[68:71], v[140:143]
    v_mfma_f32_16x16x32_bf16 v[172:175], a[96:99], a[72:75], v[172:175]
    v_mfma_f32_16x16x32_bf16 v[204:207], a[96:99], a[76:79], v[204:207]
    buffer_load_dwordx4 a[36:39], v10, s[4:7], s45 offen
    v_mfma_f32_16x16x32_bf16 v[236:239], a[96:99], a[80:83], v[236:239]
    v_mfma_f32_16x16x32_bf16 v[48:51], a[100:103], a[56:59], v[48:51]
    v_mfma_f32_16x16x32_bf16 v[80:83], a[100:103], a[60:63], v[80:83]
    ds_read_b128 a[132:135], v16 offset:0
    v_mfma_f32_16x16x32_bf16 v[112:115], a[100:103], a[64:67], v[112:115]
    v_mfma_f32_16x16x32_bf16 v[144:147], a[100:103], a[68:71], v[144:147]
    v_mfma_f32_16x16x32_bf16 v[176:179], a[100:103], a[72:75], v[176:179]
    v_mfma_f32_16x16x32_bf16 v[208:211], a[100:103], a[76:79], v[208:211]
    buffer_load_dwordx4 a[40:43], v11, s[4:7], s45 offen
    v_mfma_f32_16x16x32_bf16 v[240:243], a[100:103], a[80:83], v[240:243]
    v_mfma_f32_16x16x32_bf16 v[52:55], a[104:107], a[56:59], v[52:55]
    v_mfma_f32_16x16x32_bf16 v[84:87], a[104:107], a[60:63], v[84:87]
    ds_read_b128 a[136:139], v16 offset:14336
    v_mfma_f32_16x16x32_bf16 v[116:119], a[104:107], a[64:67], v[116:119]
    v_mfma_f32_16x16x32_bf16 v[148:151], a[104:107], a[68:71], v[148:151]
    v_mfma_f32_16x16x32_bf16 v[180:183], a[104:107], a[72:75], v[180:183]
    v_mfma_f32_16x16x32_bf16 v[212:215], a[104:107], a[76:79], v[212:215]
    buffer_load_dwordx4 a[44:47], v12, s[4:7], s45 offen
    v_mfma_f32_16x16x32_bf16 v[244:247], a[104:107], a[80:83], v[244:247]
    v_mfma_f32_16x16x32_bf16 v[56:59], a[108:111], a[56:59], v[56:59]
    v_mfma_f32_16x16x32_bf16 v[88:91], a[108:111], a[60:63], v[88:91]
    ds_read_b128 a[140:143], v16 offset:28672
    v_mfma_f32_16x16x32_bf16 v[120:123], a[108:111], a[64:67], v[120:123]
    v_mfma_f32_16x16x32_bf16 v[152:155], a[108:111], a[68:71], v[152:155]
    v_mfma_f32_16x16x32_bf16 v[184:187], a[108:111], a[72:75], v[184:187]
    v_mfma_f32_16x16x32_bf16 v[216:219], a[108:111], a[76:79], v[216:219]
    buffer_load_dwordx4 a[48:51], v13, s[4:7], s45 offen
    v_mfma_f32_16x16x32_bf16 v[248:251], a[108:111], a[80:83], v[248:251]
    v_mfma_f32_16x16x32_bf16 v[60:63], a[112:115], a[56:59], v[60:63]
    v_mfma_f32_16x16x32_bf16 v[92:95], a[112:115], a[60:63], v[92:95]
    ds_read_b128 a[144:147], v16 offset:43008
    v_mfma_f32_16x16x32_bf16 v[124:127], a[112:115], a[64:67], v[124:127]
    v_mfma_f32_16x16x32_bf16 v[156:159], a[112:115], a[68:71], v[156:159]
    v_mfma_f32_16x16x32_bf16 v[188:191], a[112:115], a[72:75], v[188:191]
    v_mfma_f32_16x16x32_bf16 v[220:223], a[112:115], a[76:79], v[220:223]
    buffer_load_dwordx4 a[52:55], v14, s[4:7], s45 offen
    v_mfma_f32_16x16x32_bf16 v[252:255], a[112:115], a[80:83], v[252:255]
    v_add_u32 v15, s86, v2
    v_add_u32 v16, 57344, v15
    s_waitcnt vmcnt(9) lgkmcnt(0)
    s_barrier
    v_mfma_f32_16x16x32_bf16 v[32:35], a[116:119], a[0:3], v[32:35]
    v_mfma_f32_16x16x32_bf16 v[64:67], a[116:119], a[4:7], v[64:67]
    ds_read_b128 a[84:87], v15 offset:0
    v_mfma_f32_16x16x32_bf16 v[96:99], a[116:119], a[8:11], v[96:99]
    v_mfma_f32_16x16x32_bf16 v[128:131], a[116:119], a[12:15], v[128:131]
    s_add_u32 s43, s41, s89
    s_mov_b32 m0, s43
    s_add_u32 s44, s40, s89
    buffer_load_dwordx4 v2, s[4:7], s44 offen lds
    v_mfma_f32_16x16x32_bf16 v[160:163], a[116:119], a[16:19], v[160:163]
    v_mfma_f32_16x16x32_bf16 v[192:195], a[116:119], a[20:23], v[192:195]
    v_mfma_f32_16x16x32_bf16 v[224:227], a[116:119], a[24:27], v[224:227]
    v_mfma_f32_16x16x32_bf16 v[36:39], a[120:123], a[0:3], v[36:39]
    v_mfma_f32_16x16x32_bf16 v[68:71], a[120:123], a[4:7], v[68:71]
    ds_read_b128 a[88:91], v15 offset:14336
    v_mfma_f32_16x16x32_bf16 v[100:103], a[120:123], a[8:11], v[100:103]
    v_mfma_f32_16x16x32_bf16 v[132:135], a[120:123], a[12:15], v[132:135]
    s_add_u32 s43, s41, s89
    s_add_u32 s43, s43, 14336
    s_mov_b32 m0, s43
    s_add_u32 s44, s40, s89
    buffer_load_dwordx4 v17, s[4:7], s44 offen lds
    v_mfma_f32_16x16x32_bf16 v[164:167], a[120:123], a[16:19], v[164:167]
    v_mfma_f32_16x16x32_bf16 v[196:199], a[120:123], a[20:23], v[196:199]
    s_add_u32 s45, s42, s87
    buffer_load_dwordx4 a[56:59], v8, s[4:7], s45 offen
    v_mfma_f32_16x16x32_bf16 v[228:231], a[120:123], a[24:27], v[228:231]
    v_mfma_f32_16x16x32_bf16 v[40:43], a[124:127], a[0:3], v[40:43]
    v_mfma_f32_16x16x32_bf16 v[72:75], a[124:127], a[4:7], v[72:75]
    ds_read_b128 a[92:95], v15 offset:28672
    v_mfma_f32_16x16x32_bf16 v[104:107], a[124:127], a[8:11], v[104:107]
    v_mfma_f32_16x16x32_bf16 v[136:139], a[124:127], a[12:15], v[136:139]
    v_mfma_f32_16x16x32_bf16 v[168:171], a[124:127], a[16:19], v[168:171]
    v_mfma_f32_16x16x32_bf16 v[200:203], a[124:127], a[20:23], v[200:203]
    buffer_load_dwordx4 a[60:63], v9, s[4:7], s45 offen
    v_mfma_f32_16x16x32_bf16 v[232:235], a[124:127], a[24:27], v[232:235]
    v_mfma_f32_16x16x32_bf16 v[44:47], a[128:131], a[0:3], v[44:47]
    v_mfma_f32_16x16x32_bf16 v[76:79], a[128:131], a[4:7], v[76:79]
    ds_read_b128 a[96:99], v15 offset:43008
    v_mfma_f32_16x16x32_bf16 v[108:111], a[128:131], a[8:11], v[108:111]
    v_mfma_f32_16x16x32_bf16 v[140:143], a[128:131], a[12:15], v[140:143]
    v_mfma_f32_16x16x32_bf16 v[172:175], a[128:131], a[16:19], v[172:175]
    v_mfma_f32_16x16x32_bf16 v[204:207], a[128:131], a[20:23], v[204:207]
    buffer_load_dwordx4 a[64:67], v10, s[4:7], s45 offen
    v_mfma_f32_16x16x32_bf16 v[236:239], a[128:131], a[24:27], v[236:239]
    v_mfma_f32_16x16x32_bf16 v[48:51], a[132:135], a[0:3], v[48:51]
    v_mfma_f32_16x16x32_bf16 v[80:83], a[132:135], a[4:7], v[80:83]
    ds_read_b128 a[100:103], v16 offset:0
    v_mfma_f32_16x16x32_bf16 v[112:115], a[132:135], a[8:11], v[112:115]
    v_mfma_f32_16x16x32_bf16 v[144:147], a[132:135], a[12:15], v[144:147]
    v_mfma_f32_16x16x32_bf16 v[176:179], a[132:135], a[16:19], v[176:179]
    v_mfma_f32_16x16x32_bf16 v[208:211], a[132:135], a[20:23], v[208:211]
    buffer_load_dwordx4 a[68:71], v11, s[4:7], s45 offen
    v_mfma_f32_16x16x32_bf16 v[240:243], a[132:135], a[24:27], v[240:243]
    v_mfma_f32_16x16x32_bf16 v[52:55], a[136:139], a[0:3], v[52:55]
    v_mfma_f32_16x16x32_bf16 v[84:87], a[136:139], a[4:7], v[84:87]
    ds_read_b128 a[104:107], v16 offset:14336
    v_mfma_f32_16x16x32_bf16 v[116:119], a[136:139], a[8:11], v[116:119]
    v_mfma_f32_16x16x32_bf16 v[148:151], a[136:139], a[12:15], v[148:151]
    v_mfma_f32_16x16x32_bf16 v[180:183], a[136:139], a[16:19], v[180:183]
    v_mfma_f32_16x16x32_bf16 v[212:215], a[136:139], a[20:23], v[212:215]
    buffer_load_dwordx4 a[72:75], v12, s[4:7], s45 offen
    v_mfma_f32_16x16x32_bf16 v[244:247], a[136:139], a[24:27], v[244:247]
    v_mfma_f32_16x16x32_bf16 v[56:59], a[140:143], a[0:3], v[56:59]
    v_mfma_f32_16x16x32_bf16 v[88:91], a[140:143], a[4:7], v[88:91]
    ds_read_b128 a[108:111], v16 offset:28672
    v_mfma_f32_16x16x32_bf16 v[120:123], a[140:143], a[8:11], v[120:123]
    v_mfma_f32_16x16x32_bf16 v[152:155], a[140:143], a[12:15], v[152:155]
    v_mfma_f32_16x16x32_bf16 v[184:187], a[140:143], a[16:19], v[184:187]
    v_mfma_f32_16x16x32_bf16 v[216:219], a[140:143], a[20:23], v[216:219]
    buffer_load_dwordx4 a[76:79], v13, s[4:7], s45 offen
    v_mfma_f32_16x16x32_bf16 v[248:251], a[140:143], a[24:27], v[248:251]
    v_mfma_f32_16x16x32_bf16 v[60:63], a[144:147], a[0:3], v[60:63]
    v_mfma_f32_16x16x32_bf16 v[92:95], a[144:147], a[4:7], v[92:95]
    ds_read_b128 a[112:115], v16 offset:43008
    v_mfma_f32_16x16x32_bf16 v[124:127], a[144:147], a[8:11], v[124:127]
    v_mfma_f32_16x16x32_bf16 v[156:159], a[144:147], a[12:15], v[156:159]
    v_mfma_f32_16x16x32_bf16 v[188:191], a[144:147], a[16:19], v[188:191]
    v_mfma_f32_16x16x32_bf16 v[220:223], a[144:147], a[20:23], v[220:223]
    buffer_load_dwordx4 a[80:83], v14, s[4:7], s45 offen
    v_mfma_f32_16x16x32_bf16 v[252:255], a[144:147], a[24:27], v[252:255]
    v_add_u32 v15, s87, v2
    v_add_u32 v16, 57344, v15
    s_waitcnt vmcnt(9) lgkmcnt(0)
    s_barrier
    v_mfma_f32_16x16x32_bf16 v[32:35], a[84:87], a[28:31], v[32:35]
    v_mfma_f32_16x16x32_bf16 v[64:67], a[84:87], a[32:35], v[64:67]
    ds_read_b128 a[116:119], v15 offset:0
    v_mfma_f32_16x16x32_bf16 v[96:99], a[84:87], a[36:39], v[96:99]
    v_mfma_f32_16x16x32_bf16 v[128:131], a[84:87], a[40:43], v[128:131]
    v_mfma_f32_16x16x32_bf16 v[160:163], a[84:87], a[44:47], v[160:163]
    v_mfma_f32_16x16x32_bf16 v[192:195], a[84:87], a[48:51], v[192:195]
    v_mfma_f32_16x16x32_bf16 v[224:227], a[84:87], a[52:55], v[224:227]
    v_mfma_f32_16x16x32_bf16 v[36:39], a[88:91], a[28:31], v[36:39]
    v_mfma_f32_16x16x32_bf16 v[68:71], a[88:91], a[32:35], v[68:71]
    ds_read_b128 a[120:123], v15 offset:14336
    v_mfma_f32_16x16x32_bf16 v[100:103], a[88:91], a[36:39], v[100:103]
    v_mfma_f32_16x16x32_bf16 v[132:135], a[88:91], a[40:43], v[132:135]
    v_mfma_f32_16x16x32_bf16 v[164:167], a[88:91], a[44:47], v[164:167]
    v_mfma_f32_16x16x32_bf16 v[196:199], a[88:91], a[48:51], v[196:199]
    s_add_u32 s45, s42, s88
    buffer_load_dwordx4 a[0:3], v8, s[4:7], s45 offen
    v_mfma_f32_16x16x32_bf16 v[228:231], a[88:91], a[52:55], v[228:231]
    v_mfma_f32_16x16x32_bf16 v[40:43], a[92:95], a[28:31], v[40:43]
    v_mfma_f32_16x16x32_bf16 v[72:75], a[92:95], a[32:35], v[72:75]
    ds_read_b128 a[124:127], v15 offset:28672
    v_mfma_f32_16x16x32_bf16 v[104:107], a[92:95], a[36:39], v[104:107]
    v_mfma_f32_16x16x32_bf16 v[136:139], a[92:95], a[40:43], v[136:139]
    v_mfma_f32_16x16x32_bf16 v[168:171], a[92:95], a[44:47], v[168:171]
    v_mfma_f32_16x16x32_bf16 v[200:203], a[92:95], a[48:51], v[200:203]
    buffer_load_dwordx4 a[4:7], v9, s[4:7], s45 offen
    v_mfma_f32_16x16x32_bf16 v[232:235], a[92:95], a[52:55], v[232:235]
    v_mfma_f32_16x16x32_bf16 v[44:47], a[96:99], a[28:31], v[44:47]
    v_mfma_f32_16x16x32_bf16 v[76:79], a[96:99], a[32:35], v[76:79]
    ds_read_b128 a[128:131], v15 offset:43008
    v_mfma_f32_16x16x32_bf16 v[108:111], a[96:99], a[36:39], v[108:111]
    v_mfma_f32_16x16x32_bf16 v[140:143], a[96:99], a[40:43], v[140:143]
    v_mfma_f32_16x16x32_bf16 v[172:175], a[96:99], a[44:47], v[172:175]
    v_mfma_f32_16x16x32_bf16 v[204:207], a[96:99], a[48:51], v[204:207]
    buffer_load_dwordx4 a[8:11], v10, s[4:7], s45 offen
    v_mfma_f32_16x16x32_bf16 v[236:239], a[96:99], a[52:55], v[236:239]
    v_mfma_f32_16x16x32_bf16 v[48:51], a[100:103], a[28:31], v[48:51]
    v_mfma_f32_16x16x32_bf16 v[80:83], a[100:103], a[32:35], v[80:83]
    ds_read_b128 a[132:135], v16 offset:0
    v_mfma_f32_16x16x32_bf16 v[112:115], a[100:103], a[36:39], v[112:115]
    v_mfma_f32_16x16x32_bf16 v[144:147], a[100:103], a[40:43], v[144:147]
    v_mfma_f32_16x16x32_bf16 v[176:179], a[100:103], a[44:47], v[176:179]
    v_mfma_f32_16x16x32_bf16 v[208:211], a[100:103], a[48:51], v[208:211]
    buffer_load_dwordx4 a[12:15], v11, s[4:7], s45 offen
    v_mfma_f32_16x16x32_bf16 v[240:243], a[100:103], a[52:55], v[240:243]
    v_mfma_f32_16x16x32_bf16 v[52:55], a[104:107], a[28:31], v[52:55]
    v_mfma_f32_16x16x32_bf16 v[84:87], a[104:107], a[32:35], v[84:87]
    ds_read_b128 a[136:139], v16 offset:14336
    v_mfma_f32_16x16x32_bf16 v[116:119], a[104:107], a[36:39], v[116:119]
    v_mfma_f32_16x16x32_bf16 v[148:151], a[104:107], a[40:43], v[148:151]
    v_mfma_f32_16x16x32_bf16 v[180:183], a[104:107], a[44:47], v[180:183]
    v_mfma_f32_16x16x32_bf16 v[212:215], a[104:107], a[48:51], v[212:215]
    buffer_load_dwordx4 a[16:19], v12, s[4:7], s45 offen
    v_mfma_f32_16x16x32_bf16 v[244:247], a[104:107], a[52:55], v[244:247]
    v_mfma_f32_16x16x32_bf16 v[56:59], a[108:111], a[28:31], v[56:59]
    v_mfma_f32_16x16x32_bf16 v[88:91], a[108:111], a[32:35], v[88:91]
    ds_read_b128 a[140:143], v16 offset:28672
    v_mfma_f32_16x16x32_bf16 v[120:123], a[108:111], a[36:39], v[120:123]
    v_mfma_f32_16x16x32_bf16 v[152:155], a[108:111], a[40:43], v[152:155]
    v_mfma_f32_16x16x32_bf16 v[184:187], a[108:111], a[44:47], v[184:187]
    v_mfma_f32_16x16x32_bf16 v[216:219], a[108:111], a[48:51], v[216:219]
    buffer_load_dwordx4 a[20:23], v13, s[4:7], s45 offen
    v_mfma_f32_16x16x32_bf16 v[248:251], a[108:111], a[52:55], v[248:251]
    v_mfma_f32_16x16x32_bf16 v[60:63], a[112:115], a[28:31], v[60:63]
    v_mfma_f32_16x16x32_bf16 v[92:95], a[112:115], a[32:35], v[92:95]
    ds_read_b128 a[144:147], v16 offset:43008
    v_mfma_f32_16x16x32_bf16 v[124:127], a[112:115], a[36:39], v[124:127]
    v_mfma_f32_16x16x32_bf16 v[156:159], a[112:115], a[40:43], v[156:159]
    v_mfma_f32_16x16x32_bf16 v[188:191], a[112:115], a[44:47], v[188:191]
    v_mfma_f32_16x16x32_bf16 v[220:223], a[112:115], a[48:51], v[220:223]
    buffer_load_dwordx4 a[24:27], v14, s[4:7], s45 offen
    v_mfma_f32_16x16x32_bf16 v[252:255], a[112:115], a[52:55], v[252:255]
    v_add_u32 v15, s88, v2
    v_add_u32 v16, 57344, v15
    s_waitcnt vmcnt(7) lgkmcnt(0)
    s_barrier
    v_mfma_f32_16x16x32_bf16 v[32:35], a[116:119], a[56:59], v[32:35]
    v_mfma_f32_16x16x32_bf16 v[64:67], a[116:119], a[60:63], v[64:67]
    ds_read_b128 a[84:87], v15 offset:0
    v_mfma_f32_16x16x32_bf16 v[96:99], a[116:119], a[64:67], v[96:99]
    v_mfma_f32_16x16x32_bf16 v[128:131], a[116:119], a[68:71], v[128:131]
    v_mfma_f32_16x16x32_bf16 v[160:163], a[116:119], a[72:75], v[160:163]
    v_mfma_f32_16x16x32_bf16 v[192:195], a[116:119], a[76:79], v[192:195]
    v_mfma_f32_16x16x32_bf16 v[224:227], a[116:119], a[80:83], v[224:227]
    v_mfma_f32_16x16x32_bf16 v[36:39], a[120:123], a[56:59], v[36:39]
    v_mfma_f32_16x16x32_bf16 v[68:71], a[120:123], a[60:63], v[68:71]
    ds_read_b128 a[88:91], v15 offset:14336
    v_mfma_f32_16x16x32_bf16 v[100:103], a[120:123], a[64:67], v[100:103]
    v_mfma_f32_16x16x32_bf16 v[132:135], a[120:123], a[68:71], v[132:135]
    v_mfma_f32_16x16x32_bf16 v[164:167], a[120:123], a[72:75], v[164:167]
    v_mfma_f32_16x16x32_bf16 v[196:199], a[120:123], a[76:79], v[196:199]
    s_add_u32 s45, s42, s89
    buffer_load_dwordx4 a[28:31], v8, s[4:7], s45 offen
    v_mfma_f32_16x16x32_bf16 v[228:231], a[120:123], a[80:83], v[228:231]
    v_mfma_f32_16x16x32_bf16 v[40:43], a[124:127], a[56:59], v[40:43]
    v_mfma_f32_16x16x32_bf16 v[72:75], a[124:127], a[60:63], v[72:75]
    ds_read_b128 a[92:95], v15 offset:28672
    v_mfma_f32_16x16x32_bf16 v[104:107], a[124:127], a[64:67], v[104:107]
    v_mfma_f32_16x16x32_bf16 v[136:139], a[124:127], a[68:71], v[136:139]
    v_mfma_f32_16x16x32_bf16 v[168:171], a[124:127], a[72:75], v[168:171]
    v_mfma_f32_16x16x32_bf16 v[200:203], a[124:127], a[76:79], v[200:203]
    buffer_load_dwordx4 a[32:35], v9, s[4:7], s45 offen
    v_mfma_f32_16x16x32_bf16 v[232:235], a[124:127], a[80:83], v[232:235]
    v_mfma_f32_16x16x32_bf16 v[44:47], a[128:131], a[56:59], v[44:47]
    v_mfma_f32_16x16x32_bf16 v[76:79], a[128:131], a[60:63], v[76:79]
    ds_read_b128 a[96:99], v15 offset:43008
    v_mfma_f32_16x16x32_bf16 v[108:111], a[128:131], a[64:67], v[108:111]
    v_mfma_f32_16x16x32_bf16 v[140:143], a[128:131], a[68:71], v[140:143]
    v_mfma_f32_16x16x32_bf16 v[172:175], a[128:131], a[72:75], v[172:175]
    v_mfma_f32_16x16x32_bf16 v[204:207], a[128:131], a[76:79], v[204:207]
    buffer_load_dwordx4 a[36:39], v10, s[4:7], s45 offen
    v_mfma_f32_16x16x32_bf16 v[236:239], a[128:131], a[80:83], v[236:239]
    v_mfma_f32_16x16x32_bf16 v[48:51], a[132:135], a[56:59], v[48:51]
    v_mfma_f32_16x16x32_bf16 v[80:83], a[132:135], a[60:63], v[80:83]
    ds_read_b128 a[100:103], v16 offset:0
    v_mfma_f32_16x16x32_bf16 v[112:115], a[132:135], a[64:67], v[112:115]
    v_mfma_f32_16x16x32_bf16 v[144:147], a[132:135], a[68:71], v[144:147]
    v_mfma_f32_16x16x32_bf16 v[176:179], a[132:135], a[72:75], v[176:179]
    v_mfma_f32_16x16x32_bf16 v[208:211], a[132:135], a[76:79], v[208:211]
    buffer_load_dwordx4 a[40:43], v11, s[4:7], s45 offen
    v_mfma_f32_16x16x32_bf16 v[240:243], a[132:135], a[80:83], v[240:243]
    v_mfma_f32_16x16x32_bf16 v[52:55], a[136:139], a[56:59], v[52:55]
    v_mfma_f32_16x16x32_bf16 v[84:87], a[136:139], a[60:63], v[84:87]
    ds_read_b128 a[104:107], v16 offset:14336
    v_mfma_f32_16x16x32_bf16 v[116:119], a[136:139], a[64:67], v[116:119]
    v_mfma_f32_16x16x32_bf16 v[148:151], a[136:139], a[68:71], v[148:151]
    v_mfma_f32_16x16x32_bf16 v[180:183], a[136:139], a[72:75], v[180:183]
    v_mfma_f32_16x16x32_bf16 v[212:215], a[136:139], a[76:79], v[212:215]
    buffer_load_dwordx4 a[44:47], v12, s[4:7], s45 offen
    v_mfma_f32_16x16x32_bf16 v[244:247], a[136:139], a[80:83], v[244:247]
    v_mfma_f32_16x16x32_bf16 v[56:59], a[140:143], a[56:59], v[56:59]
    v_mfma_f32_16x16x32_bf16 v[88:91], a[140:143], a[60:63], v[88:91]
    ds_read_b128 a[108:111], v16 offset:28672
    v_mfma_f32_16x16x32_bf16 v[120:123], a[140:143], a[64:67], v[120:123]
    v_mfma_f32_16x16x32_bf16 v[152:155], a[140:143], a[68:71], v[152:155]
    v_mfma_f32_16x16x32_bf16 v[184:187], a[140:143], a[72:75], v[184:187]
    v_mfma_f32_16x16x32_bf16 v[216:219], a[140:143], a[76:79], v[216:219]
    buffer_load_dwordx4 a[48:51], v13, s[4:7], s45 offen
    v_mfma_f32_16x16x32_bf16 v[248:251], a[140:143], a[80:83], v[248:251]
    v_mfma_f32_16x16x32_bf16 v[60:63], a[144:147], a[56:59], v[60:63]
    v_mfma_f32_16x16x32_bf16 v[92:95], a[144:147], a[60:63], v[92:95]
    ds_read_b128 a[112:115], v16 offset:43008
    v_mfma_f32_16x16x32_bf16 v[124:127], a[144:147], a[64:67], v[124:127]
    v_mfma_f32_16x16x32_bf16 v[156:159], a[144:147], a[68:71], v[156:159]
    v_mfma_f32_16x16x32_bf16 v[188:191], a[144:147], a[72:75], v[188:191]
    v_mfma_f32_16x16x32_bf16 v[220:223], a[144:147], a[76:79], v[220:223]
    buffer_load_dwordx4 a[52:55], v14, s[4:7], s45 offen
    v_mfma_f32_16x16x32_bf16 v[252:255], a[144:147], a[80:83], v[252:255]
    v_add_u32 v15, s89, v2
    v_add_u32 v16, 57344, v15
    s_waitcnt vmcnt(7) lgkmcnt(0)
    s_barrier
    v_mfma_f32_16x16x32_bf16 v[32:35], a[84:87], a[0:3], v[32:35]
    v_mfma_f32_16x16x32_bf16 v[64:67], a[84:87], a[4:7], v[64:67]
    ds_read_b128 a[116:119], v15 offset:0
    v_mfma_f32_16x16x32_bf16 v[96:99], a[84:87], a[8:11], v[96:99]
    v_mfma_f32_16x16x32_bf16 v[128:131], a[84:87], a[12:15], v[128:131]
    v_mfma_f32_16x16x32_bf16 v[160:163], a[84:87], a[16:19], v[160:163]
    v_mfma_f32_16x16x32_bf16 v[192:195], a[84:87], a[20:23], v[192:195]
    v_mfma_f32_16x16x32_bf16 v[224:227], a[84:87], a[24:27], v[224:227]
    v_mfma_f32_16x16x32_bf16 v[36:39], a[88:91], a[0:3], v[36:39]
    v_mfma_f32_16x16x32_bf16 v[68:71], a[88:91], a[4:7], v[68:71]
    ds_read_b128 a[120:123], v15 offset:14336
    v_mfma_f32_16x16x32_bf16 v[100:103], a[88:91], a[8:11], v[100:103]
    v_mfma_f32_16x16x32_bf16 v[132:135], a[88:91], a[12:15], v[132:135]
    v_mfma_f32_16x16x32_bf16 v[164:167], a[88:91], a[16:19], v[164:167]
    v_mfma_f32_16x16x32_bf16 v[196:199], a[88:91], a[20:23], v[196:199]
    v_mfma_f32_16x16x32_bf16 v[228:231], a[88:91], a[24:27], v[228:231]
    v_mfma_f32_16x16x32_bf16 v[40:43], a[92:95], a[0:3], v[40:43]
    v_mfma_f32_16x16x32_bf16 v[72:75], a[92:95], a[4:7], v[72:75]
    ds_read_b128 a[124:127], v15 offset:28672
    v_mfma_f32_16x16x32_bf16 v[104:107], a[92:95], a[8:11], v[104:107]
    v_mfma_f32_16x16x32_bf16 v[136:139], a[92:95], a[12:15], v[136:139]
    v_mfma_f32_16x16x32_bf16 v[168:171], a[92:95], a[16:19], v[168:171]
    v_mfma_f32_16x16x32_bf16 v[200:203], a[92:95], a[20:23], v[200:203]
    v_mfma_f32_16x16x32_bf16 v[232:235], a[92:95], a[24:27], v[232:235]
    v_mfma_f32_16x16x32_bf16 v[44:47], a[96:99], a[0:3], v[44:47]
    v_mfma_f32_16x16x32_bf16 v[76:79], a[96:99], a[4:7], v[76:79]
    ds_read_b128 a[128:131], v15 offset:43008
    v_mfma_f32_16x16x32_bf16 v[108:111], a[96:99], a[8:11], v[108:111]
    v_mfma_f32_16x16x32_bf16 v[140:143], a[96:99], a[12:15], v[140:143]
    v_mfma_f32_16x16x32_bf16 v[172:175], a[96:99], a[16:19], v[172:175]
    v_mfma_f32_16x16x32_bf16 v[204:207], a[96:99], a[20:23], v[204:207]
    v_mfma_f32_16x16x32_bf16 v[236:239], a[96:99], a[24:27], v[236:239]
    v_mfma_f32_16x16x32_bf16 v[48:51], a[100:103], a[0:3], v[48:51]
    v_mfma_f32_16x16x32_bf16 v[80:83], a[100:103], a[4:7], v[80:83]
    ds_read_b128 a[132:135], v16 offset:0
    v_mfma_f32_16x16x32_bf16 v[112:115], a[100:103], a[8:11], v[112:115]
    v_mfma_f32_16x16x32_bf16 v[144:147], a[100:103], a[12:15], v[144:147]
    v_mfma_f32_16x16x32_bf16 v[176:179], a[100:103], a[16:19], v[176:179]
    v_mfma_f32_16x16x32_bf16 v[208:211], a[100:103], a[20:23], v[208:211]
    v_mfma_f32_16x16x32_bf16 v[240:243], a[100:103], a[24:27], v[240:243]
    v_mfma_f32_16x16x32_bf16 v[52:55], a[104:107], a[0:3], v[52:55]
    v_mfma_f32_16x16x32_bf16 v[84:87], a[104:107], a[4:7], v[84:87]
    ds_read_b128 a[136:139], v16 offset:14336
    v_mfma_f32_16x16x32_bf16 v[116:119], a[104:107], a[8:11], v[116:119]
    v_mfma_f32_16x16x32_bf16 v[148:151], a[104:107], a[12:15], v[148:151]
    v_mfma_f32_16x16x32_bf16 v[180:183], a[104:107], a[16:19], v[180:183]
    v_mfma_f32_16x16x32_bf16 v[212:215], a[104:107], a[20:23], v[212:215]
    v_mfma_f32_16x16x32_bf16 v[244:247], a[104:107], a[24:27], v[244:247]
    v_mfma_f32_16x16x32_bf16 v[56:59], a[108:111], a[0:3], v[56:59]
    v_mfma_f32_16x16x32_bf16 v[88:91], a[108:111], a[4:7], v[88:91]
    ds_read_b128 a[140:143], v16 offset:28672
    v_mfma_f32_16x16x32_bf16 v[120:123], a[108:111], a[8:11], v[120:123]
    v_mfma_f32_16x16x32_bf16 v[152:155], a[108:111], a[12:15], v[152:155]
    v_mfma_f32_16x16x32_bf16 v[184:187], a[108:111], a[16:19], v[184:187]
    v_mfma_f32_16x16x32_bf16 v[216:219], a[108:111], a[20:23], v[216:219]
    v_mfma_f32_16x16x32_bf16 v[248:251], a[108:111], a[24:27], v[248:251]
    v_mfma_f32_16x16x32_bf16 v[60:63], a[112:115], a[0:3], v[60:63]
    v_mfma_f32_16x16x32_bf16 v[92:95], a[112:115], a[4:7], v[92:95]
    ds_read_b128 a[144:147], v16 offset:43008
    v_mfma_f32_16x16x32_bf16 v[124:127], a[112:115], a[8:11], v[124:127]
    v_mfma_f32_16x16x32_bf16 v[156:159], a[112:115], a[12:15], v[156:159]
    v_mfma_f32_16x16x32_bf16 v[188:191], a[112:115], a[16:19], v[188:191]
    v_mfma_f32_16x16x32_bf16 v[220:223], a[112:115], a[20:23], v[220:223]
    v_mfma_f32_16x16x32_bf16 v[252:255], a[112:115], a[24:27], v[252:255]
    s_waitcnt vmcnt(0) lgkmcnt(0)
    v_mfma_f32_16x16x32_bf16 v[32:35], a[116:119], a[28:31], v[32:35]
    v_mfma_f32_16x16x32_bf16 v[64:67], a[116:119], a[32:35], v[64:67]
    v_mfma_f32_16x16x32_bf16 v[96:99], a[116:119], a[36:39], v[96:99]
    v_mfma_f32_16x16x32_bf16 v[128:131], a[116:119], a[40:43], v[128:131]
    v_mfma_f32_16x16x32_bf16 v[160:163], a[116:119], a[44:47], v[160:163]
    v_mfma_f32_16x16x32_bf16 v[192:195], a[116:119], a[48:51], v[192:195]
    v_mfma_f32_16x16x32_bf16 v[224:227], a[116:119], a[52:55], v[224:227]
    v_mfma_f32_16x16x32_bf16 v[36:39], a[120:123], a[28:31], v[36:39]
    v_mfma_f32_16x16x32_bf16 v[68:71], a[120:123], a[32:35], v[68:71]
    v_mfma_f32_16x16x32_bf16 v[100:103], a[120:123], a[36:39], v[100:103]
    v_mfma_f32_16x16x32_bf16 v[132:135], a[120:123], a[40:43], v[132:135]
    v_mfma_f32_16x16x32_bf16 v[164:167], a[120:123], a[44:47], v[164:167]
    v_mfma_f32_16x16x32_bf16 v[196:199], a[120:123], a[48:51], v[196:199]
    v_mfma_f32_16x16x32_bf16 v[228:231], a[120:123], a[52:55], v[228:231]
    v_mfma_f32_16x16x32_bf16 v[40:43], a[124:127], a[28:31], v[40:43]
    v_mfma_f32_16x16x32_bf16 v[72:75], a[124:127], a[32:35], v[72:75]
    v_mfma_f32_16x16x32_bf16 v[104:107], a[124:127], a[36:39], v[104:107]
    v_mfma_f32_16x16x32_bf16 v[136:139], a[124:127], a[40:43], v[136:139]
    v_mfma_f32_16x16x32_bf16 v[168:171], a[124:127], a[44:47], v[168:171]
    v_mfma_f32_16x16x32_bf16 v[200:203], a[124:127], a[48:51], v[200:203]
    v_mfma_f32_16x16x32_bf16 v[232:235], a[124:127], a[52:55], v[232:235]
    v_mfma_f32_16x16x32_bf16 v[44:47], a[128:131], a[28:31], v[44:47]
    v_mfma_f32_16x16x32_bf16 v[76:79], a[128:131], a[32:35], v[76:79]
    v_mfma_f32_16x16x32_bf16 v[108:111], a[128:131], a[36:39], v[108:111]
    v_mfma_f32_16x16x32_bf16 v[140:143], a[128:131], a[40:43], v[140:143]
    v_mfma_f32_16x16x32_bf16 v[172:175], a[128:131], a[44:47], v[172:175]
    v_mfma_f32_16x16x32_bf16 v[204:207], a[128:131], a[48:51], v[204:207]
    v_mfma_f32_16x16x32_bf16 v[236:239], a[128:131], a[52:55], v[236:239]
    v_mfma_f32_16x16x32_bf16 v[48:51], a[132:135], a[28:31], v[48:51]
    v_mfma_f32_16x16x32_bf16 v[80:83], a[132:135], a[32:35], v[80:83]
    v_mfma_f32_16x16x32_bf16 v[112:115], a[132:135], a[36:39], v[112:115]
    v_mfma_f32_16x16x32_bf16 v[144:147], a[132:135], a[40:43], v[144:147]
    v_mfma_f32_16x16x32_bf16 v[176:179], a[132:135], a[44:47], v[176:179]
    v_mfma_f32_16x16x32_bf16 v[208:211], a[132:135], a[48:51], v[208:211]
    v_mfma_f32_16x16x32_bf16 v[240:243], a[132:135], a[52:55], v[240:243]
    v_mfma_f32_16x16x32_bf16 v[52:55], a[136:139], a[28:31], v[52:55]
    v_mfma_f32_16x16x32_bf16 v[84:87], a[136:139], a[32:35], v[84:87]
    v_mfma_f32_16x16x32_bf16 v[116:119], a[136:139], a[36:39], v[116:119]
    v_mfma_f32_16x16x32_bf16 v[148:151], a[136:139], a[40:43], v[148:151]
    v_mfma_f32_16x16x32_bf16 v[180:183], a[136:139], a[44:47], v[180:183]
    v_mfma_f32_16x16x32_bf16 v[212:215], a[136:139], a[48:51], v[212:215]
    v_mfma_f32_16x16x32_bf16 v[244:247], a[136:139], a[52:55], v[244:247]
    v_mfma_f32_16x16x32_bf16 v[56:59], a[140:143], a[28:31], v[56:59]
    v_mfma_f32_16x16x32_bf16 v[88:91], a[140:143], a[32:35], v[88:91]
    v_mfma_f32_16x16x32_bf16 v[120:123], a[140:143], a[36:39], v[120:123]
    v_mfma_f32_16x16x32_bf16 v[152:155], a[140:143], a[40:43], v[152:155]
    v_mfma_f32_16x16x32_bf16 v[184:187], a[140:143], a[44:47], v[184:187]
    v_mfma_f32_16x16x32_bf16 v[216:219], a[140:143], a[48:51], v[216:219]
    v_mfma_f32_16x16x32_bf16 v[248:251], a[140:143], a[52:55], v[248:251]
    v_mfma_f32_16x16x32_bf16 v[60:63], a[144:147], a[28:31], v[60:63]
    v_mfma_f32_16x16x32_bf16 v[92:95], a[144:147], a[32:35], v[92:95]
    v_mfma_f32_16x16x32_bf16 v[124:127], a[144:147], a[36:39], v[124:127]
    v_mfma_f32_16x16x32_bf16 v[156:159], a[144:147], a[40:43], v[156:159]
    v_mfma_f32_16x16x32_bf16 v[188:191], a[144:147], a[44:47], v[188:191]
    v_mfma_f32_16x16x32_bf16 v[220:223], a[144:147], a[48:51], v[220:223]
    v_mfma_f32_16x16x32_bf16 v[252:255], a[144:147], a[52:55], v[252:255]
    s_mul_i32 s40, s61, 1835008
    s_lshl_b32 s41, s60, 11
    s_add_u32 s40, s40, s41
    s_add_u32 s40, s40, 18350080
    s_mul_i32 s41, s13, 7
    s_add_u32 s42, s41, 0
    s_lshr_b32 s43, s42, 1
    s_lshl_b32 s43, s43, 15
    s_and_b32 s42, s42, 1
    s_lshl_b32 s42, s42, 10
    s_add_u32 s44, s40, s43
    s_add_u32 s44, s44, s42
    s_add_u32 s42, s41, 1
    s_lshr_b32 s43, s42, 1
    s_lshl_b32 s43, s43, 15
    s_and_b32 s42, s42, 1
    s_lshl_b32 s42, s42, 10
    s_add_u32 s45, s40, s43
    s_add_u32 s45, s45, s42
    s_add_u32 s42, s41, 2
    s_lshr_b32 s43, s42, 1
    s_lshl_b32 s43, s43, 15
    s_and_b32 s42, s42, 1
    s_lshl_b32 s42, s42, 10
    s_add_u32 s46, s40, s43
    s_add_u32 s46, s46, s42
    s_add_u32 s42, s41, 3
    s_lshr_b32 s43, s42, 1
    s_lshl_b32 s43, s43, 15
    s_and_b32 s42, s42, 1
    s_lshl_b32 s42, s42, 10
    s_add_u32 s47, s40, s43
    s_add_u32 s47, s47, s42
    s_add_u32 s42, s41, 4
    s_lshr_b32 s43, s42, 1
    s_lshl_b32 s43, s43, 15
    s_and_b32 s42, s42, 1
    s_lshl_b32 s42, s42, 10
    s_add_u32 s48, s40, s43
    s_add_u32 s48, s48, s42
    s_add_u32 s42, s41, 5
    s_lshr_b32 s43, s42, 1
    s_lshl_b32 s43, s43, 15
    s_and_b32 s42, s42, 1
    s_lshl_b32 s42, s42, 10
    s_add_u32 s49, s40, s43
    s_add_u32 s49, s49, s42
    s_add_u32 s42, s41, 6
    s_lshr_b32 s43, s42, 1
    s_lshl_b32 s43, s43, 15
    s_and_b32 s42, s42, 1
    s_lshl_b32 s42, s42, 10
    s_add_u32 s50, s40, s43
    s_add_u32 s50, s50, s42
    s_cmp_lt_u32 s61, 1
    s_cbranch_scc1 Luw_1
    s_lshl_b32 s40, s61, 7
    s_add_u32 s40, s40, 67678080
    s_cmp_lg_u32 s13, 0
    s_cbranch_scc1 Lw1d_3
    s_mov_b32 s20, 0
Lw1_2:
    buffer_load_dword v16, off, s[4:7], s40 sc1
    s_add_u32 s20, s20, 1
    s_cmp_gt_u32 s20, s23
    s_cbranch_scc1 L_fail
    s_waitcnt vmcnt(0)
    v_cmp_le_u32 vcc, 32, v16
    s_cbranch_vccnz Lw1d_3
    s_sleep 8
    s_branch Lw1_2
Lw1d_3:
    s_barrier
Luw_1:
    v_cvt_pk_bf16_f32 v32, v32, v33
    v_cvt_pk_bf16_f32 v33, v34, v35
    v_cvt_pk_bf16_f32 v34, v36, v37
    v_cvt_pk_bf16_f32 v35, v38, v39
    buffer_store_dwordx4 v[32:35], v2, s[4:7], s44 offen sc1
    s_add_u32 s44, s44, 458752
    v_cvt_pk_bf16_f32 v64, v64, v65
    v_cvt_pk_bf16_f32 v65, v66, v67
    v_cvt_pk_bf16_f32 v66, v68, v69
    v_cvt_pk_bf16_f32 v67, v70, v71
    buffer_store_dwordx4 v[64:67], v2, s[4:7], s45 offen sc1
    s_add_u32 s45, s45, 458752
    v_cvt_pk_bf16_f32 v96, v96, v97
    v_cvt_pk_bf16_f32 v97, v98, v99
    v_cvt_pk_bf16_f32 v98, v100, v101
    v_cvt_pk_bf16_f32 v99, v102, v103
    buffer_store_dwordx4 v[96:99], v2, s[4:7], s46 offen sc1
    s_add_u32 s46, s46, 458752
    v_cvt_pk_bf16_f32 v128, v128, v129
    v_cvt_pk_bf16_f32 v129, v130, v131
    v_cvt_pk_bf16_f32 v130, v132, v133
    v_cvt_pk_bf16_f32 v131, v134, v135
    buffer_store_dwordx4 v[128:131], v2, s[4:7], s47 offen sc1
    s_add_u32 s47, s47, 458752
    v_cvt_pk_bf16_f32 v160, v160, v161
    v_cvt_pk_bf16_f32 v161, v162, v163
    v_cvt_pk_bf16_f32 v162, v164, v165
    v_cvt_pk_bf16_f32 v163, v166, v167
    buffer_store_dwordx4 v[160:163], v2, s[4:7], s48 offen sc1
    s_add_u32 s48, s48, 458752
    v_cvt_pk_bf16_f32 v192, v192, v193
    v_cvt_pk_bf16_f32 v193, v194, v195
    v_cvt_pk_bf16_f32 v194, v196, v197
    v_cvt_pk_bf16_f32 v195, v198, v199
    buffer_store_dwordx4 v[192:195], v2, s[4:7], s49 offen sc1
    s_add_u32 s49, s49, 458752
    v_cvt_pk_bf16_f32 v224, v224, v225
    v_cvt_pk_bf16_f32 v225, v226, v227
    v_cvt_pk_bf16_f32 v226, v228, v229
    v_cvt_pk_bf16_f32 v227, v230, v231
    buffer_store_dwordx4 v[224:227], v2, s[4:7], s50 offen sc1
    s_add_u32 s50, s50, 458752
    v_cvt_pk_bf16_f32 v40, v40, v41
    v_cvt_pk_bf16_f32 v41, v42, v43
    v_cvt_pk_bf16_f32 v42, v44, v45
    v_cvt_pk_bf16_f32 v43, v46, v47
    buffer_store_dwordx4 v[40:43], v2, s[4:7], s44 offen sc1
    s_add_u32 s44, s44, 458752
    v_cvt_pk_bf16_f32 v72, v72, v73
    v_cvt_pk_bf16_f32 v73, v74, v75
    v_cvt_pk_bf16_f32 v74, v76, v77
    v_cvt_pk_bf16_f32 v75, v78, v79
    buffer_store_dwordx4 v[72:75], v2, s[4:7], s45 offen sc1
    s_add_u32 s45, s45, 458752
    v_cvt_pk_bf16_f32 v104, v104, v105
    v_cvt_pk_bf16_f32 v105, v106, v107
    v_cvt_pk_bf16_f32 v106, v108, v109
    v_cvt_pk_bf16_f32 v107, v110, v111
    buffer_store_dwordx4 v[104:107], v2, s[4:7], s46 offen sc1
    s_add_u32 s46, s46, 458752
    v_cvt_pk_bf16_f32 v136, v136, v137
    v_cvt_pk_bf16_f32 v137, v138, v139
    v_cvt_pk_bf16_f32 v138, v140, v141
    v_cvt_pk_bf16_f32 v139, v142, v143
    buffer_store_dwordx4 v[136:139], v2, s[4:7], s47 offen sc1
    s_add_u32 s47, s47, 458752
    v_cvt_pk_bf16_f32 v168, v168, v169
    v_cvt_pk_bf16_f32 v169, v170, v171
    v_cvt_pk_bf16_f32 v170, v172, v173
    v_cvt_pk_bf16_f32 v171, v174, v175
    buffer_store_dwordx4 v[168:171], v2, s[4:7], s48 offen sc1
    s_add_u32 s48, s48, 458752
    v_cvt_pk_bf16_f32 v200, v200, v201
    v_cvt_pk_bf16_f32 v201, v202, v203
    v_cvt_pk_bf16_f32 v202, v204, v205
    v_cvt_pk_bf16_f32 v203, v206, v207
    buffer_store_dwordx4 v[200:203], v2, s[4:7], s49 offen sc1
    s_add_u32 s49, s49, 458752
    v_cvt_pk_bf16_f32 v232, v232, v233
    v_cvt_pk_bf16_f32 v233, v234, v235
    v_cvt_pk_bf16_f32 v234, v236, v237
    v_cvt_pk_bf16_f32 v235, v238, v239
    buffer_store_dwordx4 v[232:235], v2, s[4:7], s50 offen sc1
    s_add_u32 s50, s50, 458752
    v_cvt_pk_bf16_f32 v48, v48, v49
    v_cvt_pk_bf16_f32 v49, v50, v51
    v_cvt_pk_bf16_f32 v50, v52, v53
    v_cvt_pk_bf16_f32 v51, v54, v55
    buffer_store_dwordx4 v[48:51], v2, s[4:7], s44 offen sc1
    s_add_u32 s44, s44, 458752
    v_cvt_pk_bf16_f32 v80, v80, v81
    v_cvt_pk_bf16_f32 v81, v82, v83
    v_cvt_pk_bf16_f32 v82, v84, v85
    v_cvt_pk_bf16_f32 v83, v86, v87
    buffer_store_dwordx4 v[80:83], v2, s[4:7], s45 offen sc1
    s_add_u32 s45, s45, 458752
    v_cvt_pk_bf16_f32 v112, v112, v113
    v_cvt_pk_bf16_f32 v113, v114, v115
    v_cvt_pk_bf16_f32 v114, v116, v117
    v_cvt_pk_bf16_f32 v115, v118, v119
    buffer_store_dwordx4 v[112:115], v2, s[4:7], s46 offen sc1
    s_add_u32 s46, s46, 458752
    v_cvt_pk_bf16_f32 v144, v144, v145
    v_cvt_pk_bf16_f32 v145, v146, v147
    v_cvt_pk_bf16_f32 v146, v148, v149
    v_cvt_pk_bf16_f32 v147, v150, v151
    buffer_store_dwordx4 v[144:147], v2, s[4:7], s47 offen sc1
    s_add_u32 s47, s47, 458752
    v_cvt_pk_bf16_f32 v176, v176, v177
    v_cvt_pk_bf16_f32 v177, v178, v179
    v_cvt_pk_bf16_f32 v178, v180, v181
    v_cvt_pk_bf16_f32 v179, v182, v183
    buffer_store_dwordx4 v[176:179], v2, s[4:7], s48 offen sc1
    s_add_u32 s48, s48, 458752
    v_cvt_pk_bf16_f32 v208, v208, v209
    v_cvt_pk_bf16_f32 v209, v210, v211
    v_cvt_pk_bf16_f32 v210, v212, v213
    v_cvt_pk_bf16_f32 v211, v214, v215
    buffer_store_dwordx4 v[208:211], v2, s[4:7], s49 offen sc1
    s_add_u32 s49, s49, 458752
    v_cvt_pk_bf16_f32 v240, v240, v241
    v_cvt_pk_bf16_f32 v241, v242, v243
    v_cvt_pk_bf16_f32 v242, v244, v245
    v_cvt_pk_bf16_f32 v243, v246, v247
    buffer_store_dwordx4 v[240:243], v2, s[4:7], s50 offen sc1
    s_add_u32 s50, s50, 458752
    v_cvt_pk_bf16_f32 v56, v56, v57
    v_cvt_pk_bf16_f32 v57, v58, v59
    v_cvt_pk_bf16_f32 v58, v60, v61
    v_cvt_pk_bf16_f32 v59, v62, v63
    buffer_store_dwordx4 v[56:59], v2, s[4:7], s44 offen sc1
    s_add_u32 s44, s44, 458752
    v_cvt_pk_bf16_f32 v88, v88, v89
    v_cvt_pk_bf16_f32 v89, v90, v91
    v_cvt_pk_bf16_f32 v90, v92, v93
    v_cvt_pk_bf16_f32 v91, v94, v95
    buffer_store_dwordx4 v[88:91], v2, s[4:7], s45 offen sc1
    s_add_u32 s45, s45, 458752
    v_cvt_pk_bf16_f32 v120, v120, v121
    v_cvt_pk_bf16_f32 v121, v122, v123
    v_cvt_pk_bf16_f32 v122, v124, v125
    v_cvt_pk_bf16_f32 v123, v126, v127
    buffer_store_dwordx4 v[120:123], v2, s[4:7], s46 offen sc1
    s_add_u32 s46, s46, 458752
    v_cvt_pk_bf16_f32 v152, v152, v153
    v_cvt_pk_bf16_f32 v153, v154, v155
    v_cvt_pk_bf16_f32 v154, v156, v157
    v_cvt_pk_bf16_f32 v155, v158, v159
    buffer_store_dwordx4 v[152:155], v2, s[4:7], s47 offen sc1
    s_add_u32 s47, s47, 458752
    v_cvt_pk_bf16_f32 v184, v184, v185
    v_cvt_pk_bf16_f32 v185, v186, v187
    v_cvt_pk_bf16_f32 v186, v188, v189
    v_cvt_pk_bf16_f32 v187, v190, v191
    buffer_store_dwordx4 v[184:187], v2, s[4:7], s48 offen sc1
    s_add_u32 s48, s48, 458752
    v_cvt_pk_bf16_f32 v216, v216, v217
    v_cvt_pk_bf16_f32 v217, v218, v219
    v_cvt_pk_bf16_f32 v218, v220, v221
    v_cvt_pk_bf16_f32 v219, v222, v223
    buffer_store_dwordx4 v[216:219], v2, s[4:7], s49 offen sc1
    s_add_u32 s49, s49, 458752
    v_cvt_pk_bf16_f32 v248, v248, v249
    v_cvt_pk_bf16_f32 v249, v250, v251
    v_cvt_pk_bf16_f32 v250, v252, v253
    v_cvt_pk_bf16_f32 v251, v254, v255
    buffer_store_dwordx4 v[248:251], v2, s[4:7], s50 offen sc1
    s_add_u32 s50, s50, 458752
    s_lshl_b32 s40, s61, 7
    s_add_u32 s40, s40, 67678208
    s_waitcnt vmcnt(0)
    s_barrier
    s_cmp_lg_u32 s13, 0
    s_cbranch_scc1 Lsg_5
    s_mov_b64 exec, 1
    v_mov_b32 v3, 2
    buffer_atomic_add v3, off, s[4:7], s40
    s_mov_b64 exec, -1
Lsg_5:
    s_branch W_next
T_Uh:
    s_mul_i32 s59, s61, 7
    s_mul_i32 s41, s13, 14336
    s_mul_i32 s40, s61, 57344
    s_add_u32 s40, s40, s41
    s_add_u32 s40, s40, 12845056
    s_mul_i32 s42, s60, 401408
    s_mul_i32 s43, s13, 100352
    s_add_u32 s42, s42, s43
    s_add_u32 s42, s42, 6422528
    s_add_u32 s76, s59, 0
    s_sub_u32 s43, s76, 14
    s_cmp_ge_u32 s76, 14
    s_cselect_b32 s76, s43, s76
    s_lshl_b32 s76, s76, 10
    s_add_u32 s77, s59, 1
    s_sub_u32 s43, s77, 14
    s_cmp_ge_u32 s77, 14
    s_cselect_b32 s77, s43, s77
    s_lshl_b32 s77, s77, 10
    s_add_u32 s78, s59, 2
    s_sub_u32 s43, s78, 14
    s_cmp_ge_u32 s78, 14
    s_cselect_b32 s78, s43, s78
    s_lshl_b32 s78, s78, 10
    s_add_u32 s79, s59, 3
    s_sub_u32 s43, s79, 14
    s_cmp_ge_u32 s79, 14
    s_cselect_b32 s79, s43, s79
    s_lshl_b32 s79, s79, 10
    s_add_u32 s80, s59, 4
    s_sub_u32 s43, s80, 14
    s_cmp_ge_u32 s80, 14
    s_cselect_b32 s80, s43, s80
    s_lshl_b32 s80, s80, 10
    s_add_u32 s81, s59, 5
    s_sub_u32 s43, s81, 14
    s_cmp_ge_u32 s81, 14
    s_cselect_b32 s81, s43, s81
    s_lshl_b32 s81, s81, 10
    s_add_u32 s82, s59, 6
    s_sub_u32 s43, s82, 14
    s_cmp_ge_u32 s82, 14
    s_cselect_b32 s82, s43, s82
    s_lshl_b32 s82, s82, 10
    s_add_u32 s83, s59, 7
    s_sub_u32 s43, s83, 14
    s_cmp_ge_u32 s83, 14
    s_cselect_b32 s83, s43, s83
    s_lshl_b32 s83, s83, 10
    s_add_u32 s84, s59, 8
    s_sub_u32 s43, s84, 14
    s_cmp_ge_u32 s84, 14
    s_cselect_b32 s84, s43, s84
    s_lshl_b32 s84, s84, 10
    s_add_u32 s85, s59, 9
    s_sub_u32 s43, s85, 14
    s_cmp_ge_u32 s85, 14
    s_cselect_b32 s85, s43, s85
    s_lshl_b32 s85, s85, 10
    s_add_u32 s86, s59, 10
    s_sub_u32 s43, s86, 14
    s_cmp_ge_u32 s86, 14
    s_cselect_b32 s86, s43, s86
    s_lshl_b32 s86, s86, 10
    s_add_u32 s87, s59, 11
    s_sub_u32 s43, s87, 14
    s_cmp_ge_u32 s87, 14
    s_cselect_b32 s87, s43, s87
    s_lshl_b32 s87, s87, 10
    s_add_u32 s88, s59, 12
    s_sub_u32 s43, s88, 14
    s_cmp_ge_u32 s88, 14
    s_cselect_b32 s88, s43, s88
    s_lshl_b32 s88, s88, 10
    s_add_u32 s89, s59, 13
    s_sub_u32 s43, s89, 14
    s_cmp_ge_u32 s89, 14
    s_cselect_b32 s89, s43, s89
    s_lshl_b32 s89, s89, 10
    v_add_u32 v8, 0, v2
    v_add_u32 v9, 14336, v2
    v_add_u32 v10, 28672, v2
    v_add_u32 v11, 43008, v2
    v_add_u32 v12, 57344, v2
    v_add_u32 v13, 71680, v2
    v_add_u32 v14, 86016, v2
    v_add_u32 v17, 14336, v2
    s_barrier
    s_add_u32 s43, s41, s76
    s_mov_b32 m0, s43
    s_add_u32 s44, s40, s76
    buffer_load_dwordx4 v2, s[4:7], s44 offen lds
    s_add_u32 s45, s42, s76
    buffer_load_dwordx4 a[0:3], v8, s[4:7], s45 offen
    buffer_load_dwordx4 a[4:7], v9, s[4:7], s45 offen
    buffer_load_dwordx4 a[8:11], v10, s[4:7], s45 offen
    buffer_load_dwordx4 a[12:15], v11, s[4:7], s45 offen
    buffer_load_dwordx4 a[16:19], v12, s[4:7], s45 offen
    buffer_load_dwordx4 a[20:23], v13, s[4:7], s45 offen
    buffer_load_dwordx4 a[24:27], v14, s[4:7], s45 offen
    s_add_u32 s43, s41, s77
    s_mov_b32 m0, s43
    s_add_u32 s44, s40, s77
    buffer_load_dwordx4 v2, s[4:7], s44 offen lds
    s_add_u32 s45, s42, s77
    buffer_load_dwordx4 a[28:31], v8, s[4:7], s45 offen
    buffer_load_dwordx4 a[32:35], v9, s[4:7], s45 offen
    buffer_load_dwordx4 a[36:39], v10, s[4:7], s45 offen
    buffer_load_dwordx4 a[40:43], v11, s[4:7], s45 offen
    buffer_load_dwordx4 a[44:47], v12, s[4:7], s45 offen
    buffer_load_dwordx4 a[48:51], v13, s[4:7], s45 offen
    buffer_load_dwordx4 a[52:55], v14, s[4:7], s45 offen
    s_add_u32 s43, s41, s78
    s_mov_b32 m0, s43
    s_add_u32 s44, s40, s78
    buffer_load_dwordx4 v2, s[4:7], s44 offen lds
    s_add_u32 s43, s41, s79
    s_mov_b32 m0, s43
    s_add_u32 s44, s40, s79
    buffer_load_dwordx4 v2, s[4:7], s44 offen lds
    v_add_u32 v15, s76, v2
    v_add_u32 v16, 57344, v15
    s_waitcnt vmcnt(17)
    s_barrier
    ds_read_b128 a[84:87], v15 offset:0
    ds_read_b128 a[88:91], v15 offset:14336
    ds_read_b128 a[92:95], v15 offset:28672
    ds_read_b128 a[96:99], v15 offset:43008
    v_add_u32 v15, s77, v2
    v_add_u32 v16, 57344, v15
    s_waitcnt vmcnt(9) lgkmcnt(0)
    s_barrier
    v_mfma_f32_16x16x32_bf16 v[32:35], a[84:87], a[0:3], 0
    v_mfma_f32_16x16x32_bf16 v[64:67], a[84:87], a[4:7], 0
    ds_read_b128 a[116:119], v15 offset:0
    v_mfma_f32_16x16x32_bf16 v[96:99], a[84:87], a[8:11], 0
    v_mfma_f32_16x16x32_bf16 v[128:131], a[84:87], a[12:15], 0
    s_add_u32 s43, s41, s80
    s_mov_b32 m0, s43
    s_add_u32 s44, s40, s80
    buffer_load_dwordx4 v2, s[4:7], s44 offen lds
    v_mfma_f32_16x16x32_bf16 v[160:163], a[84:87], a[16:19], 0
    v_mfma_f32_16x16x32_bf16 v[192:195], a[84:87], a[20:23], 0
    s_add_u32 s45, s42, s78
    buffer_load_dwordx4 a[56:59], v8, s[4:7], s45 offen
    v_mfma_f32_16x16x32_bf16 v[224:227], a[84:87], a[24:27], 0
    v_mfma_f32_16x16x32_bf16 v[36:39], a[88:91], a[0:3], 0
    v_mfma_f32_16x16x32_bf16 v[68:71], a[88:91], a[4:7], 0
    ds_read_b128 a[120:123], v15 offset:14336
    v_mfma_f32_16x16x32_bf16 v[100:103], a[88:91], a[8:11], 0
    v_mfma_f32_16x16x32_bf16 v[132:135], a[88:91], a[12:15], 0
    buffer_load_dwordx4 a[60:63], v9, s[4:7], s45 offen
    v_mfma_f32_16x16x32_bf16 v[164:167], a[88:91], a[16:19], 0
    v_mfma_f32_16x16x32_bf16 v[196:199], a[88:91], a[20:23], 0
    buffer_load_dwordx4 a[64:67], v10, s[4:7], s45 offen
    v_mfma_f32_16x16x32_bf16 v[228:231], a[88:91], a[24:27], 0
    v_mfma_f32_16x16x32_bf16 v[40:43], a[92:95], a[0:3], 0
    v_mfma_f32_16x16x32_bf16 v[72:75], a[92:95], a[4:7], 0
    ds_read_b128 a[124:127], v15 offset:28672
    v_mfma_f32_16x16x32_bf16 v[104:107], a[92:95], a[8:11], 0
    v_mfma_f32_16x16x32_bf16 v[136:139], a[92:95], a[12:15], 0
    buffer_load_dwordx4 a[68:71], v11, s[4:7], s45 offen
    v_mfma_f32_16x16x32_bf16 v[168:171], a[92:95], a[16:19], 0
    v_mfma_f32_16x16x32_bf16 v[200:203], a[92:95], a[20:23], 0
    buffer_load_dwordx4 a[72:75], v12, s[4:7], s45 offen
    v_mfma_f32_16x16x32_bf16 v[232:235], a[92:95], a[24:27], 0
    v_mfma_f32_16x16x32_bf16 v[44:47], a[96:99], a[0:3], 0
    v_mfma_f32_16x16x32_bf16 v[76:79], a[96:99], a[4:7], 0
    ds_read_b128 a[128:131], v15 offset:43008
    v_mfma_f32_16x16x32_bf16 v[108:111], a[96:99], a[8:11], 0
    v_mfma_f32_16x16x32_bf16 v[140:143], a[96:99], a[12:15], 0
    buffer_load_dwordx4 a[76:79], v13, s[4:7], s45 offen
    v_mfma_f32_16x16x32_bf16 v[172:175], a[96:99], a[16:19], 0
    v_mfma_f32_16x16x32_bf16 v[204:207], a[96:99], a[20:23], 0
    buffer_load_dwordx4 a[80:83], v14, s[4:7], s45 offen
    v_mfma_f32_16x16x32_bf16 v[236:239], a[96:99], a[24:27], 0
    v_add_u32 v15, s78, v2
    v_add_u32 v16, 57344, v15
    s_waitcnt vmcnt(9) lgkmcnt(0)
    s_barrier
    v_mfma_f32_16x16x32_bf16 v[32:35], a[116:119], a[28:31], v[32:35]
    v_mfma_f32_16x16x32_bf16 v[64:67], a[116:119], a[32:35], v[64:67]
    ds_read_b128 a[84:87], v15 offset:0
    v_mfma_f32_16x16x32_bf16 v[96:99], a[116:119], a[36:39], v[96:99]
    v_mfma_f32_16x16x32_bf16 v[128:131], a[116:119], a[40:43], v[128:131]
    s_add_u32 s43, s41, s81
    s_mov_b32 m0, s43
    s_add_u32 s44, s40, s81
    buffer_load_dwordx4 v2, s[4:7], s44 offen lds
    v_mfma_f32_16x16x32_bf16 v[160:163], a[116:119], a[44:47], v[160:163]
    v_mfma_f32_16x16x32_bf16 v[192:195], a[116:119], a[48:51], v[192:195]
    s_add_u32 s45, s42, s79
    buffer_load_dwordx4 a[0:3], v8, s[4:7], s45 offen
    v_mfma_f32_16x16x32_bf16 v[224:227], a[116:119], a[52:55], v[224:227]
    v_mfma_f32_16x16x32_bf16 v[36:39], a[120:123], a[28:31], v[36:39]
    v_mfma_f32_16x16x32_bf16 v[68:71], a[120:123], a[32:35], v[68:71]
    ds_read_b128 a[88:91], v15 offset:14336
    v_mfma_f32_16x16x32_bf16 v[100:103], a[120:123], a[36:39], v[100:103]
    v_mfma_f32_16x16x32_bf16 v[132:135], a[120:123], a[40:43], v[132:135]
    buffer_load_dwordx4 a[4:7], v9, s[4:7], s45 offen
    v_mfma_f32_16x16x32_bf16 v[164:167], a[120:123], a[44:47], v[164:167]
    v_mfma_f32_16x16x32_bf16 v[196:199], a[120:123], a[48:51], v[196:199]
    buffer_load_dwordx4 a[8:11], v10, s[4:7], s45 offen
    v_mfma_f32_16x16x32_bf16 v[228:231], a[120:123], a[52:55], v[228:231]
    v_mfma_f32_16x16x32_bf16 v[40:43], a[124:127], a[28:31], v[40:43]
    v_mfma_f32_16x16x32_bf16 v[72:75], a[124:127], a[32:35], v[72:75]
    ds_read_b128 a[92:95], v15 offset:28672
    v_mfma_f32_16x16x32_bf16 v[104:107], a[124:127], a[36:39], v[104:107]
    v_mfma_f32_16x16x32_bf16 v[136:139], a[124:127], a[40:43], v[136:139]
    buffer_load_dwordx4 a[12:15], v11, s[4:7], s45 offen
    v_mfma_f32_16x16x32_bf16 v[168:171], a[124:127], a[44:47], v[168:171]
    v_mfma_f32_16x16x32_bf16 v[200:203], a[124:127], a[48:51], v[200:203]
    buffer_load_dwordx4 a[16:19], v12, s[4:7], s45 offen
    v_mfma_f32_16x16x32_bf16 v[232:235], a[124:127], a[52:55], v[232:235]
    v_mfma_f32_16x16x32_bf16 v[44:47], a[128:131], a[28:31], v[44:47]
    v_mfma_f32_16x16x32_bf16 v[76:79], a[128:131], a[32:35], v[76:79]
    ds_read_b128 a[96:99], v15 offset:43008
    v_mfma_f32_16x16x32_bf16 v[108:111], a[128:131], a[36:39], v[108:111]
    v_mfma_f32_16x16x32_bf16 v[140:143], a[128:131], a[40:43], v[140:143]
    buffer_load_dwordx4 a[20:23], v13, s[4:7], s45 offen
    v_mfma_f32_16x16x32_bf16 v[172:175], a[128:131], a[44:47], v[172:175]
    v_mfma_f32_16x16x32_bf16 v[204:207], a[128:131], a[48:51], v[204:207]
    buffer_load_dwordx4 a[24:27], v14, s[4:7], s45 offen
    v_mfma_f32_16x16x32_bf16 v[236:239], a[128:131], a[52:55], v[236:239]
    v_add_u32 v15, s79, v2
    v_add_u32 v16, 57344, v15
    s_waitcnt vmcnt(8) lgkmcnt(0)
    s_barrier
    v_mfma_f32_16x16x32_bf16 v[32:35], a[84:87], a[56:59], v[32:35]
    v_mfma_f32_16x16x32_bf16 v[64:67], a[84:87], a[60:63], v[64:67]
    ds_read_b128 a[116:119], v15 offset:0
    v_mfma_f32_16x16x32_bf16 v[96:99], a[84:87], a[64:67], v[96:99]
    v_mfma_f32_16x16x32_bf16 v[128:131], a[84:87], a[68:71], v[128:131]
    s_add_u32 s43, s41, s82
    s_mov_b32 m0, s43
    s_add_u32 s44, s40, s82
    buffer_load_dwordx4 v2, s[4:7], s44 offen lds
    v_mfma_f32_16x16x32_bf16 v[160:163], a[84:87], a[72:75], v[160:163]
    v_mfma_f32_16x16x32_bf16 v[192:195], a[84:87], a[76:79], v[192:195]
    s_add_u32 s45, s42, s80
    buffer_load_dwordx4 a[28:31], v8, s[4:7], s45 offen
    v_mfma_f32_16x16x32_bf16 v[224:227], a[84:87], a[80:83], v[224:227]
    v_mfma_f32_16x16x32_bf16 v[36:39], a[88:91], a[56:59], v[36:39]
    v_mfma_f32_16x16x32_bf16 v[68:71], a[88:91], a[60:63], v[68:71]
    ds_read_b128 a[120:123], v15 offset:14336
    v_mfma_f32_16x16x32_bf16 v[100:103], a[88:91], a[64:67], v[100:103]
    v_mfma_f32_16x16x32_bf16 v[132:135], a[88:91], a[68:71], v[132:135]
    buffer_load_dwordx4 a[32:35], v9, s[4:7], s45 offen
    v_mfma_f32_16x16x32_bf16 v[164:167], a[88:91], a[72:75], v[164:167]
    v_mfma_f32_16x16x32_bf16 v[196:199], a[88:91], a[76:79], v[196:199]
    buffer_load_dwordx4 a[36:39], v10, s[4:7], s45 offen
    v_mfma_f32_16x16x32_bf16 v[228:231], a[88:91], a[80:83], v[228:231]
    v_mfma_f32_16x16x32_bf16 v[40:43], a[92:95], a[56:59], v[40:43]
    v_mfma_f32_16x16x32_bf16 v[72:75], a[92:95], a[60:63], v[72:75]
    ds_read_b128 a[124:127], v15 offset:28672
    v_mfma_f32_16x16x32_bf16 v[104:107], a[92:95], a[64:67], v[104:107]
    v_mfma_f32_16x16x32_bf16 v[136:139], a[92:95], a[68:71], v[136:139]
    buffer_load_dwordx4 a[40:43], v11, s[4:7], s45 offen
    v_mfma_f32_16x16x32_bf16 v[168:171], a[92:95], a[72:75], v[168:171]
    v_mfma_f32_16x16x32_bf16 v[200:203], a[92:95], a[76:79], v[200:203]
    buffer_load_dwordx4 a[44:47], v12, s[4:7], s45 offen
    v_mfma_f32_16x16x32_bf16 v[232:235], a[92:95], a[80:83], v[232:235]
    v_mfma_f32_16x16x32_bf16 v[44:47], a[96:99], a[56:59], v[44:47]
    v_mfma_f32_16x16x32_bf16 v[76:79], a[96:99], a[60:63], v[76:79]
    ds_read_b128 a[128:131], v15 offset:43008
    v_mfma_f32_16x16x32_bf16 v[108:111], a[96:99], a[64:67], v[108:111]
    v_mfma_f32_16x16x32_bf16 v[140:143], a[96:99], a[68:71], v[140:143]
    buffer_load_dwordx4 a[48:51], v13, s[4:7], s45 offen
    v_mfma_f32_16x16x32_bf16 v[172:175], a[96:99], a[72:75], v[172:175]
    v_mfma_f32_16x16x32_bf16 v[204:207], a[96:99], a[76:79], v[204:207]
    buffer_load_dwordx4 a[52:55], v14, s[4:7], s45 offen
    v_mfma_f32_16x16x32_bf16 v[236:239], a[96:99], a[80:83], v[236:239]
    v_add_u32 v15, s80, v2
    v_add_u32 v16, 57344, v15
    s_waitcnt vmcnt(8) lgkmcnt(0)
    s_barrier
    v_mfma_f32_16x16x32_bf16 v[32:35], a[116:119], a[0:3], v[32:35]
    v_mfma_f32_16x16x32_bf16 v[64:67], a[116:119], a[4:7], v[64:67]
    ds_read_b128 a[84:87], v15 offset:0
    v_mfma_f32_16x16x32_bf16 v[96:99], a[116:119], a[8:11], v[96:99]
    v_mfma_f32_16x16x32_bf16 v[128:131], a[116:119], a[12:15], v[128:131]
    s_add_u32 s43, s41, s83
    s_mov_b32 m0, s43
    s_add_u32 s44, s40, s83
    buffer_load_dwordx4 v2, s[4:7], s44 offen lds
    v_mfma_f32_16x16x32_bf16 v[160:163], a[116:119], a[16:19], v[160:163]
    v_mfma_f32_16x16x32_bf16 v[192:195], a[116:119], a[20:23], v[192:195]
    s_add_u32 s45, s42, s81
    buffer_load_dwordx4 a[56:59], v8, s[4:7], s45 offen
    v_mfma_f32_16x16x32_bf16 v[224:227], a[116:119], a[24:27], v[224:227]
    v_mfma_f32_16x16x32_bf16 v[36:39], a[120:123], a[0:3], v[36:39]
    v_mfma_f32_16x16x32_bf16 v[68:71], a[120:123], a[4:7], v[68:71]
    ds_read_b128 a[88:91], v15 offset:14336
    v_mfma_f32_16x16x32_bf16 v[100:103], a[120:123], a[8:11], v[100:103]
    v_mfma_f32_16x16x32_bf16 v[132:135], a[120:123], a[12:15], v[132:135]
    buffer_load_dwordx4 a[60:63], v9, s[4:7], s45 offen
    v_mfma_f32_16x16x32_bf16 v[164:167], a[120:123], a[16:19], v[164:167]
    v_mfma_f32_16x16x32_bf16 v[196:199], a[120:123], a[20:23], v[196:199]
    buffer_load_dwordx4 a[64:67], v10, s[4:7], s45 offen
    v_mfma_f32_16x16x32_bf16 v[228:231], a[120:123], a[24:27], v[228:231]
    v_mfma_f32_16x16x32_bf16 v[40:43], a[124:127], a[0:3], v[40:43]
    v_mfma_f32_16x16x32_bf16 v[72:75], a[124:127], a[4:7], v[72:75]
    ds_read_b128 a[92:95], v15 offset:28672
    v_mfma_f32_16x16x32_bf16 v[104:107], a[124:127], a[8:11], v[104:107]
    v_mfma_f32_16x16x32_bf16 v[136:139], a[124:127], a[12:15], v[136:139]
    buffer_load_dwordx4 a[68:71], v11, s[4:7], s45 offen
    v_mfma_f32_16x16x32_bf16 v[168:171], a[124:127], a[16:19], v[168:171]
    v_mfma_f32_16x16x32_bf16 v[200:203], a[124:127], a[20:23], v[200:203]
    buffer_load_dwordx4 a[72:75], v12, s[4:7], s45 offen
    v_mfma_f32_16x16x32_bf16 v[232:235], a[124:127], a[24:27], v[232:235]
    v_mfma_f32_16x16x32_bf16 v[44:47], a[128:131], a[0:3], v[44:47]
    v_mfma_f32_16x16x32_bf16 v[76:79], a[128:131], a[4:7], v[76:79]
    ds_read_b128 a[96:99], v15 offset:43008
    v_mfma_f32_16x16x32_bf16 v[108:111], a[128:131], a[8:11], v[108:111]
    v_mfma_f32_16x16x32_bf16 v[140:143], a[128:131], a[12:15], v[140:143]
    buffer_load_dwordx4 a[76:79], v13, s[4:7], s45 offen
    v_mfma_f32_16x16x32_bf16 v[172:175], a[128:131], a[16:19], v[172:175]
    v_mfma_f32_16x16x32_bf16 v[204:207], a[128:131], a[20:23], v[204:207]
    buffer_load_dwordx4 a[80:83], v14, s[4:7], s45 offen
    v_mfma_f32_16x16x32_bf16 v[236:239], a[128:131], a[24:27], v[236:239]
    v_add_u32 v15, s81, v2
    v_add_u32 v16, 57344, v15
    s_waitcnt vmcnt(8) lgkmcnt(0)
    s_barrier
    v_mfma_f32_16x16x32_bf16 v[32:35], a[84:87], a[28:31], v[32:35]
    v_mfma_f32_16x16x32_bf16 v[64:67], a[84:87], a[32:35], v[64:67]
    ds_read_b128 a[116:119], v15 offset:0
    v_mfma_f32_16x16x32_bf16 v[96:99], a[84:87], a[36:39], v[96:99]
    v_mfma_f32_16x16x32_bf16 v[128:131], a[84:87], a[40:43], v[128:131]
    s_add_u32 s43, s41, s84
    s_mov_b32 m0, s43
    s_add_u32 s44, s40, s84
    buffer_load_dwordx4 v2, s[4:7], s44 offen lds
    v_mfma_f32_16x16x32_bf16 v[160:163], a[84:87], a[44:47], v[160:163]
    v_mfma_f32_16x16x32_bf16 v[192:195], a[84:87], a[48:51], v[192:195]
    s_add_u32 s45, s42, s82
    buffer_load_dwordx4 a[0:3], v8, s[4:7], s45 offen
    v_mfma_f32_16x16x32_bf16 v[224:227], a[84:87], a[52:55], v[224:227]
    v_mfma_f32_16x16x32_bf16 v[36:39], a[88:91], a[28:31], v[36:39]
    v_mfma_f32_16x16x32_bf16 v[68:71], a[88:91], a[32:35], v[68:71]
    ds_read_b128 a[120:123], v15 offset:14336
    v_mfma_f32_16x16x32_bf16 v[100:103], a[88:91], a[36:39], v[100:103]
    v_mfma_f32_16x16x32_bf16 v[132:135], a[88:91], a[40:43], v[132:135]
    buffer_load_dwordx4 a[4:7], v9, s[4:7], s45 offen
    v_mfma_f32_16x16x32_bf16 v[164:167], a[88:91], a[44:47], v[164:167]
    v_mfma_f32_16x16x32_bf16 v[196:199], a[88:91], a[48:51], v[196:199]
    buffer_load_dwordx4 a[8:11], v10, s[4:7], s45 offen
    v_mfma_f32_16x16x32_bf16 v[228:231], a[88:91], a[52:55], v[228:231]
    v_mfma_f32_16x16x32_bf16 v[40:43], a[92:95], a[28:31], v[40:43]
    v_mfma_f32_16x16x32_bf16 v[72:75], a[92:95], a[32:35], v[72:75]
    ds_read_b128 a[124:127], v15 offset:28672
    v_mfma_f32_16x16x32_bf16 v[104:107], a[92:95], a[36:39], v[104:107]
    v_mfma_f32_16x16x32_bf16 v[136:139], a[92:95], a[40:43], v[136:139]
    buffer_load_dwordx4 a[12:15], v11, s[4:7], s45 offen
    v_mfma_f32_16x16x32_bf16 v[168:171], a[92:95], a[44:47], v[168:171]
    v_mfma_f32_16x16x32_bf16 v[200:203], a[92:95], a[48:51], v[200:203]
    buffer_load_dwordx4 a[16:19], v12, s[4:7], s45 offen
    v_mfma_f32_16x16x32_bf16 v[232:235], a[92:95], a[52:55], v[232:235]
    v_mfma_f32_16x16x32_bf16 v[44:47], a[96:99], a[28:31], v[44:47]
    v_mfma_f32_16x16x32_bf16 v[76:79], a[96:99], a[32:35], v[76:79]
    ds_read_b128 a[128:131], v15 offset:43008
    v_mfma_f32_16x16x32_bf16 v[108:111], a[96:99], a[36:39], v[108:111]
    v_mfma_f32_16x16x32_bf16 v[140:143], a[96:99], a[40:43], v[140:143]
    buffer_load_dwordx4 a[20:23], v13, s[4:7], s45 offen
    v_mfma_f32_16x16x32_bf16 v[172:175], a[96:99], a[44:47], v[172:175]
    v_mfma_f32_16x16x32_bf16 v[204:207], a[96:99], a[48:51], v[204:207]
    buffer_load_dwordx4 a[24:27], v14, s[4:7], s45 offen
    v_mfma_f32_16x16x32_bf16 v[236:239], a[96:99], a[52:55], v[236:239]
    v_add_u32 v15, s82, v2
    v_add_u32 v16, 57344, v15
    s_waitcnt vmcnt(8) lgkmcnt(0)
    s_barrier
    v_mfma_f32_16x16x32_bf16 v[32:35], a[116:119], a[56:59], v[32:35]
    v_mfma_f32_16x16x32_bf16 v[64:67], a[116:119], a[60:63], v[64:67]
    ds_read_b128 a[84:87], v15 offset:0
    v_mfma_f32_16x16x32_bf16 v[96:99], a[116:119], a[64:67], v[96:99]
    v_mfma_f32_16x16x32_bf16 v[128:131], a[116:119], a[68:71], v[128:131]
    s_add_u32 s43, s41, s85
    s_mov_b32 m0, s43
    s_add_u32 s44, s40, s85
    buffer_load_dwordx4 v2, s[4:7], s44 offen lds
    v_mfma_f32_16x16x32_bf16 v[160:163], a[116:119], a[72:75], v[160:163]
    v_mfma_f32_16x16x32_bf16 v[192:195], a[116:119], a[76:79], v[192:195]
    s_add_u32 s45, s42, s83
    buffer_load_dwordx4 a[28:31], v8, s[4:7], s45 offen
    v_mfma_f32_16x16x32_bf16 v[224:227], a[116:119], a[80:83], v[224:227]
    v_mfma_f32_16x16x32_bf16 v[36:39], a[120:123], a[56:59], v[36:39]
    v_mfma_f32_16x16x32_bf16 v[68:71], a[120:123], a[60:63], v[68:71]
    ds_read_b128 a[88:91], v15 offset:14336
    v_mfma_f32_16x16x32_bf16 v[100:103], a[120:123], a[64:67], v[100:103]
    v_mfma_f32_16x16x32_bf16 v[132:135], a[120:123], a[68:71], v[132:135]
    buffer_load_dwordx4 a[32:35], v9, s[4:7], s45 offen
    v_mfma_f32_16x16x32_bf16 v[164:167], a[120:123], a[72:75], v[164:167]
    v_mfma_f32_16x16x32_bf16 v[196:199], a[120:123], a[76:79], v[196:199]
    buffer_load_dwordx4 a[36:39], v10, s[4:7], s45 offen
    v_mfma_f32_16x16x32_bf16 v[228:231], a[120:123], a[80:83], v[228:231]
    v_mfma_f32_16x16x32_bf16 v[40:43], a[124:127], a[56:59], v[40:43]
    v_mfma_f32_16x16x32_bf16 v[72:75], a[124:127], a[60:63], v[72:75]
    ds_read_b128 a[92:95], v15 offset:28672
    v_mfma_f32_16x16x32_bf16 v[104:107], a[124:127], a[64:67], v[104:107]
    v_mfma_f32_16x16x32_bf16 v[136:139], a[124:127], a[68:71], v[136:139]
    buffer_load_dwordx4 a[40:43], v11, s[4:7], s45 offen
    v_mfma_f32_16x16x32_bf16 v[168:171], a[124:127], a[72:75], v[168:171]
    v_mfma_f32_16x16x32_bf16 v[200:203], a[124:127], a[76:79], v[200:203]
    buffer_load_dwordx4 a[44:47], v12, s[4:7], s45 offen
    v_mfma_f32_16x16x32_bf16 v[232:235], a[124:127], a[80:83], v[232:235]
    v_mfma_f32_16x16x32_bf16 v[44:47], a[128:131], a[56:59], v[44:47]
    v_mfma_f32_16x16x32_bf16 v[76:79], a[128:131], a[60:63], v[76:79]
    ds_read_b128 a[96:99], v15 offset:43008
    v_mfma_f32_16x16x32_bf16 v[108:111], a[128:131], a[64:67], v[108:111]
    v_mfma_f32_16x16x32_bf16 v[140:143], a[128:131], a[68:71], v[140:143]
    buffer_load_dwordx4 a[48:51], v13, s[4:7], s45 offen
    v_mfma_f32_16x16x32_bf16 v[172:175], a[128:131], a[72:75], v[172:175]
    v_mfma_f32_16x16x32_bf16 v[204:207], a[128:131], a[76:79], v[204:207]
    buffer_load_dwordx4 a[52:55], v14, s[4:7], s45 offen
    v_mfma_f32_16x16x32_bf16 v[236:239], a[128:131], a[80:83], v[236:239]
    v_add_u32 v15, s83, v2
    v_add_u32 v16, 57344, v15
    s_waitcnt vmcnt(8) lgkmcnt(0)
    s_barrier
    v_mfma_f32_16x16x32_bf16 v[32:35], a[84:87], a[0:3], v[32:35]
    v_mfma_f32_16x16x32_bf16 v[64:67], a[84:87], a[4:7], v[64:67]
    ds_read_b128 a[116:119], v15 offset:0
    v_mfma_f32_16x16x32_bf16 v[96:99], a[84:87], a[8:11], v[96:99]
    v_mfma_f32_16x16x32_bf16 v[128:131], a[84:87], a[12:15], v[128:131]
    s_add_u32 s43, s41, s86
    s_mov_b32 m0, s43
    s_add_u32 s44, s40, s86
    buffer_load_dwordx4 v2, s[4:7], s44 offen lds
    v_mfma_f32_16x16x32_bf16 v[160:163], a[84:87], a[16:19], v[160:163]
    v_mfma_f32_16x16x32_bf16 v[192:195], a[84:87], a[20:23], v[192:195]
    s_add_u32 s45, s42, s84
    buffer_load_dwordx4 a[56:59], v8, s[4:7], s45 offen
    v_mfma_f32_16x16x32_bf16 v[224:227], a[84:87], a[24:27], v[224:227]
    v_mfma_f32_16x16x32_bf16 v[36:39], a[88:91], a[0:3], v[36:39]
    v_mfma_f32_16x16x32_bf16 v[68:71], a[88:91], a[4:7], v[68:71]
    ds_read_b128 a[120:123], v15 offset:14336
    v_mfma_f32_16x16x32_bf16 v[100:103], a[88:91], a[8:11], v[100:103]
    v_mfma_f32_16x16x32_bf16 v[132:135], a[88:91], a[12:15], v[132:135]
    buffer_load_dwordx4 a[60:63], v9, s[4:7], s45 offen
    v_mfma_f32_16x16x32_bf16 v[164:167], a[88:91], a[16:19], v[164:167]
    v_mfma_f32_16x16x32_bf16 v[196:199], a[88:91], a[20:23], v[196:199]
    buffer_load_dwordx4 a[64:67], v10, s[4:7], s45 offen
    v_mfma_f32_16x16x32_bf16 v[228:231], a[88:91], a[24:27], v[228:231]
    v_mfma_f32_16x16x32_bf16 v[40:43], a[92:95], a[0:3], v[40:43]
    v_mfma_f32_16x16x32_bf16 v[72:75], a[92:95], a[4:7], v[72:75]
    ds_read_b128 a[124:127], v15 offset:28672
    v_mfma_f32_16x16x32_bf16 v[104:107], a[92:95], a[8:11], v[104:107]
    v_mfma_f32_16x16x32_bf16 v[136:139], a[92:95], a[12:15], v[136:139]
    buffer_load_dwordx4 a[68:71], v11, s[4:7], s45 offen
    v_mfma_f32_16x16x32_bf16 v[168:171], a[92:95], a[16:19], v[168:171]
    v_mfma_f32_16x16x32_bf16 v[200:203], a[92:95], a[20:23], v[200:203]
    buffer_load_dwordx4 a[72:75], v12, s[4:7], s45 offen
    v_mfma_f32_16x16x32_bf16 v[232:235], a[92:95], a[24:27], v[232:235]
    v_mfma_f32_16x16x32_bf16 v[44:47], a[96:99], a[0:3], v[44:47]
    v_mfma_f32_16x16x32_bf16 v[76:79], a[96:99], a[4:7], v[76:79]
    ds_read_b128 a[128:131], v15 offset:43008
    v_mfma_f32_16x16x32_bf16 v[108:111], a[96:99], a[8:11], v[108:111]
    v_mfma_f32_16x16x32_bf16 v[140:143], a[96:99], a[12:15], v[140:143]
    buffer_load_dwordx4 a[76:79], v13, s[4:7], s45 offen
    v_mfma_f32_16x16x32_bf16 v[172:175], a[96:99], a[16:19], v[172:175]
    v_mfma_f32_16x16x32_bf16 v[204:207], a[96:99], a[20:23], v[204:207]
    buffer_load_dwordx4 a[80:83], v14, s[4:7], s45 offen
    v_mfma_f32_16x16x32_bf16 v[236:239], a[96:99], a[24:27], v[236:239]
    v_add_u32 v15, s84, v2
    v_add_u32 v16, 57344, v15
    s_waitcnt vmcnt(8) lgkmcnt(0)
    s_barrier
    v_mfma_f32_16x16x32_bf16 v[32:35], a[116:119], a[28:31], v[32:35]
    v_mfma_f32_16x16x32_bf16 v[64:67], a[116:119], a[32:35], v[64:67]
    ds_read_b128 a[84:87], v15 offset:0
    v_mfma_f32_16x16x32_bf16 v[96:99], a[116:119], a[36:39], v[96:99]
    v_mfma_f32_16x16x32_bf16 v[128:131], a[116:119], a[40:43], v[128:131]
    s_add_u32 s43, s41, s87
    s_mov_b32 m0, s43
    s_add_u32 s44, s40, s87
    buffer_load_dwordx4 v2, s[4:7], s44 offen lds
    v_mfma_f32_16x16x32_bf16 v[160:163], a[116:119], a[44:47], v[160:163]
    v_mfma_f32_16x16x32_bf16 v[192:195], a[116:119], a[48:51], v[192:195]
    s_add_u32 s45, s42, s85
    buffer_load_dwordx4 a[0:3], v8, s[4:7], s45 offen
    v_mfma_f32_16x16x32_bf16 v[224:227], a[116:119], a[52:55], v[224:227]
    v_mfma_f32_16x16x32_bf16 v[36:39], a[120:123], a[28:31], v[36:39]
    v_mfma_f32_16x16x32_bf16 v[68:71], a[120:123], a[32:35], v[68:71]
    ds_read_b128 a[88:91], v15 offset:14336
    v_mfma_f32_16x16x32_bf16 v[100:103], a[120:123], a[36:39], v[100:103]
    v_mfma_f32_16x16x32_bf16 v[132:135], a[120:123], a[40:43], v[132:135]
    buffer_load_dwordx4 a[4:7], v9, s[4:7], s45 offen
    v_mfma_f32_16x16x32_bf16 v[164:167], a[120:123], a[44:47], v[164:167]
    v_mfma_f32_16x16x32_bf16 v[196:199], a[120:123], a[48:51], v[196:199]
    buffer_load_dwordx4 a[8:11], v10, s[4:7], s45 offen
    v_mfma_f32_16x16x32_bf16 v[228:231], a[120:123], a[52:55], v[228:231]
    v_mfma_f32_16x16x32_bf16 v[40:43], a[124:127], a[28:31], v[40:43]
    v_mfma_f32_16x16x32_bf16 v[72:75], a[124:127], a[32:35], v[72:75]
    ds_read_b128 a[92:95], v15 offset:28672
    v_mfma_f32_16x16x32_bf16 v[104:107], a[124:127], a[36:39], v[104:107]
    v_mfma_f32_16x16x32_bf16 v[136:139], a[124:127], a[40:43], v[136:139]
    buffer_load_dwordx4 a[12:15], v11, s[4:7], s45 offen
    v_mfma_f32_16x16x32_bf16 v[168:171], a[124:127], a[44:47], v[168:171]
    v_mfma_f32_16x16x32_bf16 v[200:203], a[124:127], a[48:51], v[200:203]
    buffer_load_dwordx4 a[16:19], v12, s[4:7], s45 offen
    v_mfma_f32_16x16x32_bf16 v[232:235], a[124:127], a[52:55], v[232:235]
    v_mfma_f32_16x16x32_bf16 v[44:47], a[128:131], a[28:31], v[44:47]
    v_mfma_f32_16x16x32_bf16 v[76:79], a[128:131], a[32:35], v[76:79]
    ds_read_b128 a[96:99], v15 offset:43008
    v_mfma_f32_16x16x32_bf16 v[108:111], a[128:131], a[36:39], v[108:111]
    v_mfma_f32_16x16x32_bf16 v[140:143], a[128:131], a[40:43], v[140:143]
    buffer_load_dwordx4 a[20:23], v13, s[4:7], s45 offen
    v_mfma_f32_16x16x32_bf16 v[172:175], a[128:131], a[44:47], v[172:175]
    v_mfma_f32_16x16x32_bf16 v[204:207], a[128:131], a[48:51], v[204:207]
    buffer_load_dwordx4 a[24:27], v14, s[4:7], s45 offen
    v_mfma_f32_16x16x32_bf16 v[236:239], a[128:131], a[52:55], v[236:239]
    v_add_u32 v15, s85, v2
    v_add_u32 v16, 57344, v15
    s_waitcnt vmcnt(8) lgkmcnt(0)
    s_barrier
    v_mfma_f32_16x16x32_bf16 v[32:35], a[84:87], a[56:59], v[32:35]
    v_mfma_f32_16x16x32_bf16 v[64:67], a[84:87], a[60:63], v[64:67]
    ds_read_b128 a[116:119], v15 offset:0
    v_mfma_f32_16x16x32_bf16 v[96:99], a[84:87], a[64:67], v[96:99]
    v_mfma_f32_16x16x32_bf16 v[128:131], a[84:87], a[68:71], v[128:131]
    s_add_u32 s43, s41, s88
    s_mov_b32 m0, s43
    s_add_u32 s44, s40, s88
    buffer_load_dwordx4 v2, s[4:7], s44 offen lds
    v_mfma_f32_16x16x32_bf16 v[160:163], a[84:87], a[72:75], v[160:163]
    v_mfma_f32_16x16x32_bf16 v[192:195], a[84:87], a[76:79], v[192:195]
    s_add_u32 s45, s42, s86
    buffer_load_dwordx4 a[28:31], v8, s[4:7], s45 offen
    v_mfma_f32_16x16x32_bf16 v[224:227], a[84:87], a[80:83], v[224:227]
    v_mfma_f32_16x16x32_bf16 v[36:39], a[88:91], a[56:59], v[36:39]
    v_mfma_f32_16x16x32_bf16 v[68:71], a[88:91], a[60:63], v[68:71]
    ds_read_b128 a[120:123], v15 offset:14336
    v_mfma_f32_16x16x32_bf16 v[100:103], a[88:91], a[64:67], v[100:103]
    v_mfma_f32_16x16x32_bf16 v[132:135], a[88:91], a[68:71], v[132:135]
    buffer_load_dwordx4 a[32:35], v9, s[4:7], s45 offen
    v_mfma_f32_16x16x32_bf16 v[164:167], a[88:91], a[72:75], v[164:167]
    v_mfma_f32_16x16x32_bf16 v[196:199], a[88:91], a[76:79], v[196:199]
    buffer_load_dwordx4 a[36:39], v10, s[4:7], s45 offen
    v_mfma_f32_16x16x32_bf16 v[228:231], a[88:91], a[80:83], v[228:231]
    v_mfma_f32_16x16x32_bf16 v[40:43], a[92:95], a[56:59], v[40:43]
    v_mfma_f32_16x16x32_bf16 v[72:75], a[92:95], a[60:63], v[72:75]
    ds_read_b128 a[124:127], v15 offset:28672
    v_mfma_f32_16x16x32_bf16 v[104:107], a[92:95], a[64:67], v[104:107]
    v_mfma_f32_16x16x32_bf16 v[136:139], a[92:95], a[68:71], v[136:139]
    buffer_load_dwordx4 a[40:43], v11, s[4:7], s45 offen
    v_mfma_f32_16x16x32_bf16 v[168:171], a[92:95], a[72:75], v[168:171]
    v_mfma_f32_16x16x32_bf16 v[200:203], a[92:95], a[76:79], v[200:203]
    buffer_load_dwordx4 a[44:47], v12, s[4:7], s45 offen
    v_mfma_f32_16x16x32_bf16 v[232:235], a[92:95], a[80:83], v[232:235]
    v_mfma_f32_16x16x32_bf16 v[44:47], a[96:99], a[56:59], v[44:47]
    v_mfma_f32_16x16x32_bf16 v[76:79], a[96:99], a[60:63], v[76:79]
    ds_read_b128 a[128:131], v15 offset:43008
    v_mfma_f32_16x16x32_bf16 v[108:111], a[96:99], a[64:67], v[108:111]
    v_mfma_f32_16x16x32_bf16 v[140:143], a[96:99], a[68:71], v[140:143]
    buffer_load_dwordx4 a[48:51], v13, s[4:7], s45 offen
    v_mfma_f32_16x16x32_bf16 v[172:175], a[96:99], a[72:75], v[172:175]
    v_mfma_f32_16x16x32_bf16 v[204:207], a[96:99], a[76:79], v[204:207]
    buffer_load_dwordx4 a[52:55], v14, s[4:7], s45 offen
    v_mfma_f32_16x16x32_bf16 v[236:239], a[96:99], a[80:83], v[236:239]
    v_add_u32 v15, s86, v2
    v_add_u32 v16, 57344, v15
    s_waitcnt vmcnt(8) lgkmcnt(0)
    s_barrier
    v_mfma_f32_16x16x32_bf16 v[32:35], a[116:119], a[0:3], v[32:35]
    v_mfma_f32_16x16x32_bf16 v[64:67], a[116:119], a[4:7], v[64:67]
    ds_read_b128 a[84:87], v15 offset:0
    v_mfma_f32_16x16x32_bf16 v[96:99], a[116:119], a[8:11], v[96:99]
    v_mfma_f32_16x16x32_bf16 v[128:131], a[116:119], a[12:15], v[128:131]
    s_add_u32 s43, s41, s89
    s_mov_b32 m0, s43
    s_add_u32 s44, s40, s89
    buffer_load_dwordx4 v2, s[4:7], s44 offen lds
    v_mfma_f32_16x16x32_bf16 v[160:163], a[116:119], a[16:19], v[160:163]
    v_mfma_f32_16x16x32_bf16 v[192:195], a[116:119], a[20:23], v[192:195]
    s_add_u32 s45, s42, s87
    buffer_load_dwordx4 a[56:59], v8, s[4:7], s45 offen
    v_mfma_f32_16x16x32_bf16 v[224:227], a[116:119], a[24:27], v[224:227]
    v_mfma_f32_16x16x32_bf16 v[36:39], a[120:123], a[0:3], v[36:39]
    v_mfma_f32_16x16x32_bf16 v[68:71], a[120:123], a[4:7], v[68:71]
    ds_read_b128 a[88:91], v15 offset:14336
    v_mfma_f32_16x16x32_bf16 v[100:103], a[120:123], a[8:11], v[100:103]
    v_mfma_f32_16x16x32_bf16 v[132:135], a[120:123], a[12:15], v[132:135]
    buffer_load_dwordx4 a[60:63], v9, s[4:7], s45 offen
    v_mfma_f32_16x16x32_bf16 v[164:167], a[120:123], a[16:19], v[164:167]
    v_mfma_f32_16x16x32_bf16 v[196:199], a[120:123], a[20:23], v[196:199]
    buffer_load_dwordx4 a[64:67], v10, s[4:7], s45 offen
    v_mfma_f32_16x16x32_bf16 v[228:231], a[120:123], a[24:27], v[228:231]
    v_mfma_f32_16x16x32_bf16 v[40:43], a[124:127], a[0:3], v[40:43]
    v_mfma_f32_16x16x32_bf16 v[72:75], a[124:127], a[4:7], v[72:75]
    ds_read_b128 a[92:95], v15 offset:28672
    v_mfma_f32_16x16x32_bf16 v[104:107], a[124:127], a[8:11], v[104:107]
    v_mfma_f32_16x16x32_bf16 v[136:139], a[124:127], a[12:15], v[136:139]
    buffer_load_dwordx4 a[68:71], v11, s[4:7], s45 offen
    v_mfma_f32_16x16x32_bf16 v[168:171], a[124:127], a[16:19], v[168:171]
    v_mfma_f32_16x16x32_bf16 v[200:203], a[124:127], a[20:23], v[200:203]
    buffer_load_dwordx4 a[72:75], v12, s[4:7], s45 offen
    v_mfma_f32_16x16x32_bf16 v[232:235], a[124:127], a[24:27], v[232:235]
    v_mfma_f32_16x16x32_bf16 v[44:47], a[128:131], a[0:3], v[44:47]
    v_mfma_f32_16x16x32_bf16 v[76:79], a[128:131], a[4:7], v[76:79]
    ds_read_b128 a[96:99], v15 offset:43008
    v_mfma_f32_16x16x32_bf16 v[108:111], a[128:131], a[8:11], v[108:111]
    v_mfma_f32_16x16x32_bf16 v[140:143], a[128:131], a[12:15], v[140:143]
    buffer_load_dwordx4 a[76:79], v13, s[4:7], s45 offen
    v_mfma_f32_16x16x32_bf16 v[172:175], a[128:131], a[16:19], v[172:175]
    v_mfma_f32_16x16x32_bf16 v[204:207], a[128:131], a[20:23], v[204:207]
    buffer_load_dwordx4 a[80:83], v14, s[4:7], s45 offen
    v_mfma_f32_16x16x32_bf16 v[236:239], a[128:131], a[24:27], v[236:239]
    v_add_u32 v15, s87, v2
    v_add_u32 v16, 57344, v15
    s_waitcnt vmcnt(8) lgkmcnt(0)
    s_barrier
    v_mfma_f32_16x16x32_bf16 v[32:35], a[84:87], a[28:31], v[32:35]
    v_mfma_f32_16x16x32_bf16 v[64:67], a[84:87], a[32:35], v[64:67]
    ds_read_b128 a[116:119], v15 offset:0
    v_mfma_f32_16x16x32_bf16 v[96:99], a[84:87], a[36:39], v[96:99]
    v_mfma_f32_16x16x32_bf16 v[128:131], a[84:87], a[40:43], v[128:131]
    v_mfma_f32_16x16x32_bf16 v[160:163], a[84:87], a[44:47], v[160:163]
    v_mfma_f32_16x16x32_bf16 v[192:195], a[84:87], a[48:51], v[192:195]
    s_add_u32 s45, s42, s88
    buffer_load_dwordx4 a[0:3], v8, s[4:7], s45 offen
    v_mfma_f32_16x16x32_bf16 v[224:227], a[84:87], a[52:55], v[224:227]
    v_mfma_f32_16x16x32_bf16 v[36:39], a[88:91], a[28:31], v[36:39]
    v_mfma_f32_16x16x32_bf16 v[68:71], a[88:91], a[32:35], v[68:71]
    ds_read_b128 a[120:123], v15 offset:14336
    v_mfma_f32_16x16x32_bf16 v[100:103], a[88:91], a[36:39], v[100:103]
    v_mfma_f32_16x16x32_bf16 v[132:135], a[88:91], a[40:43], v[132:135]
    buffer_load_dwordx4 a[4:7], v9, s[4:7], s45 offen
    v_mfma_f32_16x16x32_bf16 v[164:167], a[88:91], a[44:47], v[164:167]
    v_mfma_f32_16x16x32_bf16 v[196:199], a[88:91], a[48:51], v[196:199]
    buffer_load_dwordx4 a[8:11], v10, s[4:7], s45 offen
    v_mfma_f32_16x16x32_bf16 v[228:231], a[88:91], a[52:55], v[228:231]
    v_mfma_f32_16x16x32_bf16 v[40:43], a[92:95], a[28:31], v[40:43]
    v_mfma_f32_16x16x32_bf16 v[72:75], a[92:95], a[32:35], v[72:75]
    ds_read_b128 a[124:127], v15 offset:28672
    v_mfma_f32_16x16x32_bf16 v[104:107], a[92:95], a[36:39], v[104:107]
    v_mfma_f32_16x16x32_bf16 v[136:139], a[92:95], a[40:43], v[136:139]
    buffer_load_dwordx4 a[12:15], v11, s[4:7], s45 offen
    v_mfma_f32_16x16x32_bf16 v[168:171], a[92:95], a[44:47], v[168:171]
    v_mfma_f32_16x16x32_bf16 v[200:203], a[92:95], a[48:51], v[200:203]
    buffer_load_dwordx4 a[16:19], v12, s[4:7], s45 offen
    v_mfma_f32_16x16x32_bf16 v[232:235], a[92:95], a[52:55], v[232:235]
    v_mfma_f32_16x16x32_bf16 v[44:47], a[96:99], a[28:31], v[44:47]
    v_mfma_f32_16x16x32_bf16 v[76:79], a[96:99], a[32:35], v[76:79]
    ds_read_b128 a[128:131], v15 offset:43008
    v_mfma_f32_16x16x32_bf16 v[108:111], a[96:99], a[36:39], v[108:111]
    v_mfma_f32_16x16x32_bf16 v[140:143], a[96:99], a[40:43], v[140:143]
    buffer_load_dwordx4 a[20:23], v13, s[4:7], s45 offen
    v_mfma_f32_16x16x32_bf16 v[172:175], a[96:99], a[44:47], v[172:175]
    v_mfma_f32_16x16x32_bf16 v[204:207], a[96:99], a[48:51], v[204:207]
    buffer_load_dwordx4 a[24:27], v14, s[4:7], s45 offen
    v_mfma_f32_16x16x32_bf16 v[236:239], a[96:99], a[52:55], v[236:239]
    v_add_u32 v15, s88, v2
    v_add_u32 v16, 57344, v15
    s_waitcnt vmcnt(7) lgkmcnt(0)
    s_barrier
    v_mfma_f32_16x16x32_bf16 v[32:35], a[116:119], a[56:59], v[32:35]
    v_mfma_f32_16x16x32_bf16 v[64:67], a[116:119], a[60:63], v[64:67]
    ds_read_b128 a[84:87], v15 offset:0
    v_mfma_f32_16x16x32_bf16 v[96:99], a[116:119], a[64:67], v[96:99]
    v_mfma_f32_16x16x32_bf16 v[128:131], a[116:119], a[68:71], v[128:131]
    v_mfma_f32_16x16x32_bf16 v[160:163], a[116:119], a[72:75], v[160:163]
    v_mfma_f32_16x16x32_bf16 v[192:195], a[116:119], a[76:79], v[192:195]
    s_add_u32 s45, s42, s89
    buffer_load_dwordx4 a[28:31], v8, s[4:7], s45 offen
    v_mfma_f32_16x16x32_bf16 v[224:227], a[116:119], a[80:83], v[224:227]
    v_mfma_f32_16x16x32_bf16 v[36:39], a[120:123], a[56:59], v[36:39]
    v_mfma_f32_16x16x32_bf16 v[68:71], a[120:123], a[60:63], v[68:71]
    ds_read_b128 a[88:91], v15 offset:14336
    v_mfma_f32_16x16x32_bf16 v[100:103], a[120:123], a[64:67], v[100:103]
    v_mfma_f32_16x16x32_bf16 v[132:135], a[120:123], a[68:71], v[132:135]
    buffer_load_dwordx4 a[32:35], v9, s[4:7], s45 offen
    v_mfma_f32_16x16x32_bf16 v[164:167], a[120:123], a[72:75], v[164:167]
    v_mfma_f32_16x16x32_bf16 v[196:199], a[120:123], a[76:79], v[196:199]
    buffer_load_dwordx4 a[36:39], v10, s[4:7], s45 offen
    v_mfma_f32_16x16x32_bf16 v[228:231], a[120:123], a[80:83], v[228:231]
    v_mfma_f32_16x16x32_bf16 v[40:43], a[124:127], a[56:59], v[40:43]
    v_mfma_f32_16x16x32_bf16 v[72:75], a[124:127], a[60:63], v[72:75]
    ds_read_b128 a[92:95], v15 offset:28672
    v_mfma_f32_16x16x32_bf16 v[104:107], a[124:127], a[64:67], v[104:107]
    v_mfma_f32_16x16x32_bf16 v[136:139], a[124:127], a[68:71], v[136:139]
    buffer_load_dwordx4 a[40:43], v11, s[4:7], s45 offen
    v_mfma_f32_16x16x32_bf16 v[168:171], a[124:127], a[72:75], v[168:171]
    v_mfma_f32_16x16x32_bf16 v[200:203], a[124:127], a[76:79], v[200:203]
    buffer_load_dwordx4 a[44:47], v12, s[4:7], s45 offen
    v_mfma_f32_16x16x32_bf16 v[232:235], a[124:127], a[80:83], v[232:235]
    v_mfma_f32_16x16x32_bf16 v[44:47], a[128:131], a[56:59], v[44:47]
    v_mfma_f32_16x16x32_bf16 v[76:79], a[128:131], a[60:63], v[76:79]
    ds_read_b128 a[96:99], v15 offset:43008
    v_mfma_f32_16x16x32_bf16 v[108:111], a[128:131], a[64:67], v[108:111]
    v_mfma_f32_16x16x32_bf16 v[140:143], a[128:131], a[68:71], v[140:143]
    buffer_load_dwordx4 a[48:51], v13, s[4:7], s45 offen
    v_mfma_f32_16x16x32_bf16 v[172:175], a[128:131], a[72:75], v[172:175]
    v_mfma_f32_16x16x32_bf16 v[204:207], a[128:131], a[76:79], v[204:207]
    buffer_load_dwordx4 a[52:55], v14, s[4:7], s45 offen
    v_mfma_f32_16x16x32_bf16 v[236:239], a[128:131], a[80:83], v[236:239]
    v_add_u32 v15, s89, v2
    v_add_u32 v16, 57344, v15
    s_waitcnt vmcnt(7) lgkmcnt(0)
    s_barrier
    v_mfma_f32_16x16x32_bf16 v[32:35], a[84:87], a[0:3], v[32:35]
    v_mfma_f32_16x16x32_bf16 v[64:67], a[84:87], a[4:7], v[64:67]
    ds_read_b128 a[116:119], v15 offset:0
    v_mfma_f32_16x16x32_bf16 v[96:99], a[84:87], a[8:11], v[96:99]
    v_mfma_f32_16x16x32_bf16 v[128:131], a[84:87], a[12:15], v[128:131]
    v_mfma_f32_16x16x32_bf16 v[160:163], a[84:87], a[16:19], v[160:163]
    v_mfma_f32_16x16x32_bf16 v[192:195], a[84:87], a[20:23], v[192:195]
    v_mfma_f32_16x16x32_bf16 v[224:227], a[84:87], a[24:27], v[224:227]
    v_mfma_f32_16x16x32_bf16 v[36:39], a[88:91], a[0:3], v[36:39]
    v_mfma_f32_16x16x32_bf16 v[68:71], a[88:91], a[4:7], v[68:71]
    ds_read_b128 a[120:123], v15 offset:14336
    v_mfma_f32_16x16x32_bf16 v[100:103], a[88:91], a[8:11], v[100:103]
    v_mfma_f32_16x16x32_bf16 v[132:135], a[88:91], a[12:15], v[132:135]
    v_mfma_f32_16x16x32_bf16 v[164:167], a[88:91], a[16:19], v[164:167]
    v_mfma_f32_16x16x32_bf16 v[196:199], a[88:91], a[20:23], v[196:199]
    v_mfma_f32_16x16x32_bf16 v[228:231], a[88:91], a[24:27], v[228:231]
    v_mfma_f32_16x16x32_bf16 v[40:43], a[92:95], a[0:3], v[40:43]
    v_mfma_f32_16x16x32_bf16 v[72:75], a[92:95], a[4:7], v[72:75]
    ds_read_b128 a[124:127], v15 offset:28672
    v_mfma_f32_16x16x32_bf16 v[104:107], a[92:95], a[8:11], v[104:107]
    v_mfma_f32_16x16x32_bf16 v[136:139], a[92:95], a[12:15], v[136:139]
    v_mfma_f32_16x16x32_bf16 v[168:171], a[92:95], a[16:19], v[168:171]
    v_mfma_f32_16x16x32_bf16 v[200:203], a[92:95], a[20:23], v[200:203]
    v_mfma_f32_16x16x32_bf16 v[232:235], a[92:95], a[24:27], v[232:235]
    v_mfma_f32_16x16x32_bf16 v[44:47], a[96:99], a[0:3], v[44:47]
    v_mfma_f32_16x16x32_bf16 v[76:79], a[96:99], a[4:7], v[76:79]
    ds_read_b128 a[128:131], v15 offset:43008
    v_mfma_f32_16x16x32_bf16 v[108:111], a[96:99], a[8:11], v[108:111]
    v_mfma_f32_16x16x32_bf16 v[140:143], a[96:99], a[12:15], v[140:143]
    v_mfma_f32_16x16x32_bf16 v[172:175], a[96:99], a[16:19], v[172:175]
    v_mfma_f32_16x16x32_bf16 v[204:207], a[96:99], a[20:23], v[204:207]
    v_mfma_f32_16x16x32_bf16 v[236:239], a[96:99], a[24:27], v[236:239]
    s_waitcnt vmcnt(0) lgkmcnt(0)
    v_mfma_f32_16x16x32_bf16 v[32:35], a[116:119], a[28:31], v[32:35]
    v_mfma_f32_16x16x32_bf16 v[64:67], a[116:119], a[32:35], v[64:67]
    v_mfma_f32_16x16x32_bf16 v[96:99], a[116:119], a[36:39], v[96:99]
    v_mfma_f32_16x16x32_bf16 v[128:131], a[116:119], a[40:43], v[128:131]
    v_mfma_f32_16x16x32_bf16 v[160:163], a[116:119], a[44:47], v[160:163]
    v_mfma_f32_16x16x32_bf16 v[192:195], a[116:119], a[48:51], v[192:195]
    v_mfma_f32_16x16x32_bf16 v[224:227], a[116:119], a[52:55], v[224:227]
    v_mfma_f32_16x16x32_bf16 v[36:39], a[120:123], a[28:31], v[36:39]
    v_mfma_f32_16x16x32_bf16 v[68:71], a[120:123], a[32:35], v[68:71]
    v_mfma_f32_16x16x32_bf16 v[100:103], a[120:123], a[36:39], v[100:103]
    v_mfma_f32_16x16x32_bf16 v[132:135], a[120:123], a[40:43], v[132:135]
    v_mfma_f32_16x16x32_bf16 v[164:167], a[120:123], a[44:47], v[164:167]
    v_mfma_f32_16x16x32_bf16 v[196:199], a[120:123], a[48:51], v[196:199]
    v_mfma_f32_16x16x32_bf16 v[228:231], a[120:123], a[52:55], v[228:231]
    v_mfma_f32_16x16x32_bf16 v[40:43], a[124:127], a[28:31], v[40:43]
    v_mfma_f32_16x16x32_bf16 v[72:75], a[124:127], a[32:35], v[72:75]
    v_mfma_f32_16x16x32_bf16 v[104:107], a[124:127], a[36:39], v[104:107]
    v_mfma_f32_16x16x32_bf16 v[136:139], a[124:127], a[40:43], v[136:139]
    v_mfma_f32_16x16x32_bf16 v[168:171], a[124:127], a[44:47], v[168:171]
    v_mfma_f32_16x16x32_bf16 v[200:203], a[124:127], a[48:51], v[200:203]
    v_mfma_f32_16x16x32_bf16 v[232:235], a[124:127], a[52:55], v[232:235]
    v_mfma_f32_16x16x32_bf16 v[44:47], a[128:131], a[28:31], v[44:47]
    v_mfma_f32_16x16x32_bf16 v[76:79], a[128:131], a[32:35], v[76:79]
    v_mfma_f32_16x16x32_bf16 v[108:111], a[128:131], a[36:39], v[108:111]
    v_mfma_f32_16x16x32_bf16 v[140:143], a[128:131], a[40:43], v[140:143]
    v_mfma_f32_16x16x32_bf16 v[172:175], a[128:131], a[44:47], v[172:175]
    v_mfma_f32_16x16x32_bf16 v[204:207], a[128:131], a[48:51], v[204:207]
    v_mfma_f32_16x16x32_bf16 v[236:239], a[128:131], a[52:55], v[236:239]
    s_mul_i32 s40, s61, 917504
    s_lshl_b32 s41, s60, 11
    s_add_u32 s40, s40, s41
    s_add_u32 s40, s40, 18350080
    s_mul_i32 s41, s13, 7
    s_add_u32 s42, s41, 0
    s_lshr_b32 s43, s42, 1
    s_lshl_b32 s43, s43, 15
    s_and_b32 s42, s42, 1
    s_lshl_b32 s42, s42, 10
    s_add_u32 s44, s40, s43
    s_add_u32 s44, s44, s42
    s_add_u32 s42, s41, 1
    s_lshr_b32 s43, s42, 1
    s_lshl_b32 s43, s43, 15
    s_and_b32 s42, s42, 1
    s_lshl_b32 s42, s42, 10
    s_add_u32 s45, s40, s43
    s_add_u32 s45, s45, s42
    s_add_u32 s42, s41, 2
    s_lshr_b32 s43, s42, 1
    s_lshl_b32 s43, s43, 15
    s_and_b32 s42, s42, 1
    s_lshl_b32 s42, s42, 10
    s_add_u32 s46, s40, s43
    s_add_u32 s46, s46, s42
    s_add_u32 s42, s41, 3
    s_lshr_b32 s43, s42, 1
    s_lshl_b32 s43, s43, 15
    s_and_b32 s42, s42, 1
    s_lshl_b32 s42, s42, 10
    s_add_u32 s47, s40, s43
    s_add_u32 s47, s47, s42
    s_add_u32 s42, s41, 4
    s_lshr_b32 s43, s42, 1
    s_lshl_b32 s43, s43, 15
    s_and_b32 s42, s42, 1
    s_lshl_b32 s42, s42, 10
    s_add_u32 s48, s40, s43
    s_add_u32 s48, s48, s42
    s_add_u32 s42, s41, 5
    s_lshr_b32 s43, s42, 1
    s_lshl_b32 s43, s43, 15
    s_and_b32 s42, s42, 1
    s_lshl_b32 s42, s42, 10
    s_add_u32 s49, s40, s43
    s_add_u32 s49, s49, s42
    s_add_u32 s42, s41, 6
    s_lshr_b32 s43, s42, 1
    s_lshl_b32 s43, s43, 15
    s_and_b32 s42, s42, 1
    s_lshl_b32 s42, s42, 10
    s_add_u32 s50, s40, s43
    s_add_u32 s50, s50, s42
    v_cvt_pk_bf16_f32 v32, v32, v33
    v_cvt_pk_bf16_f32 v33, v34, v35
    v_cvt_pk_bf16_f32 v34, v36, v37
    v_cvt_pk_bf16_f32 v35, v38, v39
    buffer_store_dwordx4 v[32:35], v2, s[4:7], s44 offen sc1
    s_add_u32 s44, s44, 458752
    v_cvt_pk_bf16_f32 v64, v64, v65
    v_cvt_pk_bf16_f32 v65, v66, v67
    v_cvt_pk_bf16_f32 v66, v68, v69
    v_cvt_pk_bf16_f32 v67, v70, v71
    buffer_store_dwordx4 v[64:67], v2, s[4:7], s45 offen sc1
    s_add_u32 s45, s45, 458752
    v_cvt_pk_bf16_f32 v96, v96, v97
    v_cvt_pk_bf16_f32 v97, v98, v99
    v_cvt_pk_bf16_f32 v98, v100, v101
    v_cvt_pk_bf16_f32 v99, v102, v103
    buffer_store_dwordx4 v[96:99], v2, s[4:7], s46 offen sc1
    s_add_u32 s46, s46, 458752
    v_cvt_pk_bf16_f32 v128, v128, v129
    v_cvt_pk_bf16_f32 v129, v130, v131
    v_cvt_pk_bf16_f32 v130, v132, v133
    v_cvt_pk_bf16_f32 v131, v134, v135
    buffer_store_dwordx4 v[128:131], v2, s[4:7], s47 offen sc1
    s_add_u32 s47, s47, 458752
    v_cvt_pk_bf16_f32 v160, v160, v161
    v_cvt_pk_bf16_f32 v161, v162, v163
    v_cvt_pk_bf16_f32 v162, v164, v165
    v_cvt_pk_bf16_f32 v163, v166, v167
    buffer_store_dwordx4 v[160:163], v2, s[4:7], s48 offen sc1
    s_add_u32 s48, s48, 458752
    v_cvt_pk_bf16_f32 v192, v192, v193
    v_cvt_pk_bf16_f32 v193, v194, v195
    v_cvt_pk_bf16_f32 v194, v196, v197
    v_cvt_pk_bf16_f32 v195, v198, v199
    buffer_store_dwordx4 v[192:195], v2, s[4:7], s49 offen sc1
    s_add_u32 s49, s49, 458752
    v_cvt_pk_bf16_f32 v224, v224, v225
    v_cvt_pk_bf16_f32 v225, v226, v227
    v_cvt_pk_bf16_f32 v226, v228, v229
    v_cvt_pk_bf16_f32 v227, v230, v231
    buffer_store_dwordx4 v[224:227], v2, s[4:7], s50 offen sc1
    s_add_u32 s50, s50, 458752
    v_cvt_pk_bf16_f32 v40, v40, v41
    v_cvt_pk_bf16_f32 v41, v42, v43
    v_cvt_pk_bf16_f32 v42, v44, v45
    v_cvt_pk_bf16_f32 v43, v46, v47
    buffer_store_dwordx4 v[40:43], v2, s[4:7], s44 offen sc1
    s_add_u32 s44, s44, 458752
    v_cvt_pk_bf16_f32 v72, v72, v73
    v_cvt_pk_bf16_f32 v73, v74, v75
    v_cvt_pk_bf16_f32 v74, v76, v77
    v_cvt_pk_bf16_f32 v75, v78, v79
    buffer_store_dwordx4 v[72:75], v2, s[4:7], s45 offen sc1
    s_add_u32 s45, s45, 458752
    v_cvt_pk_bf16_f32 v104, v104, v105
    v_cvt_pk_bf16_f32 v105, v106, v107
    v_cvt_pk_bf16_f32 v106, v108, v109
    v_cvt_pk_bf16_f32 v107, v110, v111
    buffer_store_dwordx4 v[104:107], v2, s[4:7], s46 offen sc1
    s_add_u32 s46, s46, 458752
    v_cvt_pk_bf16_f32 v136, v136, v137
    v_cvt_pk_bf16_f32 v137, v138, v139
    v_cvt_pk_bf16_f32 v138, v140, v141
    v_cvt_pk_bf16_f32 v139, v142, v143
    buffer_store_dwordx4 v[136:139], v2, s[4:7], s47 offen sc1
    s_add_u32 s47, s47, 458752
    v_cvt_pk_bf16_f32 v168, v168, v169
    v_cvt_pk_bf16_f32 v169, v170, v171
    v_cvt_pk_bf16_f32 v170, v172, v173
    v_cvt_pk_bf16_f32 v171, v174, v175
    buffer_store_dwordx4 v[168:171], v2, s[4:7], s48 offen sc1
    s_add_u32 s48, s48, 458752
    v_cvt_pk_bf16_f32 v200, v200, v201
    v_cvt_pk_bf16_f32 v201, v202, v203
    v_cvt_pk_bf16_f32 v202, v204, v205
    v_cvt_pk_bf16_f32 v203, v206, v207
    buffer_store_dwordx4 v[200:203], v2, s[4:7], s49 offen sc1
    s_add_u32 s49, s49, 458752
    v_cvt_pk_bf16_f32 v232, v232, v233
    v_cvt_pk_bf16_f32 v233, v234, v235
    v_cvt_pk_bf16_f32 v234, v236, v237
    v_cvt_pk_bf16_f32 v235, v238, v239
    buffer_store_dwordx4 v[232:235], v2, s[4:7], s50 offen sc1
    s_add_u32 s50, s50, 458752
    s_mov_b32 s40, 67678208
    s_waitcnt vmcnt(0)
    s_barrier
    s_cmp_lg_u32 s13, 0
    s_cbranch_scc1 Lsg_6
    s_mov_b64 exec, 1
    v_mov_b32 v3, 2
    buffer_atomic_add v3, off, s[4:7], s40
    s_mov_b64 exec, -1
Lsg_6:
    s_branch W_next
T_Uq:
    s_mul_i32 s40, s13, 14336
    s_add_u32 s40, s40, 12845056
    s_mul_i32 s42, s60, 401408
    s_mul_i32 s43, s64, 100352
    s_add_u32 s42, s42, s43
    s_add_u32 s42, s42, 6422528
    v_add_u32 v8, 0, v2
    v_add_u32 v9, 14336, v2
    v_add_u32 v10, 28672, v2
    v_add_u32 v11, 43008, v2
    v_add_u32 v12, 57344, v2
    v_add_u32 v13, 71680, v2
    v_add_u32 v14, 86016, v2
    buffer_load_dwordx4 a[0:3], v2, s[4:7], s40 offen offset:0
    buffer_load_dwordx4 a[4:7], v8, s[4:7], s42 offen offset:0
    buffer_load_dwordx4 a[8:11], v9, s[4:7], s42 offen offset:0
    buffer_load_dwordx4 a[12:15], v10, s[4:7], s42 offen offset:0
    buffer_load_dwordx4 a[16:19], v11, s[4:7], s42 offen offset:0
    buffer_load_dwordx4 a[20:23], v12, s[4:7], s42 offen offset:0
    buffer_load_dwordx4 a[24:27], v13, s[4:7], s42 offen offset:0
    buffer_load_dwordx4 a[28:31], v14, s[4:7], s42 offen offset:0
    buffer_load_dwordx4 a[32:35], v2, s[4:7], s40 offen offset:1024
    buffer_load_dwordx4 a[36:39], v8, s[4:7], s42 offen offset:1024
    buffer_load_dwordx4 a[40:43], v9, s[4:7], s42 offen offset:1024
    buffer_load_dwordx4 a[44:47], v10, s[4:7], s42 offen offset:1024
    buffer_load_dwordx4 a[48:51], v11, s[4:7], s42 offen offset:1024
    buffer_load_dwordx4 a[52:55], v12, s[4:7], s42 offen offset:1024
    buffer_load_dwordx4 a[56:59], v13, s[4:7], s42 offen offset:1024
    buffer_load_dwordx4 a[60:63], v14, s[4:7], s42 offen offset:1024
    buffer_load_dwordx4 a[64:67], v2, s[4:7], s40 offen offset:2048
    buffer_load_dwordx4 a[68:71], v8, s[4:7], s42 offen offset:2048
    buffer_load_dwordx4 a[72:75], v9, s[4:7], s42 offen offset:2048
    buffer_load_dwordx4 a[76:79], v10, s[4:7], s42 offen offset:2048
    buffer_load_dwordx4 a[80:83], v11, s[4:7], s42 offen offset:2048
    buffer_load_dwordx4 a[84:87], v12, s[4:7], s42 offen offset:2048
    buffer_load_dwordx4 a[88:91], v13, s[4:7], s42 offen offset:2048
    buffer_load_dwordx4 a[92:95], v14, s[4:7], s42 offen offset:2048
    buffer_load_dwordx4 a[96:99], v2, s[4:7], s40 offen offset:3072
    buffer_load_dwordx4 a[100:103], v8, s[4:7], s42 offen offset:3072
    buffer_load_dwordx4 a[104:107], v9, s[4:7], s42 offen offset:3072
    buffer_load_dwordx4 a[108:111], v10, s[4:7], s42 offen offset:3072
    buffer_load_dwordx4 a[112:115], v11, s[4:7], s42 offen offset:3072
    buffer_load_dwordx4 a[116:119], v12, s[4:7], s42 offen offset:3072
    buffer_load_dwordx4 a[120:123], v13, s[4:7], s42 offen offset:3072
    buffer_load_dwordx4 a[124:127], v14, s[4:7], s42 offen offset:3072
    s_add_u32 s40, s40, 4096
    s_add_u32 s42, s42, 4096
    buffer_load_dwordx4 a[128:131], v2, s[4:7], s40 offen offset:0
    buffer_load_dwordx4 a[132:135], v8, s[4:7], s42 offen offset:0
    buffer_load_dwordx4 a[136:139], v9, s[4:7], s42 offen offset:0
    buffer_load_dwordx4 a[140:143], v10, s[4:7], s42 offen offset:0
    buffer_load_dwordx4 a[144:147], v11, s[4:7], s42 offen offset:0
    buffer_load_dwordx4 a[148:151], v12, s[4:7], s42 offen offset:0
    buffer_load_dwordx4 a[152:155], v13, s[4:7], s42 offen offset:0
    buffer_load_dwordx4 a[156:159], v14, s[4:7], s42 offen offset:0
    buffer_load_dwordx4 a[160:163], v2, s[4:7], s40 offen offset:1024
    buffer_load_dwordx4 a[164:167], v8, s[4:7], s42 offen offset:1024
    buffer_load_dwordx4 a[168:171], v9, s[4:7], s42 offen offset:1024
    buffer_load_dwordx4 a[172:175], v10, s[4:7], s42 offen offset:1024
    buffer_load_dwordx4 a[176:179], v11, s[4:7], s42 offen offset:1024
    buffer_load_dwordx4 a[180:183], v12, s[4:7], s42 offen offset:1024
    buffer_load_dwordx4 a[184:187], v13, s[4:7], s42 offen offset:1024
    buffer_load_dwordx4 a[188:191], v14, s[4:7], s42 offen offset:1024
    s_waitcnt vmcnt(40)
    v_mfma_f32_16x16x32_bf16 v[32:35], a[0:3], a[4:7], 0
    v_mfma_f32_16x16x32_bf16 v[36:39], a[0:3], a[8:11], 0
    v_mfma_f32_16x16x32_bf16 v[40:43], a[0:3], a[12:15], 0
    v_mfma_f32_16x16x32_bf16 v[44:47], a[0:3], a[16:19], 0
    v_mfma_f32_16x16x32_bf16 v[48:51], a[0:3], a[20:23], 0
    v_mfma_f32_16x16x32_bf16 v[52:55], a[0:3], a[24:27], 0
    v_mfma_f32_16x16x32_bf16 v[56:59], a[0:3], a[28:31], 0
    buffer_load_dwordx4 a[0:3], v2, s[4:7], s40 offen offset:2048
    buffer_load_dwordx4 a[4:7], v8, s[4:7], s42 offen offset:2048
    buffer_load_dwordx4 a[8:11], v9, s[4:7], s42 offen offset:2048
    buffer_load_dwordx4 a[12:15], v10, s[4:7], s42 offen offset:2048
    buffer_load_dwordx4 a[16:19], v11, s[4:7], s42 offen offset:2048
    buffer_load_dwordx4 a[20:23], v12, s[4:7], s42 offen offset:2048
    buffer_load_dwordx4 a[24:27], v13, s[4:7], s42 offen offset:2048
    buffer_load_dwordx4 a[28:31], v14, s[4:7], s42 offen offset:2048
    s_waitcnt vmcnt(40)
    v_mfma_f32_16x16x32_bf16 v[32:35], a[32:35], a[36:39], v[32:35]
    v_mfma_f32_16x16x32_bf16 v[36:39], a[32:35], a[40:43], v[36:39]
    v_mfma_f32_16x16x32_bf16 v[40:43], a[32:35], a[44:47], v[40:43]
    v_mfma_f32_16x16x32_bf16 v[44:47], a[32:35], a[48:51], v[44:47]
    v_mfma_f32_16x16x32_bf16 v[48:51], a[32:35], a[52:55], v[48:51]
    v_mfma_f32_16x16x32_bf16 v[52:55], a[32:35], a[56:59], v[52:55]
    v_mfma_f32_16x16x32_bf16 v[56:59], a[32:35], a[60:63], v[56:59]
    buffer_load_dwordx4 a[32:35], v2, s[4:7], s40 offen offset:3072
    buffer_load_dwordx4 a[36:39], v8, s[4:7], s42 offen offset:3072
    buffer_load_dwordx4 a[40:43], v9, s[4:7], s42 offen offset:3072
    buffer_load_dwordx4 a[44:47], v10, s[4:7], s42 offen offset:3072
    buffer_load_dwordx4 a[48:51], v11, s[4:7], s42 offen offset:3072
    buffer_load_dwordx4 a[52:55], v12, s[4:7], s42 offen offset:3072
    buffer_load_dwordx4 a[56:59], v13, s[4:7], s42 offen offset:3072
    buffer_load_dwordx4 a[60:63], v14, s[4:7], s42 offen offset:3072
    s_add_u32 s40, s40, 4096
    s_add_u32 s42, s42, 4096
    s_waitcnt vmcnt(40)
    v_mfma_f32_16x16x32_bf16 v[32:35], a[64:67], a[68:71], v[32:35]
    v_mfma_f32_16x16x32_bf16 v[36:39], a[64:67], a[72:75], v[36:39]
    v_mfma_f32_16x16x32_bf16 v[40:43], a[64:67], a[76:79], v[40:43]
    v_mfma_f32_16x16x32_bf16 v[44:47], a[64:67], a[80:83], v[44:47]
    v_mfma_f32_16x16x32_bf16 v[48:51], a[64:67], a[84:87], v[48:51]
    v_mfma_f32_16x16x32_bf16 v[52:55], a[64:67], a[88:91], v[52:55]
    v_mfma_f32_16x16x32_bf16 v[56:59], a[64:67], a[92:95], v[56:59]
    buffer_load_dwordx4 a[64:67], v2, s[4:7], s40 offen offset:0
    buffer_load_dwordx4 a[68:71], v8, s[4:7], s42 offen offset:0
    buffer_load_dwordx4 a[72:75], v9, s[4:7], s42 offen offset:0
    buffer_load_dwordx4 a[76:79], v10, s[4:7], s42 offen offset:0
    buffer_load_dwordx4 a[80:83], v11, s[4:7], s42 offen offset:0
    buffer_load_dwordx4 a[84:87], v12, s[4:7], s42 offen offset:0
    buffer_load_dwordx4 a[88:91], v13, s[4:7], s42 offen offset:0
    buffer_load_dwordx4 a[92:95], v14, s[4:7], s42 offen offset:0
    s_waitcnt vmcnt(40)
    v_mfma_f32_16x16x32_bf16 v[32:35], a[96:99], a[100:103], v[32:35]
    v_mfma_f32_16x16x32_bf16 v[36:39], a[96:99], a[104:107], v[36:39]
    v_mfma_f32_16x16x32_bf16 v[40:43], a[96:99], a[108:111], v[40:43]
    v_mfma_f32_16x16x32_bf16 v[44:47], a[96:99], a[112:115], v[44:47]
    v_mfma_f32_16x16x32_bf16 v[48:51], a[96:99], a[116:119], v[48:51]
    v_mfma_f32_16x16x32_bf16 v[52:55], a[96:99], a[120:123], v[52:55]
    v_mfma_f32_16x16x32_bf16 v[56:59], a[96:99], a[124:127], v[56:59]
    buffer_load_dwordx4 a[96:99], v2, s[4:7], s40 offen offset:1024
    buffer_load_dwordx4 a[100:103], v8, s[4:7], s42 offen offset:1024
    buffer_load_dwordx4 a[104:107], v9, s[4:7], s42 offen offset:1024
    buffer_load_dwordx4 a[108:111], v10, s[4:7], s42 offen offset:1024
    buffer_load_dwordx4 a[112:115], v11, s[4:7], s42 offen offset:1024
    buffer_load_dwordx4 a[116:119], v12, s[4:7], s42 offen offset:1024
    buffer_load_dwordx4 a[120:123], v13, s[4:7], s42 offen offset:1024
    buffer_load_dwordx4 a[124:127], v14, s[4:7], s42 offen offset:1024
    s_waitcnt vmcnt(40)
    v_mfma_f32_16x16x32_bf16 v[32:35], a[128:131], a[132:135], v[32:35]
    v_mfma_f32_16x16x32_bf16 v[36:39], a[128:131], a[136:139], v[36:39]
    v_mfma_f32_16x16x32_bf16 v[40:43], a[128:131], a[140:143], v[40:43]
    v_mfma_f32_16x16x32_bf16 v[44:47], a[128:131], a[144:147], v[44:47]
    v_mfma_f32_16x16x32_bf16 v[48:51], a[128:131], a[148:151], v[48:51]
    v_mfma_f32_16x16x32_bf16 v[52:55], a[128:131], a[152:155], v[52:55]
    v_mfma_f32_16x16x32_bf16 v[56:59], a[128:131], a[156:159], v[56:59]
    buffer_load_dwordx4 a[128:131], v2, s[4:7], s40 offen offset:2048
    buffer_load_dwordx4 a[132:135], v8, s[4:7], s42 offen offset:2048
    buffer_load_dwordx4 a[136:139], v9, s[4:7], s42 offen offset:2048
    buffer_load_dwordx4 a[140:143], v10, s[4:7], s42 offen offset:2048
    buffer_load_dwordx4 a[144:147], v11, s[4:7], s42 offen offset:2048
    buffer_load_dwordx4 a[148:151], v12, s[4:7], s42 offen offset:2048
    buffer_load_dwordx4 a[152:155], v13, s[4:7], s42 offen offset:2048
    buffer_load_dwordx4 a[156:159], v14, s[4:7], s42 offen offset:2048
    s_waitcnt vmcnt(40)
    v_mfma_f32_16x16x32_bf16 v[32:35], a[160:163], a[164:167], v[32:35]
    v_mfma_f32_16x16x32_bf16 v[36:39], a[160:163], a[168:171], v[36:39]
    v_mfma_f32_16x16x32_bf16 v[40:43], a[160:163], a[172:175], v[40:43]
    v_mfma_f32_16x16x32_bf16 v[44:47], a[160:163], a[176:179], v[44:47]
    v_mfma_f32_16x16x32_bf16 v[48:51], a[160:163], a[180:183], v[48:51]
    v_mfma_f32_16x16x32_bf16 v[52:55], a[160:163], a[184:187], v[52:55]
    v_mfma_f32_16x16x32_bf16 v[56:59], a[160:163], a[188:191], v[56:59]
    buffer_load_dwordx4 a[160:163], v2, s[4:7], s40 offen offset:3072
    buffer_load_dwordx4 a[164:167], v8, s[4:7], s42 offen offset:3072
    buffer_load_dwordx4 a[168:171], v9, s[4:7], s42 offen offset:3072
    buffer_load_dwordx4 a[172:175], v10, s[4:7], s42 offen offset:3072
    buffer_load_dwordx4 a[176:179], v11, s[4:7], s42 offen offset:3072
    buffer_load_dwordx4 a[180:183], v12, s[4:7], s42 offen offset:3072
    buffer_load_dwordx4 a[184:187], v13, s[4:7], s42 offen offset:3072
    buffer_load_dwordx4 a[188:191], v14, s[4:7], s42 offen offset:3072
    s_add_u32 s40, s40, 4096
    s_add_u32 s42, s42, 4096
    s_waitcnt vmcnt(40)
    v_mfma_f32_16x16x32_bf16 v[32:35], a[0:3], a[4:7], v[32:35]
    v_mfma_f32_16x16x32_bf16 v[36:39], a[0:3], a[8:11], v[36:39]
    v_mfma_f32_16x16x32_bf16 v[40:43], a[0:3], a[12:15], v[40:43]
    v_mfma_f32_16x16x32_bf16 v[44:47], a[0:3], a[16:19], v[44:47]
    v_mfma_f32_16x16x32_bf16 v[48:51], a[0:3], a[20:23], v[48:51]
    v_mfma_f32_16x16x32_bf16 v[52:55], a[0:3], a[24:27], v[52:55]
    v_mfma_f32_16x16x32_bf16 v[56:59], a[0:3], a[28:31], v[56:59]
    buffer_load_dwordx4 a[0:3], v2, s[4:7], s40 offen offset:0
    buffer_load_dwordx4 a[4:7], v8, s[4:7], s42 offen offset:0
    buffer_load_dwordx4 a[8:11], v9, s[4:7], s42 offen offset:0
    buffer_load_dwordx4 a[12:15], v10, s[4:7], s42 offen offset:0
    buffer_load_dwordx4 a[16:19], v11, s[4:7], s42 offen offset:0
    buffer_load_dwordx4 a[20:23], v12, s[4:7], s42 offen offset:0
    buffer_load_dwordx4 a[24:27], v13, s[4:7], s42 offen offset:0
    buffer_load_dwordx4 a[28:31], v14, s[4:7], s42 offen offset:0
    s_waitcnt vmcnt(40)
    v_mfma_f32_16x16x32_bf16 v[32:35], a[32:35], a[36:39], v[32:35]
    v_mfma_f32_16x16x32_bf16 v[36:39], a[32:35], a[40:43], v[36:39]
    v_mfma_f32_16x16x32_bf16 v[40:43], a[32:35], a[44:47], v[40:43]
    v_mfma_f32_16x16x32_bf16 v[44:47], a[32:35], a[48:51], v[44:47]
    v_mfma_f32_16x16x32_bf16 v[48:51], a[32:35], a[52:55], v[48:51]
    v_mfma_f32_16x16x32_bf16 v[52:55], a[32:35], a[56:59], v[52:55]
    v_mfma_f32_16x16x32_bf16 v[56:59], a[32:35], a[60:63], v[56:59]
    buffer_load_dwordx4 a[32:35], v2, s[4:7], s40 offen offset:1024
    buffer_load_dwordx4 a[36:39], v8, s[4:7], s42 offen offset:1024
    buffer_load_dwordx4 a[40:43], v9, s[4:7], s42 offen offset:1024
    buffer_load_dwordx4 a[44:47], v10, s[4:7], s42 offen offset:1024
    buffer_load_dwordx4 a[48:51], v11, s[4:7], s42 offen offset:1024
    buffer_load_dwordx4 a[52:55], v12, s[4:7], s42 offen offset:1024
    buffer_load_dwordx4 a[56:59], v13, s[4:7], s42 offen offset:1024
    buffer_load_dwordx4 a[60:63], v14, s[4:7], s42 offen offset:1024
    s_waitcnt vmcnt(40)
    v_mfma_f32_16x16x32_bf16 v[32:35], a[64:67], a[68:71], v[32:35]
    v_mfma_f32_16x16x32_bf16 v[36:39], a[64:67], a[72:75], v[36:39]
    v_mfma_f32_16x16x32_bf16 v[40:43], a[64:67], a[76:79], v[40:43]
    v_mfma_f32_16x16x32_bf16 v[44:47], a[64:67], a[80:83], v[44:47]
    v_mfma_f32_16x16x32_bf16 v[48:51], a[64:67], a[84:87], v[48:51]
    v_mfma_f32_16x16x32_bf16 v[52:55], a[64:67], a[88:91], v[52:55]
    v_mfma_f32_16x16x32_bf16 v[56:59], a[64:67], a[92:95], v[56:59]
    s_waitcnt vmcnt(32)
    v_mfma_f32_16x16x32_bf16 v[32:35], a[96:99], a[100:103], v[32:35]
    v_mfma_f32_16x16x32_bf16 v[36:39], a[96:99], a[104:107], v[36:39]
    v_mfma_f32_16x16x32_bf16 v[40:43], a[96:99], a[108:111], v[40:43]
    v_mfma_f32_16x16x32_bf16 v[44:47], a[96:99], a[112:115], v[44:47]
    v_mfma_f32_16x16x32_bf16 v[48:51], a[96:99], a[116:119], v[48:51]
    v_mfma_f32_16x16x32_bf16 v[52:55], a[96:99], a[120:123], v[52:55]
    v_mfma_f32_16x16x32_bf16 v[56:59], a[96:99], a[124:127], v[56:59]
    s_waitcnt vmcnt(24)
    v_mfma_f32_16x16x32_bf16 v[32:35], a[128:131], a[132:135], v[32:35]
    v_mfma_f32_16x16x32_bf16 v[36:39], a[128:131], a[136:139], v[36:39]
    v_mfma_f32_16x16x32_bf16 v[40:43], a[128:131], a[140:143], v[40:43]
    v_mfma_f32_16x16x32_bf16 v[44:47], a[128:131], a[144:147], v[44:47]
    v_mfma_f32_16x16x32_bf16 v[48:51], a[128:131], a[148:151], v[48:51]
    v_mfma_f32_16x16x32_bf16 v[52:55], a[128:131], a[152:155], v[52:55]
    v_mfma_f32_16x16x32_bf16 v[56:59], a[128:131], a[156:159], v[56:59]
    s_waitcnt vmcnt(16)
    v_mfma_f32_16x16x32_bf16 v[32:35], a[160:163], a[164:167], v[32:35]
    v_mfma_f32_16x16x32_bf16 v[36:39], a[160:163], a[168:171], v[36:39]
    v_mfma_f32_16x16x32_bf16 v[40:43], a[160:163], a[172:175], v[40:43]
    v_mfma_f32_16x16x32_bf16 v[44:47], a[160:163], a[176:179], v[44:47]
    v_mfma_f32_16x16x32_bf16 v[48:51], a[160:163], a[180:183], v[48:51]
    v_mfma_f32_16x16x32_bf16 v[52:55], a[160:163], a[184:187], v[52:55]
    v_mfma_f32_16x16x32_bf16 v[56:59], a[160:163], a[188:191], v[56:59]
    s_waitcnt vmcnt(8)
    v_mfma_f32_16x16x32_bf16 v[32:35], a[0:3], a[4:7], v[32:35]
    v_mfma_f32_16x16x32_bf16 v[36:39], a[0:3], a[8:11], v[36:39]
    v_mfma_f32_16x16x32_bf16 v[40:43], a[0:3], a[12:15], v[40:43]
    v_mfma_f32_16x16x32_bf16 v[44:47], a[0:3], a[16:19], v[44:47]
    v_mfma_f32_16x16x32_bf16 v[48:51], a[0:3], a[20:23], v[48:51]
    v_mfma_f32_16x16x32_bf16 v[52:55], a[0:3], a[24:27], v[52:55]
    v_mfma_f32_16x16x32_bf16 v[56:59], a[0:3], a[28:31], v[56:59]
    s_waitcnt vmcnt(0)
    v_mfma_f32_16x16x32_bf16 v[32:35], a[32:35], a[36:39], v[32:35]
    v_mfma_f32_16x16x32_bf16 v[36:39], a[32:35], a[40:43], v[36:39]
    v_mfma_f32_16x16x32_bf16 v[40:43], a[32:35], a[44:47], v[40:43]
    v_mfma_f32_16x16x32_bf16 v[44:47], a[32:35], a[48:51], v[44:47]
    v_mfma_f32_16x16x32_bf16 v[48:51], a[32:35], a[52:55], v[48:51]
    v_mfma_f32_16x16x32_bf16 v[52:55], a[32:35], a[56:59], v[52:55]
    v_mfma_f32_16x16x32_bf16 v[56:59], a[32:35], a[60:63], v[56:59]
    s_lshr_b32 s40, s13, 1
    s_mul_i32 s40, s40, 458752
    s_lshl_b32 s41, s60, 11
    s_add_u32 s40, s40, s41
    s_and_b32 s41, s13, 1
    s_lshl_b32 s41, s41, 3
    s_add_u32 s40, s40, s41
    s_add_u32 s40, s40, 18350080
    s_mul_i32 s41, s64, 7
    s_add_u32 s42, s41, 0
    s_lshr_b32 s43, s42, 1
    s_lshl_b32 s43, s43, 15
    s_and_b32 s42, s42, 1
    s_lshl_b32 s42, s42, 10
    s_add_u32 s43, s43, s42
    s_add_u32 s43, s43, s40
    v_cvt_pk_bf16_f32 v32, v32, v33
    v_cvt_pk_bf16_f32 v33, v34, v35
    buffer_store_dwordx2 v[32:33], v2, s[4:7], s43 offen sc1
    s_add_u32 s42, s41, 1
    s_lshr_b32 s43, s42, 1
    s_lshl_b32 s43, s43, 15
    s_and_b32 s42, s42, 1
    s_lshl_b32 s42, s42, 10
    s_add_u32 s43, s43, s42
    s_add_u32 s43, s43, s40
    v_cvt_pk_bf16_f32 v36, v36, v37
    v_cvt_pk_bf16_f32 v37, v38, v39
    buffer_store_dwordx2 v[36:37], v2, s[4:7], s43 offen sc1
    s_add_u32 s42, s41, 2
    s_lshr_b32 s43, s42, 1
    s_lshl_b32 s43, s43, 15
    s_and_b32 s42, s42, 1
    s_lshl_b32 s42, s42, 10
    s_add_u32 s43, s43, s42
    s_add_u32 s43, s43, s40
    v_cvt_pk_bf16_f32 v40, v40, v41
    v_cvt_pk_bf16_f32 v41, v42, v43
    buffer_store_dwordx2 v[40:41], v2, s[4:7], s43 offen sc1
    s_add_u32 s42, s41, 3
    s_lshr_b32 s43, s42, 1
    s_lshl_b32 s43, s43, 15
    s_and_b32 s42, s42, 1
    s_lshl_b32 s42, s42, 10
    s_add_u32 s43, s43, s42
    s_add_u32 s43, s43, s40
    v_cvt_pk_bf16_f32 v44, v44, v45
    v_cvt_pk_bf16_f32 v45, v46, v47
    buffer_store_dwordx2 v[44:45], v2, s[4:7], s43 offen sc1
    s_add_u32 s42, s41, 4
    s_lshr_b32 s43, s42, 1
    s_lshl_b32 s43, s43, 15
    s_and_b32 s42, s42, 1
    s_lshl_b32 s42, s42, 10
    s_add_u32 s43, s43, s42
    s_add_u32 s43, s43, s40
    v_cvt_pk_bf16_f32 v48, v48, v49
    v_cvt_pk_bf16_f32 v49, v50, v51
    buffer_store_dwordx2 v[48:49], v2, s[4:7], s43 offen sc1
    s_add_u32 s42, s41, 5
    s_lshr_b32 s43, s42, 1
    s_lshl_b32 s43, s43, 15
    s_and_b32 s42, s42, 1
    s_lshl_b32 s42, s42, 10
    s_add_u32 s43, s43, s42
    s_add_u32 s43, s43, s40
    v_cvt_pk_bf16_f32 v52, v52, v53
    v_cvt_pk_bf16_f32 v53, v54, v55
    buffer_store_dwordx2 v[52:53], v2, s[4:7], s43 offen sc1
    s_add_u32 s42, s41, 6
    s_lshr_b32 s43, s42, 1
    s_lshl_b32 s43, s43, 15
    s_and_b32 s42, s42, 1
    s_lshl_b32 s42, s42, 10
    s_add_u32 s43, s43, s42
    s_add_u32 s43, s43, s40
    v_cvt_pk_bf16_f32 v56, v56, v57
    v_cvt_pk_bf16_f32 v57, v58, v59
    buffer_store_dwordx2 v[56:57], v2, s[4:7], s43 offen sc1
    s_mov_b32 s40, 67690752
    s_waitcnt vmcnt(0)
    s_barrier
    s_cmp_lg_u32 s13, 0
    s_cbranch_scc1 Lsg_7
    s_mov_b64 exec, 1
    v_mov_b32 v3, 1
    buffer_atomic_add v3, off, s[4:7], s40
    s_mov_b64 exec, -1
Lsg_7:
    s_branch W_next
T_W:
    v_and_b32 v10, 8, v1
    v_mov_b32 v8, 0x4444
    v_mov_b32 v11, 0xeeee
    v_cmp_ne_u32 vcc, 0, v10
    s_lshl_b32 s62, s61, 2
    s_add_u32 s62, s62, s13
    v_cndmask_b32 v8, v8, v11, vcc
    s_mul_i32 s42, s60, 802816
    s_mul_i32 s43, s64, 100352
    s_add_u32 s42, s42, s43
    s_add_u32 s42, s42, 6422528
    s_add_u32 s43, s42, 0
    buffer_load_dwordx4 a[0:3], v2, s[4:7], s43 offen offset:0
    buffer_load_dwordx4 a[4:7], v2, s[4:7], s43 offen offset:1024
    buffer_load_dwordx4 a[8:11], v2, s[4:7], s43 offen offset:2048
    buffer_load_dwordx4 a[12:15], v2, s[4:7], s43 offen offset:3072
    s_add_u32 s43, s43, 4096
    buffer_load_dwordx4 a[16:19], v2, s[4:7], s43 offen offset:0
    buffer_load_dwordx4 a[20:23], v2, s[4:7], s43 offen offset:1024
    buffer_load_dwordx4 a[24:27], v2, s[4:7], s43 offen offset:2048
    buffer_load_dwordx4 a[28:31], v2, s[4:7], s43 offen offset:3072
    s_add_u32 s43, s43, 4096
    buffer_load_dwordx4 a[32:35], v2, s[4:7], s43 offen offset:0
    buffer_load_dwordx4 a[36:39], v2, s[4:7], s43 offen offset:1024
    buffer_load_dwordx4 a[40:43], v2, s[4:7], s43 offen offset:2048
    buffer_load_dwordx4 a[44:47], v2, s[4:7], s43 offen offset:3072
    s_add_u32 s43, s43, 4096
    buffer_load_dwordx4 a[48:51], v2, s[4:7], s43 offen offset:0
    buffer_load_dwordx4 a[52:55], v2, s[4:7], s43 offen offset:1024
    s_add_u32 s43, s42, 401408
    buffer_load_dwordx4 a[56:59], v2, s[4:7], s43 offen offset:0
    buffer_load_dwordx4 a[60:63], v2, s[4:7], s43 offen offset:1024
    buffer_load_dwordx4 a[64:67], v2, s[4:7], s43 offen offset:2048
    buffer_load_dwordx4 a[68:71], v2, s[4:7], s43 offen offset:3072
    s_add_u32 s43, s43, 4096
    buffer_load_dwordx4 a[72:75], v2, s[4:7], s43 offen offset:0
    buffer_load_dwordx4 a[76:79], v2, s[4:7], s43 offen offset:1024
    buffer_load_dwordx4 a[80:83], v2, s[4:7], s43 offen offset:2048
    buffer_load_dwordx4 a[84:87], v2, s[4:7], s43 offen offset:3072
    s_add_u32 s43, s43, 4096
    buffer_load_dwordx4 a[88:91], v2, s[4:7], s43 offen offset:0
    buffer_load_dwordx4 a[92:95], v2, s[4:7], s43 offen offset:1024
    buffer_load_dwordx4 a[96:99], v2, s[4:7], s43 offen offset:2048
    buffer_load_dwordx4 a[100:103], v2, s[4:7], s43 offen offset:3072
    s_add_u32 s43, s43, 4096
    buffer_load_dwordx4 a[104:107], v2, s[4:7], s43 offen offset:0
    buffer_load_dwordx4 a[108:111], v2, s[4:7], s43 offen offset:1024
    s_add_u32 s43, s42, 14336
    buffer_load_dwordx4 a[112:115], v2, s[4:7], s43 offen offset:0
    buffer_load_dwordx4 a[116:119], v2, s[4:7], s43 offen offset:1024
    buffer_load_dwordx4 a[120:123], v2, s[4:7], s43 offen offset:2048
    buffer_load_dwordx4 a[124:127], v2, s[4:7], s43 offen offset:3072
    s_add_u32 s43, s43, 4096
    buffer_load_dwordx4 a[128:131], v2, s[4:7], s43 offen offset:0
    buffer_load_dwordx4 a[132:135], v2, s[4:7], s43 offen offset:1024
    buffer_load_dwordx4 a[136:139], v2, s[4:7], s43 offen offset:2048
    buffer_load_dwordx4 a[140:143], v2, s[4:7], s43 offen offset:3072
    s_add_u32 s43, s43, 4096
    buffer_load_dwordx4 a[144:147], v2, s[4:7], s43 offen offset:0
    buffer_load_dwordx4 a[148:151], v2, s[4:7], s43 offen offset:1024
    buffer_load_dwordx4 a[152:155], v2, s[4:7], s43 offen offset:2048
    buffer_load_dwordx4 a[156:159], v2, s[4:7], s43 offen offset:3072
    s_add_u32 s43, s43, 4096
    buffer_load_dwordx4 a[160:163], v2, s[4:7], s43 offen offset:0
    buffer_load_dwordx4 a[164:167], v2, s[4:7], s43 offen offset:1024
    s_add_u32 s40, s62, 63
    s_and_b32 s40, s40, 63
    s_mul_i32 s40, s40, 7168
    s_add_u32 s40, s40, 63963136
    s_add_u32 s41, s40, 4096
    s_mov_b32 s20, 0
Lwm_8:
    buffer_load_dwordx4 v[16:19], v2, s[4:7], s40 offen offset:0 sc1
    buffer_load_dwordx4 v[20:23], v2, s[4:7], s40 offen offset:1024 sc1
    buffer_load_dwordx4 v[24:27], v2, s[4:7], s40 offen offset:2048 sc1
    buffer_load_dwordx4 v[28:31], v2, s[4:7], s40 offen offset:3072 sc1
    buffer_load_dwordx4 v[32:35], v2, s[4:7], s41 offen offset:0 sc1
    buffer_load_dwordx4 v[36:39], v2, s[4:7], s41 offen offset:1024 sc1
    buffer_load_dwordx4 v[40:43], v2, s[4:7], s41 offen offset:2048 sc1
    s_add_u32 s20, s20, 1
    s_cmp_gt_u32 s20, s23
    s_cbranch_scc1 L_fail
    s_waitcnt vmcnt(0)
    v_max3_u32 v10, v16, v17, v18
    v_max3_u32 v10, v10, v19, v20
    v_max3_u32 v10, v10, v21, v22
    v_max3_u32 v10, v10, v23, v24
    v_max3_u32 v10, v10, v25, v26
    v_max3_u32 v10, v10, v27, v28
    v_max3_u32 v10, v10, v29, v30
    v_max3_u32 v10, v10, v31, v32
    v_max3_u32 v10, v10, v33, v34
    v_max3_u32 v10, v10, v35, v36
    v_max3_u32 v10, v10, v37, v38
    v_max3_u32 v10, v10, v39, v40
    v_max3_u32 v10, v10, v41, v42
    v_max_u32 v10, v10, v43
    v_cmp_eq_u32 vcc, -1, v10
    s_cbranch_vccz Lwd_9
Lwl_10:
    s_sleep 4
    s_cmp_ge_u32 s61, 14
    s_cbranch_scc1 Lwl_10f
    s_sleep 48
Lwl_10f:
    buffer_load_dword v10, off, s[4:7], s41 offset:2048 sc1
    s_add_u32 s20, s20, 1
    s_cmp_gt_u32 s20, s23
    s_cbranch_scc1 L_fail
    s_waitcnt vmcnt(0)
    v_cmp_eq_u32 vcc, -1, v10
    s_cbranch_vccnz Lwl_10
    s_branch Lwm_8
Lwd_9:
    s_mul_i32 s44, s62, 229376
    s_mul_i32 s45, s60, 28672
    s_add_u32 s44, s44, s45
    s_mul_i32 s45, s64, 7168
    s_add_u32 s44, s44, s45
    s_add_u32 s44, s44, 48168960
    v_mov_b64 v[48:49], 0
    v_mov_b64 v[50:51], 0
    v_mov_b64 v[52:53], 0
    v_mov_b64 v[54:55], 0
    v_mov_b64 v[56:57], 0
    v_mov_b64 v[58:59], 0
    v_mov_b64 v[60:61], 0
    v_mov_b64 v[62:63], 0
    v_mov_b64 v[64:65], 0
    v_mov_b64 v[66:67], 0
    v_mov_b64 v[68:69], 0
    v_mov_b64 v[70:71], 0
    v_mov_b64 v[72:73], 0
    v_mov_b64 v[74:75], 0
    v_mov_b64 v[76:77], 0
    v_mov_b64 v[78:79], 0
    v_mov_b64 v[80:81], 0
    v_mov_b64 v[82:83], 0
    v_mov_b64 v[84:85], 0
    v_mov_b64 v[86:87], 0
    v_mov_b64 v[88:89], 0
    v_mov_b64 v[90:91], 0
    v_mov_b64 v[92:93], 0
    v_mov_b64 v[94:95], 0
    v_mov_b64 v[96:97], 0
    v_mov_b64 v[98:99], 0
    v_mov_b64 v[100:101], 0
    v_mov_b64 v[102:103], 0
    s_add_u32 s43, s42, 415744
    buffer_load_dwordx4 a[168:171], v2, s[4:7], s43 offen offset:0
    buffer_load_dwordx4 a[172:175], v2, s[4:7], s43 offen offset:1024
    buffer_load_dwordx4 a[176:179], v2, s[4:7], s43 offen offset:2048
    buffer_load_dwordx4 a[180:183], v2, s[4:7], s43 offen offset:3072
    s_add_u32 s43, s43, 4096
    buffer_load_dwordx4 a[184:187], v2, s[4:7], s43 offen offset:0
    buffer_load_dwordx4 a[188:191], v2, s[4:7], s43 offen offset:1024
    buffer_load_dwordx4 a[192:195], v2, s[4:7], s43 offen offset:2048
    buffer_load_dwordx4 a[196:199], v2, s[4:7], s43 offen offset:3072
    s_add_u32 s43, s43, 4096
    buffer_load_dwordx4 a[200:203], v2, s[4:7], s43 offen offset:0
    buffer_load_dwordx4 a[204:207], v2, s[4:7], s43 offen offset:1024
    buffer_load_dwordx4 a[208:211], v2, s[4:7], s43 offen offset:2048
    buffer_load_dwordx4 a[212:215], v2, s[4:7], s43 offen offset:3072
    s_add_u32 s43, s43, 4096
    buffer_load_dwordx4 a[216:219], v2, s[4:7], s43 offen offset:0
    buffer_load_dwordx4 a[220:223], v2, s[4:7], s43 offen offset:1024
    v_smfmac_f32_16x16x64_bf16 v[48:51], v[16:19], a[0:7], v8
    v_smfmac_f32_16x16x64_bf16 v[48:51], v[20:23], a[8:15], v8
    v_smfmac_f32_16x16x64_bf16 v[48:51], v[24:27], a[16:23], v8
    v_smfmac_f32_16x16x64_bf16 v[48:51], v[28:31], a[24:31], v8
    v_smfmac_f32_16x16x64_bf16 v[48:51], v[32:35], a[32:39], v8
    v_smfmac_f32_16x16x64_bf16 v[48:51], v[36:39], a[40:47], v8
    v_smfmac_f32_16x16x64_bf16 v[48:51], v[40:43], a[48:55], v8
    s_add_u32 s43, s42, 28672
    buffer_load_dwordx4 a[0:3], v2, s[4:7], s43 offen offset:0
    buffer_load_dwordx4 a[4:7], v2, s[4:7], s43 offen offset:1024
    buffer_load_dwordx4 a[8:11], v2, s[4:7], s43 offen offset:2048
    buffer_load_dwordx4 a[12:15], v2, s[4:7], s43 offen offset:3072
    s_add_u32 s43, s43, 4096
    buffer_load_dwordx4 a[16:19], v2, s[4:7], s43 offen offset:0
    buffer_load_dwordx4 a[20:23], v2, s[4:7], s43 offen offset:1024
    buffer_load_dwordx4 a[24:27], v2, s[4:7], s43 offen offset:2048
    buffer_load_dwordx4 a[28:31], v2, s[4:7], s43 offen offset:3072
    s_add_u32 s43, s43, 4096
    buffer_load_dwordx4 a[32:35], v2, s[4:7], s43 offen offset:0
    buffer_load_dwordx4 a[36:39], v2, s[4:7], s43 offen offset:1024
    buffer_load_dwordx4 a[40:43], v2, s[4:7], s43 offen offset:2048
    buffer_load_dwordx4 a[44:47], v2, s[4:7], s43 offen offset:3072
    s_add_u32 s43, s43, 4096
    buffer_load_dwordx4 a[48:51], v2, s[4:7], s43 offen offset:0
    buffer_load_dwordx4 a[52:55], v2, s[4:7], s43 offen offset:1024
    v_smfmac_f32_16x16x64_bf16 v[52:55], v[16:19], a[56:63], v8
    v_smfmac_f32_16x16x64_bf16 v[52:55], v[20:23], a[64:71], v8
    v_smfmac_f32_16x16x64_bf16 v[52:55], v[24:27], a[72:79], v8
    v_smfmac_f32_16x16x64_bf16 v[52:55], v[28:31], a[80:87], v8
    v_smfmac_f32_16x16x64_bf16 v[52:55], v[32:35], a[88:95], v8
    v_smfmac_f32_16x16x64_bf16 v[52:55], v[36:39], a[96:103], v8
    v_smfmac_f32_16x16x64_bf16 v[52:55], v[40:43], a[104:111], v8
    s_add_u32 s43, s42, 430080
    buffer_load_dwordx4 a[56:59], v2, s[4:7], s43 offen offset:0
    buffer_load_dwordx4 a[60:63], v2, s[4:7], s43 offen offset:1024
    buffer_load_dwordx4 a[64:67], v2, s[4:7], s43 offen offset:2048
    buffer_load_dwordx4 a[68:71], v2, s[4:7], s43 offen offset:3072
    s_add_u32 s43, s43, 4096
    buffer_load_dwordx4 a[72:75], v2, s[4:7], s43 offen offset:0
    buffer_load_dwordx4 a[76:79], v2, s[4:7], s43 offen offset:1024
    buffer_load_dwordx4 a[80:83], v2, s[4:7], s43 offen offset:2048
    buffer_load_dwordx4 a[84:87], v2, s[4:7], s43 offen offset:3072
    s_add_u32 s43, s43, 4096
    buffer_load_dwordx4 a[88:91], v2, s[4:7], s43 offen offset:0
    buffer_load_dwordx4 a[92:95], v2, s[4:7], s43 offen offset:1024
    buffer_load_dwordx4 a[96:99], v2, s[4:7], s43 offen offset:2048
    buffer_load_dwordx4 a[100:103], v2, s[4:7], s43 offen offset:3072
    s_add_u32 s43, s43, 4096
    buffer_load_dwordx4 a[104:107], v2, s[4:7], s43 offen offset:0
    buffer_load_dwordx4 a[108:111], v2, s[4:7], s43 offen offset:1024
    v_smfmac_f32_16x16x64_bf16 v[56:59], v[16:19], a[112:119], v8
    v_smfmac_f32_16x16x64_bf16 v[56:59], v[20:23], a[120:127], v8
    v_smfmac_f32_16x16x64_bf16 v[56:59], v[24:27], a[128:135], v8
    v_smfmac_f32_16x16x64_bf16 v[56:59], v[28:31], a[136:143], v8
    v_smfmac_f32_16x16x64_bf16 v[56:59], v[32:35], a[144:151], v8
    v_smfmac_f32_16x16x64_bf16 v[56:59], v[36:39], a[152:159], v8
    v_smfmac_f32_16x16x64_bf16 v[56:59], v[40:43], a[160:167], v8
    s_add_u32 s43, s42, 43008
    buffer_load_dwordx4 a[112:115], v2, s[4:7], s43 offen offset:0
    buffer_load_dwordx4 a[116:119], v2, s[4:7], s43 offen offset:1024
    buffer_load_dwordx4 a[120:123], v2, s[4:7], s43 offen offset:2048
    buffer_load_dwordx4 a[124:127], v2, s[4:7], s43 offen offset:3072
    s_add_u32 s43, s43, 4096
    buffer_load_dwordx4 a[128:131], v2, s[4:7], s43 offen offset:0
    buffer_load_dwordx4 a[132:135], v2, s[4:7], s43 offen offset:1024
    buffer_load_dwordx4 a[136:139], v2, s[4:7], s43 offen offset:2048
    buffer_load_dwordx4 a[140:143], v2, s[4:7], s43 offen offset:3072
    s_add_u32 s43, s43, 4096
    buffer_load_dwordx4 a[144:147], v2, s[4:7], s43 offen offset:0
    buffer_load_dwordx4 a[148:151], v2, s[4:7], s43 offen offset:1024
    buffer_load_dwordx4 a[152:155], v2, s[4:7], s43 offen offset:2048
    buffer_load_dwordx4 a[156:159], v2, s[4:7], s43 offen offset:3072
    s_add_u32 s43, s43, 4096
    buffer_load_dwordx4 a[160:163], v2, s[4:7], s43 offen offset:0
    buffer_load_dwordx4 a[164:167], v2, s[4:7], s43 offen offset:1024
    s_waitcnt vmcnt(42)
    v_smfmac_f32_16x16x64_bf16 v[60:63], v[16:19], a[168:175], v8
    v_smfmac_f32_16x16x64_bf16 v[60:63], v[20:23], a[176:183], v8
    v_smfmac_f32_16x16x64_bf16 v[60:63], v[24:27], a[184:191], v8
    v_smfmac_f32_16x16x64_bf16 v[60:63], v[28:31], a[192:199], v8
    v_smfmac_f32_16x16x64_bf16 v[60:63], v[32:35], a[200:207], v8
    v_smfmac_f32_16x16x64_bf16 v[60:63], v[36:39], a[208:215], v8
    v_smfmac_f32_16x16x64_bf16 v[60:63], v[40:43], a[216:223], v8
    s_add_u32 s43, s42, 444416
    buffer_load_dwordx4 a[168:171], v2, s[4:7], s43 offen offset:0
    buffer_load_dwordx4 a[172:175], v2, s[4:7], s43 offen offset:1024
    buffer_load_dwordx4 a[176:179], v2, s[4:7], s43 offen offset:2048
    buffer_load_dwordx4 a[180:183], v2, s[4:7], s43 offen offset:3072
    s_add_u32 s43, s43, 4096
    buffer_load_dwordx4 a[184:187], v2, s[4:7], s43 offen offset:0
    buffer_load_dwordx4 a[188:191], v2, s[4:7], s43 offen offset:1024
    buffer_load_dwordx4 a[192:195], v2, s[4:7], s43 offen offset:2048
    buffer_load_dwordx4 a[196:199], v2, s[4:7], s43 offen offset:3072
    s_add_u32 s43, s43, 4096
    buffer_load_dwordx4 a[200:203], v2, s[4:7], s43 offen offset:0
    buffer_load_dwordx4 a[204:207], v2, s[4:7], s43 offen offset:1024
    buffer_load_dwordx4 a[208:211], v2, s[4:7], s43 offen offset:2048
    buffer_load_dwordx4 a[212:215], v2, s[4:7], s43 offen offset:3072
    s_add_u32 s43, s43, 4096
    buffer_load_dwordx4 a[216:219], v2, s[4:7], s43 offen offset:0
    buffer_load_dwordx4 a[220:223], v2, s[4:7], s43 offen offset:1024
    s_waitcnt vmcnt(42)
    v_smfmac_f32_16x16x64_bf16 v[64:67], v[16:19], a[0:7], v8
    v_smfmac_f32_16x16x64_bf16 v[64:67], v[20:23], a[8:15], v8
    v_smfmac_f32_16x16x64_bf16 v[64:67], v[24:27], a[16:23], v8
    v_smfmac_f32_16x16x64_bf16 v[64:67], v[28:31], a[24:31], v8
    v_smfmac_f32_16x16x64_bf16 v[64:67], v[32:35], a[32:39], v8
    v_smfmac_f32_16x16x64_bf16 v[64:67], v[36:39], a[40:47], v8
    v_smfmac_f32_16x16x64_bf16 v[64:67], v[40:43], a[48:55], v8
    s_add_u32 s43, s42, 57344
    buffer_load_dwordx4 a[0:3], v2, s[4:7], s43 offen offset:0
    buffer_load_dwordx4 a[4:7], v2, s[4:7], s43 offen offset:1024
    buffer_load_dwordx4 a[8:11], v2, s[4:7], s43 offen offset:2048
    buffer_load_dwordx4 a[12:15], v2, s[4:7], s43 offen offset:3072
    s_add_u32 s43, s43, 4096
    buffer_load_dwordx4 a[16:19], v2, s[4:7], s43 offen offset:0
    buffer_load_dwordx4 a[20:23], v2, s[4:7], s43 offen offset:1024
    buffer_load_dwordx4 a[24:27], v2, s[4:7], s43 offen offset:2048
    buffer_load_dwordx4 a[28:31], v2, s[4:7], s43 offen offset:3072
    s_add_u32 s43, s43, 4096
    buffer_load_dwordx4 a[32:35], v2, s[4:7], s43 offen offset:0
    buffer_load_dwordx4 a[36:39], v2, s[4:7], s43 offen offset:1024
    buffer_load_dwordx4 a[40:43], v2, s[4:7], s43 offen offset:2048
    buffer_load_dwordx4 a[44:47], v2, s[4:7], s43 offen offset:3072
    s_add_u32 s43, s43, 4096
    buffer_load_dwordx4 a[48:51], v2, s[4:7], s43 offen offset:0
    buffer_load_dwordx4 a[52:55], v2, s[4:7], s43 offen offset:1024
    s_waitcnt vmcnt(42)
    v_smfmac_f32_16x16x64_bf16 v[68:71], v[16:19], a[56:63], v8
    v_smfmac_f32_16x16x64_bf16 v[68:71], v[20:23], a[64:71], v8
    v_smfmac_f32_16x16x64_bf16 v[68:71], v[24:27], a[72:79], v8
    v_smfmac_f32_16x16x64_bf16 v[68:71], v[28:31], a[80:87], v8
    v_smfmac_f32_16x16x64_bf16 v[68:71], v[32:35], a[88:95], v8
    v_smfmac_f32_16x16x64_bf16 v[68:71], v[36:39], a[96:103], v8
    v_smfmac_f32_16x16x64_bf16 v[68:71], v[40:43], a[104:111], v8
    s_add_u32 s43, s42, 458752
    buffer_load_dwordx4 a[56:59], v2, s[4:7], s43 offen offset:0
    buffer_load_dwordx4 a[60:63], v2, s[4:7], s43 offen offset:1024
    buffer_load_dwordx4 a[64:67], v2, s[4:7], s43 offen offset:2048
    buffer_load_dwordx4 a[68:71], v2, s[4:7], s43 offen offset:3072
    s_add_u32 s43, s43, 4096
    buffer_load_dwordx4 a[72:75], v2, s[4:7], s43 offen offset:0
    buffer_load_dwordx4 a[76:79], v2, s[4:7], s43 offen offset:1024
    buffer_load_dwordx4 a[80:83], v2, s[4:7], s43 offen offset:2048
    buffer_load_dwordx4 a[84:87], v2, s[4:7], s43 offen offset:3072
    s_add_u32 s43, s43, 4096
    buffer_load_dwordx4 a[88:91], v2, s[4:7], s43 offen offset:0
    buffer_load_dwordx4 a[92:95], v2, s[4:7], s43 offen offset:1024
    buffer_load_dwordx4 a[96:99], v2, s[4:7], s43 offen offset:2048
    buffer_load_dwordx4 a[100:103], v2, s[4:7], s43 offen offset:3072
    s_add_u32 s43, s43, 4096
    buffer_load_dwordx4 a[104:107], v2, s[4:7], s43 offen offset:0
    buffer_load_dwordx4 a[108:111], v2, s[4:7], s43 offen offset:1024
    s_waitcnt vmcnt(42)
    v_smfmac_f32_16x16x64_bf16 v[72:75], v[16:19], a[112:119], v8
    v_smfmac_f32_16x16x64_bf16 v[72:75], v[20:23], a[120:127], v8
    v_smfmac_f32_16x16x64_bf16 v[72:75], v[24:27], a[128:135], v8
    v_smfmac_f32_16x16x64_bf16 v[72:75], v[28:31], a[136:143], v8
    v_smfmac_f32_16x16x64_bf16 v[72:75], v[32:35], a[144:151], v8
    v_smfmac_f32_16x16x64_bf16 v[72:75], v[36:39], a[152:159], v8
    v_smfmac_f32_16x16x64_bf16 v[72:75], v[40:43], a[160:167], v8
    s_add_u32 s43, s42, 71680
    buffer_load_dwordx4 a[112:115], v2, s[4:7], s43 offen offset:0
    buffer_load_dwordx4 a[116:119], v2, s[4:7], s43 offen offset:1024
    buffer_load_dwordx4 a[120:123], v2, s[4:7], s43 offen offset:2048
    buffer_load_dwordx4 a[124:127], v2, s[4:7], s43 offen offset:3072
    s_add_u32 s43, s43, 4096
    buffer_load_dwordx4 a[128:131], v2, s[4:7], s43 offen offset:0
    buffer_load_dwordx4 a[132:135], v2, s[4:7], s43 offen offset:1024
    buffer_load_dwordx4 a[136:139], v2, s[4:7], s43 offen offset:2048
    buffer_load_dwordx4 a[140:143], v2, s[4:7], s43 offen offset:3072
    s_add_u32 s43, s43, 4096
    buffer_load_dwordx4 a[144:147], v2, s[4:7], s43 offen offset:0
    buffer_load_dwordx4 a[148:151], v2, s[4:7], s43 offen offset:1024
    buffer_load_dwordx4 a[152:155], v2, s[4:7], s43 offen offset:2048
    buffer_load_dwordx4 a[156:159], v2, s[4:7], s43 offen offset:3072
    s_add_u32 s43, s43, 4096
    buffer_load_dwordx4 a[160:163], v2, s[4:7], s43 offen offset:0
    buffer_load_dwordx4 a[164:167], v2, s[4:7], s43 offen offset:1024
    s_waitcnt vmcnt(42)
    v_smfmac_f32_16x16x64_bf16 v[76:79], v[16:19], a[168:175], v8
    v_smfmac_f32_16x16x64_bf16 v[76:79], v[20:23], a[176:183], v8
    v_smfmac_f32_16x16x64_bf16 v[76:79], v[24:27], a[184:191], v8
    v_smfmac_f32_16x16x64_bf16 v[76:79], v[28:31], a[192:199], v8
    v_smfmac_f32_16x16x64_bf16 v[76:79], v[32:35], a[200:207], v8
    v_smfmac_f32_16x16x64_bf16 v[76:79], v[36:39], a[208:215], v8
    v_smfmac_f32_16x16x64_bf16 v[76:79], v[40:43], a[216:223], v8
    s_add_u32 s43, s42, 473088
    buffer_load_dwordx4 a[168:171], v2, s[4:7], s43 offen offset:0
    buffer_load_dwordx4 a[172:175], v2, s[4:7], s43 offen offset:1024
    buffer_load_dwordx4 a[176:179], v2, s[4:7], s43 offen offset:2048
    buffer_load_dwordx4 a[180:183], v2, s[4:7], s43 offen offset:3072
    s_add_u32 s43, s43, 4096
    buffer_load_dwordx4 a[184:187], v2, s[4:7], s43 offen offset:0
    buffer_load_dwordx4 a[188:191], v2, s[4:7], s43 offen offset:1024
    buffer_load_dwordx4 a[192:195], v2, s[4:7], s43 offen offset:2048
    buffer_load_dwordx4 a[196:199], v2, s[4:7], s43 offen offset:3072
    s_add_u32 s43, s43, 4096
    buffer_load_dwordx4 a[200:203], v2, s[4:7], s43 offen offset:0
    buffer_load_dwordx4 a[204:207], v2, s[4:7], s43 offen offset:1024
    buffer_load_dwordx4 a[208:211], v2, s[4:7], s43 offen offset:2048
    buffer_load_dwordx4 a[212:215], v2, s[4:7], s43 offen offset:3072
    s_add_u32 s43, s43, 4096
    buffer_load_dwordx4 a[216:219], v2, s[4:7], s43 offen offset:0
    buffer_load_dwordx4 a[220:223], v2, s[4:7], s43 offen offset:1024
    s_waitcnt vmcnt(42)
    v_smfmac_f32_16x16x64_bf16 v[80:83], v[16:19], a[0:7], v8
    v_smfmac_f32_16x16x64_bf16 v[80:83], v[20:23], a[8:15], v8
    v_smfmac_f32_16x16x64_bf16 v[80:83], v[24:27], a[16:23], v8
    v_smfmac_f32_16x16x64_bf16 v[80:83], v[28:31], a[24:31], v8
    v_smfmac_f32_16x16x64_bf16 v[80:83], v[32:35], a[32:39], v8
    v_smfmac_f32_16x16x64_bf16 v[80:83], v[36:39], a[40:47], v8
    v_smfmac_f32_16x16x64_bf16 v[80:83], v[40:43], a[48:55], v8
    s_add_u32 s43, s42, 86016
    buffer_load_dwordx4 a[0:3], v2, s[4:7], s43 offen offset:0
    buffer_load_dwordx4 a[4:7], v2, s[4:7], s43 offen offset:1024
    buffer_load_dwordx4 a[8:11], v2, s[4:7], s43 offen offset:2048
    buffer_load_dwordx4 a[12:15], v2, s[4:7], s43 offen offset:3072
    s_add_u32 s43, s43, 4096
    buffer_load_dwordx4 a[16:19], v2, s[4:7], s43 offen offset:0
    buffer_load_dwordx4 a[20:23], v2, s[4:7], s43 offen offset:1024
    buffer_load_dwordx4 a[24:27], v2, s[4:7], s43 offen offset:2048
    buffer_load_dwordx4 a[28:31], v2, s[4:7], s43 offen offset:3072
    s_add_u32 s43, s43, 4096
    buffer_load_dwordx4 a[32:35], v2, s[4:7], s43 offen offset:0
    buffer_load_dwordx4 a[36:39], v2, s[4:7], s43 offen offset:1024
    buffer_load_dwordx4 a[40:43], v2, s[4:7], s43 offen offset:2048
    buffer_load_dwordx4 a[44:47], v2, s[4:7], s43 offen offset:3072
    s_add_u32 s43, s43, 4096
    buffer_load_dwordx4 a[48:51], v2, s[4:7], s43 offen offset:0
    buffer_load_dwordx4 a[52:55], v2, s[4:7], s43 offen offset:1024
    s_waitcnt vmcnt(42)
    v_smfmac_f32_16x16x64_bf16 v[84:87], v[16:19], a[56:63], v8
    v_smfmac_f32_16x16x64_bf16 v[84:87], v[20:23], a[64:71], v8
    v_smfmac_f32_16x16x64_bf16 v[84:87], v[24:27], a[72:79], v8
    v_smfmac_f32_16x16x64_bf16 v[84:87], v[28:31], a[80:87], v8
    v_smfmac_f32_16x16x64_bf16 v[84:87], v[32:35], a[88:95], v8
    v_smfmac_f32_16x16x64_bf16 v[84:87], v[36:39], a[96:103], v8
    v_smfmac_f32_16x16x64_bf16 v[84:87], v[40:43], a[104:111], v8
    s_add_u32 s43, s42, 487424
    buffer_load_dwordx4 a[56:59], v2, s[4:7], s43 offen offset:0
    buffer_load_dwordx4 a[60:63], v2, s[4:7], s43 offen offset:1024
    buffer_load_dwordx4 a[64:67], v2, s[4:7], s43 offen offset:2048
    buffer_load_dwordx4 a[68:71], v2, s[4:7], s43 offen offset:3072
    s_add_u32 s43, s43, 4096
    buffer_load_dwordx4 a[72:75], v2, s[4:7], s43 offen offset:0
    buffer_load_dwordx4 a[76:79], v2, s[4:7], s43 offen offset:1024
    buffer_load_dwordx4 a[80:83], v2, s[4:7], s43 offen offset:2048
    buffer_load_dwordx4 a[84:87], v2, s[4:7], s43 offen offset:3072
    s_add_u32 s43, s43, 4096
    buffer_load_dwordx4 a[88:91], v2, s[4:7], s43 offen offset:0
    buffer_load_dwordx4 a[92:95], v2, s[4:7], s43 offen offset:1024
    buffer_load_dwordx4 a[96:99], v2, s[4:7], s43 offen offset:2048
    buffer_load_dwordx4 a[100:103], v2, s[4:7], s43 offen offset:3072
    s_add_u32 s43, s43, 4096
    buffer_load_dwordx4 a[104:107], v2, s[4:7], s43 offen offset:0
    buffer_load_dwordx4 a[108:111], v2, s[4:7], s43 offen offset:1024
    s_waitcnt vmcnt(42)
    v_smfmac_f32_16x16x64_bf16 v[88:91], v[16:19], a[112:119], v8
    v_smfmac_f32_16x16x64_bf16 v[88:91], v[20:23], a[120:127], v8
    v_smfmac_f32_16x16x64_bf16 v[88:91], v[24:27], a[128:135], v8
    v_smfmac_f32_16x16x64_bf16 v[88:91], v[28:31], a[136:143], v8
    v_smfmac_f32_16x16x64_bf16 v[88:91], v[32:35], a[144:151], v8
    v_smfmac_f32_16x16x64_bf16 v[88:91], v[36:39], a[152:159], v8
    v_smfmac_f32_16x16x64_bf16 v[88:91], v[40:43], a[160:167], v8
    s_waitcnt vmcnt(28)
    v_smfmac_f32_16x16x64_bf16 v[92:95], v[16:19], a[168:175], v8
    v_smfmac_f32_16x16x64_bf16 v[92:95], v[20:23], a[176:183], v8
    v_smfmac_f32_16x16x64_bf16 v[92:95], v[24:27], a[184:191], v8
    v_smfmac_f32_16x16x64_bf16 v[92:95], v[28:31], a[192:199], v8
    v_smfmac_f32_16x16x64_bf16 v[92:95], v[32:35], a[200:207], v8
    v_smfmac_f32_16x16x64_bf16 v[92:95], v[36:39], a[208:215], v8
    v_smfmac_f32_16x16x64_bf16 v[92:95], v[40:43], a[216:223], v8
    s_waitcnt vmcnt(14)
    v_smfmac_f32_16x16x64_bf16 v[96:99], v[16:19], a[0:7], v8
    v_smfmac_f32_16x16x64_bf16 v[96:99], v[20:23], a[8:15], v8
    v_smfmac_f32_16x16x64_bf16 v[96:99], v[24:27], a[16:23], v8
    v_smfmac_f32_16x16x64_bf16 v[96:99], v[28:31], a[24:31], v8
    v_smfmac_f32_16x16x64_bf16 v[96:99], v[32:35], a[32:39], v8
    v_smfmac_f32_16x16x64_bf16 v[96:99], v[36:39], a[40:47], v8
    v_smfmac_f32_16x16x64_bf16 v[96:99], v[40:43], a[48:55], v8
    s_waitcnt vmcnt(0)
    v_smfmac_f32_16x16x64_bf16 v[100:103], v[16:19], a[56:63], v8
    v_smfmac_f32_16x16x64_bf16 v[100:103], v[20:23], a[64:71], v8
    v_smfmac_f32_16x16x64_bf16 v[100:103], v[24:27], a[72:79], v8
    v_smfmac_f32_16x16x64_bf16 v[100:103], v[28:31], a[80:87], v8
    v_smfmac_f32_16x16x64_bf16 v[100:103], v[32:35], a[88:95], v8
    v_smfmac_f32_16x16x64_bf16 v[100:103], v[36:39], a[96:103], v8
    v_smfmac_f32_16x16x64_bf16 v[100:103], v[40:43], a[104:111], v8
    s_nop 7
    v_cvt_pk_bf16_f32 v104, v48, v49
    v_cvt_pk_bf16_f32 v105, v52, v53
    v_cvt_pk_bf16_f32 v106, v50, v51
    v_cvt_pk_bf16_f32 v107, v54, v55
    buffer_store_dwordx4 v[104:107], v2, s[4:7], s44 offen offset:0 sc1
    v_cvt_pk_bf16_f32 v108, v56, v57
    v_cvt_pk_bf16_f32 v109, v60, v61
    v_cvt_pk_bf16_f32 v110, v58, v59
    v_cvt_pk_bf16_f32 v111, v62, v63
    buffer_store_dwordx4 v[108:111], v2, s[4:7], s44 offen offset:1024 sc1
    v_cvt_pk_bf16_f32 v112, v64, v65
    v_cvt_pk_bf16_f32 v113, v68, v69
    v_cvt_pk_bf16_f32 v114, v66, v67
    v_cvt_pk_bf16_f32 v115, v70, v71
    buffer_store_dwordx4 v[112:115], v2, s[4:7], s44 offen offset:2048 sc1
    v_cvt_pk_bf16_f32 v116, v72, v73
    v_cvt_pk_bf16_f32 v117, v76, v77
    v_cvt_pk_bf16_f32 v118, v74, v75
    v_cvt_pk_bf16_f32 v119, v78, v79
    buffer_store_dwordx4 v[116:119], v2, s[4:7], s44 offen offset:3072 sc1
    s_add_u32 s44, s44, 4096
    v_cvt_pk_bf16_f32 v120, v80, v81
    v_cvt_pk_bf16_f32 v121, v84, v85
    v_cvt_pk_bf16_f32 v122, v82, v83
    v_cvt_pk_bf16_f32 v123, v86, v87
    buffer_store_dwordx4 v[120:123], v2, s[4:7], s44 offen offset:0 sc1
    v_cvt_pk_bf16_f32 v124, v88, v89
    v_cvt_pk_bf16_f32 v125, v92, v93
    v_cvt_pk_bf16_f32 v126, v90, v91
    v_cvt_pk_bf16_f32 v127, v94, v95
    buffer_store_dwordx4 v[124:127], v2, s[4:7], s44 offen offset:1024 sc1
    v_cvt_pk_bf16_f32 v128, v96, v97
    v_cvt_pk_bf16_f32 v129, v100, v101
    v_cvt_pk_bf16_f32 v130, v98, v99
    v_cvt_pk_bf16_f32 v131, v102, v103
    buffer_store_dwordx4 v[128:131], v2, s[4:7], s44 offen offset:2048 sc1
    s_lshl_b32 s40, s61, 7
    s_add_u32 s40, s40, 67682304
    s_waitcnt vmcnt(0)
    s_barrier
    s_cmp_lg_u32 s13, 0
    s_cbranch_scc1 Lsg_11
    s_mov_b64 exec, 1
    v_mov_b32 v3, 1
    buffer_atomic_add v3, off, s[4:7], s40
    s_mov_b64 exec, -1
Lsg_11:
    s_branch W_next
T_P:
    s_min_u32 s59, s61, 13
    s_lshl_b32 s62, s61, 2
    s_add_u32 s62, s62, s13
    s_mul_i32 s40, s62, 49152
    s_add_u32 s40, s40, 64421888
    s_lshl_b32 s41, s60, 11
    s_add_u32 s41, s41, s40
    s_lshr_b32 s42, s60, 1
    s_lshl_b32 s42, s42, 11
    s_and_b32 s43, s60, 1
    s_lshl_b32 s43, s43, 2
    s_add_u32 s42, s42, s43
    s_add_u32 s42, s42, s40
    s_add_u32 s42, s42, 32768
    v_mov_b32 v20, -1
    v_mov_b32 v21, -1
    v_mov_b32 v22, -1
    v_mov_b32 v23, -1
    buffer_store_dwordx4 v[20:23], v2, s[4:7], s41 offen offset:0 sc1
    buffer_store_dword v20, v2, s[4:7], s42 offen offset:0 sc1
    buffer_store_dword v20, v2, s[4:7], s42 offen offset:8 sc1
    buffer_store_dwordx4 v[20:23], v2, s[4:7], s41 offen offset:1024 sc1
    buffer_store_dword v20, v2, s[4:7], s42 offen offset:1024 sc1
    buffer_store_dword v20, v2, s[4:7], s42 offen offset:1032 sc1
    s_mul_i32 s41, s13, 28672
    s_mul_i32 s40, s61, 114688
    s_add_u32 s40, s40, s41
    s_add_u32 s40, s40, 12845056
    s_mul_i32 s42, s60, 401408
    s_mul_i32 s43, s13, 100352
    s_add_u32 s42, s42, s43
    s_add_u32 s42, s42, 0
    s_add_u32 s76, s59, 0
    s_sub_u32 s43, s76, 14
    s_cmp_ge_u32 s76, 14
    s_cselect_b32 s76, s43, s76
    s_lshl_b32 s76, s76, 10
    s_add_u32 s77, s59, 1
    s_sub_u32 s43, s77, 14
    s_cmp_ge_u32 s77, 14
    s_cselect_b32 s77, s43, s77
    s_lshl_b32 s77, s77, 10
    s_add_u32 s78, s59, 2
    s_sub_u32 s43, s78, 14
    s_cmp_ge_u32 s78, 14
    s_cselect_b32 s78, s43, s78
    s_lshl_b32 s78, s78, 10
    s_add_u32 s79, s59, 3
    s_sub_u32 s43, s79, 14
    s_cmp_ge_u32 s79, 14
    s_cselect_b32 s79, s43, s79
    s_lshl_b32 s79, s79, 10
    s_add_u32 s80, s59, 4
    s_sub_u32 s43, s80, 14
    s_cmp_ge_u32 s80, 14
    s_cselect_b32 s80, s43, s80
    s_lshl_b32 s80, s80, 10
    s_add_u32 s81, s59, 5
    s_sub_u32 s43, s81, 14
    s_cmp_ge_u32 s81, 14
    s_cselect_b32 s81, s43, s81
    s_lshl_b32 s81, s81, 10
    s_add_u32 s82, s59, 6
    s_sub_u32 s43, s82, 14
    s_cmp_ge_u32 s82, 14
    s_cselect_b32 s82, s43, s82
    s_lshl_b32 s82, s82, 10
    s_add_u32 s83, s59, 7
    s_sub_u32 s43, s83, 14
    s_cmp_ge_u32 s83, 14
    s_cselect_b32 s83, s43, s83
    s_lshl_b32 s83, s83, 10
    s_add_u32 s84, s59, 8
    s_sub_u32 s43, s84, 14
    s_cmp_ge_u32 s84, 14
    s_cselect_b32 s84, s43, s84
    s_lshl_b32 s84, s84, 10
    s_add_u32 s85, s59, 9
    s_sub_u32 s43, s85, 14
    s_cmp_ge_u32 s85, 14
    s_cselect_b32 s85, s43, s85
    s_lshl_b32 s85, s85, 10
    s_add_u32 s86, s59, 10
    s_sub_u32 s43, s86, 14
    s_cmp_ge_u32 s86, 14
    s_cselect_b32 s86, s43, s86
    s_lshl_b32 s86, s86, 10
    s_add_u32 s87, s59, 11
    s_sub_u32 s43, s87, 14
    s_cmp_ge_u32 s87, 14
    s_cselect_b32 s87, s43, s87
    s_lshl_b32 s87, s87, 10
    s_add_u32 s88, s59, 12
    s_sub_u32 s43, s88, 14
    s_cmp_ge_u32 s88, 14
    s_cselect_b32 s88, s43, s88
    s_lshl_b32 s88, s88, 10
    s_add_u32 s89, s59, 13
    s_sub_u32 s43, s89, 14
    s_cmp_ge_u32 s89, 14
    s_cselect_b32 s89, s43, s89
    s_lshl_b32 s89, s89, 10
    v_add_u32 v8, 0, v2
    v_add_u32 v9, 14336, v2
    v_add_u32 v10, 28672, v2
    v_add_u32 v11, 43008, v2
    v_add_u32 v12, 57344, v2
    v_add_u32 v13, 71680, v2
    v_add_u32 v14, 86016, v2
    v_add_u32 v17, 14336, v2
    s_barrier
    s_add_u32 s43, s41, s76
    s_mov_b32 m0, s43
    s_add_u32 s44, s40, s76
    buffer_load_dwordx4 v2, s[4:7], s44 offen lds
    s_add_u32 s43, s41, s76
    s_add_u32 s43, s43, 14336
    s_mov_b32 m0, s43
    s_add_u32 s44, s40, s76
    buffer_load_dwordx4 v17, s[4:7], s44 offen lds
    s_add_u32 s45, s42, s76
    buffer_load_dwordx4 a[0:3], v8, s[4:7], s45 offen
    buffer_load_dwordx4 a[4:7], v9, s[4:7], s45 offen
    buffer_load_dwordx4 a[8:11], v10, s[4:7], s45 offen
    buffer_load_dwordx4 a[12:15], v11, s[4:7], s45 offen
    buffer_load_dwordx4 a[16:19], v12, s[4:7], s45 offen
    buffer_load_dwordx4 a[20:23], v13, s[4:7], s45 offen
    buffer_load_dwordx4 a[24:27], v14, s[4:7], s45 offen
    s_add_u32 s43, s41, s77
    s_mov_b32 m0, s43
    s_add_u32 s44, s40, s77
    buffer_load_dwordx4 v2, s[4:7], s44 offen lds
    s_add_u32 s43, s41, s77
    s_add_u32 s43, s43, 14336
    s_mov_b32 m0, s43
    s_add_u32 s44, s40, s77
    buffer_load_dwordx4 v17, s[4:7], s44 offen lds
    s_add_u32 s45, s42, s77
    buffer_load_dwordx4 a[28:31], v8, s[4:7], s45 offen
    buffer_load_dwordx4 a[32:35], v9, s[4:7], s45 offen
    buffer_load_dwordx4 a[36:39], v10, s[4:7], s45 offen
    buffer_load_dwordx4 a[40:43], v11, s[4:7], s45 offen
    buffer_load_dwordx4 a[44:47], v12, s[4:7], s45 offen
    buffer_load_dwordx4 a[48:51], v13, s[4:7], s45 offen
    buffer_load_dwordx4 a[52:55], v14, s[4:7], s45 offen
    s_add_u32 s43, s41, s78
    s_mov_b32 m0, s43
    s_add_u32 s44, s40, s78
    buffer_load_dwordx4 v2, s[4:7], s44 offen lds
    s_add_u32 s43, s41, s78
    s_add_u32 s43, s43, 14336
    s_mov_b32 m0, s43
    s_add_u32 s44, s40, s78
    buffer_load_dwordx4 v17, s[4:7], s44 offen lds
    s_add_u32 s43, s41, s79
    s_mov_b32 m0, s43
    s_add_u32 s44, s40, s79
    buffer_load_dwordx4 v2, s[4:7], s44 offen lds
    s_add_u32 s43, s41, s79
    s_add_u32 s43, s43, 14336
    s_mov_b32 m0, s43
    s_add_u32 s44, s40, s79
    buffer_load_dwordx4 v17, s[4:7], s44 offen lds
    v_add_u32 v15, s76, v2
    v_add_u32 v16, 57344, v15
    s_waitcnt vmcnt(20)
    s_barrier
    ds_read_b128 a[84:87], v15 offset:0
    ds_read_b128 a[88:91], v15 offset:14336
    ds_read_b128 a[92:95], v15 offset:28672
    ds_read_b128 a[96:99], v15 offset:43008
    ds_read_b128 a[100:103], v16 offset:0
    ds_read_b128 a[104:107], v16 offset:14336
    ds_read_b128 a[108:111], v16 offset:28672
    ds_read_b128 a[112:115], v16 offset:43008
    v_add_u32 v15, s77, v2
    v_add_u32 v16, 57344, v15
    s_waitcnt vmcnt(11) lgkmcnt(0)
    s_barrier
    v_mfma_f32_16x16x32_bf16 v[32:35], a[0:3], a[84:87], 0
    v_mfma_f32_16x16x32_bf16 v[64:67], a[4:7], a[84:87], 0
    ds_read_b128 a[116:119], v15 offset:0
    v_mfma_f32_16x16x32_bf16 v[96:99], a[8:11], a[84:87], 0
    v_mfma_f32_16x16x32_bf16 v[128:131], a[12:15], a[84:87], 0
    s_add_u32 s43, s41, s80
    s_mov_b32 m0, s43
    s_add_u32 s44, s40, s80
    buffer_load_dwordx4 v2, s[4:7], s44 offen lds
    v_mfma_f32_16x16x32_bf16 v[160:163], a[16:19], a[84:87], 0
    v_mfma_f32_16x16x32_bf16 v[192:195], a[20:23], a[84:87], 0
    v_mfma_f32_16x16x32_bf16 v[224:227], a[24:27], a[84:87], 0
    v_mfma_f32_16x16x32_bf16 v[36:39], a[0:3], a[88:91], 0
    v_mfma_f32_16x16x32_bf16 v[68:71], a[4:7], a[88:91], 0
    ds_read_b128 a[120:123], v15 offset:14336
    v_mfma_f32_16x16x32_bf16 v[100:103], a[8:11], a[88:91], 0
    v_mfma_f32_16x16x32_bf16 v[132:135], a[12:15], a[88:91], 0
    s_add_u32 s43, s41, s80
    s_add_u32 s43, s43, 14336
    s_mov_b32 m0, s43
    s_add_u32 s44, s40, s80
    buffer_load_dwordx4 v17, s[4:7], s44 offen lds
    v_mfma_f32_16x16x32_bf16 v[164:167], a[16:19], a[88:91], 0
    v_mfma_f32_16x16x32_bf16 v[196:199], a[20:23], a[88:91], 0
    s_add_u32 s45, s42, s78
    buffer_load_dwordx4 a[56:59], v8, s[4:7], s45 offen
    v_mfma_f32_16x16x32_bf16 v[228:231], a[24:27], a[88:91], 0
    v_mfma_f32_16x16x32_bf16 v[40:43], a[0:3], a[92:95], 0
    v_mfma_f32_16x16x32_bf16 v[72:75], a[4:7], a[92:95], 0
    ds_read_b128 a[124:127], v15 offset:28672
    v_mfma_f32_16x16x32_bf16 v[104:107], a[8:11], a[92:95], 0
    v_mfma_f32_16x16x32_bf16 v[136:139], a[12:15], a[92:95], 0
    v_mfma_f32_16x16x32_bf16 v[168:171], a[16:19], a[92:95], 0
    v_mfma_f32_16x16x32_bf16 v[200:203], a[20:23], a[92:95], 0
    buffer_load_dwordx4 a[60:63], v9, s[4:7], s45 offen
    v_mfma_f32_16x16x32_bf16 v[232:235], a[24:27], a[92:95], 0
    v_mfma_f32_16x16x32_bf16 v[44:47], a[0:3], a[96:99], 0
    v_mfma_f32_16x16x32_bf16 v[76:79], a[4:7], a[96:99], 0
    ds_read_b128 a[128:131], v15 offset:43008
    v_mfma_f32_16x16x32_bf16 v[108:111], a[8:11], a[96:99], 0
    v_mfma_f32_16x16x32_bf16 v[140:143], a[12:15], a[96:99], 0
    v_mfma_f32_16x16x32_bf16 v[172:175], a[16:19], a[96:99], 0
    v_mfma_f32_16x16x32_bf16 v[204:207], a[20:23], a[96:99], 0
    buffer_load_dwordx4 a[64:67], v10, s[4:7], s45 offen
    v_mfma_f32_16x16x32_bf16 v[236:239], a[24:27], a[96:99], 0
    v_mfma_f32_16x16x32_bf16 v[48:51], a[0:3], a[100:103], 0
    v_mfma_f32_16x16x32_bf16 v[80:83], a[4:7], a[100:103], 0
    ds_read_b128 a[132:135], v16 offset:0
    v_mfma_f32_16x16x32_bf16 v[112:115], a[8:11], a[100:103], 0
    v_mfma_f32_16x16x32_bf16 v[144:147], a[12:15], a[100:103], 0
    v_mfma_f32_16x16x32_bf16 v[176:179], a[16:19], a[100:103], 0
    v_mfma_f32_16x16x32_bf16 v[208:211], a[20:23], a[100:103], 0
    buffer_load_dwordx4 a[68:71], v11, s[4:7], s45 offen
    v_mfma_f32_16x16x32_bf16 v[240:243], a[24:27], a[100:103], 0
    v_mfma_f32_16x16x32_bf16 v[52:55], a[0:3], a[104:107], 0
    v_mfma_f32_16x16x32_bf16 v[84:87], a[4:7], a[104:107], 0
    ds_read_b128 a[136:139], v16 offset:14336
    v_mfma_f32_16x16x32_bf16 v[116:119], a[8:11], a[104:107], 0
    v_mfma_f32_16x16x32_bf16 v[148:151], a[12:15], a[104:107], 0
    v_mfma_f32_16x16x32_bf16 v[180:183], a[16:19], a[104:107], 0
    v_mfma_f32_16x16x32_bf16 v[212:215], a[20:23], a[104:107], 0
    buffer_load_dwordx4 a[72:75], v12, s[4:7], s45 offen
    v_mfma_f32_16x16x32_bf16 v[244:247], a[24:27], a[104:107], 0
    v_mfma_f32_16x16x32_bf16 v[56:59], a[0:3], a[108:111], 0
    v_mfma_f32_16x16x32_bf16 v[88:91], a[4:7], a[108:111], 0
    ds_read_b128 a[140:143], v16 offset:28672
    v_mfma_f32_16x16x32_bf16 v[120:123], a[8:11], a[108:111], 0
    v_mfma_f32_16x16x32_bf16 v[152:155], a[12:15], a[108:111], 0
    v_mfma_f32_16x16x32_bf16 v[184:187], a[16:19], a[108:111], 0
    v_mfma_f32_16x16x32_bf16 v[216:219], a[20:23], a[108:111], 0
    buffer_load_dwordx4 a[76:79], v13, s[4:7], s45 offen
    v_mfma_f32_16x16x32_bf16 v[248:251], a[24:27], a[108:111], 0
    v_mfma_f32_16x16x32_bf16 v[60:63], a[0:3], a[112:115], 0
    v_mfma_f32_16x16x32_bf16 v[92:95], a[4:7], a[112:115], 0
    ds_read_b128 a[144:147], v16 offset:43008
    v_mfma_f32_16x16x32_bf16 v[124:127], a[8:11], a[112:115], 0
    v_mfma_f32_16x16x32_bf16 v[156:159], a[12:15], a[112:115], 0
    v_mfma_f32_16x16x32_bf16 v[188:191], a[16:19], a[112:115], 0
    v_mfma_f32_16x16x32_bf16 v[220:223], a[20:23], a[112:115], 0
    buffer_load_dwordx4 a[80:83], v14, s[4:7], s45 offen
    v_mfma_f32_16x16x32_bf16 v[252:255], a[24:27], a[112:115], 0
    v_add_u32 v15, s78, v2
    v_add_u32 v16, 57344, v15
    s_waitcnt vmcnt(11) lgkmcnt(0)
    s_barrier
    v_mfma_f32_16x16x32_bf16 v[32:35], a[28:31], a[116:119], v[32:35]
    v_mfma_f32_16x16x32_bf16 v[64:67], a[32:35], a[116:119], v[64:67]
    ds_read_b128 a[84:87], v15 offset:0
    v_mfma_f32_16x16x32_bf16 v[96:99], a[36:39], a[116:119], v[96:99]
    v_mfma_f32_16x16x32_bf16 v[128:131], a[40:43], a[116:119], v[128:131]
    s_add_u32 s43, s41, s81
    s_mov_b32 m0, s43
    s_add_u32 s44, s40, s81
    buffer_load_dwordx4 v2, s[4:7], s44 offen lds
    v_mfma_f32_16x16x32_bf16 v[160:163], a[44:47], a[116:119], v[160:163]
    v_mfma_f32_16x16x32_bf16 v[192:195], a[48:51], a[116:119], v[192:195]
    v_mfma_f32_16x16x32_bf16 v[224:227], a[52:55], a[116:119], v[224:227]
    v_mfma_f32_16x16x32_bf16 v[36:39], a[28:31], a[120:123], v[36:39]
    v_mfma_f32_16x16x32_bf16 v[68:71], a[32:35], a[120:123], v[68:71]
    ds_read_b128 a[88:91], v15 offset:14336
    v_mfma_f32_16x16x32_bf16 v[100:103], a[36:39], a[120:123], v[100:103]
    v_mfma_f32_16x16x32_bf16 v[132:135], a[40:43], a[120:123], v[132:135]
    s_add_u32 s43, s41, s81
    s_add_u32 s43, s43, 14336
    s_mov_b32 m0, s43
    s_add_u32 s44, s40, s81
    buffer_load_dwordx4 v17, s[4:7], s44 offen lds
    v_mfma_f32_16x16x32_bf16 v[164:167], a[44:47], a[120:123], v[164:167]
    v_mfma_f32_16x16x32_bf16 v[196:199], a[48:51], a[120:123], v[196:199]
    s_add_u32 s45, s42, s79
    buffer_load_dwordx4 a[0:3], v8, s[4:7], s45 offen
    v_mfma_f32_16x16x32_bf16 v[228:231], a[52:55], a[120:123], v[228:231]
    v_mfma_f32_16x16x32_bf16 v[40:43], a[28:31], a[124:127], v[40:43]
    v_mfma_f32_16x16x32_bf16 v[72:75], a[32:35], a[124:127], v[72:75]
    ds_read_b128 a[92:95], v15 offset:28672
    v_mfma_f32_16x16x32_bf16 v[104:107], a[36:39], a[124:127], v[104:107]
    v_mfma_f32_16x16x32_bf16 v[136:139], a[40:43], a[124:127], v[136:139]
    v_mfma_f32_16x16x32_bf16 v[168:171], a[44:47], a[124:127], v[168:171]
    v_mfma_f32_16x16x32_bf16 v[200:203], a[48:51], a[124:127], v[200:203]
    buffer_load_dwordx4 a[4:7], v9, s[4:7], s45 offen
    v_mfma_f32_16x16x32_bf16 v[232:235], a[52:55], a[124:127], v[232:235]
    v_mfma_f32_16x16x32_bf16 v[44:47], a[28:31], a[128:131], v[44:47]
    v_mfma_f32_16x16x32_bf16 v[76:79], a[32:35], a[128:131], v[76:79]
    ds_read_b128 a[96:99], v15 offset:43008
    v_mfma_f32_16x16x32_bf16 v[108:111], a[36:39], a[128:131], v[108:111]
    v_mfma_f32_16x16x32_bf16 v[140:143], a[40:43], a[128:131], v[140:143]
    v_mfma_f32_16x16x32_bf16 v[172:175], a[44:47], a[128:131], v[172:175]
    v_mfma_f32_16x16x32_bf16 v[204:207], a[48:51], a[128:131], v[204:207]
    buffer_load_dwordx4 a[8:11], v10, s[4:7], s45 offen
    v_mfma_f32_16x16x32_bf16 v[236:239], a[52:55], a[128:131], v[236:239]
    v_mfma_f32_16x16x32_bf16 v[48:51], a[28:31], a[132:135], v[48:51]
    v_mfma_f32_16x16x32_bf16 v[80:83], a[32:35], a[132:135], v[80:83]
    ds_read_b128 a[100:103], v16 offset:0
    v_mfma_f32_16x16x32_bf16 v[112:115], a[36:39], a[132:135], v[112:115]
    v_mfma_f32_16x16x32_bf16 v[144:147], a[40:43], a[132:135], v[144:147]
    v_mfma_f32_16x16x32_bf16 v[176:179], a[44:47], a[132:135], v[176:179]
    v_mfma_f32_16x16x32_bf16 v[208:211], a[48:51], a[132:135], v[208:211]
    buffer_load_dwordx4 a[12:15], v11, s[4:7], s45 offen
    v_mfma_f32_16x16x32_bf16 v[240:243], a[52:55], a[132:135], v[240:243]
    v_mfma_f32_16x16x32_bf16 v[52:55], a[28:31], a[136:139], v[52:55]
    v_mfma_f32_16x16x32_bf16 v[84:87], a[32:35], a[136:139], v[84:87]
    ds_read_b128 a[104:107], v16 offset:14336
    v_mfma_f32_16x16x32_bf16 v[116:119], a[36:39], a[136:139], v[116:119]
    v_mfma_f32_16x16x32_bf16 v[148:151], a[40:43], a[136:139], v[148:151]
    v_mfma_f32_16x16x32_bf16 v[180:183], a[44:47], a[136:139], v[180:183]
    v_mfma_f32_16x16x32_bf16 v[212:215], a[48:51], a[136:139], v[212:215]
    buffer_load_dwordx4 a[16:19], v12, s[4:7], s45 offen
    v_mfma_f32_16x16x32_bf16 v[244:247], a[52:55], a[136:139], v[244:247]
    v_mfma_f32_16x16x32_bf16 v[56:59], a[28:31], a[140:143], v[56:59]
    v_mfma_f32_16x16x32_bf16 v[88:91], a[32:35], a[140:143], v[88:91]
    ds_read_b128 a[108:111], v16 offset:28672
    v_mfma_f32_16x16x32_bf16 v[120:123], a[36:39], a[140:143], v[120:123]
    v_mfma_f32_16x16x32_bf16 v[152:155], a[40:43], a[140:143], v[152:155]
    v_mfma_f32_16x16x32_bf16 v[184:187], a[44:47], a[140:143], v[184:187]
    v_mfma_f32_16x16x32_bf16 v[216:219], a[48:51], a[140:143], v[216:219]
    buffer_load_dwordx4 a[20:23], v13, s[4:7], s45 offen
    v_mfma_f32_16x16x32_bf16 v[248:251], a[52:55], a[140:143], v[248:251]
    v_mfma_f32_16x16x32_bf16 v[60:63], a[28:31], a[144:147], v[60:63]
    v_mfma_f32_16x16x32_bf16 v[92:95], a[32:35], a[144:147], v[92:95]
    ds_read_b128 a[112:115], v16 offset:43008
    v_mfma_f32_16x16x32_bf16 v[124:127], a[36:39], a[144:147], v[124:127]
    v_mfma_f32_16x16x32_bf16 v[156:159], a[40:43], a[144:147], v[156:159]
    v_mfma_f32_16x16x32_bf16 v[188:191], a[44:47], a[144:147], v[188:191]
    v_mfma_f32_16x16x32_bf16 v[220:223], a[48:51], a[144:147], v[220:223]
    buffer_load_dwordx4 a[24:27], v14, s[4:7], s45 offen
    v_mfma_f32_16x16x32_bf16 v[252:255], a[52:55], a[144:147], v[252:255]
    v_add_u32 v15, s79, v2
    v_add_u32 v16, 57344, v15
    s_waitcnt vmcnt(9) lgkmcnt(0)
    s_barrier
    v_mfma_f32_16x16x32_bf16 v[32:35], a[56:59], a[84:87], v[32:35]
    v_mfma_f32_16x16x32_bf16 v[64:67], a[60:63], a[84:87], v[64:67]
    ds_read_b128 a[116:119], v15 offset:0
    v_mfma_f32_16x16x32_bf16 v[96:99], a[64:67], a[84:87], v[96:99]
    v_mfma_f32_16x16x32_bf16 v[128:131], a[68:71], a[84:87], v[128:131]
    s_add_u32 s43, s41, s82
    s_mov_b32 m0, s43
    s_add_u32 s44, s40, s82
    buffer_load_dwordx4 v2, s[4:7], s44 offen lds
    v_mfma_f32_16x16x32_bf16 v[160:163], a[72:75], a[84:87], v[160:163]
    v_mfma_f32_16x16x32_bf16 v[192:195], a[76:79], a[84:87], v[192:195]
    v_mfma_f32_16x16x32_bf16 v[224:227], a[80:83], a[84:87], v[224:227]
    v_mfma_f32_16x16x32_bf16 v[36:39], a[56:59], a[88:91], v[36:39]
    v_mfma_f32_16x16x32_bf16 v[68:71], a[60:63], a[88:91], v[68:71]
    ds_read_b128 a[120:123], v15 offset:14336
    v_mfma_f32_16x16x32_bf16 v[100:103], a[64:67], a[88:91], v[100:103]
    v_mfma_f32_16x16x32_bf16 v[132:135], a[68:71], a[88:91], v[132:135]
    s_add_u32 s43, s41, s82
    s_add_u32 s43, s43, 14336
    s_mov_b32 m0, s43
    s_add_u32 s44, s40, s82
    buffer_load_dwordx4 v17, s[4:7], s44 offen lds
    v_mfma_f32_16x16x32_bf16 v[164:167], a[72:75], a[88:91], v[164:167]
    v_mfma_f32_16x16x32_bf16 v[196:199], a[76:79], a[88:91], v[196:199]
    s_add_u32 s45, s42, s80
    buffer_load_dwordx4 a[28:31], v8, s[4:7], s45 offen
    v_mfma_f32_16x16x32_bf16 v[228:231], a[80:83], a[88:91], v[228:231]
    v_mfma_f32_16x16x32_bf16 v[40:43], a[56:59], a[92:95], v[40:43]
    v_mfma_f32_16x16x32_bf16 v[72:75], a[60:63], a[92:95], v[72:75]
    ds_read_b128 a[124:127], v15 offset:28672
    v_mfma_f32_16x16x32_bf16 v[104:107], a[64:67], a[92:95], v[104:107]
    v_mfma_f32_16x16x32_bf16 v[136:139], a[68:71], a[92:95], v[136:139]
    v_mfma_f32_16x16x32_bf16 v[168:171], a[72:75], a[92:95], v[168:171]
    v_mfma_f32_16x16x32_bf16 v[200:203], a[76:79], a[92:95], v[200:203]
    buffer_load_dwordx4 a[32:35], v9, s[4:7], s45 offen
    v_mfma_f32_16x16x32_bf16 v[232:235], a[80:83], a[92:95], v[232:235]
    v_mfma_f32_16x16x32_bf16 v[44:47], a[56:59], a[96:99], v[44:47]
    v_mfma_f32_16x16x32_bf16 v[76:79], a[60:63], a[96:99], v[76:79]
    ds_read_b128 a[128:131], v15 offset:43008
    v_mfma_f32_16x16x32_bf16 v[108:111], a[64:67], a[96:99], v[108:111]
    v_mfma_f32_16x16x32_bf16 v[140:143], a[68:71], a[96:99], v[140:143]
    v_mfma_f32_16x16x32_bf16 v[172:175], a[72:75], a[96:99], v[172:175]
    v_mfma_f32_16x16x32_bf16 v[204:207], a[76:79], a[96:99], v[204:207]
    buffer_load_dwordx4 a[36:39], v10, s[4:7], s45 offen
    v_mfma_f32_16x16x32_bf16 v[236:239], a[80:83], a[96:99], v[236:239]
    v_mfma_f32_16x16x32_bf16 v[48:51], a[56:59], a[100:103], v[48:51]
    v_mfma_f32_16x16x32_bf16 v[80:83], a[60:63], a[100:103], v[80:83]
    ds_read_b128 a[132:135], v16 offset:0
    v_mfma_f32_16x16x32_bf16 v[112:115], a[64:67], a[100:103], v[112:115]
    v_mfma_f32_16x16x32_bf16 v[144:147], a[68:71], a[100:103], v[144:147]
    v_mfma_f32_16x16x32_bf16 v[176:179], a[72:75], a[100:103], v[176:179]
    v_mfma_f32_16x16x32_bf16 v[208:211], a[76:79], a[100:103], v[208:211]
    buffer_load_dwordx4 a[40:43], v11, s[4:7], s45 offen
    v_mfma_f32_16x16x32_bf16 v[240:243], a[80:83], a[100:103], v[240:243]
    v_mfma_f32_16x16x32_bf16 v[52:55], a[56:59], a[104:107], v[52:55]
    v_mfma_f32_16x16x32_bf16 v[84:87], a[60:63], a[104:107], v[84:87]
    ds_read_b128 a[136:139], v16 offset:14336
    v_mfma_f32_16x16x32_bf16 v[116:119], a[64:67], a[104:107], v[116:119]
    v_mfma_f32_16x16x32_bf16 v[148:151], a[68:71], a[104:107], v[148:151]
    v_mfma_f32_16x16x32_bf16 v[180:183], a[72:75], a[104:107], v[180:183]
    v_mfma_f32_16x16x32_bf16 v[212:215], a[76:79], a[104:107], v[212:215]
    buffer_load_dwordx4 a[44:47], v12, s[4:7], s45 offen
    v_mfma_f32_16x16x32_bf16 v[244:247], a[80:83], a[104:107], v[244:247]
    v_mfma_f32_16x16x32_bf16 v[56:59], a[56:59], a[108:111], v[56:59]
    v_mfma_f32_16x16x32_bf16 v[88:91], a[60:63], a[108:111], v[88:91]
    ds_read_b128 a[140:143], v16 offset:28672
    v_mfma_f32_16x16x32_bf16 v[120:123], a[64:67], a[108:111], v[120:123]
    v_mfma_f32_16x16x32_bf16 v[152:155], a[68:71], a[108:111], v[152:155]
    v_mfma_f32_16x16x32_bf16 v[184:187], a[72:75], a[108:111], v[184:187]
    v_mfma_f32_16x16x32_bf16 v[216:219], a[76:79], a[108:111], v[216:219]
    buffer_load_dwordx4 a[48:51], v13, s[4:7], s45 offen
    v_mfma_f32_16x16x32_bf16 v[248:251], a[80:83], a[108:111], v[248:251]
    v_mfma_f32_16x16x32_bf16 v[60:63], a[56:59], a[112:115], v[60:63]
    v_mfma_f32_16x16x32_bf16 v[92:95], a[60:63], a[112:115], v[92:95]
    ds_read_b128 a[144:147], v16 offset:43008
    v_mfma_f32_16x16x32_bf16 v[124:127], a[64:67], a[112:115], v[124:127]
    v_mfma_f32_16x16x32_bf16 v[156:159], a[68:71], a[112:115], v[156:159]
    v_mfma_f32_16x16x32_bf16 v[188:191], a[72:75], a[112:115], v[188:191]
    v_mfma_f32_16x16x32_bf16 v[220:223], a[76:79], a[112:115], v[220:223]
    buffer_load_dwordx4 a[52:55], v14, s[4:7], s45 offen
    v_mfma_f32_16x16x32_bf16 v[252:255], a[80:83], a[112:115], v[252:255]
    v_add_u32 v15, s80, v2
    v_add_u32 v16, 57344, v15
    s_waitcnt vmcnt(9) lgkmcnt(0)
    s_barrier
    v_mfma_f32_16x16x32_bf16 v[32:35], a[0:3], a[116:119], v[32:35]
    v_mfma_f32_16x16x32_bf16 v[64:67], a[4:7], a[116:119], v[64:67]
    ds_read_b128 a[84:87], v15 offset:0
    v_mfma_f32_16x16x32_bf16 v[96:99], a[8:11], a[116:119], v[96:99]
    v_mfma_f32_16x16x32_bf16 v[128:131], a[12:15], a[116:119], v[128:131]
    s_add_u32 s43, s41, s83
    s_mov_b32 m0, s43
    s_add_u32 s44, s40, s83
    buffer_load_dwordx4 v2, s[4:7], s44 offen lds
    v_mfma_f32_16x16x32_bf16 v[160:163], a[16:19], a[116:119], v[160:163]
    v_mfma_f32_16x16x32_bf16 v[192:195], a[20:23], a[116:119], v[192:195]
    v_mfma_f32_16x16x32_bf16 v[224:227], a[24:27], a[116:119], v[224:227]
    v_mfma_f32_16x16x32_bf16 v[36:39], a[0:3], a[120:123], v[36:39]
    v_mfma_f32_16x16x32_bf16 v[68:71], a[4:7], a[120:123], v[68:71]
    ds_read_b128 a[88:91], v15 offset:14336
    v_mfma_f32_16x16x32_bf16 v[100:103], a[8:11], a[120:123], v[100:103]
    v_mfma_f32_16x16x32_bf16 v[132:135], a[12:15], a[120:123], v[132:135]
    s_add_u32 s43, s41, s83
    s_add_u32 s43, s43, 14336
    s_mov_b32 m0, s43
    s_add_u32 s44, s40, s83
    buffer_load_dwordx4 v17, s[4:7], s44 offen lds
    v_mfma_f32_16x16x32_bf16 v[164:167], a[16:19], a[120:123], v[164:167]
    v_mfma_f32_16x16x32_bf16 v[196:199], a[20:23], a[120:123], v[196:199]
    s_add_u32 s45, s42, s81
    buffer_load_dwordx4 a[56:59], v8, s[4:7], s45 offen
    v_mfma_f32_16x16x32_bf16 v[228:231], a[24:27], a[120:123], v[228:231]
    v_mfma_f32_16x16x32_bf16 v[40:43], a[0:3], a[124:127], v[40:43]
    v_mfma_f32_16x16x32_bf16 v[72:75], a[4:7], a[124:127], v[72:75]
    ds_read_b128 a[92:95], v15 offset:28672
    v_mfma_f32_16x16x32_bf16 v[104:107], a[8:11], a[124:127], v[104:107]
    v_mfma_f32_16x16x32_bf16 v[136:139], a[12:15], a[124:127], v[136:139]
    v_mfma_f32_16x16x32_bf16 v[168:171], a[16:19], a[124:127], v[168:171]
    v_mfma_f32_16x16x32_bf16 v[200:203], a[20:23], a[124:127], v[200:203]
    buffer_load_dwordx4 a[60:63], v9, s[4:7], s45 offen
    v_mfma_f32_16x16x32_bf16 v[232:235], a[24:27], a[124:127], v[232:235]
    v_mfma_f32_16x16x32_bf16 v[44:47], a[0:3], a[128:131], v[44:47]
    v_mfma_f32_16x16x32_bf16 v[76:79], a[4:7], a[128:131], v[76:79]
    ds_read_b128 a[96:99], v15 offset:43008
    v_mfma_f32_16x16x32_bf16 v[108:111], a[8:11], a[128:131], v[108:111]
    v_mfma_f32_16x16x32_bf16 v[140:143], a[12:15], a[128:131], v[140:143]
    v_mfma_f32_16x16x32_bf16 v[172:175], a[16:19], a[128:131], v[172:175]
    v_mfma_f32_16x16x32_bf16 v[204:207], a[20:23], a[128:131], v[204:207]
    buffer_load_dwordx4 a[64:67], v10, s[4:7], s45 offen
    v_mfma_f32_16x16x32_bf16 v[236:239], a[24:27], a[128:131], v[236:239]
    v_mfma_f32_16x16x32_bf16 v[48:51], a[0:3], a[132:135], v[48:51]
    v_mfma_f32_16x16x32_bf16 v[80:83], a[4:7], a[132:135], v[80:83]
    ds_read_b128 a[100:103], v16 offset:0
    v_mfma_f32_16x16x32_bf16 v[112:115], a[8:11], a[132:135], v[112:115]
    v_mfma_f32_16x16x32_bf16 v[144:147], a[12:15], a[132:135], v[144:147]
    v_mfma_f32_16x16x32_bf16 v[176:179], a[16:19], a[132:135], v[176:179]
    v_mfma_f32_16x16x32_bf16 v[208:211], a[20:23], a[132:135], v[208:211]
    buffer_load_dwordx4 a[68:71], v11, s[4:7], s45 offen
    v_mfma_f32_16x16x32_bf16 v[240:243], a[24:27], a[132:135], v[240:243]
    v_mfma_f32_16x16x32_bf16 v[52:55], a[0:3], a[136:139], v[52:55]
    v_mfma_f32_16x16x32_bf16 v[84:87], a[4:7], a[136:139], v[84:87]
    ds_read_b128 a[104:107], v16 offset:14336
    v_mfma_f32_16x16x32_bf16 v[116:119], a[8:11], a[136:139], v[116:119]
    v_mfma_f32_16x16x32_bf16 v[148:151], a[12:15], a[136:139], v[148:151]
    v_mfma_f32_16x16x32_bf16 v[180:183], a[16:19], a[136:139], v[180:183]
    v_mfma_f32_16x16x32_bf16 v[212:215], a[20:23], a[136:139], v[212:215]
    buffer_load_dwordx4 a[72:75], v12, s[4:7], s45 offen
    v_mfma_f32_16x16x32_bf16 v[244:247], a[24:27], a[136:139], v[244:247]
    v_mfma_f32_16x16x32_bf16 v[56:59], a[0:3], a[140:143], v[56:59]
    v_mfma_f32_16x16x32_bf16 v[88:91], a[4:7], a[140:143], v[88:91]
    ds_read_b128 a[108:111], v16 offset:28672
    v_mfma_f32_16x16x32_bf16 v[120:123], a[8:11], a[140:143], v[120:123]
    v_mfma_f32_16x16x32_bf16 v[152:155], a[12:15], a[140:143], v[152:155]
    v_mfma_f32_16x16x32_bf16 v[184:187], a[16:19], a[140:143], v[184:187]
    v_mfma_f32_16x16x32_bf16 v[216:219], a[20:23], a[140:143], v[216:219]
    buffer_load_dwordx4 a[76:79], v13, s[4:7], s45 offen
    v_mfma_f32_16x16x32_bf16 v[248:251], a[24:27], a[140:143], v[248:251]
    v_mfma_f32_16x16x32_bf16 v[60:63], a[0:3], a[144:147], v[60:63]
    v_mfma_f32_16x16x32_bf16 v[92:95], a[4:7], a[144:147], v[92:95]
    ds_read_b128 a[112:115], v16 offset:43008
    v_mfma_f32_16x16x32_bf16 v[124:127], a[8:11], a[144:147], v[124:127]
    v_mfma_f32_16x16x32_bf16 v[156:159], a[12:15], a[144:147], v[156:159]
    v_mfma_f32_16x16x32_bf16 v[188:191], a[16:19], a[144:147], v[188:191]
    v_mfma_f32_16x16x32_bf16 v[220:223], a[20:23], a[144:147], v[220:223]
    buffer_load_dwordx4 a[80:83], v14, s[4:7], s45 offen
    v_mfma_f32_16x16x32_bf16 v[252:255], a[24:27], a[144:147], v[252:255]
    v_add_u32 v15, s81, v2
    v_add_u32 v16, 57344, v15
    s_waitcnt vmcnt(9) lgkmcnt(0)
    s_barrier
    v_mfma_f32_16x16x32_bf16 v[32:35], a[28:31], a[84:87], v[32:35]
    v_mfma_f32_16x16x32_bf16 v[64:67], a[32:35], a[84:87], v[64:67]
    ds_read_b128 a[116:119], v15 offset:0
    v_mfma_f32_16x16x32_bf16 v[96:99], a[36:39], a[84:87], v[96:99]
    v_mfma_f32_16x16x32_bf16 v[128:131], a[40:43], a[84:87], v[128:131]
    s_add_u32 s43, s41, s84
    s_mov_b32 m0, s43
    s_add_u32 s44, s40, s84
    buffer_load_dwordx4 v2, s[4:7], s44 offen lds
    v_mfma_f32_16x16x32_bf16 v[160:163], a[44:47], a[84:87], v[160:163]
    v_mfma_f32_16x16x32_bf16 v[192:195], a[48:51], a[84:87], v[192:195]
    v_mfma_f32_16x16x32_bf16 v[224:227], a[52:55], a[84:87], v[224:227]
    v_mfma_f32_16x16x32_bf16 v[36:39], a[28:31], a[88:91], v[36:39]
    v_mfma_f32_16x16x32_bf16 v[68:71], a[32:35], a[88:91], v[68:71]
    ds_read_b128 a[120:123], v15 offset:14336
    v_mfma_f32_16x16x32_bf16 v[100:103], a[36:39], a[88:91], v[100:103]
    v_mfma_f32_16x16x32_bf16 v[132:135], a[40:43], a[88:91], v[132:135]
    s_add_u32 s43, s41, s84
    s_add_u32 s43, s43, 14336
    s_mov_b32 m0, s43
    s_add_u32 s44, s40, s84
    buffer_load_dwordx4 v17, s[4:7], s44 offen lds
    v_mfma_f32_16x16x32_bf16 v[164:167], a[44:47], a[88:91], v[164:167]
    v_mfma_f32_16x16x32_bf16 v[196:199], a[48:51], a[88:91], v[196:199]
    s_add_u32 s45, s42, s82
    buffer_load_dwordx4 a[0:3], v8, s[4:7], s45 offen
    v_mfma_f32_16x16x32_bf16 v[228:231], a[52:55], a[88:91], v[228:231]
    v_mfma_f32_16x16x32_bf16 v[40:43], a[28:31], a[92:95], v[40:43]
    v_mfma_f32_16x16x32_bf16 v[72:75], a[32:35], a[92:95], v[72:75]
    ds_read_b128 a[124:127], v15 offset:28672
    v_mfma_f32_16x16x32_bf16 v[104:107], a[36:39], a[92:95], v[104:107]
    v_mfma_f32_16x16x32_bf16 v[136:139], a[40:43], a[92:95], v[136:139]
    v_mfma_f32_16x16x32_bf16 v[168:171], a[44:47], a[92:95], v[168:171]
    v_mfma_f32_16x16x32_bf16 v[200:203], a[48:51], a[92:95], v[200:203]
    buffer_load_dwordx4 a[4:7], v9, s[4:7], s45 offen
    v_mfma_f32_16x16x32_bf16 v[232:235], a[52:55], a[92:95], v[232:235]
    v_mfma_f32_16x16x32_bf16 v[44:47], a[28:31], a[96:99], v[44:47]
    v_mfma_f32_16x16x32_bf16 v[76:79], a[32:35], a[96:99], v[76:79]
    ds_read_b128 a[128:131], v15 offset:43008
    v_mfma_f32_16x16x32_bf16 v[108:111], a[36:39], a[96:99], v[108:111]
    v_mfma_f32_16x16x32_bf16 v[140:143], a[40:43], a[96:99], v[140:143]
    v_mfma_f32_16x16x32_bf16 v[172:175], a[44:47], a[96:99], v[172:175]
    v_mfma_f32_16x16x32_bf16 v[204:207], a[48:51], a[96:99], v[204:207]
    buffer_load_dwordx4 a[8:11], v10, s[4:7], s45 offen
    v_mfma_f32_16x16x32_bf16 v[236:239], a[52:55], a[96:99], v[236:239]
    v_mfma_f32_16x16x32_bf16 v[48:51], a[28:31], a[100:103], v[48:51]
    v_mfma_f32_16x16x32_bf16 v[80:83], a[32:35], a[100:103], v[80:83]
    ds_read_b128 a[132:135], v16 offset:0
    v_mfma_f32_16x16x32_bf16 v[112:115], a[36:39], a[100:103], v[112:115]
    v_mfma_f32_16x16x32_bf16 v[144:147], a[40:43], a[100:103], v[144:147]
    v_mfma_f32_16x16x32_bf16 v[176:179], a[44:47], a[100:103], v[176:179]
    v_mfma_f32_16x16x32_bf16 v[208:211], a[48:51], a[100:103], v[208:211]
    buffer_load_dwordx4 a[12:15], v11, s[4:7], s45 offen
    v_mfma_f32_16x16x32_bf16 v[240:243], a[52:55], a[100:103], v[240:243]
    v_mfma_f32_16x16x32_bf16 v[52:55], a[28:31], a[104:107], v[52:55]
    v_mfma_f32_16x16x32_bf16 v[84:87], a[32:35], a[104:107], v[84:87]
    ds_read_b128 a[136:139], v16 offset:14336
    v_mfma_f32_16x16x32_bf16 v[116:119], a[36:39], a[104:107], v[116:119]
    v_mfma_f32_16x16x32_bf16 v[148:151], a[40:43], a[104:107], v[148:151]
    v_mfma_f32_16x16x32_bf16 v[180:183], a[44:47], a[104:107], v[180:183]
    v_mfma_f32_16x16x32_bf16 v[212:215], a[48:51], a[104:107], v[212:215]
    buffer_load_dwordx4 a[16:19], v12, s[4:7], s45 offen
    v_mfma_f32_16x16x32_bf16 v[244:247], a[52:55], a[104:107], v[244:247]
    v_mfma_f32_16x16x32_bf16 v[56:59], a[28:31], a[108:111], v[56:59]
    v_mfma_f32_16x16x32_bf16 v[88:91], a[32:35], a[108:111], v[88:91]
    ds_read_b128 a[140:143], v16 offset:28672
    v_mfma_f32_16x16x32_bf16 v[120:123], a[36:39], a[108:111], v[120:123]
    v_mfma_f32_16x16x32_bf16 v[152:155], a[40:43], a[108:111], v[152:155]
    v_mfma_f32_16x16x32_bf16 v[184:187], a[44:47], a[108:111], v[184:187]
    v_mfma_f32_16x16x32_bf16 v[216:219], a[48:51], a[108:111], v[216:219]
    buffer_load_dwordx4 a[20:23], v13, s[4:7], s45 offen
    v_mfma_f32_16x16x32_bf16 v[248:251], a[52:55], a[108:111], v[248:251]
    v_mfma_f32_16x16x32_bf16 v[60:63], a[28:31], a[112:115], v[60:63]
    v_mfma_f32_16x16x32_bf16 v[92:95], a[32:35], a[112:115], v[92:95]
    ds_read_b128 a[144:147], v16 offset:43008
    v_mfma_f32_16x16x32_bf16 v[124:127], a[36:39], a[112:115], v[124:127]
    v_mfma_f32_16x16x32_bf16 v[156:159], a[40:43], a[112:115], v[156:159]
    v_mfma_f32_16x16x32_bf16 v[188:191], a[44:47], a[112:115], v[188:191]
    v_mfma_f32_16x16x32_bf16 v[220:223], a[48:51], a[112:115], v[220:223]
    buffer_load_dwordx4 a[24:27], v14, s[4:7], s45 offen
    v_mfma_f32_16x16x32_bf16 v[252:255], a[52:55], a[112:115], v[252:255]
    v_add_u32 v15, s82, v2
    v_add_u32 v16, 57344, v15
    s_waitcnt vmcnt(9) lgkmcnt(0)
    s_barrier
    v_mfma_f32_16x16x32_bf16 v[32:35], a[56:59], a[116:119], v[32:35]
    v_mfma_f32_16x16x32_bf16 v[64:67], a[60:63], a[116:119], v[64:67]
    ds_read_b128 a[84:87], v15 offset:0
    v_mfma_f32_16x16x32_bf16 v[96:99], a[64:67], a[116:119], v[96:99]
    v_mfma_f32_16x16x32_bf16 v[128:131], a[68:71], a[116:119], v[128:131]
    s_add_u32 s43, s41, s85
    s_mov_b32 m0, s43
    s_add_u32 s44, s40, s85
    buffer_load_dwordx4 v2, s[4:7], s44 offen lds
    v_mfma_f32_16x16x32_bf16 v[160:163], a[72:75], a[116:119], v[160:163]
    v_mfma_f32_16x16x32_bf16 v[192:195], a[76:79], a[116:119], v[192:195]
    v_mfma_f32_16x16x32_bf16 v[224:227], a[80:83], a[116:119], v[224:227]
    v_mfma_f32_16x16x32_bf16 v[36:39], a[56:59], a[120:123], v[36:39]
    v_mfma_f32_16x16x32_bf16 v[68:71], a[60:63], a[120:123], v[68:71]
    ds_read_b128 a[88:91], v15 offset:14336
    v_mfma_f32_16x16x32_bf16 v[100:103], a[64:67], a[120:123], v[100:103]
    v_mfma_f32_16x16x32_bf16 v[132:135], a[68:71], a[120:123], v[132:135]
    s_add_u32 s43, s41, s85
    s_add_u32 s43, s43, 14336
    s_mov_b32 m0, s43
    s_add_u32 s44, s40, s85
    buffer_load_dwordx4 v17, s[4:7], s44 offen lds
    v_mfma_f32_16x16x32_bf16 v[164:167], a[72:75], a[120:123], v[164:167]
    v_mfma_f32_16x16x32_bf16 v[196:199], a[76:79], a[120:123], v[196:199]
    s_add_u32 s45, s42, s83
    buffer_load_dwordx4 a[28:31], v8, s[4:7], s45 offen
    v_mfma_f32_16x16x32_bf16 v[228:231], a[80:83], a[120:123], v[228:231]
    v_mfma_f32_16x16x32_bf16 v[40:43], a[56:59], a[124:127], v[40:43]
    v_mfma_f32_16x16x32_bf16 v[72:75], a[60:63], a[124:127], v[72:75]
    ds_read_b128 a[92:95], v15 offset:28672
    v_mfma_f32_16x16x32_bf16 v[104:107], a[64:67], a[124:127], v[104:107]
    v_mfma_f32_16x16x32_bf16 v[136:139], a[68:71], a[124:127], v[136:139]
    v_mfma_f32_16x16x32_bf16 v[168:171], a[72:75], a[124:127], v[168:171]
    v_mfma_f32_16x16x32_bf16 v[200:203], a[76:79], a[124:127], v[200:203]
    buffer_load_dwordx4 a[32:35], v9, s[4:7], s45 offen
    v_mfma_f32_16x16x32_bf16 v[232:235], a[80:83], a[124:127], v[232:235]
    v_mfma_f32_16x16x32_bf16 v[44:47], a[56:59], a[128:131], v[44:47]
    v_mfma_f32_16x16x32_bf16 v[76:79], a[60:63], a[128:131], v[76:79]
    ds_read_b128 a[96:99], v15 offset:43008
    v_mfma_f32_16x16x32_bf16 v[108:111], a[64:67], a[128:131], v[108:111]
    v_mfma_f32_16x16x32_bf16 v[140:143], a[68:71], a[128:131], v[140:143]
    v_mfma_f32_16x16x32_bf16 v[172:175], a[72:75], a[128:131], v[172:175]
    v_mfma_f32_16x16x32_bf16 v[204:207], a[76:79], a[128:131], v[204:207]
    buffer_load_dwordx4 a[36:39], v10, s[4:7], s45 offen
    v_mfma_f32_16x16x32_bf16 v[236:239], a[80:83], a[128:131], v[236:239]
    v_mfma_f32_16x16x32_bf16 v[48:51], a[56:59], a[132:135], v[48:51]
    v_mfma_f32_16x16x32_bf16 v[80:83], a[60:63], a[132:135], v[80:83]
    ds_read_b128 a[100:103], v16 offset:0
    v_mfma_f32_16x16x32_bf16 v[112:115], a[64:67], a[132:135], v[112:115]
    v_mfma_f32_16x16x32_bf16 v[144:147], a[68:71], a[132:135], v[144:147]
    v_mfma_f32_16x16x32_bf16 v[176:179], a[72:75], a[132:135], v[176:179]
    v_mfma_f32_16x16x32_bf16 v[208:211], a[76:79], a[132:135], v[208:211]
    buffer_load_dwordx4 a[40:43], v11, s[4:7], s45 offen
    v_mfma_f32_16x16x32_bf16 v[240:243], a[80:83], a[132:135], v[240:243]
    v_mfma_f32_16x16x32_bf16 v[52:55], a[56:59], a[136:139], v[52:55]
    v_mfma_f32_16x16x32_bf16 v[84:87], a[60:63], a[136:139], v[84:87]
    ds_read_b128 a[104:107], v16 offset:14336
    v_mfma_f32_16x16x32_bf16 v[116:119], a[64:67], a[136:139], v[116:119]
    v_mfma_f32_16x16x32_bf16 v[148:151], a[68:71], a[136:139], v[148:151]
    v_mfma_f32_16x16x32_bf16 v[180:183], a[72:75], a[136:139], v[180:183]
    v_mfma_f32_16x16x32_bf16 v[212:215], a[76:79], a[136:139], v[212:215]
    buffer_load_dwordx4 a[44:47], v12, s[4:7], s45 offen
    v_mfma_f32_16x16x32_bf16 v[244:247], a[80:83], a[136:139], v[244:247]
    v_mfma_f32_16x16x32_bf16 v[56:59], a[56:59], a[140:143], v[56:59]
    v_mfma_f32_16x16x32_bf16 v[88:91], a[60:63], a[140:143], v[88:91]
    ds_read_b128 a[108:111], v16 offset:28672
    v_mfma_f32_16x16x32_bf16 v[120:123], a[64:67], a[140:143], v[120:123]
    v_mfma_f32_16x16x32_bf16 v[152:155], a[68:71], a[140:143], v[152:155]
    v_mfma_f32_16x16x32_bf16 v[184:187], a[72:75], a[140:143], v[184:187]
    v_mfma_f32_16x16x32_bf16 v[216:219], a[76:79], a[140:143], v[216:219]
    buffer_load_dwordx4 a[48:51], v13, s[4:7], s45 offen
    v_mfma_f32_16x16x32_bf16 v[248:251], a[80:83], a[140:143], v[248:251]
    v_mfma_f32_16x16x32_bf16 v[60:63], a[56:59], a[144:147], v[60:63]
    v_mfma_f32_16x16x32_bf16 v[92:95], a[60:63], a[144:147], v[92:95]
    ds_read_b128 a[112:115], v16 offset:43008
    v_mfma_f32_16x16x32_bf16 v[124:127], a[64:67], a[144:147], v[124:127]
    v_mfma_f32_16x16x32_bf16 v[156:159], a[68:71], a[144:147], v[156:159]
    v_mfma_f32_16x16x32_bf16 v[188:191], a[72:75], a[144:147], v[188:191]
    v_mfma_f32_16x16x32_bf16 v[220:223], a[76:79], a[144:147], v[220:223]
    buffer_load_dwordx4 a[52:55], v14, s[4:7], s45 offen
    v_mfma_f32_16x16x32_bf16 v[252:255], a[80:83], a[144:147], v[252:255]
    v_add_u32 v15, s83, v2
    v_add_u32 v16, 57344, v15
    s_waitcnt vmcnt(9) lgkmcnt(0)
    s_barrier
    v_mfma_f32_16x16x32_bf16 v[32:35], a[0:3], a[84:87], v[32:35]
    v_mfma_f32_16x16x32_bf16 v[64:67], a[4:7], a[84:87], v[64:67]
    ds_read_b128 a[116:119], v15 offset:0
    v_mfma_f32_16x16x32_bf16 v[96:99], a[8:11], a[84:87], v[96:99]
    v_mfma_f32_16x16x32_bf16 v[128:131], a[12:15], a[84:87], v[128:131]
    s_add_u32 s43, s41, s86
    s_mov_b32 m0, s43
    s_add_u32 s44, s40, s86
    buffer_load_dwordx4 v2, s[4:7], s44 offen lds
    v_mfma_f32_16x16x32_bf16 v[160:163], a[16:19], a[84:87], v[160:163]
    v_mfma_f32_16x16x32_bf16 v[192:195], a[20:23], a[84:87], v[192:195]
    v_mfma_f32_16x16x32_bf16 v[224:227], a[24:27], a[84:87], v[224:227]
    v_mfma_f32_16x16x32_bf16 v[36:39], a[0:3], a[88:91], v[36:39]
    v_mfma_f32_16x16x32_bf16 v[68:71], a[4:7], a[88:91], v[68:71]
    ds_read_b128 a[120:123], v15 offset:14336
    v_mfma_f32_16x16x32_bf16 v[100:103], a[8:11], a[88:91], v[100:103]
    v_mfma_f32_16x16x32_bf16 v[132:135], a[12:15], a[88:91], v[132:135]
    s_add_u32 s43, s41, s86
    s_add_u32 s43, s43, 14336
    s_mov_b32 m0, s43
    s_add_u32 s44, s40, s86
    buffer_load_dwordx4 v17, s[4:7], s44 offen lds
    v_mfma_f32_16x16x32_bf16 v[164:167], a[16:19], a[88:91], v[164:167]
    v_mfma_f32_16x16x32_bf16 v[196:199], a[20:23], a[88:91], v[196:199]
    s_add_u32 s45, s42, s84
    buffer_load_dwordx4 a[56:59], v8, s[4:7], s45 offen
    v_mfma_f32_16x16x32_bf16 v[228:231], a[24:27], a[88:91], v[228:231]
    v_mfma_f32_16x16x32_bf16 v[40:43], a[0:3], a[92:95], v[40:43]
    v_mfma_f32_16x16x32_bf16 v[72:75], a[4:7], a[92:95], v[72:75]
    ds_read_b128 a[124:127], v15 offset:28672
    v_mfma_f32_16x16x32_bf16 v[104:107], a[8:11], a[92:95], v[104:107]
    v_mfma_f32_16x16x32_bf16 v[136:139], a[12:15], a[92:95], v[136:139]
    v_mfma_f32_16x16x32_bf16 v[168:171], a[16:19], a[92:95], v[168:171]
    v_mfma_f32_16x16x32_bf16 v[200:203], a[20:23], a[92:95], v[200:203]
    buffer_load_dwordx4 a[60:63], v9, s[4:7], s45 offen
    v_mfma_f32_16x16x32_bf16 v[232:235], a[24:27], a[92:95], v[232:235]
    v_mfma_f32_16x16x32_bf16 v[44:47], a[0:3], a[96:99], v[44:47]
    v_mfma_f32_16x16x32_bf16 v[76:79], a[4:7], a[96:99], v[76:79]
    ds_read_b128 a[128:131], v15 offset:43008
    v_mfma_f32_16x16x32_bf16 v[108:111], a[8:11], a[96:99], v[108:111]
    v_mfma_f32_16x16x32_bf16 v[140:143], a[12:15], a[96:99], v[140:143]
    v_mfma_f32_16x16x32_bf16 v[172:175], a[16:19], a[96:99], v[172:175]
    v_mfma_f32_16x16x32_bf16 v[204:207], a[20:23], a[96:99], v[204:207]
    buffer_load_dwordx4 a[64:67], v10, s[4:7], s45 offen
    v_mfma_f32_16x16x32_bf16 v[236:239], a[24:27], a[96:99], v[236:239]
    v_mfma_f32_16x16x32_bf16 v[48:51], a[0:3], a[100:103], v[48:51]
    v_mfma_f32_16x16x32_bf16 v[80:83], a[4:7], a[100:103], v[80:83]
    ds_read_b128 a[132:135], v16 offset:0
    v_mfma_f32_16x16x32_bf16 v[112:115], a[8:11], a[100:103], v[112:115]
    v_mfma_f32_16x16x32_bf16 v[144:147], a[12:15], a[100:103], v[144:147]
    v_mfma_f32_16x16x32_bf16 v[176:179], a[16:19], a[100:103], v[176:179]
    v_mfma_f32_16x16x32_bf16 v[208:211], a[20:23], a[100:103], v[208:211]
    buffer_load_dwordx4 a[68:71], v11, s[4:7], s45 offen
    v_mfma_f32_16x16x32_bf16 v[240:243], a[24:27], a[100:103], v[240:243]
    v_mfma_f32_16x16x32_bf16 v[52:55], a[0:3], a[104:107], v[52:55]
    v_mfma_f32_16x16x32_bf16 v[84:87], a[4:7], a[104:107], v[84:87]
    ds_read_b128 a[136:139], v16 offset:14336
    v_mfma_f32_16x16x32_bf16 v[116:119], a[8:11], a[104:107], v[116:119]
    v_mfma_f32_16x16x32_bf16 v[148:151], a[12:15], a[104:107], v[148:151]
    v_mfma_f32_16x16x32_bf16 v[180:183], a[16:19], a[104:107], v[180:183]
    v_mfma_f32_16x16x32_bf16 v[212:215], a[20:23], a[104:107], v[212:215]
    buffer_load_dwordx4 a[72:75], v12, s[4:7], s45 offen
    v_mfma_f32_16x16x32_bf16 v[244:247], a[24:27], a[104:107], v[244:247]
    v_mfma_f32_16x16x32_bf16 v[56:59], a[0:3], a[108:111], v[56:59]
    v_mfma_f32_16x16x32_bf16 v[88:91], a[4:7], a[108:111], v[88:91]
    ds_read_b128 a[140:143], v16 offset:28672
    v_mfma_f32_16x16x32_bf16 v[120:123], a[8:11], a[108:111], v[120:123]
    v_mfma_f32_16x16x32_bf16 v[152:155], a[12:15], a[108:111], v[152:155]
    v_mfma_f32_16x16x32_bf16 v[184:187], a[16:19], a[108:111], v[184:187]
    v_mfma_f32_16x16x32_bf16 v[216:219], a[20:23], a[108:111], v[216:219]
    buffer_load_dwordx4 a[76:79], v13, s[4:7], s45 offen
    v_mfma_f32_16x16x32_bf16 v[248:251], a[24:27], a[108:111], v[248:251]
    v_mfma_f32_16x16x32_bf16 v[60:63], a[0:3], a[112:115], v[60:63]
    v_mfma_f32_16x16x32_bf16 v[92:95], a[4:7], a[112:115], v[92:95]
    ds_read_b128 a[144:147], v16 offset:43008
    v_mfma_f32_16x16x32_bf16 v[124:127], a[8:11], a[112:115], v[124:127]
    v_mfma_f32_16x16x32_bf16 v[156:159], a[12:15], a[112:115], v[156:159]
    v_mfma_f32_16x16x32_bf16 v[188:191], a[16:19], a[112:115], v[188:191]
    v_mfma_f32_16x16x32_bf16 v[220:223], a[20:23], a[112:115], v[220:223]
    buffer_load_dwordx4 a[80:83], v14, s[4:7], s45 offen
    v_mfma_f32_16x16x32_bf16 v[252:255], a[24:27], a[112:115], v[252:255]
    v_add_u32 v15, s84, v2
    v_add_u32 v16, 57344, v15
    s_waitcnt vmcnt(9) lgkmcnt(0)
    s_barrier
    v_mfma_f32_16x16x32_bf16 v[32:35], a[28:31], a[116:119], v[32:35]
    v_mfma_f32_16x16x32_bf16 v[64:67], a[32:35], a[116:119], v[64:67]
    ds_read_b128 a[84:87], v15 offset:0
    v_mfma_f32_16x16x32_bf16 v[96:99], a[36:39], a[116:119], v[96:99]
    v_mfma_f32_16x16x32_bf16 v[128:131], a[40:43], a[116:119], v[128:131]
    s_add_u32 s43, s41, s87
    s_mov_b32 m0, s43
    s_add_u32 s44, s40, s87
    buffer_load_dwordx4 v2, s[4:7], s44 offen lds
    v_mfma_f32_16x16x32_bf16 v[160:163], a[44:47], a[116:119], v[160:163]
    v_mfma_f32_16x16x32_bf16 v[192:195], a[48:51], a[116:119], v[192:195]
    v_mfma_f32_16x16x32_bf16 v[224:227], a[52:55], a[116:119], v[224:227]
    v_mfma_f32_16x16x32_bf16 v[36:39], a[28:31], a[120:123], v[36:39]
    v_mfma_f32_16x16x32_bf16 v[68:71], a[32:35], a[120:123], v[68:71]
    ds_read_b128 a[88:91], v15 offset:14336
    v_mfma_f32_16x16x32_bf16 v[100:103], a[36:39], a[120:123], v[100:103]
    v_mfma_f32_16x16x32_bf16 v[132:135], a[40:43], a[120:123], v[132:135]
    s_add_u32 s43, s41, s87
    s_add_u32 s43, s43, 14336
    s_mov_b32 m0, s43
    s_add_u32 s44, s40, s87
    buffer_load_dwordx4 v17, s[4:7], s44 offen lds
    v_mfma_f32_16x16x32_bf16 v[164:167], a[44:47], a[120:123], v[164:167]
    v_mfma_f32_16x16x32_bf16 v[196:199], a[48:51], a[120:123], v[196:199]
    s_add_u32 s45, s42, s85
    buffer_load_dwordx4 a[0:3], v8, s[4:7], s45 offen
    v_mfma_f32_16x16x32_bf16 v[228:231], a[52:55], a[120:123], v[228:231]
    v_mfma_f32_16x16x32_bf16 v[40:43], a[28:31], a[124:127], v[40:43]
    v_mfma_f32_16x16x32_bf16 v[72:75], a[32:35], a[124:127], v[72:75]
    ds_read_b128 a[92:95], v15 offset:28672
    v_mfma_f32_16x16x32_bf16 v[104:107], a[36:39], a[124:127], v[104:107]
    v_mfma_f32_16x16x32_bf16 v[136:139], a[40:43], a[124:127], v[136:139]
    v_mfma_f32_16x16x32_bf16 v[168:171], a[44:47], a[124:127], v[168:171]
    v_mfma_f32_16x16x32_bf16 v[200:203], a[48:51], a[124:127], v[200:203]
    buffer_load_dwordx4 a[4:7], v9, s[4:7], s45 offen
    v_mfma_f32_16x16x32_bf16 v[232:235], a[52:55], a[124:127], v[232:235]
    v_mfma_f32_16x16x32_bf16 v[44:47], a[28:31], a[128:131], v[44:47]
    v_mfma_f32_16x16x32_bf16 v[76:79], a[32:35], a[128:131], v[76:79]
    ds_read_b128 a[96:99], v15 offset:43008
    v_mfma_f32_16x16x32_bf16 v[108:111], a[36:39], a[128:131], v[108:111]
    v_mfma_f32_16x16x32_bf16 v[140:143], a[40:43], a[128:131], v[140:143]
    v_mfma_f32_16x16x32_bf16 v[172:175], a[44:47], a[128:131], v[172:175]
    v_mfma_f32_16x16x32_bf16 v[204:207], a[48:51], a[128:131], v[204:207]
    buffer_load_dwordx4 a[8:11], v10, s[4:7], s45 offen
    v_mfma_f32_16x16x32_bf16 v[236:239], a[52:55], a[128:131], v[236:239]
    v_mfma_f32_16x16x32_bf16 v[48:51], a[28:31], a[132:135], v[48:51]
    v_mfma_f32_16x16x32_bf16 v[80:83], a[32:35], a[132:135], v[80:83]
    ds_read_b128 a[100:103], v16 offset:0
    v_mfma_f32_16x16x32_bf16 v[112:115], a[36:39], a[132:135], v[112:115]
    v_mfma_f32_16x16x32_bf16 v[144:147], a[40:43], a[132:135], v[144:147]
    v_mfma_f32_16x16x32_bf16 v[176:179], a[44:47], a[132:135], v[176:179]
    v_mfma_f32_16x16x32_bf16 v[208:211], a[48:51], a[132:135], v[208:211]
    buffer_load_dwordx4 a[12:15], v11, s[4:7], s45 offen
    v_mfma_f32_16x16x32_bf16 v[240:243], a[52:55], a[132:135], v[240:243]
    v_mfma_f32_16x16x32_bf16 v[52:55], a[28:31], a[136:139], v[52:55]
    v_mfma_f32_16x16x32_bf16 v[84:87], a[32:35], a[136:139], v[84:87]
    ds_read_b128 a[104:107], v16 offset:14336
    v_mfma_f32_16x16x32_bf16 v[116:119], a[36:39], a[136:139], v[116:119]
    v_mfma_f32_16x16x32_bf16 v[148:151], a[40:43], a[136:139], v[148:151]
    v_mfma_f32_16x16x32_bf16 v[180:183], a[44:47], a[136:139], v[180:183]
    v_mfma_f32_16x16x32_bf16 v[212:215], a[48:51], a[136:139], v[212:215]
    buffer_load_dwordx4 a[16:19], v12, s[4:7], s45 offen
    v_mfma_f32_16x16x32_bf16 v[244:247], a[52:55], a[136:139], v[244:247]
    v_mfma_f32_16x16x32_bf16 v[56:59], a[28:31], a[140:143], v[56:59]
    v_mfma_f32_16x16x32_bf16 v[88:91], a[32:35], a[140:143], v[88:91]
    ds_read_b128 a[108:111], v16 offset:28672
    v_mfma_f32_16x16x32_bf16 v[120:123], a[36:39], a[140:143], v[120:123]
    v_mfma_f32_16x16x32_bf16 v[152:155], a[40:43], a[140:143], v[152:155]
    v_mfma_f32_16x16x32_bf16 v[184:187], a[44:47], a[140:143], v[184:187]
    v_mfma_f32_16x16x32_bf16 v[216:219], a[48:51], a[140:143], v[216:219]
    buffer_load_dwordx4 a[20:23], v13, s[4:7], s45 offen
    v_mfma_f32_16x16x32_bf16 v[248:251], a[52:55], a[140:143], v[248:251]
    v_mfma_f32_16x16x32_bf16 v[60:63], a[28:31], a[144:147], v[60:63]
    v_mfma_f32_16x16x32_bf16 v[92:95], a[32:35], a[144:147], v[92:95]
    ds_read_b128 a[112:115], v16 offset:43008
    v_mfma_f32_16x16x32_bf16 v[124:127], a[36:39], a[144:147], v[124:127]
    v_mfma_f32_16x16x32_bf16 v[156:159], a[40:43], a[144:147], v[156:159]
    v_mfma_f32_16x16x32_bf16 v[188:191], a[44:47], a[144:147], v[188:191]
    v_mfma_f32_16x16x32_bf16 v[220:223], a[48:51], a[144:147], v[220:223]
    buffer_load_dwordx4 a[24:27], v14, s[4:7], s45 offen
    v_mfma_f32_16x16x32_bf16 v[252:255], a[52:55], a[144:147], v[252:255]
    v_add_u32 v15, s85, v2
    v_add_u32 v16, 57344, v15
    s_waitcnt vmcnt(9) lgkmcnt(0)
    s_barrier
    v_mfma_f32_16x16x32_bf16 v[32:35], a[56:59], a[84:87], v[32:35]
    v_mfma_f32_16x16x32_bf16 v[64:67], a[60:63], a[84:87], v[64:67]
    ds_read_b128 a[116:119], v15 offset:0
    v_mfma_f32_16x16x32_bf16 v[96:99], a[64:67], a[84:87], v[96:99]
    v_mfma_f32_16x16x32_bf16 v[128:131], a[68:71], a[84:87], v[128:131]
    s_add_u32 s43, s41, s88
    s_mov_b32 m0, s43
    s_add_u32 s44, s40, s88
    buffer_load_dwordx4 v2, s[4:7], s44 offen lds
    v_mfma_f32_16x16x32_bf16 v[160:163], a[72:75], a[84:87], v[160:163]
    v_mfma_f32_16x16x32_bf16 v[192:195], a[76:79], a[84:87], v[192:195]
    v_mfma_f32_16x16x32_bf16 v[224:227], a[80:83], a[84:87], v[224:227]
    v_mfma_f32_16x16x32_bf16 v[36:39], a[56:59], a[88:91], v[36:39]
    v_mfma_f32_16x16x32_bf16 v[68:71], a[60:63], a[88:91], v[68:71]
    ds_read_b128 a[120:123], v15 offset:14336
    v_mfma_f32_16x16x32_bf16 v[100:103], a[64:67], a[88:91], v[100:103]
    v_mfma_f32_16x16x32_bf16 v[132:135], a[68:71], a[88:91], v[132:135]
    s_add_u32 s43, s41, s88
    s_add_u32 s43, s43, 14336
    s_mov_b32 m0, s43
    s_add_u32 s44, s40, s88
    buffer_load_dwordx4 v17, s[4:7], s44 offen lds
    v_mfma_f32_16x16x32_bf16 v[164:167], a[72:75], a[88:91], v[164:167]
    v_mfma_f32_16x16x32_bf16 v[196:199], a[76:79], a[88:91], v[196:199]
    s_add_u32 s45, s42, s86
    buffer_load_dwordx4 a[28:31], v8, s[4:7], s45 offen
    v_mfma_f32_16x16x32_bf16 v[228:231], a[80:83], a[88:91], v[228:231]
    v_mfma_f32_16x16x32_bf16 v[40:43], a[56:59], a[92:95], v[40:43]
    v_mfma_f32_16x16x32_bf16 v[72:75], a[60:63], a[92:95], v[72:75]
    ds_read_b128 a[124:127], v15 offset:28672
    v_mfma_f32_16x16x32_bf16 v[104:107], a[64:67], a[92:95], v[104:107]
    v_mfma_f32_16x16x32_bf16 v[136:139], a[68:71], a[92:95], v[136:139]
    v_mfma_f32_16x16x32_bf16 v[168:171], a[72:75], a[92:95], v[168:171]
    v_mfma_f32_16x16x32_bf16 v[200:203], a[76:79], a[92:95], v[200:203]
    buffer_load_dwordx4 a[32:35], v9, s[4:7], s45 offen
    v_mfma_f32_16x16x32_bf16 v[232:235], a[80:83], a[92:95], v[232:235]
    v_mfma_f32_16x16x32_bf16 v[44:47], a[56:59], a[96:99], v[44:47]
    v_mfma_f32_16x16x32_bf16 v[76:79], a[60:63], a[96:99], v[76:79]
    ds_read_b128 a[128:131], v15 offset:43008
    v_mfma_f32_16x16x32_bf16 v[108:111], a[64:67], a[96:99], v[108:111]
    v_mfma_f32_16x16x32_bf16 v[140:143], a[68:71], a[96:99], v[140:143]
    v_mfma_f32_16x16x32_bf16 v[172:175], a[72:75], a[96:99], v[172:175]
    v_mfma_f32_16x16x32_bf16 v[204:207], a[76:79], a[96:99], v[204:207]
    buffer_load_dwordx4 a[36:39], v10, s[4:7], s45 offen
    v_mfma_f32_16x16x32_bf16 v[236:239], a[80:83], a[96:99], v[236:239]
    v_mfma_f32_16x16x32_bf16 v[48:51], a[56:59], a[100:103], v[48:51]
    v_mfma_f32_16x16x32_bf16 v[80:83], a[60:63], a[100:103], v[80:83]
    ds_read_b128 a[132:135], v16 offset:0
    v_mfma_f32_16x16x32_bf16 v[112:115], a[64:67], a[100:103], v[112:115]
    v_mfma_f32_16x16x32_bf16 v[144:147], a[68:71], a[100:103], v[144:147]
    v_mfma_f32_16x16x32_bf16 v[176:179], a[72:75], a[100:103], v[176:179]
    v_mfma_f32_16x16x32_bf16 v[208:211], a[76:79], a[100:103], v[208:211]
    buffer_load_dwordx4 a[40:43], v11, s[4:7], s45 offen
    v_mfma_f32_16x16x32_bf16 v[240:243], a[80:83], a[100:103], v[240:243]
    v_mfma_f32_16x16x32_bf16 v[52:55], a[56:59], a[104:107], v[52:55]
    v_mfma_f32_16x16x32_bf16 v[84:87], a[60:63], a[104:107], v[84:87]
    ds_read_b128 a[136:139], v16 offset:14336
    v_mfma_f32_16x16x32_bf16 v[116:119], a[64:67], a[104:107], v[116:119]
    v_mfma_f32_16x16x32_bf16 v[148:151], a[68:71], a[104:107], v[148:151]
    v_mfma_f32_16x16x32_bf16 v[180:183], a[72:75], a[104:107], v[180:183]
    v_mfma_f32_16x16x32_bf16 v[212:215], a[76:79], a[104:107], v[212:215]
    buffer_load_dwordx4 a[44:47], v12, s[4:7], s45 offen
    v_mfma_f32_16x16x32_bf16 v[244:247], a[80:83], a[104:107], v[244:247]
    v_mfma_f32_16x16x32_bf16 v[56:59], a[56:59], a[108:111], v[56:59]
    v_mfma_f32_16x16x32_bf16 v[88:91], a[60:63], a[108:111], v[88:91]
    ds_read_b128 a[140:143], v16 offset:28672
    v_mfma_f32_16x16x32_bf16 v[120:123], a[64:67], a[108:111], v[120:123]
    v_mfma_f32_16x16x32_bf16 v[152:155], a[68:71], a[108:111], v[152:155]
    v_mfma_f32_16x16x32_bf16 v[184:187], a[72:75], a[108:111], v[184:187]
    v_mfma_f32_16x16x32_bf16 v[216:219], a[76:79], a[108:111], v[216:219]
    buffer_load_dwordx4 a[48:51], v13, s[4:7], s45 offen
    v_mfma_f32_16x16x32_bf16 v[248:251], a[80:83], a[108:111], v[248:251]
    v_mfma_f32_16x16x32_bf16 v[60:63], a[56:59], a[112:115], v[60:63]
    v_mfma_f32_16x16x32_bf16 v[92:95], a[60:63], a[112:115], v[92:95]
    ds_read_b128 a[144:147], v16 offset:43008
    v_mfma_f32_16x16x32_bf16 v[124:127], a[64:67], a[112:115], v[124:127]
    v_mfma_f32_16x16x32_bf16 v[156:159], a[68:71], a[112:115], v[156:159]
    v_mfma_f32_16x16x32_bf16 v[188:191], a[72:75], a[112:115], v[188:191]
    v_mfma_f32_16x16x32_bf16 v[220:223], a[76:79], a[112:115], v[220:223]
    buffer_load_dwordx4 a[52:55], v14, s[4:7], s45 offen
    v_mfma_f32_16x16x32_bf16 v[252:255], a[80:83], a[112:115], v[252:255]
    v_add_u32 v15, s86, v2
    v_add_u32 v16, 57344, v15
    s_waitcnt vmcnt(9) lgkmcnt(0)
    s_barrier
    v_mfma_f32_16x16x32_bf16 v[32:35], a[0:3], a[116:119], v[32:35]
    v_mfma_f32_16x16x32_bf16 v[64:67], a[4:7], a[116:119], v[64:67]
    ds_read_b128 a[84:87], v15 offset:0
    v_mfma_f32_16x16x32_bf16 v[96:99], a[8:11], a[116:119], v[96:99]
    v_mfma_f32_16x16x32_bf16 v[128:131], a[12:15], a[116:119], v[128:131]
    s_add_u32 s43, s41, s89
    s_mov_b32 m0, s43
    s_add_u32 s44, s40, s89
    buffer_load_dwordx4 v2, s[4:7], s44 offen lds
    v_mfma_f32_16x16x32_bf16 v[160:163], a[16:19], a[116:119], v[160:163]
    v_mfma_f32_16x16x32_bf16 v[192:195], a[20:23], a[116:119], v[192:195]
    v_mfma_f32_16x16x32_bf16 v[224:227], a[24:27], a[116:119], v[224:227]
    v_mfma_f32_16x16x32_bf16 v[36:39], a[0:3], a[120:123], v[36:39]
    v_mfma_f32_16x16x32_bf16 v[68:71], a[4:7], a[120:123], v[68:71]
    ds_read_b128 a[88:91], v15 offset:14336
    v_mfma_f32_16x16x32_bf16 v[100:103], a[8:11], a[120:123], v[100:103]
    v_mfma_f32_16x16x32_bf16 v[132:135], a[12:15], a[120:123], v[132:135]
    s_add_u32 s43, s41, s89
    s_add_u32 s43, s43, 14336
    s_mov_b32 m0, s43
    s_add_u32 s44, s40, s89
    buffer_load_dwordx4 v17, s[4:7], s44 offen lds
    v_mfma_f32_16x16x32_bf16 v[164:167], a[16:19], a[120:123], v[164:167]
    v_mfma_f32_16x16x32_bf16 v[196:199], a[20:23], a[120:123], v[196:199]
    s_add_u32 s45, s42, s87
    buffer_load_dwordx4 a[56:59], v8, s[4:7], s45 offen
    v_mfma_f32_16x16x32_bf16 v[228:231], a[24:27], a[120:123], v[228:231]
    v_mfma_f32_16x16x32_bf16 v[40:43], a[0:3], a[124:127], v[40:43]
    v_mfma_f32_16x16x32_bf16 v[72:75], a[4:7], a[124:127], v[72:75]
    ds_read_b128 a[92:95], v15 offset:28672
    v_mfma_f32_16x16x32_bf16 v[104:107], a[8:11], a[124:127], v[104:107]
    v_mfma_f32_16x16x32_bf16 v[136:139], a[12:15], a[124:127], v[136:139]
    v_mfma_f32_16x16x32_bf16 v[168:171], a[16:19], a[124:127], v[168:171]
    v_mfma_f32_16x16x32_bf16 v[200:203], a[20:23], a[124:127], v[200:203]
    buffer_load_dwordx4 a[60:63], v9, s[4:7], s45 offen
    v_mfma_f32_16x16x32_bf16 v[232:235], a[24:27], a[124:127], v[232:235]
    v_mfma_f32_16x16x32_bf16 v[44:47], a[0:3], a[128:131], v[44:47]
    v_mfma_f32_16x16x32_bf16 v[76:79], a[4:7], a[128:131], v[76:79]
    ds_read_b128 a[96:99], v15 offset:43008
    v_mfma_f32_16x16x32_bf16 v[108:111], a[8:11], a[128:131], v[108:111]
    v_mfma_f32_16x16x32_bf16 v[140:143], a[12:15], a[128:131], v[140:143]
    v_mfma_f32_16x16x32_bf16 v[172:175], a[16:19], a[128:131], v[172:175]
    v_mfma_f32_16x16x32_bf16 v[204:207], a[20:23], a[128:131], v[204:207]
    buffer_load_dwordx4 a[64:67], v10, s[4:7], s45 offen
    v_mfma_f32_16x16x32_bf16 v[236:239], a[24:27], a[128:131], v[236:239]
    v_mfma_f32_16x16x32_bf16 v[48:51], a[0:3], a[132:135], v[48:51]
    v_mfma_f32_16x16x32_bf16 v[80:83], a[4:7], a[132:135], v[80:83]
    ds_read_b128 a[100:103], v16 offset:0
    v_mfma_f32_16x16x32_bf16 v[112:115], a[8:11], a[132:135], v[112:115]
    v_mfma_f32_16x16x32_bf16 v[144:147], a[12:15], a[132:135], v[144:147]
    v_mfma_f32_16x16x32_bf16 v[176:179], a[16:19], a[132:135], v[176:179]
    v_mfma_f32_16x16x32_bf16 v[208:211], a[20:23], a[132:135], v[208:211]
    buffer_load_dwordx4 a[68:71], v11, s[4:7], s45 offen
    v_mfma_f32_16x16x32_bf16 v[240:243], a[24:27], a[132:135], v[240:243]
    v_mfma_f32_16x16x32_bf16 v[52:55], a[0:3], a[136:139], v[52:55]
    v_mfma_f32_16x16x32_bf16 v[84:87], a[4:7], a[136:139], v[84:87]
    ds_read_b128 a[104:107], v16 offset:14336
    v_mfma_f32_16x16x32_bf16 v[116:119], a[8:11], a[136:139], v[116:119]
    v_mfma_f32_16x16x32_bf16 v[148:151], a[12:15], a[136:139], v[148:151]
    v_mfma_f32_16x16x32_bf16 v[180:183], a[16:19], a[136:139], v[180:183]
    v_mfma_f32_16x16x32_bf16 v[212:215], a[20:23], a[136:139], v[212:215]
    buffer_load_dwordx4 a[72:75], v12, s[4:7], s45 offen
    v_mfma_f32_16x16x32_bf16 v[244:247], a[24:27], a[136:139], v[244:247]
    v_mfma_f32_16x16x32_bf16 v[56:59], a[0:3], a[140:143], v[56:59]
    v_mfma_f32_16x16x32_bf16 v[88:91], a[4:7], a[140:143], v[88:91]
    ds_read_b128 a[108:111], v16 offset:28672
    v_mfma_f32_16x16x32_bf16 v[120:123], a[8:11], a[140:143], v[120:123]
    v_mfma_f32_16x16x32_bf16 v[152:155], a[12:15], a[140:143], v[152:155]
    v_mfma_f32_16x16x32_bf16 v[184:187], a[16:19], a[140:143], v[184:187]
    v_mfma_f32_16x16x32_bf16 v[216:219], a[20:23], a[140:143], v[216:219]
    buffer_load_dwordx4 a[76:79], v13, s[4:7], s45 offen
    v_mfma_f32_16x16x32_bf16 v[248:251], a[24:27], a[140:143], v[248:251]
    v_mfma_f32_16x16x32_bf16 v[60:63], a[0:3], a[144:147], v[60:63]
    v_mfma_f32_16x16x32_bf16 v[92:95], a[4:7], a[144:147], v[92:95]
    ds_read_b128 a[112:115], v16 offset:43008
    v_mfma_f32_16x16x32_bf16 v[124:127], a[8:11], a[144:147], v[124:127]
    v_mfma_f32_16x16x32_bf16 v[156:159], a[12:15], a[144:147], v[156:159]
    v_mfma_f32_16x16x32_bf16 v[188:191], a[16:19], a[144:147], v[188:191]
    v_mfma_f32_16x16x32_bf16 v[220:223], a[20:23], a[144:147], v[220:223]
    buffer_load_dwordx4 a[80:83], v14, s[4:7], s45 offen
    v_mfma_f32_16x16x32_bf16 v[252:255], a[24:27], a[144:147], v[252:255]
    v_add_u32 v15, s87, v2
    v_add_u32 v16, 57344, v15
    s_waitcnt vmcnt(9) lgkmcnt(0)
    s_barrier
    v_mfma_f32_16x16x32_bf16 v[32:35], a[28:31], a[84:87], v[32:35]
    v_mfma_f32_16x16x32_bf16 v[64:67], a[32:35], a[84:87], v[64:67]
    ds_read_b128 a[116:119], v15 offset:0
    v_mfma_f32_16x16x32_bf16 v[96:99], a[36:39], a[84:87], v[96:99]
    v_mfma_f32_16x16x32_bf16 v[128:131], a[40:43], a[84:87], v[128:131]
    v_mfma_f32_16x16x32_bf16 v[160:163], a[44:47], a[84:87], v[160:163]
    v_mfma_f32_16x16x32_bf16 v[192:195], a[48:51], a[84:87], v[192:195]
    v_mfma_f32_16x16x32_bf16 v[224:227], a[52:55], a[84:87], v[224:227]
    v_mfma_f32_16x16x32_bf16 v[36:39], a[28:31], a[88:91], v[36:39]
    v_mfma_f32_16x16x32_bf16 v[68:71], a[32:35], a[88:91], v[68:71]
    ds_read_b128 a[120:123], v15 offset:14336
    v_mfma_f32_16x16x32_bf16 v[100:103], a[36:39], a[88:91], v[100:103]
    v_mfma_f32_16x16x32_bf16 v[132:135], a[40:43], a[88:91], v[132:135]
    v_mfma_f32_16x16x32_bf16 v[164:167], a[44:47], a[88:91], v[164:167]
    v_mfma_f32_16x16x32_bf16 v[196:199], a[48:51], a[88:91], v[196:199]
    s_add_u32 s45, s42, s88
    buffer_load_dwordx4 a[0:3], v8, s[4:7], s45 offen
    v_mfma_f32_16x16x32_bf16 v[228:231], a[52:55], a[88:91], v[228:231]
    v_mfma_f32_16x16x32_bf16 v[40:43], a[28:31], a[92:95], v[40:43]
    v_mfma_f32_16x16x32_bf16 v[72:75], a[32:35], a[92:95], v[72:75]
    ds_read_b128 a[124:127], v15 offset:28672
    v_mfma_f32_16x16x32_bf16 v[104:107], a[36:39], a[92:95], v[104:107]
    v_mfma_f32_16x16x32_bf16 v[136:139], a[40:43], a[92:95], v[136:139]
    v_mfma_f32_16x16x32_bf16 v[168:171], a[44:47], a[92:95], v[168:171]
    v_mfma_f32_16x16x32_bf16 v[200:203], a[48:51], a[92:95], v[200:203]
    buffer_load_dwordx4 a[4:7], v9, s[4:7], s45 offen
    v_mfma_f32_16x16x32_bf16 v[232:235], a[52:55], a[92:95], v[232:235]
    v_mfma_f32_16x16x32_bf16 v[44:47], a[28:31], a[96:99], v[44:47]
    v_mfma_f32_16x16x32_bf16 v[76:79], a[32:35], a[96:99], v[76:79]
    ds_read_b128 a[128:131], v15 offset:43008
    v_mfma_f32_16x16x32_bf16 v[108:111], a[36:39], a[96:99], v[108:111]
    v_mfma_f32_16x16x32_bf16 v[140:143], a[40:43], a[96:99], v[140:143]
    v_mfma_f32_16x16x32_bf16 v[172:175], a[44:47], a[96:99], v[172:175]
    v_mfma_f32_16x16x32_bf16 v[204:207], a[48:51], a[96:99], v[204:207]
    buffer_load_dwordx4 a[8:11], v10, s[4:7], s45 offen
    v_mfma_f32_16x16x32_bf16 v[236:239], a[52:55], a[96:99], v[236:239]
    v_mfma_f32_16x16x32_bf16 v[48:51], a[28:31], a[100:103], v[48:51]
    v_mfma_f32_16x16x32_bf16 v[80:83], a[32:35], a[100:103], v[80:83]
    ds_read_b128 a[132:135], v16 offset:0
    v_mfma_f32_16x16x32_bf16 v[112:115], a[36:39], a[100:103], v[112:115]
    v_mfma_f32_16x16x32_bf16 v[144:147], a[40:43], a[100:103], v[144:147]
    v_mfma_f32_16x16x32_bf16 v[176:179], a[44:47], a[100:103], v[176:179]
    v_mfma_f32_16x16x32_bf16 v[208:211], a[48:51], a[100:103], v[208:211]
    buffer_load_dwordx4 a[12:15], v11, s[4:7], s45 offen
    v_mfma_f32_16x16x32_bf16 v[240:243], a[52:55], a[100:103], v[240:243]
    v_mfma_f32_16x16x32_bf16 v[52:55], a[28:31], a[104:107], v[52:55]
    v_mfma_f32_16x16x32_bf16 v[84:87], a[32:35], a[104:107], v[84:87]
    ds_read_b128 a[136:139], v16 offset:14336
    v_mfma_f32_16x16x32_bf16 v[116:119], a[36:39], a[104:107], v[116:119]
    v_mfma_f32_16x16x32_bf16 v[148:151], a[40:43], a[104:107], v[148:151]
    v_mfma_f32_16x16x32_bf16 v[180:183], a[44:47], a[104:107], v[180:183]
    v_mfma_f32_16x16x32_bf16 v[212:215], a[48:51], a[104:107], v[212:215]
    buffer_load_dwordx4 a[16:19], v12, s[4:7], s45 offen
    v_mfma_f32_16x16x32_bf16 v[244:247], a[52:55], a[104:107], v[244:247]
    v_mfma_f32_16x16x32_bf16 v[56:59], a[28:31], a[108:111], v[56:59]
    v_mfma_f32_16x16x32_bf16 v[88:91], a[32:35], a[108:111], v[88:91]
    ds_read_b128 a[140:143], v16 offset:28672
    v_mfma_f32_16x16x32_bf16 v[120:123], a[36:39], a[108:111], v[120:123]
    v_mfma_f32_16x16x32_bf16 v[152:155], a[40:43], a[108:111], v[152:155]
    v_mfma_f32_16x16x32_bf16 v[184:187], a[44:47], a[108:111], v[184:187]
    v_mfma_f32_16x16x32_bf16 v[216:219], a[48:51], a[108:111], v[216:219]
    buffer_load_dwordx4 a[20:23], v13, s[4:7], s45 offen
    v_mfma_f32_16x16x32_bf16 v[248:251], a[52:55], a[108:111], v[248:251]
    v_mfma_f32_16x16x32_bf16 v[60:63], a[28:31], a[112:115], v[60:63]
    v_mfma_f32_16x16x32_bf16 v[92:95], a[32:35], a[112:115], v[92:95]
    ds_read_b128 a[144:147], v16 offset:43008
    v_mfma_f32_16x16x32_bf16 v[124:127], a[36:39], a[112:115], v[124:127]
    v_mfma_f32_16x16x32_bf16 v[156:159], a[40:43], a[112:115], v[156:159]
    v_mfma_f32_16x16x32_bf16 v[188:191], a[44:47], a[112:115], v[188:191]
    v_mfma_f32_16x16x32_bf16 v[220:223], a[48:51], a[112:115], v[220:223]
    buffer_load_dwordx4 a[24:27], v14, s[4:7], s45 offen
    v_mfma_f32_16x16x32_bf16 v[252:255], a[52:55], a[112:115], v[252:255]
    v_add_u32 v15, s88, v2
    v_add_u32 v16, 57344, v15
    s_waitcnt vmcnt(7) lgkmcnt(0)
    s_barrier
    v_mfma_f32_16x16x32_bf16 v[32:35], a[56:59], a[116:119], v[32:35]
    v_mfma_f32_16x16x32_bf16 v[64:67], a[60:63], a[116:119], v[64:67]
    ds_read_b128 a[84:87], v15 offset:0
    v_mfma_f32_16x16x32_bf16 v[96:99], a[64:67], a[116:119], v[96:99]
    v_mfma_f32_16x16x32_bf16 v[128:131], a[68:71], a[116:119], v[128:131]
    v_mfma_f32_16x16x32_bf16 v[160:163], a[72:75], a[116:119], v[160:163]
    v_mfma_f32_16x16x32_bf16 v[192:195], a[76:79], a[116:119], v[192:195]
    v_mfma_f32_16x16x32_bf16 v[224:227], a[80:83], a[116:119], v[224:227]
    v_mfma_f32_16x16x32_bf16 v[36:39], a[56:59], a[120:123], v[36:39]
    v_mfma_f32_16x16x32_bf16 v[68:71], a[60:63], a[120:123], v[68:71]
    ds_read_b128 a[88:91], v15 offset:14336
    v_mfma_f32_16x16x32_bf16 v[100:103], a[64:67], a[120:123], v[100:103]
    v_mfma_f32_16x16x32_bf16 v[132:135], a[68:71], a[120:123], v[132:135]
    v_mfma_f32_16x16x32_bf16 v[164:167], a[72:75], a[120:123], v[164:167]
    v_mfma_f32_16x16x32_bf16 v[196:199], a[76:79], a[120:123], v[196:199]
    s_add_u32 s45, s42, s89
    buffer_load_dwordx4 a[28:31], v8, s[4:7], s45 offen
    v_mfma_f32_16x16x32_bf16 v[228:231], a[80:83], a[120:123], v[228:231]
    v_mfma_f32_16x16x32_bf16 v[40:43], a[56:59], a[124:127], v[40:43]
    v_mfma_f32_16x16x32_bf16 v[72:75], a[60:63], a[124:127], v[72:75]
    ds_read_b128 a[92:95], v15 offset:28672
    v_mfma_f32_16x16x32_bf16 v[104:107], a[64:67], a[124:127], v[104:107]
    v_mfma_f32_16x16x32_bf16 v[136:139], a[68:71], a[124:127], v[136:139]
    v_mfma_f32_16x16x32_bf16 v[168:171], a[72:75], a[124:127], v[168:171]
    v_mfma_f32_16x16x32_bf16 v[200:203], a[76:79], a[124:127], v[200:203]
    buffer_load_dwordx4 a[32:35], v9, s[4:7], s45 offen
    v_mfma_f32_16x16x32_bf16 v[232:235], a[80:83], a[124:127], v[232:235]
    v_mfma_f32_16x16x32_bf16 v[44:47], a[56:59], a[128:131], v[44:47]
    v_mfma_f32_16x16x32_bf16 v[76:79], a[60:63], a[128:131], v[76:79]
    ds_read_b128 a[96:99], v15 offset:43008
    v_mfma_f32_16x16x32_bf16 v[108:111], a[64:67], a[128:131], v[108:111]
    v_mfma_f32_16x16x32_bf16 v[140:143], a[68:71], a[128:131], v[140:143]
    v_mfma_f32_16x16x32_bf16 v[172:175], a[72:75], a[128:131], v[172:175]
    v_mfma_f32_16x16x32_bf16 v[204:207], a[76:79], a[128:131], v[204:207]
    buffer_load_dwordx4 a[36:39], v10, s[4:7], s45 offen
    v_mfma_f32_16x16x32_bf16 v[236:239], a[80:83], a[128:131], v[236:239]
    v_mfma_f32_16x16x32_bf16 v[48:51], a[56:59], a[132:135], v[48:51]
    v_mfma_f32_16x16x32_bf16 v[80:83], a[60:63], a[132:135], v[80:83]
    ds_read_b128 a[100:103], v16 offset:0
    v_mfma_f32_16x16x32_bf16 v[112:115], a[64:67], a[132:135], v[112:115]
    v_mfma_f32_16x16x32_bf16 v[144:147], a[68:71], a[132:135], v[144:147]
    v_mfma_f32_16x16x32_bf16 v[176:179], a[72:75], a[132:135], v[176:179]
    v_mfma_f32_16x16x32_bf16 v[208:211], a[76:79], a[132:135], v[208:211]
    buffer_load_dwordx4 a[40:43], v11, s[4:7], s45 offen
    v_mfma_f32_16x16x32_bf16 v[240:243], a[80:83], a[132:135], v[240:243]
    v_mfma_f32_16x16x32_bf16 v[52:55], a[56:59], a[136:139], v[52:55]
    v_mfma_f32_16x16x32_bf16 v[84:87], a[60:63], a[136:139], v[84:87]
    ds_read_b128 a[104:107], v16 offset:14336
    v_mfma_f32_16x16x32_bf16 v[116:119], a[64:67], a[136:139], v[116:119]
    v_mfma_f32_16x16x32_bf16 v[148:151], a[68:71], a[136:139], v[148:151]
    v_mfma_f32_16x16x32_bf16 v[180:183], a[72:75], a[136:139], v[180:183]
    v_mfma_f32_16x16x32_bf16 v[212:215], a[76:79], a[136:139], v[212:215]
    buffer_load_dwordx4 a[44:47], v12, s[4:7], s45 offen
    v_mfma_f32_16x16x32_bf16 v[244:247], a[80:83], a[136:139], v[244:247]
    v_mfma_f32_16x16x32_bf16 v[56:59], a[56:59], a[140:143], v[56:59]
    v_mfma_f32_16x16x32_bf16 v[88:91], a[60:63], a[140:143], v[88:91]
    ds_read_b128 a[108:111], v16 offset:28672
    v_mfma_f32_16x16x32_bf16 v[120:123], a[64:67], a[140:143], v[120:123]
    v_mfma_f32_16x16x32_bf16 v[152:155], a[68:71], a[140:143], v[152:155]
    v_mfma_f32_16x16x32_bf16 v[184:187], a[72:75], a[140:143], v[184:187]
    v_mfma_f32_16x16x32_bf16 v[216:219], a[76:79], a[140:143], v[216:219]
    buffer_load_dwordx4 a[48:51], v13, s[4:7], s45 offen
    v_mfma_f32_16x16x32_bf16 v[248:251], a[80:83], a[140:143], v[248:251]
    v_mfma_f32_16x16x32_bf16 v[60:63], a[56:59], a[144:147], v[60:63]
    v_mfma_f32_16x16x32_bf16 v[92:95], a[60:63], a[144:147], v[92:95]
    ds_read_b128 a[112:115], v16 offset:43008
    v_mfma_f32_16x16x32_bf16 v[124:127], a[64:67], a[144:147], v[124:127]
    v_mfma_f32_16x16x32_bf16 v[156:159], a[68:71], a[144:147], v[156:159]
    v_mfma_f32_16x16x32_bf16 v[188:191], a[72:75], a[144:147], v[188:191]
    v_mfma_f32_16x16x32_bf16 v[220:223], a[76:79], a[144:147], v[220:223]
    buffer_load_dwordx4 a[52:55], v14, s[4:7], s45 offen
    v_mfma_f32_16x16x32_bf16 v[252:255], a[80:83], a[144:147], v[252:255]
    v_add_u32 v15, s89, v2
    v_add_u32 v16, 57344, v15
    s_waitcnt vmcnt(7) lgkmcnt(0)
    s_barrier
    v_mfma_f32_16x16x32_bf16 v[32:35], a[0:3], a[84:87], v[32:35]
    v_mfma_f32_16x16x32_bf16 v[64:67], a[4:7], a[84:87], v[64:67]
    ds_read_b128 a[116:119], v15 offset:0
    v_mfma_f32_16x16x32_bf16 v[96:99], a[8:11], a[84:87], v[96:99]
    v_mfma_f32_16x16x32_bf16 v[128:131], a[12:15], a[84:87], v[128:131]
    v_mfma_f32_16x16x32_bf16 v[160:163], a[16:19], a[84:87], v[160:163]
    v_mfma_f32_16x16x32_bf16 v[192:195], a[20:23], a[84:87], v[192:195]
    v_mfma_f32_16x16x32_bf16 v[224:227], a[24:27], a[84:87], v[224:227]
    v_mfma_f32_16x16x32_bf16 v[36:39], a[0:3], a[88:91], v[36:39]
    v_mfma_f32_16x16x32_bf16 v[68:71], a[4:7], a[88:91], v[68:71]
    ds_read_b128 a[120:123], v15 offset:14336
    v_mfma_f32_16x16x32_bf16 v[100:103], a[8:11], a[88:91], v[100:103]
    v_mfma_f32_16x16x32_bf16 v[132:135], a[12:15], a[88:91], v[132:135]
    v_mfma_f32_16x16x32_bf16 v[164:167], a[16:19], a[88:91], v[164:167]
    v_mfma_f32_16x16x32_bf16 v[196:199], a[20:23], a[88:91], v[196:199]
    v_mfma_f32_16x16x32_bf16 v[228:231], a[24:27], a[88:91], v[228:231]
    v_mfma_f32_16x16x32_bf16 v[40:43], a[0:3], a[92:95], v[40:43]
    v_mfma_f32_16x16x32_bf16 v[72:75], a[4:7], a[92:95], v[72:75]
    ds_read_b128 a[124:127], v15 offset:28672
    v_mfma_f32_16x16x32_bf16 v[104:107], a[8:11], a[92:95], v[104:107]
    v_mfma_f32_16x16x32_bf16 v[136:139], a[12:15], a[92:95], v[136:139]
    v_mfma_f32_16x16x32_bf16 v[168:171], a[16:19], a[92:95], v[168:171]
    v_mfma_f32_16x16x32_bf16 v[200:203], a[20:23], a[92:95], v[200:203]
    v_mfma_f32_16x16x32_bf16 v[232:235], a[24:27], a[92:95], v[232:235]
    v_mfma_f32_16x16x32_bf16 v[44:47], a[0:3], a[96:99], v[44:47]
    v_mfma_f32_16x16x32_bf16 v[76:79], a[4:7], a[96:99], v[76:79]
    ds_read_b128 a[128:131], v15 offset:43008
    v_mfma_f32_16x16x32_bf16 v[108:111], a[8:11], a[96:99], v[108:111]
    v_mfma_f32_16x16x32_bf16 v[140:143], a[12:15], a[96:99], v[140:143]
    v_mfma_f32_16x16x32_bf16 v[172:175], a[16:19], a[96:99], v[172:175]
    v_mfma_f32_16x16x32_bf16 v[204:207], a[20:23], a[96:99], v[204:207]
    v_mfma_f32_16x16x32_bf16 v[236:239], a[24:27], a[96:99], v[236:239]
    v_mfma_f32_16x16x32_bf16 v[48:51], a[0:3], a[100:103], v[48:51]
    v_mfma_f32_16x16x32_bf16 v[80:83], a[4:7], a[100:103], v[80:83]
    ds_read_b128 a[132:135], v16 offset:0
    v_mfma_f32_16x16x32_bf16 v[112:115], a[8:11], a[100:103], v[112:115]
    v_mfma_f32_16x16x32_bf16 v[144:147], a[12:15], a[100:103], v[144:147]
    v_mfma_f32_16x16x32_bf16 v[176:179], a[16:19], a[100:103], v[176:179]
    v_mfma_f32_16x16x32_bf16 v[208:211], a[20:23], a[100:103], v[208:211]
    v_mfma_f32_16x16x32_bf16 v[240:243], a[24:27], a[100:103], v[240:243]
    v_mfma_f32_16x16x32_bf16 v[52:55], a[0:3], a[104:107], v[52:55]
    v_mfma_f32_16x16x32_bf16 v[84:87], a[4:7], a[104:107], v[84:87]
    ds_read_b128 a[136:139], v16 offset:14336
    v_mfma_f32_16x16x32_bf16 v[116:119], a[8:11], a[104:107], v[116:119]
    v_mfma_f32_16x16x32_bf16 v[148:151], a[12:15], a[104:107], v[148:151]
    v_mfma_f32_16x16x32_bf16 v[180:183], a[16:19], a[104:107], v[180:183]
    v_mfma_f32_16x16x32_bf16 v[212:215], a[20:23], a[104:107], v[212:215]
    v_mfma_f32_16x16x32_bf16 v[244:247], a[24:27], a[104:107], v[244:247]
    v_mfma_f32_16x16x32_bf16 v[56:59], a[0:3], a[108:111], v[56:59]
    v_mfma_f32_16x16x32_bf16 v[88:91], a[4:7], a[108:111], v[88:91]
    ds_read_b128 a[140:143], v16 offset:28672
    v_mfma_f32_16x16x32_bf16 v[120:123], a[8:11], a[108:111], v[120:123]
    v_mfma_f32_16x16x32_bf16 v[152:155], a[12:15], a[108:111], v[152:155]
    v_mfma_f32_16x16x32_bf16 v[184:187], a[16:19], a[108:111], v[184:187]
    v_mfma_f32_16x16x32_bf16 v[216:219], a[20:23], a[108:111], v[216:219]
    v_mfma_f32_16x16x32_bf16 v[248:251], a[24:27], a[108:111], v[248:251]
    v_mfma_f32_16x16x32_bf16 v[60:63], a[0:3], a[112:115], v[60:63]
    v_mfma_f32_16x16x32_bf16 v[92:95], a[4:7], a[112:115], v[92:95]
    ds_read_b128 a[144:147], v16 offset:43008
    v_mfma_f32_16x16x32_bf16 v[124:127], a[8:11], a[112:115], v[124:127]
    v_mfma_f32_16x16x32_bf16 v[156:159], a[12:15], a[112:115], v[156:159]
    v_mfma_f32_16x16x32_bf16 v[188:191], a[16:19], a[112:115], v[188:191]
    v_mfma_f32_16x16x32_bf16 v[220:223], a[20:23], a[112:115], v[220:223]
    v_mfma_f32_16x16x32_bf16 v[252:255], a[24:27], a[112:115], v[252:255]
    s_waitcnt vmcnt(0) lgkmcnt(0)
    v_mfma_f32_16x16x32_bf16 v[32:35], a[28:31], a[116:119], v[32:35]
    v_mfma_f32_16x16x32_bf16 v[64:67], a[32:35], a[116:119], v[64:67]
    v_mfma_f32_16x16x32_bf16 v[96:99], a[36:39], a[116:119], v[96:99]
    v_mfma_f32_16x16x32_bf16 v[128:131], a[40:43], a[116:119], v[128:131]
    v_mfma_f32_16x16x32_bf16 v[160:163], a[44:47], a[116:119], v[160:163]
    v_mfma_f32_16x16x32_bf16 v[192:195], a[48:51], a[116:119], v[192:195]
    v_mfma_f32_16x16x32_bf16 v[224:227], a[52:55], a[116:119], v[224:227]
    v_mfma_f32_16x16x32_bf16 v[36:39], a[28:31], a[120:123], v[36:39]
    v_mfma_f32_16x16x32_bf16 v[68:71], a[32:35], a[120:123], v[68:71]
    v_mfma_f32_16x16x32_bf16 v[100:103], a[36:39], a[120:123], v[100:103]
    v_mfma_f32_16x16x32_bf16 v[132:135], a[40:43], a[120:123], v[132:135]
    v_mfma_f32_16x16x32_bf16 v[164:167], a[44:47], a[120:123], v[164:167]
    v_mfma_f32_16x16x32_bf16 v[196:199], a[48:51], a[120:123], v[196:199]
    v_mfma_f32_16x16x32_bf16 v[228:231], a[52:55], a[120:123], v[228:231]
    v_mfma_f32_16x16x32_bf16 v[40:43], a[28:31], a[124:127], v[40:43]
    v_mfma_f32_16x16x32_bf16 v[72:75], a[32:35], a[124:127], v[72:75]
    v_mfma_f32_16x16x32_bf16 v[104:107], a[36:39], a[124:127], v[104:107]
    v_mfma_f32_16x16x32_bf16 v[136:139], a[40:43], a[124:127], v[136:139]
    v_mfma_f32_16x16x32_bf16 v[168:171], a[44:47], a[124:127], v[168:171]
    v_mfma_f32_16x16x32_bf16 v[200:203], a[48:51], a[124:127], v[200:203]
    v_mfma_f32_16x16x32_bf16 v[232:235], a[52:55], a[124:127], v[232:235]
    v_mfma_f32_16x16x32_bf16 v[44:47], a[28:31], a[128:131], v[44:47]
    v_mfma_f32_16x16x32_bf16 v[76:79], a[32:35], a[128:131], v[76:79]
    v_mfma_f32_16x16x32_bf16 v[108:111], a[36:39], a[128:131], v[108:111]
    v_mfma_f32_16x16x32_bf16 v[140:143], a[40:43], a[128:131], v[140:143]
    v_mfma_f32_16x16x32_bf16 v[172:175], a[44:47], a[128:131], v[172:175]
    v_mfma_f32_16x16x32_bf16 v[204:207], a[48:51], a[128:131], v[204:207]
    v_mfma_f32_16x16x32_bf16 v[236:239], a[52:55], a[128:131], v[236:239]
    v_mfma_f32_16x16x32_bf16 v[48:51], a[28:31], a[132:135], v[48:51]
    v_mfma_f32_16x16x32_bf16 v[80:83], a[32:35], a[132:135], v[80:83]
    v_mfma_f32_16x16x32_bf16 v[112:115], a[36:39], a[132:135], v[112:115]
    v_mfma_f32_16x16x32_bf16 v[144:147], a[40:43], a[132:135], v[144:147]
    v_mfma_f32_16x16x32_bf16 v[176:179], a[44:47], a[132:135], v[176:179]
    v_mfma_f32_16x16x32_bf16 v[208:211], a[48:51], a[132:135], v[208:211]
    v_mfma_f32_16x16x32_bf16 v[240:243], a[52:55], a[132:135], v[240:243]
    v_mfma_f32_16x16x32_bf16 v[52:55], a[28:31], a[136:139], v[52:55]
    v_mfma_f32_16x16x32_bf16 v[84:87], a[32:35], a[136:139], v[84:87]
    v_mfma_f32_16x16x32_bf16 v[116:119], a[36:39], a[136:139], v[116:119]
    v_mfma_f32_16x16x32_bf16 v[148:151], a[40:43], a[136:139], v[148:151]
    v_mfma_f32_16x16x32_bf16 v[180:183], a[44:47], a[136:139], v[180:183]
    v_mfma_f32_16x16x32_bf16 v[212:215], a[48:51], a[136:139], v[212:215]
    v_mfma_f32_16x16x32_bf16 v[244:247], a[52:55], a[136:139], v[244:247]
    v_mfma_f32_16x16x32_bf16 v[56:59], a[28:31], a[140:143], v[56:59]
    v_mfma_f32_16x16x32_bf16 v[88:91], a[32:35], a[140:143], v[88:91]
    v_mfma_f32_16x16x32_bf16 v[120:123], a[36:39], a[140:143], v[120:123]
    v_mfma_f32_16x16x32_bf16 v[152:155], a[40:43], a[140:143], v[152:155]
    v_mfma_f32_16x16x32_bf16 v[184:187], a[44:47], a[140:143], v[184:187]
    v_mfma_f32_16x16x32_bf16 v[216:219], a[48:51], a[140:143], v[216:219]
    v_mfma_f32_16x16x32_bf16 v[248:251], a[52:55], a[140:143], v[248:251]
    v_mfma_f32_16x16x32_bf16 v[60:63], a[28:31], a[144:147], v[60:63]
    v_mfma_f32_16x16x32_bf16 v[92:95], a[32:35], a[144:147], v[92:95]
    v_mfma_f32_16x16x32_bf16 v[124:127], a[36:39], a[144:147], v[124:127]
    v_mfma_f32_16x16x32_bf16 v[156:159], a[40:43], a[144:147], v[156:159]
    v_mfma_f32_16x16x32_bf16 v[188:191], a[44:47], a[144:147], v[188:191]
    v_mfma_f32_16x16x32_bf16 v[220:223], a[48:51], a[144:147], v[220:223]
    v_mfma_f32_16x16x32_bf16 v[252:255], a[52:55], a[144:147], v[252:255]
    s_lshl_b32 s40, s61, 7
    s_add_u32 s40, s40, 67691008
    s_waitcnt vmcnt(0)
    s_barrier
    s_cmp_lg_u32 s13, 0
    s_cbranch_scc1 Lsg_12
    s_mov_b64 exec, 1
    v_mov_b32 v3, 1
    buffer_atomic_add v3, off, s[4:7], s40
    s_mov_b64 exec, -1
Lsg_12:
    s_mul_i32 s40, s13, 7
    s_lshr_b32 s40, s40, 1
    s_lshl_b32 s40, s40, 10
    s_and_b32 s41, s13, 1
    s_lshl_b32 s42, s41, 3
    s_add_u32 s42, s42, s40
    s_mul_i32 s43, s41, 1016
    s_add_u32 s43, s43, 8
    s_add_u32 s43, s43, s40
    v_add_u32 v16, s42, v2
    v_add_u32 v17, s43, v2
    v_add_u32 v21, 57344, v16
    v_add_u32 v22, 57344, v17
    s_barrier
    v_cvt_pk_bf16_f32 v32, v32, v33
    v_cvt_pk_bf16_f32 v33, v34, v35
    ds_write_b64 v16, v[32:33] offset:0
    v_cvt_pk_bf16_f32 v64, v64, v65
    v_cvt_pk_bf16_f32 v65, v66, v67
    ds_write_b64 v17, v[64:65] offset:0
    v_cvt_pk_bf16_f32 v96, v96, v97
    v_cvt_pk_bf16_f32 v97, v98, v99
    ds_write_b64 v16, v[96:97] offset:1024
    v_cvt_pk_bf16_f32 v128, v128, v129
    v_cvt_pk_bf16_f32 v129, v130, v131
    ds_write_b64 v17, v[128:129] offset:1024
    v_cvt_pk_bf16_f32 v160, v160, v161
    v_cvt_pk_bf16_f32 v161, v162, v163
    ds_write_b64 v16, v[160:161] offset:2048
    v_cvt_pk_bf16_f32 v192, v192, v193
    v_cvt_pk_bf16_f32 v193, v194, v195
    ds_write_b64 v17, v[192:193] offset:2048
    v_cvt_pk_bf16_f32 v224, v224, v225
    v_cvt_pk_bf16_f32 v225, v226, v227
    ds_write_b64 v16, v[224:225] offset:3072
    v_cvt_pk_bf16_f32 v36, v36, v37
    v_cvt_pk_bf16_f32 v37, v38, v39
    ds_write_b64 v16, v[36:37] offset:14336
    v_cvt_pk_bf16_f32 v68, v68, v69
    v_cvt_pk_bf16_f32 v69, v70, v71
    ds_write_b64 v17, v[68:69] offset:14336
    v_cvt_pk_bf16_f32 v100, v100, v101
    v_cvt_pk_bf16_f32 v101, v102, v103
    ds_write_b64 v16, v[100:101] offset:15360
    v_cvt_pk_bf16_f32 v132, v132, v133
    v_cvt_pk_bf16_f32 v133, v134, v135
    ds_write_b64 v17, v[132:133] offset:15360
    v_cvt_pk_bf16_f32 v164, v164, v165
    v_cvt_pk_bf16_f32 v165, v166, v167
    ds_write_b64 v16, v[164:165] offset:16384
    v_cvt_pk_bf16_f32 v196, v196, v197
    v_cvt_pk_bf16_f32 v197, v198, v199
    ds_write_b64 v17, v[196:197] offset:16384
    v_cvt_pk_bf16_f32 v228, v228, v229
    v_cvt_pk_bf16_f32 v229, v230, v231
    ds_write_b64 v16, v[228:229] offset:17408
    v_cvt_pk_bf16_f32 v40, v40, v41
    v_cvt_pk_bf16_f32 v41, v42, v43
    ds_write_b64 v16, v[40:41] offset:28672
    v_cvt_pk_bf16_f32 v72, v72, v73
    v_cvt_pk_bf16_f32 v73, v74, v75
    ds_write_b64 v17, v[72:73] offset:28672
    v_cvt_pk_bf16_f32 v104, v104, v105
    v_cvt_pk_bf16_f32 v105, v106, v107
    ds_write_b64 v16, v[104:105] offset:29696
    v_cvt_pk_bf16_f32 v136, v136, v137
    v_cvt_pk_bf16_f32 v137, v138, v139
    ds_write_b64 v17, v[136:137] offset:29696
    v_cvt_pk_bf16_f32 v168, v168, v169
    v_cvt_pk_bf16_f32 v169, v170, v171
    ds_write_b64 v16, v[168:169] offset:30720
    v_cvt_pk_bf16_f32 v200, v200, v201
    v_cvt_pk_bf16_f32 v201, v202, v203
    ds_write_b64 v17, v[200:201] offset:30720
    v_cvt_pk_bf16_f32 v232, v232, v233
    v_cvt_pk_bf16_f32 v233, v234, v235
    ds_write_b64 v16, v[232:233] offset:31744
    v_cvt_pk_bf16_f32 v44, v44, v45
    v_cvt_pk_bf16_f32 v45, v46, v47
    ds_write_b64 v16, v[44:45] offset:43008
    v_cvt_pk_bf16_f32 v76, v76, v77
    v_cvt_pk_bf16_f32 v77, v78, v79
    ds_write_b64 v17, v[76:77] offset:43008
    v_cvt_pk_bf16_f32 v108, v108, v109
    v_cvt_pk_bf16_f32 v109, v110, v111
    ds_write_b64 v16, v[108:109] offset:44032
    v_cvt_pk_bf16_f32 v140, v140, v141
    v_cvt_pk_bf16_f32 v141, v142, v143
    ds_write_b64 v17, v[140:141] offset:44032
    v_cvt_pk_bf16_f32 v172, v172, v173
    v_cvt_pk_bf16_f32 v173, v174, v175
    ds_write_b64 v16, v[172:173] offset:45056
    v_cvt_pk_bf16_f32 v204, v204, v205
    v_cvt_pk_bf16_f32 v205, v206, v207
    ds_write_b64 v17, v[204:205] offset:45056
    v_cvt_pk_bf16_f32 v236, v236, v237
    v_cvt_pk_bf16_f32 v237, v238, v239
    ds_write_b64 v16, v[236:237] offset:46080
    v_cvt_pk_bf16_f32 v48, v48, v49
    v_cvt_pk_bf16_f32 v49, v50, v51
    ds_write_b64 v21, v[48:49] offset:0
    v_cvt_pk_bf16_f32 v80, v80, v81
    v_cvt_pk_bf16_f32 v81, v82, v83
    ds_write_b64 v22, v[80:81] offset:0
    v_cvt_pk_bf16_f32 v112, v112, v113
    v_cvt_pk_bf16_f32 v113, v114, v115
    ds_write_b64 v21, v[112:113] offset:1024
    v_cvt_pk_bf16_f32 v144, v144, v145
    v_cvt_pk_bf16_f32 v145, v146, v147
    ds_write_b64 v22, v[144:145] offset:1024
    v_cvt_pk_bf16_f32 v176, v176, v177
    v_cvt_pk_bf16_f32 v177, v178, v179
    ds_write_b64 v21, v[176:177] offset:2048
    v_cvt_pk_bf16_f32 v208, v208, v209
    v_cvt_pk_bf16_f32 v209, v210, v211
    ds_write_b64 v22, v[208:209] offset:2048
    v_cvt_pk_bf16_f32 v240, v240, v241
    v_cvt_pk_bf16_f32 v241, v242, v243
    ds_write_b64 v21, v[240:241] offset:3072
    v_cvt_pk_bf16_f32 v52, v52, v53
    v_cvt_pk_bf16_f32 v53, v54, v55
    ds_write_b64 v21, v[52:53] offset:14336
    v_cvt_pk_bf16_f32 v84, v84, v85
    v_cvt_pk_bf16_f32 v85, v86, v87
    ds_write_b64 v22, v[84:85] offset:14336
    v_cvt_pk_bf16_f32 v116, v116, v117
    v_cvt_pk_bf16_f32 v117, v118, v119
    ds_write_b64 v21, v[116:117] offset:15360
    v_cvt_pk_bf16_f32 v148, v148, v149
    v_cvt_pk_bf16_f32 v149, v150, v151
    ds_write_b64 v22, v[148:149] offset:15360
    v_cvt_pk_bf16_f32 v180, v180, v181
    v_cvt_pk_bf16_f32 v181, v182, v183
    ds_write_b64 v21, v[180:181] offset:16384
    v_cvt_pk_bf16_f32 v212, v212, v213
    v_cvt_pk_bf16_f32 v213, v214, v215
    ds_write_b64 v22, v[212:213] offset:16384
    v_cvt_pk_bf16_f32 v244, v244, v245
    v_cvt_pk_bf16_f32 v245, v246, v247
    ds_write_b64 v21, v[244:245] offset:17408
    v_cvt_pk_bf16_f32 v56, v56, v57
    v_cvt_pk_bf16_f32 v57, v58, v59
    ds_write_b64 v21, v[56:57] offset:28672
    v_cvt_pk_bf16_f32 v88, v88, v89
    v_cvt_pk_bf16_f32 v89, v90, v91
    ds_write_b64 v22, v[88:89] offset:28672
    v_cvt_pk_bf16_f32 v120, v120, v121
    v_cvt_pk_bf16_f32 v121, v122, v123
    ds_write_b64 v21, v[120:121] offset:29696
    v_cvt_pk_bf16_f32 v152, v152, v153
    v_cvt_pk_bf16_f32 v153, v154, v155
    ds_write_b64 v22, v[152:153] offset:29696
    v_cvt_pk_bf16_f32 v184, v184, v185
    v_cvt_pk_bf16_f32 v185, v186, v187
    ds_write_b64 v21, v[184:185] offset:30720
    v_cvt_pk_bf16_f32 v216, v216, v217
    v_cvt_pk_bf16_f32 v217, v218, v219
    ds_write_b64 v22, v[216:217] offset:30720
    v_cvt_pk_bf16_f32 v248, v248, v249
    v_cvt_pk_bf16_f32 v249, v250, v251
    ds_write_b64 v21, v[248:249] offset:31744
    v_cvt_pk_bf16_f32 v60, v60, v61
    v_cvt_pk_bf16_f32 v61, v62, v63
    ds_write_b64 v21, v[60:61] offset:43008
    v_cvt_pk_bf16_f32 v92, v92, v93
    v_cvt_pk_bf16_f32 v93, v94, v95
    ds_write_b64 v22, v[92:93] offset:43008
    v_cvt_pk_bf16_f32 v124, v124, v125
    v_cvt_pk_bf16_f32 v125, v126, v127
    ds_write_b64 v21, v[124:125] offset:44032
    v_cvt_pk_bf16_f32 v156, v156, v157
    v_cvt_pk_bf16_f32 v157, v158, v159
    ds_write_b64 v22, v[156:157] offset:44032
    v_cvt_pk_bf16_f32 v188, v188, v189
    v_cvt_pk_bf16_f32 v189, v190, v191
    ds_write_b64 v21, v[188:189] offset:45056
    v_cvt_pk_bf16_f32 v220, v220, v221
    v_cvt_pk_bf16_f32 v221, v222, v223
    ds_write_b64 v22, v[220:221] offset:45056
    v_cvt_pk_bf16_f32 v252, v252, v253
    v_cvt_pk_bf16_f32 v253, v254, v255
    ds_write_b64 v21, v[252:253] offset:46080
    s_lshl_b32 s62, s61, 2
    s_add_u32 s62, s62, s13
    s_mul_i32 s40, s62, 28672
    s_add_u32 s40, s40, 14680064
    v_and_b32 v18, 0x310, v2
    v_bfe_u32 v19, v1, 1, 2
    v_lshl_add_u32 v18, v19, 6, v18
    v_bfe_u32 v19, v1, 3, 1
    v_lshl_add_u32 v18, v19, 5, v18
    s_waitcnt lgkmcnt(0)
    buffer_load_dwordx4 v[32:35], v18, s[4:7], s40 offen offset:0
    buffer_load_dwordx4 v[36:39], v18, s[4:7], s40 offen offset:1024
    buffer_load_dwordx4 v[40:43], v18, s[4:7], s40 offen offset:2048
    buffer_load_dwordx4 v[44:47], v18, s[4:7], s40 offen offset:3072
    s_add_u32 s40, s40, 4096
    buffer_load_dwordx4 v[48:51], v18, s[4:7], s40 offen offset:0
    buffer_load_dwordx4 v[52:55], v18, s[4:7], s40 offen offset:1024
    buffer_load_dwordx4 v[56:59], v18, s[4:7], s40 offen offset:2048
    buffer_load_dwordx4 v[60:63], v18, s[4:7], s40 offen offset:3072
    s_add_u32 s40, s40, 4096
    buffer_load_dwordx4 v[64:67], v18, s[4:7], s40 offen offset:0
    buffer_load_dwordx4 v[68:71], v18, s[4:7], s40 offen offset:1024
    buffer_load_dwordx4 v[72:75], v18, s[4:7], s40 offen offset:2048
    buffer_load_dwordx4 v[76:79], v18, s[4:7], s40 offen offset:3072
    s_add_u32 s40, s40, 4096
    buffer_load_dwordx4 v[80:83], v18, s[4:7], s40 offen offset:0
    buffer_load_dwordx4 v[84:87], v18, s[4:7], s40 offen offset:1024
    buffer_load_dwordx4 v[88:91], v18, s[4:7], s40 offen offset:2048
    buffer_load_dwordx4 v[92:95], v18, s[4:7], s40 offen offset:3072
    s_add_u32 s40, s40, 4096
    buffer_load_dwordx4 v[96:99], v18, s[4:7], s40 offen offset:0
    buffer_load_dwordx4 v[100:103], v18, s[4:7], s40 offen offset:1024
    buffer_load_dwordx4 v[104:107], v18, s[4:7], s40 offen offset:2048
    buffer_load_dwordx4 v[108:111], v18, s[4:7], s40 offen offset:3072
    s_add_u32 s40, s40, 4096
    buffer_load_dwordx4 v[112:115], v18, s[4:7], s40 offen offset:0
    buffer_load_dwordx4 v[116:119], v18, s[4:7], s40 offen offset:1024
    buffer_load_dwordx4 v[120:123], v18, s[4:7], s40 offen offset:2048
    buffer_load_dwordx4 v[124:127], v18, s[4:7], s40 offen offset:3072
    s_add_u32 s40, s40, 4096
    buffer_load_dwordx4 v[128:131], v18, s[4:7], s40 offen offset:0
    buffer_load_dwordx4 v[132:135], v18, s[4:7], s40 offen offset:1024
    buffer_load_dwordx4 v[136:139], v18, s[4:7], s40 offen offset:2048
    buffer_load_dwordx4 v[140:143], v18, s[4:7], s40 offen offset:3072
    s_add_u32 s40, s40, 4096
    s_barrier
    s_mul_i32 s41, s13, 28672
    v_add_u32 v21, s41, v2
    ds_read_b128 a[0:3], v21 offset:0
    ds_read_b128 a[4:7], v21 offset:1024
    ds_read_b128 a[8:11], v21 offset:2048
    ds_read_b128 a[12:15], v21 offset:3072
    ds_read_b128 a[16:19], v21 offset:4096
    ds_read_b128 a[20:23], v21 offset:5120
    ds_read_b128 a[24:27], v21 offset:6144
    ds_read_b128 a[28:31], v21 offset:7168
    ds_read_b128 a[32:35], v21 offset:8192
    ds_read_b128 a[36:39], v21 offset:9216
    ds_read_b128 a[40:43], v21 offset:10240
    ds_read_b128 a[44:47], v21 offset:11264
    ds_read_b128 a[48:51], v21 offset:12288
    ds_read_b128 a[52:55], v21 offset:13312
    ds_read_b128 a[56:59], v21 offset:14336
    ds_read_b128 a[60:63], v21 offset:15360
    ds_read_b128 a[64:67], v21 offset:16384
    ds_read_b128 a[68:71], v21 offset:17408
    ds_read_b128 a[72:75], v21 offset:18432
    ds_read_b128 a[76:79], v21 offset:19456
    ds_read_b128 a[80:83], v21 offset:20480
    ds_read_b128 a[84:87], v21 offset:21504
    ds_read_b128 a[88:91], v21 offset:22528
    ds_read_b128 a[92:95], v21 offset:23552
    ds_read_b128 a[96:99], v21 offset:24576
    ds_read_b128 a[100:103], v21 offset:25600
    ds_read_b128 a[104:107], v21 offset:26624
    ds_read_b128 a[108:111], v21 offset:27648
    s_cmp_lg_u32 s62, 63
    s_cbranch_scc1 Lq63_13
    s_mul_i32 s40, s60, 28672
    s_add_u32 s40, s40, 47710208
    s_waitcnt lgkmcnt(0)
    buffer_store_dwordx4 a[0:3], v2, s[4:7], s40 offen offset:0 sc1
    buffer_store_dwordx4 a[4:7], v2, s[4:7], s40 offen offset:1024 sc1
    buffer_store_dwordx4 a[8:11], v2, s[4:7], s40 offen offset:2048 sc1
    buffer_store_dwordx4 a[12:15], v2, s[4:7], s40 offen offset:3072 sc1
    s_add_u32 s40, s40, 4096
    buffer_store_dwordx4 a[16:19], v2, s[4:7], s40 offen offset:0 sc1
    buffer_store_dwordx4 a[20:23], v2, s[4:7], s40 offen offset:1024 sc1
    buffer_store_dwordx4 a[24:27], v2, s[4:7], s40 offen offset:2048 sc1
    buffer_store_dwordx4 a[28:31], v2, s[4:7], s40 offen offset:3072 sc1
    s_add_u32 s40, s40, 4096
    buffer_store_dwordx4 a[32:35], v2, s[4:7], s40 offen offset:0 sc1
    buffer_store_dwordx4 a[36:39], v2, s[4:7], s40 offen offset:1024 sc1
    buffer_store_dwordx4 a[40:43], v2, s[4:7], s40 offen offset:2048 sc1
    buffer_store_dwordx4 a[44:47], v2, s[4:7], s40 offen offset:3072 sc1
    s_add_u32 s40, s40, 4096
    buffer_store_dwordx4 a[48:51], v2, s[4:7], s40 offen offset:0 sc1
    buffer_store_dwordx4 a[52:55], v2, s[4:7], s40 offen offset:1024 sc1
    buffer_store_dwordx4 a[56:59], v2, s[4:7], s40 offen offset:2048 sc1
    buffer_store_dwordx4 a[60:63], v2, s[4:7], s40 offen offset:3072 sc1
    s_add_u32 s40, s40, 4096
    buffer_store_dwordx4 a[64:67], v2, s[4:7], s40 offen offset:0 sc1
    buffer_store_dwordx4 a[68:71], v2, s[4:7], s40 offen offset:1024 sc1
    buffer_store_dwordx4 a[72:75], v2, s[4:7], s40 offen offset:2048 sc1
    buffer_store_dwordx4 a[76:79], v2, s[4:7], s40 offen offset:3072 sc1
    s_add_u32 s40, s40, 4096
    buffer_store_dwordx4 a[80:83], v2, s[4:7], s40 offen offset:0 sc1
    buffer_store_dwordx4 a[84:87], v2, s[4:7], s40 offen offset:1024 sc1
    buffer_store_dwordx4 a[88:91], v2, s[4:7], s40 offen offset:2048 sc1
    buffer_store_dwordx4 a[92:95], v2, s[4:7], s40 offen offset:3072 sc1
    s_add_u32 s40, s40, 4096
    buffer_store_dwordx4 a[96:99], v2, s[4:7], s40 offen offset:0 sc1
    buffer_store_dwordx4 a[100:103], v2, s[4:7], s40 offen offset:1024 sc1
    buffer_store_dwordx4 a[104:107], v2, s[4:7], s40 offen offset:2048 sc1
    buffer_store_dwordx4 a[108:111], v2, s[4:7], s40 offen offset:3072 sc1
    s_add_u32 s40, s40, 4096
    s_waitcnt vmcnt(0)
    s_mov_b64 exec, 1
    v_mov_b32 v21, 2
    s_mov_b32 s40, 67680256
    buffer_atomic_add v21, off, s[4:7], s40
    s_mov_b64 exec, -1
    s_branch W_next
Lq63_13:
    v_lshrrev_b32 v18, 4, v1
    v_and_b32 v19, 15, v1
    v_lshrrev_b32 v20, 1, v18
    v_lshlrev_b32 v20, 8, v20
    v_and_b32 v21, 7, v19
    v_lshl_add_u32 v20, v21, 4, v20
    v_and_b32 v21, 1, v18
    v_lshl_add_u32 v20, v21, 7, v20
    v_lshlrev_b32 v21, 2, v18
    v_cmp_gt_u32 s[44:45], v21, v19
    v_add_u32 v21, 1, v21
    v_cmp_gt_u32 s[46:47], v21, v19
    v_add_u32 v21, 1, v21
    v_cmp_gt_u32 s[48:49], v21, v19
    v_add_u32 v21, 1, v21
    v_cmp_gt_u32 s[50:51], v21, v19
    v_cmp_gt_u32 s[52:53], 2, v18
    s_waitcnt vmcnt(0) lgkmcnt(0)
    v_mfma_f32_16x16x32_bf16 v[200:203], v[32:35], a[0:3], 0
    v_mfma_f32_16x16x32_bf16 v[204:207], v[32:35], a[56:59], 0
    v_mfma_f32_16x16x32_bf16 v[208:211], v[88:91], a[56:59], 0
    v_mfma_f32_16x16x32_bf16 v[200:203], v[36:39], a[4:7], v[200:203]
    v_mfma_f32_16x16x32_bf16 v[204:207], v[36:39], a[60:63], v[204:207]
    v_mfma_f32_16x16x32_bf16 v[208:211], v[92:95], a[60:63], v[208:211]
    v_mfma_f32_16x16x32_bf16 v[200:203], v[40:43], a[8:11], v[200:203]
    v_mfma_f32_16x16x32_bf16 v[204:207], v[40:43], a[64:67], v[204:207]
    v_mfma_f32_16x16x32_bf16 v[208:211], v[96:99], a[64:67], v[208:211]
    v_mfma_f32_16x16x32_bf16 v[200:203], v[44:47], a[12:15], v[200:203]
    v_mfma_f32_16x16x32_bf16 v[204:207], v[44:47], a[68:71], v[204:207]
    v_mfma_f32_16x16x32_bf16 v[208:211], v[100:103], a[68:71], v[208:211]
    v_mfma_f32_16x16x32_bf16 v[200:203], v[48:51], a[16:19], v[200:203]
    v_mfma_f32_16x16x32_bf16 v[204:207], v[48:51], a[72:75], v[204:207]
    v_mfma_f32_16x16x32_bf16 v[208:211], v[104:107], a[72:75], v[208:211]
    v_mfma_f32_16x16x32_bf16 v[200:203], v[52:55], a[20:23], v[200:203]
    v_mfma_f32_16x16x32_bf16 v[204:207], v[52:55], a[76:79], v[204:207]
    v_mfma_f32_16x16x32_bf16 v[208:211], v[108:111], a[76:79], v[208:211]
    v_mfma_f32_16x16x32_bf16 v[200:203], v[56:59], a[24:27], v[200:203]
    v_mfma_f32_16x16x32_bf16 v[204:207], v[56:59], a[80:83], v[204:207]
    v_mfma_f32_16x16x32_bf16 v[208:211], v[112:115], a[80:83], v[208:211]
    v_mfma_f32_16x16x32_bf16 v[200:203], v[60:63], a[28:31], v[200:203]
    v_mfma_f32_16x16x32_bf16 v[204:207], v[60:63], a[84:87], v[204:207]
    v_mfma_f32_16x16x32_bf16 v[208:211], v[116:119], a[84:87], v[208:211]
    v_mfma_f32_16x16x32_bf16 v[200:203], v[64:67], a[32:35], v[200:203]
    v_mfma_f32_16x16x32_bf16 v[204:207], v[64:67], a[88:91], v[204:207]
    v_mfma_f32_16x16x32_bf16 v[208:211], v[120:123], a[88:91], v[208:211]
    v_mfma_f32_16x16x32_bf16 v[200:203], v[68:71], a[36:39], v[200:203]
    v_mfma_f32_16x16x32_bf16 v[204:207], v[68:71], a[92:95], v[204:207]
    v_mfma_f32_16x16x32_bf16 v[208:211], v[124:127], a[92:95], v[208:211]
    v_mfma_f32_16x16x32_bf16 v[200:203], v[72:75], a[40:43], v[200:203]
    v_mfma_f32_16x16x32_bf16 v[204:207], v[72:75], a[96:99], v[204:207]
    v_mfma_f32_16x16x32_bf16 v[208:211], v[128:131], a[96:99], v[208:211]
    v_mfma_f32_16x16x32_bf16 v[200:203], v[76:79], a[44:47], v[200:203]
    v_mfma_f32_16x16x32_bf16 v[204:207], v[76:79], a[100:103], v[204:207]
    v_mfma_f32_16x16x32_bf16 v[208:211], v[132:135], a[100:103], v[208:211]
    v_mfma_f32_16x16x32_bf16 v[200:203], v[80:83], a[48:51], v[200:203]
    v_mfma_f32_16x16x32_bf16 v[204:207], v[80:83], a[104:107], v[204:207]
    v_mfma_f32_16x16x32_bf16 v[208:211], v[136:139], a[104:107], v[208:211]
    v_mfma_f32_16x16x32_bf16 v[200:203], v[84:87], a[52:55], v[200:203]
    v_mfma_f32_16x16x32_bf16 v[204:207], v[84:87], a[108:111], v[204:207]
    v_mfma_f32_16x16x32_bf16 v[208:211], v[140:143], a[108:111], v[208:211]
    s_add_u32 s40, s62, 63
    s_and_b32 s40, s40, 63
    s_mul_i32 s40, s40, 7168
    s_add_u32 s40, s40, 63963136
    s_add_u32 s41, s40, 4096
    s_mov_b32 s20, 0
Lpm_14:
    buffer_load_dwordx4 v[144:147], v20, s[4:7], s40 offen offset:0 sc1
    buffer_load_dwordx4 v[148:151], v20, s[4:7], s40 offen offset:512 sc1
    buffer_load_dwordx4 v[152:155], v20, s[4:7], s40 offen offset:1024 sc1
    buffer_load_dwordx4 v[156:159], v20, s[4:7], s40 offen offset:1536 sc1
    buffer_load_dwordx4 v[160:163], v20, s[4:7], s40 offen offset:2048 sc1
    buffer_load_dwordx4 v[164:167], v20, s[4:7], s40 offen offset:2560 sc1
    buffer_load_dwordx4 v[168:171], v20, s[4:7], s40 offen offset:3072 sc1
    buffer_load_dwordx4 v[172:175], v20, s[4:7], s40 offen offset:3584 sc1
    buffer_load_dwordx4 v[176:179], v20, s[4:7], s41 offen offset:0 sc1
    buffer_load_dwordx4 v[180:183], v20, s[4:7], s41 offen offset:512 sc1
    buffer_load_dwordx4 v[184:187], v20, s[4:7], s41 offen offset:1024 sc1
    buffer_load_dwordx4 v[188:191], v20, s[4:7], s41 offen offset:1536 sc1
    buffer_load_dwordx4 v[192:195], v20, s[4:7], s41 offen offset:2048 sc1
    buffer_load_dwordx4 v[196:199], v20, s[4:7], s41 offen offset:2560 sc1
    s_add_u32 s20, s20, 1
    s_cmp_gt_u32 s20, s23
    s_cbranch_scc1 L_fail
    s_waitcnt vmcnt(0)
    v_max3_u32 v21, v144, v145, v146
    v_max3_u32 v21, v21, v147, v148
    v_max3_u32 v21, v21, v149, v150
    v_max3_u32 v21, v21, v151, v152
    v_max3_u32 v21, v21, v153, v154
    v_max3_u32 v21, v21, v155, v156
    v_max3_u32 v21, v21, v157, v158
    v_max3_u32 v21, v21, v159, v160
    v_max3_u32 v21, v21, v161, v162
    v_max3_u32 v21, v21, v163, v164
    v_max3_u32 v21, v21, v165, v166
    v_max3_u32 v21, v21, v167, v168
    v_max3_u32 v21, v21, v169, v170
    v_max3_u32 v21, v21, v171, v172
    v_max3_u32 v21, v21, v173, v174
    v_max3_u32 v21, v21, v175, v176
    v_max3_u32 v21, v21, v177, v178
    v_max3_u32 v21, v21, v179, v180
    v_max3_u32 v21, v21, v181, v182
    v_max3_u32 v21, v21, v183, v184
    v_max3_u32 v21, v21, v185, v186
    v_max3_u32 v21, v21, v187, v188
    v_max3_u32 v21, v21, v189, v190
    v_max3_u32 v21, v21, v191, v192
    v_max3_u32 v21, v21, v193, v194
    v_max3_u32 v21, v21, v195, v196
    v_max3_u32 v21, v21, v197, v198
    v_max_u32 v21, v21, v199
    v_cmp_eq_u32 vcc, -1, v21
    s_cbranch_vccz Lpd_15
    s_cmp_ge_u32 s62, 63
    s_cbranch_scc1 Lpm_14
Lpl_16:
    s_sleep 2
    s_cmp_ge_u32 s62, 60
    s_cbranch_scc1 Lpl_16f
    s_sleep 120
Lpl_16f:
    buffer_load_dword v21, v20, s[4:7], s41 offen offset:2560 sc1
    s_add_u32 s20, s20, 1
    s_cmp_gt_u32 s20, s23
    s_cbranch_scc1 L_fail
    s_waitcnt vmcnt(0)
    v_cmp_eq_u32 vcc, -1, v21
    s_cbranch_vccnz Lpl_16
    s_branch Lpm_14
Lpd_15:
    v_mfma_f32_16x16x32_bf16 v[212:215], v[144:147], a[0:3], 0
    v_mfma_f32_16x16x32_bf16 v[216:219], v[144:147], a[56:59], 0
    v_mfma_f32_16x16x32_bf16 v[212:215], v[148:151], a[4:7], v[212:215]
    v_mfma_f32_16x16x32_bf16 v[216:219], v[148:151], a[60:63], v[216:219]
    v_mfma_f32_16x16x32_bf16 v[212:215], v[152:155], a[8:11], v[212:215]
    v_mfma_f32_16x16x32_bf16 v[216:219], v[152:155], a[64:67], v[216:219]
    v_mfma_f32_16x16x32_bf16 v[212:215], v[156:159], a[12:15], v[212:215]
    v_mfma_f32_16x16x32_bf16 v[216:219], v[156:159], a[68:71], v[216:219]
    v_mfma_f32_16x16x32_bf16 v[212:215], v[160:163], a[16:19], v[212:215]
    v_mfma_f32_16x16x32_bf16 v[216:219], v[160:163], a[72:75], v[216:219]
    v_mfma_f32_16x16x32_bf16 v[212:215], v[164:167], a[20:23], v[212:215]
    v_mfma_f32_16x16x32_bf16 v[216:219], v[164:167], a[76:79], v[216:219]
    v_mfma_f32_16x16x32_bf16 v[212:215], v[168:171], a[24:27], v[212:215]
    v_mfma_f32_16x16x32_bf16 v[216:219], v[168:171], a[80:83], v[216:219]
    v_mfma_f32_16x16x32_bf16 v[212:215], v[172:175], a[28:31], v[212:215]
    v_mfma_f32_16x16x32_bf16 v[216:219], v[172:175], a[84:87], v[216:219]
    v_mfma_f32_16x16x32_bf16 v[212:215], v[176:179], a[32:35], v[212:215]
    v_mfma_f32_16x16x32_bf16 v[216:219], v[176:179], a[88:91], v[216:219]
    v_mfma_f32_16x16x32_bf16 v[212:215], v[180:183], a[36:39], v[212:215]
    v_mfma_f32_16x16x32_bf16 v[216:219], v[180:183], a[92:95], v[216:219]
    v_mfma_f32_16x16x32_bf16 v[212:215], v[184:187], a[40:43], v[212:215]
    v_mfma_f32_16x16x32_bf16 v[216:219], v[184:187], a[96:99], v[216:219]
    v_mfma_f32_16x16x32_bf16 v[212:215], v[188:191], a[44:47], v[212:215]
    v_mfma_f32_16x16x32_bf16 v[216:219], v[188:191], a[100:103], v[216:219]
    v_mfma_f32_16x16x32_bf16 v[212:215], v[192:195], a[48:51], v[212:215]
    v_mfma_f32_16x16x32_bf16 v[216:219], v[192:195], a[104:107], v[216:219]
    v_mfma_f32_16x16x32_bf16 v[212:215], v[196:199], a[52:55], v[212:215]
    v_mfma_f32_16x16x32_bf16 v[216:219], v[196:199], a[108:111], v[216:219]
    s_lshl_b32 s62, s61, 2
    s_add_u32 s62, s62, s13
    s_mul_i32 s40, s62, 49152
    s_add_u32 s40, s40, 64421888
    s_lshl_b32 s41, s60, 11
    s_add_u32 s41, s41, s40
    s_lshr_b32 s42, s60, 1
    s_lshl_b32 s42, s42, 11
    s_and_b32 s43, s60, 1
    s_lshl_b32 s43, s43, 2
    s_add_u32 s42, s42, s43
    s_add_u32 s42, s42, s40
    s_add_u32 s42, s42, 32768
    v_mov_b32 v23, 0xff800000
    s_nop 1
    v_cndmask_b32 v200, v200, v23, s[44:45]
    v_cndmask_b32 v201, v201, v23, s[46:47]
    v_cndmask_b32 v202, v202, v23, s[48:49]
    v_cndmask_b32 v203, v203, v23, s[50:51]
    v_cndmask_b32 v208, v208, v23, s[44:45]
    v_cndmask_b32 v209, v209, v23, s[46:47]
    v_cndmask_b32 v210, v210, v23, s[48:49]
    v_cndmask_b32 v211, v211, v23, s[50:51]
    v_max3_f32 v24, v212, v213, v214
    v_max3_f32 v24, v24, v215, v200
    v_max3_f32 v24, v24, v201, v202
    v_max_f32 v24, v24, v203
    v_mov_b32 v26, v24
    s_nop 1
    v_permlane16_swap_b32 v24, v26
    v_max_f32 v24, v24, v26
    v_mov_b32 v26, v24
    s_nop 1
    v_permlane32_swap_b32 v24, v26
    v_max_f32 v24, v24, v26
    v_pk_add_f32 v[212:213], v[212:213], v[24:25] op_sel_hi:[1,0] neg_lo:[0,1] neg_hi:[0,1]
    v_pk_add_f32 v[214:215], v[214:215], v[24:25] op_sel_hi:[1,0] neg_lo:[0,1] neg_hi:[0,1]
    v_pk_add_f32 v[200:201], v[200:201], v[24:25] op_sel_hi:[1,0] neg_lo:[0,1] neg_hi:[0,1]
    v_pk_add_f32 v[202:203], v[202:203], v[24:25] op_sel_hi:[1,0] neg_lo:[0,1] neg_hi:[0,1]
    v_exp_f32 v212, v212
    v_exp_f32 v213, v213
    v_exp_f32 v214, v214
    v_exp_f32 v215, v215
    v_exp_f32 v200, v200
    v_exp_f32 v201, v201
    v_exp_f32 v202, v202
    v_exp_f32 v203, v203
    s_nop 0
    v_pk_add_f32 v[28:29], v[212:213], v[214:215]
    v_add_f32 v28, v28, v29
    v_cndmask_b32 v28, 0, v28, s[52:53]
    v_mov_b32 v29, 0
    v_pk_add_f32 v[28:29], v[28:29], v[200:201]
    v_pk_add_f32 v[28:29], v[28:29], v[202:203]
    v_add_f32 v28, v28, v29
    v_mov_b32 v26, v28
    s_nop 1
    v_permlane16_swap_b32 v28, v26
    v_add_f32 v28, v28, v26
    v_mov_b32 v26, v28
    s_nop 1
    v_permlane32_swap_b32 v28, v26
    v_add_f32 v28, v28, v26
    v_rcp_f32 v28, v28
    s_nop 0
    v_pk_mul_f32 v[212:213], v[212:213], v[28:29] op_sel_hi:[1,0]
    v_pk_mul_f32 v[214:215], v[214:215], v[28:29] op_sel_hi:[1,0]
    v_pk_mul_f32 v[200:201], v[200:201], v[28:29] op_sel_hi:[1,0]
    v_pk_mul_f32 v[202:203], v[202:203], v[28:29] op_sel_hi:[1,0]
    v_cvt_pk_bf16_f32 v220, v200, v201
    v_cvt_pk_bf16_f32 v221, v202, v203
    v_mov_b64 v[222:223], 0
    v_cvt_pk_bf16_f32 v224, v212, v213
    v_cvt_pk_bf16_f32 v225, v214, v215
    v_min_u32 v220, -2, v220
    v_min_u32 v221, -2, v221
    v_min_u32 v224, -2, v224
    v_min_u32 v225, -2, v225
    buffer_store_dwordx4 v[220:223], v2, s[4:7], s41 offen offset:0 sc1
    buffer_store_dword v224, v2, s[4:7], s42 offen offset:0 sc1
    buffer_store_dword v225, v2, s[4:7], s42 offen offset:8 sc1
    v_max3_f32 v24, v216, v217, v218
    v_max3_f32 v24, v24, v219, v204
    v_max3_f32 v24, v24, v205, v206
    v_max3_f32 v24, v24, v207, v208
    v_max3_f32 v24, v24, v209, v210
    v_max_f32 v24, v24, v211
    v_mov_b32 v26, v24
    s_nop 1
    v_permlane16_swap_b32 v24, v26
    v_max_f32 v24, v24, v26
    v_mov_b32 v26, v24
    s_nop 1
    v_permlane32_swap_b32 v24, v26
    v_max_f32 v24, v24, v26
    v_pk_add_f32 v[216:217], v[216:217], v[24:25] op_sel_hi:[1,0] neg_lo:[0,1] neg_hi:[0,1]
    v_pk_add_f32 v[218:219], v[218:219], v[24:25] op_sel_hi:[1,0] neg_lo:[0,1] neg_hi:[0,1]
    v_pk_add_f32 v[204:205], v[204:205], v[24:25] op_sel_hi:[1,0] neg_lo:[0,1] neg_hi:[0,1]
    v_pk_add_f32 v[206:207], v[206:207], v[24:25] op_sel_hi:[1,0] neg_lo:[0,1] neg_hi:[0,1]
    v_pk_add_f32 v[208:209], v[208:209], v[24:25] op_sel_hi:[1,0] neg_lo:[0,1] neg_hi:[0,1]
    v_pk_add_f32 v[210:211], v[210:211], v[24:25] op_sel_hi:[1,0] neg_lo:[0,1] neg_hi:[0,1]
    v_exp_f32 v216, v216
    v_exp_f32 v217, v217
    v_exp_f32 v218, v218
    v_exp_f32 v219, v219
    v_exp_f32 v204, v204
    v_exp_f32 v205, v205
    v_exp_f32 v206, v206
    v_exp_f32 v207, v207
    v_exp_f32 v208, v208
    v_exp_f32 v209, v209
    v_exp_f32 v210, v210
    v_exp_f32 v211, v211
    s_nop 0
    v_pk_add_f32 v[28:29], v[216:217], v[218:219]
    v_add_f32 v28, v28, v29
    v_cndmask_b32 v28, 0, v28, s[52:53]
    v_mov_b32 v29, 0
    v_pk_add_f32 v[28:29], v[28:29], v[204:205]
    v_pk_add_f32 v[28:29], v[28:29], v[206:207]
    v_pk_add_f32 v[28:29], v[28:29], v[208:209]
    v_pk_add_f32 v[28:29], v[28:29], v[210:211]
    v_add_f32 v28, v28, v29
    v_mov_b32 v26, v28
    s_nop 1
    v_permlane16_swap_b32 v28, v26
    v_add_f32 v28, v28, v26
    v_mov_b32 v26, v28
    s_nop 1
    v_permlane32_swap_b32 v28, v26
    v_add_f32 v28, v28, v26
    v_rcp_f32 v28, v28
    s_nop 0
    v_pk_mul_f32 v[216:217], v[216:217], v[28:29] op_sel_hi:[1,0]
    v_pk_mul_f32 v[218:219], v[218:219], v[28:29] op_sel_hi:[1,0]
    v_pk_mul_f32 v[204:205], v[204:205], v[28:29] op_sel_hi:[1,0]
    v_pk_mul_f32 v[206:207], v[206:207], v[28:29] op_sel_hi:[1,0]
    v_pk_mul_f32 v[208:209], v[208:209], v[28:29] op_sel_hi:[1,0]
    v_pk_mul_f32 v[210:211], v[210:211], v[28:29] op_sel_hi:[1,0]
    v_cvt_pk_bf16_f32 v228, v204, v205
    v_cvt_pk_bf16_f32 v229, v206, v207
    v_cvt_pk_bf16_f32 v230, v208, v209
    v_cvt_pk_bf16_f32 v231, v210, v211
    v_cvt_pk_bf16_f32 v232, v216, v217
    v_cvt_pk_bf16_f32 v233, v218, v219
    v_min_u32 v228, -2, v228
    v_min_u32 v229, -2, v229
    v_min_u32 v230, -2, v230
    v_min_u32 v231, -2, v231
    v_min_u32 v232, -2, v232
    v_min_u32 v233, -2, v233
    buffer_store_dwordx4 v[228:231], v2, s[4:7], s41 offen offset:1024 sc1
    buffer_store_dword v232, v2, s[4:7], s42 offen offset:1024 sc1
    buffer_store_dword v233, v2, s[4:7], s42 offen offset:1032 sc1
    s_branch W_next
T_V:
    s_lshr_b32 s61, s62, 2
    s_lshl_b32 s40, s61, 7
    s_add_u32 s40, s40, 67678208
    s_cmp_lg_u32 s13, 0
    s_cbranch_scc1 Lw1d_18
    s_mov_b32 s20, 0
Lw1_17:
    buffer_load_dword v16, off, s[4:7], s40 sc1
    s_add_u32 s20, s20, 1
    s_cmp_gt_u32 s20, s23
    s_cbranch_scc1 L_fail
    s_waitcnt vmcnt(0)
    v_cmp_le_u32 vcc, 32, v16
    s_cbranch_vccnz Lw1d_18
    s_sleep 16
    s_branch Lw1_17
Lw1d_18:
    s_barrier
    s_mov_b32 s40, 67690752
    s_cmp_lg_u32 s13, 0
    s_cbranch_scc1 Lw1d_21
    s_mov_b32 s20, 0
Lw1_20:
    buffer_load_dword v16, off, s[4:7], s40 sc1
    s_add_u32 s20, s20, 1
    s_cmp_gt_u32 s20, s23
    s_cbranch_scc1 L_fail
    s_waitcnt vmcnt(0)
    v_cmp_le_u32 vcc, 64, v16
    s_cbranch_vccnz Lw1d_21
    s_sleep 16
    s_branch Lw1_20
Lw1d_21:
    s_barrier
    s_mul_i32 s40, s62, 458752
    s_lshl_b32 s41, s64, 16
    s_add_u32 s40, s40, s41
    s_lshl_b32 s41, s13, 13
    s_add_u32 s40, s40, s41
    s_add_u32 s40, s40, 18350080
    s_add_u32 s41, s40, 0
    buffer_load_dwordx4 v[32:35], v2, s[4:7], s41 offen offset:0 sc1
    buffer_load_dwordx4 v[48:51], v2, s[4:7], s41 offen offset:1024 sc1
    buffer_load_dwordx4 v[36:39], v2, s[4:7], s41 offen offset:2048 sc1
    buffer_load_dwordx4 v[52:55], v2, s[4:7], s41 offen offset:3072 sc1
    s_add_u32 s41, s40, 4096
    buffer_load_dwordx4 v[40:43], v2, s[4:7], s41 offen offset:0 sc1
    buffer_load_dwordx4 v[56:59], v2, s[4:7], s41 offen offset:1024 sc1
    buffer_load_dwordx4 v[44:47], v2, s[4:7], s41 offen offset:2048 sc1
    buffer_load_dwordx4 v[60:63], v2, s[4:7], s41 offen offset:3072 sc1
    s_add_u32 s41, s40, 32768
    buffer_load_dwordx4 v[64:67], v2, s[4:7], s41 offen offset:0 sc1
    buffer_load_dwordx4 v[80:83], v2, s[4:7], s41 offen offset:1024 sc1
    buffer_load_dwordx4 v[68:71], v2, s[4:7], s41 offen offset:2048 sc1
    buffer_load_dwordx4 v[84:87], v2, s[4:7], s41 offen offset:3072 sc1
    s_add_u32 s41, s40, 36864
    buffer_load_dwordx4 v[72:75], v2, s[4:7], s41 offen offset:0 sc1
    buffer_load_dwordx4 v[88:91], v2, s[4:7], s41 offen offset:1024 sc1
    buffer_load_dwordx4 v[76:79], v2, s[4:7], s41 offen offset:2048 sc1
    buffer_load_dwordx4 v[92:95], v2, s[4:7], s41 offen offset:3072 sc1
    s_load_dwordx2 s[68:69], s[0:1], 0
    s_mov_b32 s70, 1835008
    s_mov_b32 s71, 0x20000
    s_load_dwordx2 s[72:73], s[0:1], 96
    s_mov_b32 s74, 1835008
    s_mov_b32 s75, 0x20000
    s_lshl_b32 s42, s62, 5
    s_lshl_b32 s43, s63, 4
    s_add_u32 s42, s42, s43
    v_and_b32 v17, 15, v1
    v_add_u32 v17, s42, v17
    v_mul_u32_u24 v18, 896, v17
    v_lshrrev_b32 v19, 4, v1
    s_lshl_b32 s42, s64, 7
    s_lshl_b32 s43, s13, 5
    s_add_u32 s42, s42, s43
    v_lshl_add_u32 v19, v19, 3, s42
    v_add_u32 v18, v18, v19
    v_lshrrev_b32 v24, 4, v19
    v_lshlrev_b32 v24, 8, v24
    v_and_b32 v25, 15, v19
    v_add_u32 v24, v24, v25
    v_and_b32 v25, 15, v1
    v_lshl_add_u32 v24, v25, 4, v24
    s_lshl_b32 s43, s62, 1
    s_add_u32 s43, s43, s63
    s_mul_i32 s43, s43, 14336
    s_add_u32 s43, s43, 12845056
    s_waitcnt lgkmcnt(0)
    s_and_b32 s69, s69, 0xffff
    s_and_b32 s73, s73, 0xffff
    buffer_load_dwordx2 v[20:21], v18, s[68:71], 0 offen
    buffer_load_dwordx2 v[22:23], v24, s[4:7], s43 offen
    s_mov_b32 s40, 67690624
    s_cmp_lg_u32 s13, 0
    s_cbranch_scc1 Lw1d_24
    s_mov_b32 s20, 0
Lw1_23:
    buffer_load_dword v16, off, s[4:7], s40 sc1
    s_add_u32 s20, s20, 1
    s_cmp_gt_u32 s20, s23
    s_cbranch_scc1 L_fail
    s_waitcnt vmcnt(0)
    v_cmp_le_u32 vcc, 28, v16
    s_cbranch_vccnz Lw1d_24
    s_sleep 16
    s_branch Lw1_23
Lw1d_24:
    s_barrier
    s_mov_b32 s40, 67674112
    buffer_load_dwordx4 v[168:171], off, s[4:7], s40 offset:0 sc1
    buffer_load_dwordx4 v[172:175], off, s[4:7], s40 offset:16 sc1
    buffer_load_dwordx4 v[176:179], off, s[4:7], s40 offset:32 sc1
    buffer_load_dwordx4 v[180:183], off, s[4:7], s40 offset:48 sc1
    v_mov_b32 v184, 0x40000000
    v_mov_b32 v185, 0
    s_waitcnt vmcnt(0)
    v_cmp_eq_u32 vcc, v168, v17
    v_mov_b32 v16, 0
    s_nop 0
    v_cndmask_b32 v184, v184, v16, vcc
    v_cndmask_b32 v185, v185, v176, vcc
    v_cmp_eq_u32 vcc, v169, v17
    v_mov_b32 v16, 1792
    s_nop 0
    v_cndmask_b32 v184, v184, v16, vcc
    v_cndmask_b32 v185, v185, v177, vcc
    v_cmp_eq_u32 vcc, v170, v17
    v_mov_b32 v16, 3584
    s_nop 0
    v_cndmask_b32 v184, v184, v16, vcc
    v_cndmask_b32 v185, v185, v178, vcc
    v_cmp_eq_u32 vcc, v171, v17
    v_mov_b32 v16, 5376
    s_nop 0
    v_cndmask_b32 v184, v184, v16, vcc
    v_cndmask_b32 v185, v185, v179, vcc
    v_cmp_eq_u32 vcc, v172, v17
    v_mov_b32 v16, 7168
    s_nop 0
    v_cndmask_b32 v184, v184, v16, vcc
    v_cndmask_b32 v185, v185, v180, vcc
    v_cmp_eq_u32 vcc, v173, v17
    v_mov_b32 v16, 8960
    s_nop 0
    v_cndmask_b32 v184, v184, v16, vcc
    v_cndmask_b32 v185, v185, v181, vcc
    v_cmp_eq_u32 vcc, v174, v17
    v_mov_b32 v16, 10752
    s_nop 0
    v_cndmask_b32 v184, v184, v16, vcc
    v_cndmask_b32 v185, v185, v182, vcc
    v_cmp_eq_u32 vcc, v175, v17
    v_mov_b32 v16, 12544
    s_nop 0
    v_cndmask_b32 v184, v184, v16, vcc
    v_cndmask_b32 v185, v185, v183, vcc
    v_lshl_add_u32 v184, v19, 1, v184
    s_mov_b32 s40, 67608576
    buffer_load_dwordx4 v[188:191], v184, s[4:7], s40 offen sc1
    s_mov_b32 s40, 67622912
    buffer_load_dwordx4 v[192:195], v184, s[4:7], s40 offen sc1
    s_mov_b32 s40, 67637248
    buffer_load_dwordx4 v[196:199], v184, s[4:7], s40 offen sc1
    s_mov_b32 s40, 67651584
    buffer_load_dwordx4 v[200:203], v184, s[4:7], s40 offen sc1
    s_waitcnt vmcnt(0)
    s_mov_b32 s54, 0xffff0000
    v_pk_add_f32 v[188:189], v[188:189], v[192:193]
    v_pk_add_f32 v[196:197], v[196:197], v[200:201]
    v_pk_add_f32 v[188:189], v[188:189], v[196:197]
    v_pk_add_f32 v[190:191], v[190:191], v[194:195]
    v_pk_add_f32 v[198:199], v[198:199], v[202:203]
    v_pk_add_f32 v[190:191], v[190:191], v[198:199]
    v_cvt_pk_bf16_f32 v188, v188, v188
    v_and_b32 v188, s54, v188
    v_mul_f32 v188, v188, v185
    v_cvt_pk_bf16_f32 v188, v188, v188
    v_and_b32 v188, s54, v188
    v_lshlrev_b32 v192, 16, v22
    v_add_f32 v192, v192, v188
    v_cvt_pk_bf16_f32 v192, v192, v192
    v_and_b32 v192, s54, v192
    v_lshlrev_b32 v196, 16, v20
    v_cvt_pk_bf16_f32 v189, v189, v189
    v_and_b32 v189, s54, v189
    v_mul_f32 v189, v189, v185
    v_cvt_pk_bf16_f32 v189, v189, v189
    v_and_b32 v189, s54, v189
    v_and_b32 v193, s54, v22
    v_add_f32 v193, v193, v189
    v_cvt_pk_bf16_f32 v193, v193, v193
    v_and_b32 v193, s54, v193
    v_and_b32 v197, s54, v20
    v_cvt_pk_bf16_f32 v190, v190, v190
    v_and_b32 v190, s54, v190
    v_mul_f32 v190, v190, v185
    v_cvt_pk_bf16_f32 v190, v190, v190
    v_and_b32 v190, s54, v190
    v_lshlrev_b32 v194, 16, v23
    v_add_f32 v194, v194, v190
    v_cvt_pk_bf16_f32 v194, v194, v194
    v_and_b32 v194, s54, v194
    v_lshlrev_b32 v198, 16, v21
    v_cvt_pk_bf16_f32 v191, v191, v191
    v_and_b32 v191, s54, v191
    v_mul_f32 v191, v191, v185
    v_cvt_pk_bf16_f32 v191, v191, v191
    v_and_b32 v191, s54, v191
    v_and_b32 v195, s54, v23
    v_add_f32 v195, v195, v191
    v_cvt_pk_bf16_f32 v195, v195, v195
    v_and_b32 v195, s54, v195
    v_and_b32 v199, s54, v21
    s_lshl_b32 s40, s61, 7
    s_add_u32 s40, s40, 67691008
    s_cmp_lg_u32 s13, 0
    s_cbranch_scc1 Lw1d_27
    s_mov_b32 s20, 0
Lw1_26:
    buffer_load_dword v16, off, s[4:7], s40 sc1
    s_add_u32 s20, s20, 1
    s_cmp_gt_u32 s20, s23
    s_cbranch_scc1 L_fail
    s_waitcnt vmcnt(0)
    v_cmp_le_u32 vcc, 16, v16
    s_cbranch_vccnz Lw1d_27
    s_sleep 32
    s_branch Lw1_26
Lw1d_27:
    s_barrier
    s_add_u32 s40, s62, 63
    s_and_b32 s40, s40, 63
    s_sub_u32 s41, s62, 61
    s_cmp_lt_u32 s41, 2
    s_cselect_b32 s40, s62, s40
    s_mul_i32 s40, s40, 7168
    s_add_u32 s40, s40, 63963136
    s_cmp_lg_u32 s13, 0
    s_cbranch_scc1 Lw1d_30
    s_mov_b32 s20, 0
Lw1_29:
    buffer_load_dword v16, off, s[4:7], s40 sc1
    s_add_u32 s20, s20, 1
    s_cmp_gt_u32 s20, s23
    s_cbranch_scc1 L_fail
    s_waitcnt vmcnt(0)
    v_cmp_ne_u32 vcc, -1, v16
    s_cbranch_vccnz Lw1d_30
    s_sleep 2
    s_cmp_ge_u32 s62, 60
    s_cbranch_scc1 Lw1_29
    s_sleep 120
    s_branch Lw1_29
Lw1d_30:
    s_barrier
    s_mov_b32 s20, 0
    s_cmp_ge_u32 s62, 61
    s_cbranch_scc1 Lvl_32
    s_cmp_ge_u32 s62, 60
    s_cselect_b32 s40, s62, s61
    s_cselect_b32 s41, 14, 32
    s_lshl_b32 s40, s40, 7
    s_add_u32 s40, s40, 67682304
    s_cmp_lg_u32 s13, 0
    s_cbranch_scc1 Lw1d_34
    s_mov_b32 s20, 0
Lw1_33:
    buffer_load_dword v16, off, s[4:7], s40 sc1
    s_add_u32 s20, s20, 1
    s_cmp_gt_u32 s20, s23
    s_cbranch_scc1 L_fail
    s_waitcnt vmcnt(0)
    v_cmp_le_u32 vcc, s41, v16
    s_cbranch_vccnz Lw1d_34
    s_sleep 2
    s_cmp_ge_u32 s62, 56
    s_cbranch_scc1 Lw1_33
    s_sleep 48
    s_branch Lw1_33
Lw1d_34:
    s_barrier
Lvl_32:
    s_mul_i32 s44, s62, 229376
    s_mul_i32 s45, s13, 57344
    s_add_u32 s44, s44, s45
    s_lshl_b32 s45, s64, 12
    s_add_u32 s44, s44, s45
    s_add_u32 s44, s44, 48168960
    s_add_u32 s45, s44, 28672
    s_mul_i32 s40, s62, 49152
    s_lshl_b32 s41, s63, 10
    s_add_u32 s40, s40, s41
    s_add_u32 s40, s40, 64421888
    s_lshl_b32 s41, s13, 13
    s_add_u32 s41, s41, s40
    s_add_u32 s42, s41, 4096
    s_lshl_b32 s43, s13, 12
    s_add_u32 s43, s43, s40
    s_add_u32 s43, s43, 32768
Lvp_36:
    buffer_load_dwordx4 v[128:131], v2, s[4:7], s41 offen offset:0 sc1
    buffer_load_dwordx4 v[132:135], v2, s[4:7], s41 offen offset:2048 sc1
    buffer_load_dwordx4 v[136:139], v2, s[4:7], s42 offen offset:0 sc1
    buffer_load_dwordx4 v[140:143], v2, s[4:7], s42 offen offset:2048 sc1
    buffer_load_dwordx4 v[144:147], v2, s[4:7], s43 offen offset:0 sc1
    buffer_load_dwordx4 v[148:151], v2, s[4:7], s43 offen offset:2048 sc1
    buffer_load_dwordx4 v[96:99], v2, s[4:7], s44 offen offset:0 sc1
    buffer_load_dwordx4 v[104:107], v2, s[4:7], s44 offen offset:1024 sc1
    buffer_load_dwordx4 v[112:115], v2, s[4:7], s44 offen offset:2048 sc1
    buffer_load_dwordx4 v[120:123], v2, s[4:7], s44 offen offset:3072 sc1
    buffer_load_dwordx4 v[100:103], v2, s[4:7], s45 offen offset:0 sc1
    buffer_load_dwordx4 v[108:111], v2, s[4:7], s45 offen offset:1024 sc1
    buffer_load_dwordx4 v[116:119], v2, s[4:7], s45 offen offset:2048 sc1
    buffer_load_dwordx4 v[124:127], v2, s[4:7], s45 offen offset:3072 sc1
    s_add_u32 s20, s20, 1
    s_cmp_gt_u32 s20, s23
    s_cbranch_scc1 L_fail
    s_waitcnt vmcnt(8)
    v_max3_u32 v16, v128, v129, v130
    v_max3_u32 v16, v16, v131, v132
    v_max3_u32 v16, v16, v133, v134
    v_max3_u32 v16, v16, v135, v136
    v_max3_u32 v16, v16, v137, v138
    v_max3_u32 v16, v16, v139, v140
    v_max3_u32 v16, v16, v141, v142
    v_max3_u32 v16, v16, v143, v144
    v_max3_u32 v16, v16, v145, v146
    v_max3_u32 v16, v16, v147, v148
    v_max3_u32 v16, v16, v149, v150
    v_max_u32 v16, v16, v151
    s_waitcnt vmcnt(0)
    s_cmp_lt_u32 s62, 61
    s_cbranch_scc1 Lvu_38
    v_max3_u32 v16, v16, v96, v97
    v_max3_u32 v16, v16, v98, v99
    v_max3_u32 v16, v16, v100, v101
    v_max3_u32 v16, v16, v102, v103
    v_max3_u32 v16, v16, v104, v105
    v_max3_u32 v16, v16, v106, v107
    v_max3_u32 v16, v16, v108, v109
    v_max3_u32 v16, v16, v110, v111
    v_max3_u32 v16, v16, v112, v113
    v_max3_u32 v16, v16, v114, v115
    v_max3_u32 v16, v16, v116, v117
    v_max3_u32 v16, v16, v118, v119
    v_max3_u32 v16, v16, v120, v121
    v_max3_u32 v16, v16, v122, v123
    v_max3_u32 v16, v16, v124, v125
    v_max3_u32 v16, v16, v126, v127
Lvu_38:
    v_cmp_eq_u32 vcc, -1, v16
    s_cbranch_vccz Lvq_37
    s_sleep 2
    s_cmp_ge_u32 s62, 60
    s_cbranch_scc1 Lvp_36
    s_sleep 16
    s_branch Lvp_36
Lvq_37:
    v_mfma_f32_16x16x32_bf16 v[152:155], v[32:35], v[128:131], 0
    v_mfma_f32_16x16x32_bf16 v[156:159], v[48:51], v[128:131], 0
    v_mfma_f32_16x16x32_bf16 v[160:163], v[64:67], v[128:131], 0
    v_mfma_f32_16x16x32_bf16 v[164:167], v[80:83], v[128:131], 0
    v_mfma_f32_16x16x32_bf16 v[152:155], v[36:39], v[132:135], v[152:155]
    v_mfma_f32_16x16x32_bf16 v[156:159], v[52:55], v[132:135], v[156:159]
    v_mfma_f32_16x16x32_bf16 v[160:163], v[68:71], v[132:135], v[160:163]
    v_mfma_f32_16x16x32_bf16 v[164:167], v[84:87], v[132:135], v[164:167]
    v_mfma_f32_16x16x32_bf16 v[152:155], v[40:43], v[136:139], v[152:155]
    v_mfma_f32_16x16x32_bf16 v[156:159], v[56:59], v[136:139], v[156:159]
    v_mfma_f32_16x16x32_bf16 v[160:163], v[72:75], v[136:139], v[160:163]
    v_mfma_f32_16x16x32_bf16 v[164:167], v[88:91], v[136:139], v[164:167]
    v_mfma_f32_16x16x32_bf16 v[152:155], v[44:47], v[140:143], v[152:155]
    v_mfma_f32_16x16x32_bf16 v[156:159], v[60:63], v[140:143], v[156:159]
    v_mfma_f32_16x16x32_bf16 v[160:163], v[76:79], v[140:143], v[160:163]
    v_mfma_f32_16x16x32_bf16 v[164:167], v[92:95], v[140:143], v[164:167]
    s_waitcnt vmcnt(0)
    v_mfma_f32_16x16x32_bf16 v[152:155], v[96:99], v[144:147], v[152:155]
    v_mfma_f32_16x16x32_bf16 v[156:159], v[104:107], v[144:147], v[156:159]
    v_mfma_f32_16x16x32_bf16 v[160:163], v[112:115], v[144:147], v[160:163]
    v_mfma_f32_16x16x32_bf16 v[164:167], v[120:123], v[144:147], v[164:167]
    v_mfma_f32_16x16x32_bf16 v[152:155], v[100:103], v[148:151], v[152:155]
    v_mfma_f32_16x16x32_bf16 v[156:159], v[108:111], v[148:151], v[156:159]
    v_mfma_f32_16x16x32_bf16 v[160:163], v[116:119], v[148:151], v[160:163]
    v_mfma_f32_16x16x32_bf16 v[164:167], v[124:127], v[148:151], v[164:167]
    s_lshl_b32 s40, s13, 12
    v_add_u32 v16, s40, v2
    s_lshl_b32 s40, s13, 10
    v_add_u32 v19, s40, v2
    s_nop 1
    ds_write_b128 v16, v[152:155] offset:0
    ds_write_b128 v16, v[156:159] offset:1024
    ds_write_b128 v16, v[160:163] offset:2048
    ds_write_b128 v16, v[164:167] offset:3072
    s_waitcnt lgkmcnt(0)
    s_barrier
    ds_read_b128 v[32:35], v19 offset:0
    ds_read_b128 v[36:39], v19 offset:4096
    ds_read_b128 v[40:43], v19 offset:8192
    ds_read_b128 v[44:47], v19 offset:12288
    s_waitcnt lgkmcnt(0)
    v_pk_add_f32 v[32:33], v[32:33], v[36:37]
    v_pk_add_f32 v[40:41], v[40:41], v[44:45]
    v_pk_add_f32 v[32:33], v[32:33], v[40:41]
    v_pk_add_f32 v[34:35], v[34:35], v[38:39]
    v_pk_add_f32 v[42:43], v[42:43], v[46:47]
    v_pk_add_f32 v[34:35], v[34:35], v[42:43]
    v_cvt_pk_bf16_f32 v32, v32, v32
    v_and_b32 v32, s54, v32
    v_add_f32 v32, v32, v196
    v_cvt_pk_bf16_f32 v32, v32, v32
    v_and_b32 v32, s54, v32
    v_add_f32 v32, v32, v192
    v_cvt_pk_bf16_f32 v33, v33, v33
    v_and_b32 v33, s54, v33
    v_add_f32 v33, v33, v197
    v_cvt_pk_bf16_f32 v33, v33, v33
    v_and_b32 v33, s54, v33
    v_add_f32 v33, v33, v193
    v_cvt_pk_bf16_f32 v34, v34, v34
    v_and_b32 v34, s54, v34
    v_add_f32 v34, v34, v198
    v_cvt_pk_bf16_f32 v34, v34, v34
    v_and_b32 v34, s54, v34
    v_add_f32 v34, v34, v194
    v_cvt_pk_bf16_f32 v35, v35, v35
    v_and_b32 v35, s54, v35
    v_add_f32 v35, v35, v199
    v_cvt_pk_bf16_f32 v35, v35, v35
    v_and_b32 v35, s54, v35
    v_add_f32 v35, v35, v195
    v_cvt_pk_bf16_f32 v32, v32, v33
    v_cvt_pk_bf16_f32 v33, v34, v35
    buffer_store_dwordx2 v[32:33], v18, s[72:75], 0 offen
    s_cmp_ge_u32 s62, 56
    s_cbranch_scc1 L_exit
    s_branch W_next
T_M1:
    s_load_dwordx2 s[68:69], s[0:1], 72
    s_mov_b32 s70, 1605632
    s_mov_b32 s71, 0x20000
    s_load_dwordx2 s[72:73], s[0:1], 80
    s_mov_b32 s74, 1605632
    s_mov_b32 s75, 0x20000
    s_mov_b32 s40, 67567616
    s_add_u32 s41, s40, 4096
    buffer_load_dwordx4 v[160:163], v2, s[4:7], s40 offen offset:0
    buffer_load_dwordx4 v[164:167], v2, s[4:7], s40 offen offset:1024
    buffer_load_dwordx4 v[168:171], v2, s[4:7], s40 offen offset:2048
    buffer_load_dwordx4 v[172:175], v2, s[4:7], s40 offen offset:3072
    buffer_load_dwordx4 v[176:179], v2, s[4:7], s41 offen offset:0
    buffer_load_dwordx4 v[180:183], v2, s[4:7], s41 offen offset:1024
    buffer_load_dwordx4 v[184:187], v2, s[4:7], s41 offen offset:2048
    buffer_load_dwordx4 v[188:191], v2, s[4:7], s41 offen offset:3072
    v_lshlrev_b32 v16, 2, v1
    v_sub_u32 v16, 0xffff, v16
    s_mov_b32 s54, 0xffff0000
    s_waitcnt vmcnt(0) lgkmcnt(0)
    s_and_b32 s69, s69, 0xffff
    s_and_b32 s73, s73, 0xffff
    v_ashrrev_i32 v17, 31, v160
    v_or_b32 v17, 0x80000000, v17
    v_xor_b32 v160, v160, v17
    v_subrev_u32 v17, 0, v16
    v_and_or_b32 v160, v160, s54, v17
    v_ashrrev_i32 v17, 31, v161
    v_or_b32 v17, 0x80000000, v17
    v_xor_b32 v161, v161, v17
    v_subrev_u32 v17, 1, v16
    v_and_or_b32 v161, v161, s54, v17
    v_ashrrev_i32 v17, 31, v162
    v_or_b32 v17, 0x80000000, v17
    v_xor_b32 v162, v162, v17
    v_subrev_u32 v17, 2, v16
    v_and_or_b32 v162, v162, s54, v17
    v_ashrrev_i32 v17, 31, v163
    v_or_b32 v17, 0x80000000, v17
    v_xor_b32 v163, v163, v17
    v_subrev_u32 v17, 3, v16
    v_and_or_b32 v163, v163, s54, v17
    v_ashrrev_i32 v17, 31, v164
    v_or_b32 v17, 0x80000000, v17
    v_xor_b32 v164, v164, v17
    v_subrev_u32 v17, 256, v16
    v_and_or_b32 v164, v164, s54, v17
    v_ashrrev_i32 v17, 31, v165
    v_or_b32 v17, 0x80000000, v17
    v_xor_b32 v165, v165, v17
    v_subrev_u32 v17, 257, v16
    v_and_or_b32 v165, v165, s54, v17
    v_ashrrev_i32 v17, 31, v166
    v_or_b32 v17, 0x80000000, v17
    v_xor_b32 v166, v166, v17
    v_subrev_u32 v17, 258, v16
    v_and_or_b32 v166, v166, s54, v17
    v_ashrrev_i32 v17, 31, v167
    v_or_b32 v17, 0x80000000, v17
    v_xor_b32 v167, v167, v17
    v_subrev_u32 v17, 259, v16
    v_and_or_b32 v167, v167, s54, v17
    v_ashrrev_i32 v17, 31, v168
    v_or_b32 v17, 0x80000000, v17
    v_xor_b32 v168, v168, v17
    v_subrev_u32 v17, 512, v16
    v_and_or_b32 v168, v168, s54, v17
    v_ashrrev_i32 v17, 31, v169
    v_or_b32 v17, 0x80000000, v17
    v_xor_b32 v169, v169, v17
    v_subrev_u32 v17, 513, v16
    v_and_or_b32 v169, v169, s54, v17
    v_ashrrev_i32 v17, 31, v170
    v_or_b32 v17, 0x80000000, v17
    v_xor_b32 v170, v170, v17
    v_subrev_u32 v17, 514, v16
    v_and_or_b32 v170, v170, s54, v17
    v_ashrrev_i32 v17, 31, v171
    v_or_b32 v17, 0x80000000, v17
    v_xor_b32 v171, v171, v17
    v_subrev_u32 v17, 515, v16
    v_and_or_b32 v171, v171, s54, v17
    v_ashrrev_i32 v17, 31, v172
    v_or_b32 v17, 0x80000000, v17
    v_xor_b32 v172, v172, v17
    v_subrev_u32 v17, 768, v16
    v_and_or_b32 v172, v172, s54, v17
    v_ashrrev_i32 v17, 31, v173
    v_or_b32 v17, 0x80000000, v17
    v_xor_b32 v173, v173, v17
    v_subrev_u32 v17, 769, v16
    v_and_or_b32 v173, v173, s54, v17
    v_ashrrev_i32 v17, 31, v174
    v_or_b32 v17, 0x80000000, v17
    v_xor_b32 v174, v174, v17
    v_subrev_u32 v17, 770, v16
    v_and_or_b32 v174, v174, s54, v17
    v_ashrrev_i32 v17, 31, v175
    v_or_b32 v17, 0x80000000, v17
    v_xor_b32 v175, v175, v17
    v_subrev_u32 v17, 771, v16
    v_and_or_b32 v175, v175, s54, v17
    v_ashrrev_i32 v17, 31, v176
    v_or_b32 v17, 0x80000000, v17
    v_xor_b32 v176, v176, v17
    v_subrev_u32 v17, 1024, v16
    v_and_or_b32 v176, v176, s54, v17
    v_ashrrev_i32 v17, 31, v177
    v_or_b32 v17, 0x80000000, v17
    v_xor_b32 v177, v177, v17
    v_subrev_u32 v17, 1025, v16
    v_and_or_b32 v177, v177, s54, v17
    v_ashrrev_i32 v17, 31, v178
    v_or_b32 v17, 0x80000000, v17
    v_xor_b32 v178, v178, v17
    v_subrev_u32 v17, 1026, v16
    v_and_or_b32 v178, v178, s54, v17
    v_ashrrev_i32 v17, 31, v179
    v_or_b32 v17, 0x80000000, v17
    v_xor_b32 v179, v179, v17
    v_subrev_u32 v17, 1027, v16
    v_and_or_b32 v179, v179, s54, v17
    v_ashrrev_i32 v17, 31, v180
    v_or_b32 v17, 0x80000000, v17
    v_xor_b32 v180, v180, v17
    v_subrev_u32 v17, 1280, v16
    v_and_or_b32 v180, v180, s54, v17
    v_ashrrev_i32 v17, 31, v181
    v_or_b32 v17, 0x80000000, v17
    v_xor_b32 v181, v181, v17
    v_subrev_u32 v17, 1281, v16
    v_and_or_b32 v181, v181, s54, v17
    v_ashrrev_i32 v17, 31, v182
    v_or_b32 v17, 0x80000000, v17
    v_xor_b32 v182, v182, v17
    v_subrev_u32 v17, 1282, v16
    v_and_or_b32 v182, v182, s54, v17
    v_ashrrev_i32 v17, 31, v183
    v_or_b32 v17, 0x80000000, v17
    v_xor_b32 v183, v183, v17
    v_subrev_u32 v17, 1283, v16
    v_and_or_b32 v183, v183, s54, v17
    v_ashrrev_i32 v17, 31, v184
    v_or_b32 v17, 0x80000000, v17
    v_xor_b32 v184, v184, v17
    v_subrev_u32 v17, 1536, v16
    v_and_or_b32 v184, v184, s54, v17
    v_ashrrev_i32 v17, 31, v185
    v_or_b32 v17, 0x80000000, v17
    v_xor_b32 v185, v185, v17
    v_subrev_u32 v17, 1537, v16
    v_and_or_b32 v185, v185, s54, v17
    v_ashrrev_i32 v17, 31, v186
    v_or_b32 v17, 0x80000000, v17
    v_xor_b32 v186, v186, v17
    v_subrev_u32 v17, 1538, v16
    v_and_or_b32 v186, v186, s54, v17
    v_ashrrev_i32 v17, 31, v187
    v_or_b32 v17, 0x80000000, v17
    v_xor_b32 v187, v187, v17
    v_subrev_u32 v17, 1539, v16
    v_and_or_b32 v187, v187, s54, v17
    v_ashrrev_i32 v17, 31, v188
    v_or_b32 v17, 0x80000000, v17
    v_xor_b32 v188, v188, v17
    v_subrev_u32 v17, 1792, v16
    v_and_or_b32 v188, v188, s54, v17
    v_ashrrev_i32 v17, 31, v189
    v_or_b32 v17, 0x80000000, v17
    v_xor_b32 v189, v189, v17
    v_subrev_u32 v17, 1793, v16
    v_and_or_b32 v189, v189, s54, v17
    v_ashrrev_i32 v17, 31, v190
    v_or_b32 v17, 0x80000000, v17
    v_xor_b32 v190, v190, v17
    v_subrev_u32 v17, 1794, v16
    v_and_or_b32 v190, v190, s54, v17
    v_ashrrev_i32 v17, 31, v191
    v_or_b32 v17, 0x80000000, v17
    v_xor_b32 v191, v191, v17
    v_subrev_u32 v17, 1795, v16
    v_and_or_b32 v191, v191, s54, v17
    v_max3_u32 v18, v160, v161, v162
    v_max3_u32 v18, v18, v163, v164
    v_max3_u32 v18, v18, v165, v166
    v_max3_u32 v18, v18, v167, v168
    v_max3_u32 v18, v18, v169, v170
    v_max3_u32 v18, v18, v171, v172
    v_max3_u32 v18, v18, v173, v174
    v_max3_u32 v18, v18, v175, v176
    v_max3_u32 v18, v18, v177, v178
    v_max3_u32 v18, v18, v179, v180
    v_max3_u32 v18, v18, v181, v182
    v_max3_u32 v18, v18, v183, v184
    v_max3_u32 v18, v18, v185, v186
    v_max3_u32 v18, v18, v187, v188
    v_max3_u32 v18, v18, v189, v190
    v_max_u32 v18, v18, v191
    s_nop 1
    v_max_u32_dpp v18, v18, v18 row_ror:8 row_mask:0xf bank_mask:0xf
    s_nop 1
    v_max_u32_dpp v18, v18, v18 row_ror:4 row_mask:0xf bank_mask:0xf
    s_nop 1
    v_max_u32_dpp v18, v18, v18 row_ror:2 row_mask:0xf bank_mask:0xf
    s_nop 1
    v_max_u32_dpp v18, v18, v18 row_ror:1 row_mask:0xf bank_mask:0xf
    v_mov_b32 v19, v18
    s_nop 1
    v_permlane16_swap_b32 v18, v19
    v_max_u32 v18, v18, v19
    v_mov_b32 v19, v18
    s_nop 1
    v_permlane32_swap_b32 v18, v19
    v_max_u32 v18, v18, v19
    s_nop 0
    v_readfirstlane_b32 s76, v18
    v_cmp_eq_u32 vcc, v18, v160
    s_nop 1
    v_cndmask_b32 v160, v160, 0, vcc
    v_cmp_eq_u32 vcc, v18, v161
    s_nop 1
    v_cndmask_b32 v161, v161, 0, vcc
    v_cmp_eq_u32 vcc, v18, v162
    s_nop 1
    v_cndmask_b32 v162, v162, 0, vcc
    v_cmp_eq_u32 vcc, v18, v163
    s_nop 1
    v_cndmask_b32 v163, v163, 0, vcc
    v_cmp_eq_u32 vcc, v18, v164
    s_nop 1
    v_cndmask_b32 v164, v164, 0, vcc
    v_cmp_eq_u32 vcc, v18, v165
    s_nop 1
    v_cndmask_b32 v165, v165, 0, vcc
    v_cmp_eq_u32 vcc, v18, v166
    s_nop 1
    v_cndmask_b32 v166, v166, 0, vcc
    v_cmp_eq_u32 vcc, v18, v167
    s_nop 1
    v_cndmask_b32 v167, v167, 0, vcc
    v_cmp_eq_u32 vcc, v18, v168
    s_nop 1
    v_cndmask_b32 v168, v168, 0, vcc
    v_cmp_eq_u32 vcc, v18, v169
    s_nop 1
    v_cndmask_b32 v169, v169, 0, vcc
    v_cmp_eq_u32 vcc, v18, v170
    s_nop 1
    v_cndmask_b32 v170, v170, 0, vcc
    v_cmp_eq_u32 vcc, v18, v171
    s_nop 1
    v_cndmask_b32 v171, v171, 0, vcc
    v_cmp_eq_u32 vcc, v18, v172
    s_nop 1
    v_cndmask_b32 v172, v172, 0, vcc
    v_cmp_eq_u32 vcc, v18, v173
    s_nop 1
    v_cndmask_b32 v173, v173, 0, vcc
    v_cmp_eq_u32 vcc, v18, v174
    s_nop 1
    v_cndmask_b32 v174, v174, 0, vcc
    v_cmp_eq_u32 vcc, v18, v175
    s_nop 1
    v_cndmask_b32 v175, v175, 0, vcc
    v_cmp_eq_u32 vcc, v18, v176
    s_nop 1
    v_cndmask_b32 v176, v176, 0, vcc
    v_cmp_eq_u32 vcc, v18, v177
    s_nop 1
    v_cndmask_b32 v177, v177, 0, vcc
    v_cmp_eq_u32 vcc, v18, v178
    s_nop 1
    v_cndmask_b32 v178, v178, 0, vcc
    v_cmp_eq_u32 vcc, v18, v179
    s_nop 1
    v_cndmask_b32 v179, v179, 0, vcc
    v_cmp_eq_u32 vcc, v18, v180
    s_nop 1
    v_cndmask_b32 v180, v180, 0, vcc
    v_cmp_eq_u32 vcc, v18, v181
    s_nop 1
    v_cndmask_b32 v181, v181, 0, vcc
    v_cmp_eq_u32 vcc, v18, v182
    s_nop 1
    v_cndmask_b32 v182, v182, 0, vcc
    v_cmp_eq_u32 vcc, v18, v183
    s_nop 1
    v_cndmask_b32 v183, v183, 0, vcc
    v_cmp_eq_u32 vcc, v18, v184
    s_nop 1
    v_cndmask_b32 v184, v184, 0, vcc
    v_cmp_eq_u32 vcc, v18, v185
    s_nop 1
    v_cndmask_b32 v185, v185, 0, vcc
    v_cmp_eq_u32 vcc, v18, v186
    s_nop 1
    v_cndmask_b32 v186, v186, 0, vcc
    v_cmp_eq_u32 vcc, v18, v187
    s_nop 1
    v_cndmask_b32 v187, v187, 0, vcc
    v_cmp_eq_u32 vcc, v18, v188
    s_nop 1
    v_cndmask_b32 v188, v188, 0, vcc
    v_cmp_eq_u32 vcc, v18, v189
    s_nop 1
    v_cndmask_b32 v189, v189, 0, vcc
    v_cmp_eq_u32 vcc, v18, v190
    s_nop 1
    v_cndmask_b32 v190, v190, 0, vcc
    v_cmp_eq_u32 vcc, v18, v191
    s_nop 1
    v_cndmask_b32 v191, v191, 0, vcc
    v_max3_u32 v18, v160, v161, v162
    v_max3_u32 v18, v18, v163, v164
    v_max3_u32 v18, v18, v165, v166
    v_max3_u32 v18, v18, v167, v168
    v_max3_u32 v18, v18, v169, v170
    v_max3_u32 v18, v18, v171, v172
    v_max3_u32 v18, v18, v173, v174
    v_max3_u32 v18, v18, v175, v176
    v_max3_u32 v18, v18, v177, v178
    v_max3_u32 v18, v18, v179, v180
    v_max3_u32 v18, v18, v181, v182
    v_max3_u32 v18, v18, v183, v184
    v_max3_u32 v18, v18, v185, v186
    v_max3_u32 v18, v18, v187, v188
    v_max3_u32 v18, v18, v189, v190
    v_max_u32 v18, v18, v191
    s_nop 1
    v_max_u32_dpp v18, v18, v18 row_ror:8 row_mask:0xf bank_mask:0xf
    s_nop 1
    v_max_u32_dpp v18, v18, v18 row_ror:4 row_mask:0xf bank_mask:0xf
    s_nop 1
    v_max_u32_dpp v18, v18, v18 row_ror:2 row_mask:0xf bank_mask:0xf
    s_nop 1
    v_max_u32_dpp v18, v18, v18 row_ror:1 row_mask:0xf bank_mask:0xf
    v_mov_b32 v19, v18
    s_nop 1
    v_permlane16_swap_b32 v18, v19
    v_max_u32 v18, v18, v19
    v_mov_b32 v19, v18
    s_nop 1
    v_permlane32_swap_b32 v18, v19
    v_max_u32 v18, v18, v19
    s_nop 0
    v_readfirstlane_b32 s77, v18
    v_cmp_eq_u32 vcc, v18, v160
    s_nop 1
    v_cndmask_b32 v160, v160, 0, vcc
    v_cmp_eq_u32 vcc, v18, v161
    s_nop 1
    v_cndmask_b32 v161, v161, 0, vcc
    v_cmp_eq_u32 vcc, v18, v162
    s_nop 1
    v_cndmask_b32 v162, v162, 0, vcc
    v_cmp_eq_u32 vcc, v18, v163
    s_nop 1
    v_cndmask_b32 v163, v163, 0, vcc
    v_cmp_eq_u32 vcc, v18, v164
    s_nop 1
    v_cndmask_b32 v164, v164, 0, vcc
    v_cmp_eq_u32 vcc, v18, v165
    s_nop 1
    v_cndmask_b32 v165, v165, 0, vcc
    v_cmp_eq_u32 vcc, v18, v166
    s_nop 1
    v_cndmask_b32 v166, v166, 0, vcc
    v_cmp_eq_u32 vcc, v18, v167
    s_nop 1
    v_cndmask_b32 v167, v167, 0, vcc
    v_cmp_eq_u32 vcc, v18, v168
    s_nop 1
    v_cndmask_b32 v168, v168, 0, vcc
    v_cmp_eq_u32 vcc, v18, v169
    s_nop 1
    v_cndmask_b32 v169, v169, 0, vcc
    v_cmp_eq_u32 vcc, v18, v170
    s_nop 1
    v_cndmask_b32 v170, v170, 0, vcc
    v_cmp_eq_u32 vcc, v18, v171
    s_nop 1
    v_cndmask_b32 v171, v171, 0, vcc
    v_cmp_eq_u32 vcc, v18, v172
    s_nop 1
    v_cndmask_b32 v172, v172, 0, vcc
    v_cmp_eq_u32 vcc, v18, v173
    s_nop 1
    v_cndmask_b32 v173, v173, 0, vcc
    v_cmp_eq_u32 vcc, v18, v174
    s_nop 1
    v_cndmask_b32 v174, v174, 0, vcc
    v_cmp_eq_u32 vcc, v18, v175
    s_nop 1
    v_cndmask_b32 v175, v175, 0, vcc
    v_cmp_eq_u32 vcc, v18, v176
    s_nop 1
    v_cndmask_b32 v176, v176, 0, vcc
    v_cmp_eq_u32 vcc, v18, v177
    s_nop 1
    v_cndmask_b32 v177, v177, 0, vcc
    v_cmp_eq_u32 vcc, v18, v178
    s_nop 1
    v_cndmask_b32 v178, v178, 0, vcc
    v_cmp_eq_u32 vcc, v18, v179
    s_nop 1
    v_cndmask_b32 v179, v179, 0, vcc
    v_cmp_eq_u32 vcc, v18, v180
    s_nop 1
    v_cndmask_b32 v180, v180, 0, vcc
    v_cmp_eq_u32 vcc, v18, v181
    s_nop 1
    v_cndmask_b32 v181, v181, 0, vcc
    v_cmp_eq_u32 vcc, v18, v182
    s_nop 1
    v_cndmask_b32 v182, v182, 0, vcc
    v_cmp_eq_u32 vcc, v18, v183
    s_nop 1
    v_cndmask_b32 v183, v183, 0, vcc
    v_cmp_eq_u32 vcc, v18, v184
    s_nop 1
    v_cndmask_b32 v184, v184, 0, vcc
    v_cmp_eq_u32 vcc, v18, v185
    s_nop 1
    v_cndmask_b32 v185, v185, 0, vcc
    v_cmp_eq_u32 vcc, v18, v186
    s_nop 1
    v_cndmask_b32 v186, v186, 0, vcc
    v_cmp_eq_u32 vcc, v18, v187
    s_nop 1
    v_cndmask_b32 v187, v187, 0, vcc
    v_cmp_eq_u32 vcc, v18, v188
    s_nop 1
    v_cndmask_b32 v188, v188, 0, vcc
    v_cmp_eq_u32 vcc, v18, v189
    s_nop 1
    v_cndmask_b32 v189, v189, 0, vcc
    v_cmp_eq_u32 vcc, v18, v190
    s_nop 1
    v_cndmask_b32 v190, v190, 0, vcc
    v_cmp_eq_u32 vcc, v18, v191
    s_nop 1
    v_cndmask_b32 v191, v191, 0, vcc
    v_max3_u32 v18, v160, v161, v162
    v_max3_u32 v18, v18, v163, v164
    v_max3_u32 v18, v18, v165, v166
    v_max3_u32 v18, v18, v167, v168
    v_max3_u32 v18, v18, v169, v170
    v_max3_u32 v18, v18, v171, v172
    v_max3_u32 v18, v18, v173, v174
    v_max3_u32 v18, v18, v175, v176
    v_max3_u32 v18, v18, v177, v178
    v_max3_u32 v18, v18, v179, v180
    v_max3_u32 v18, v18, v181, v182
    v_max3_u32 v18, v18, v183, v184
    v_max3_u32 v18, v18, v185, v186
    v_max3_u32 v18, v18, v187, v188
    v_max3_u32 v18, v18, v189, v190
    v_max_u32 v18, v18, v191
    s_nop 1
    v_max_u32_dpp v18, v18, v18 row_ror:8 row_mask:0xf bank_mask:0xf
    s_nop 1
    v_max_u32_dpp v18, v18, v18 row_ror:4 row_mask:0xf bank_mask:0xf
    s_nop 1
    v_max_u32_dpp v18, v18, v18 row_ror:2 row_mask:0xf bank_mask:0xf
    s_nop 1
    v_max_u32_dpp v18, v18, v18 row_ror:1 row_mask:0xf bank_mask:0xf
    v_mov_b32 v19, v18
    s_nop 1
    v_permlane16_swap_b32 v18, v19
    v_max_u32 v18, v18, v19
    v_mov_b32 v19, v18
    s_nop 1
    v_permlane32_swap_b32 v18, v19
    v_max_u32 v18, v18, v19
    s_nop 0
    v_readfirstlane_b32 s78, v18
    v_cmp_eq_u32 vcc, v18, v160
    s_nop 1
    v_cndmask_b32 v160, v160, 0, vcc
    v_cmp_eq_u32 vcc, v18, v161
    s_nop 1
    v_cndmask_b32 v161, v161, 0, vcc
    v_cmp_eq_u32 vcc, v18, v162
    s_nop 1
    v_cndmask_b32 v162, v162, 0, vcc
    v_cmp_eq_u32 vcc, v18, v163
    s_nop 1
    v_cndmask_b32 v163, v163, 0, vcc
    v_cmp_eq_u32 vcc, v18, v164
    s_nop 1
    v_cndmask_b32 v164, v164, 0, vcc
    v_cmp_eq_u32 vcc, v18, v165
    s_nop 1
    v_cndmask_b32 v165, v165, 0, vcc
    v_cmp_eq_u32 vcc, v18, v166
    s_nop 1
    v_cndmask_b32 v166, v166, 0, vcc
    v_cmp_eq_u32 vcc, v18, v167
    s_nop 1
    v_cndmask_b32 v167, v167, 0, vcc
    v_cmp_eq_u32 vcc, v18, v168
    s_nop 1
    v_cndmask_b32 v168, v168, 0, vcc
    v_cmp_eq_u32 vcc, v18, v169
    s_nop 1
    v_cndmask_b32 v169, v169, 0, vcc
    v_cmp_eq_u32 vcc, v18, v170
    s_nop 1
    v_cndmask_b32 v170, v170, 0, vcc
    v_cmp_eq_u32 vcc, v18, v171
    s_nop 1
    v_cndmask_b32 v171, v171, 0, vcc
    v_cmp_eq_u32 vcc, v18, v172
    s_nop 1
    v_cndmask_b32 v172, v172, 0, vcc
    v_cmp_eq_u32 vcc, v18, v173
    s_nop 1
    v_cndmask_b32 v173, v173, 0, vcc
    v_cmp_eq_u32 vcc, v18, v174
    s_nop 1
    v_cndmask_b32 v174, v174, 0, vcc
    v_cmp_eq_u32 vcc, v18, v175
    s_nop 1
    v_cndmask_b32 v175, v175, 0, vcc
    v_cmp_eq_u32 vcc, v18, v176
    s_nop 1
    v_cndmask_b32 v176, v176, 0, vcc
    v_cmp_eq_u32 vcc, v18, v177
    s_nop 1
    v_cndmask_b32 v177, v177, 0, vcc
    v_cmp_eq_u32 vcc, v18, v178
    s_nop 1
    v_cndmask_b32 v178, v178, 0, vcc
    v_cmp_eq_u32 vcc, v18, v179
    s_nop 1
    v_cndmask_b32 v179, v179, 0, vcc
    v_cmp_eq_u32 vcc, v18, v180
    s_nop 1
    v_cndmask_b32 v180, v180, 0, vcc
    v_cmp_eq_u32 vcc, v18, v181
    s_nop 1
    v_cndmask_b32 v181, v181, 0, vcc
    v_cmp_eq_u32 vcc, v18, v182
    s_nop 1
    v_cndmask_b32 v182, v182, 0, vcc
    v_cmp_eq_u32 vcc, v18, v183
    s_nop 1
    v_cndmask_b32 v183, v183, 0, vcc
    v_cmp_eq_u32 vcc, v18, v184
    s_nop 1
    v_cndmask_b32 v184, v184, 0, vcc
    v_cmp_eq_u32 vcc, v18, v185
    s_nop 1
    v_cndmask_b32 v185, v185, 0, vcc
    v_cmp_eq_u32 vcc, v18, v186
    s_nop 1
    v_cndmask_b32 v186, v186, 0, vcc
    v_cmp_eq_u32 vcc, v18, v187
    s_nop 1
    v_cndmask_b32 v187, v187, 0, vcc
    v_cmp_eq_u32 vcc, v18, v188
    s_nop 1
    v_cndmask_b32 v188, v188, 0, vcc
    v_cmp_eq_u32 vcc, v18, v189
    s_nop 1
    v_cndmask_b32 v189, v189, 0, vcc
    v_cmp_eq_u32 vcc, v18, v190
    s_nop 1
    v_cndmask_b32 v190, v190, 0, vcc
    v_cmp_eq_u32 vcc, v18, v191
    s_nop 1
    v_cndmask_b32 v191, v191, 0, vcc
    v_max3_u32 v18, v160, v161, v162
    v_max3_u32 v18, v18, v163, v164
    v_max3_u32 v18, v18, v165, v166
    v_max3_u32 v18, v18, v167, v168
    v_max3_u32 v18, v18, v169, v170
    v_max3_u32 v18, v18, v171, v172
    v_max3_u32 v18, v18, v173, v174
    v_max3_u32 v18, v18, v175, v176
    v_max3_u32 v18, v18, v177, v178
    v_max3_u32 v18, v18, v179, v180
    v_max3_u32 v18, v18, v181, v182
    v_max3_u32 v18, v18, v183, v184
    v_max3_u32 v18, v18, v185, v186
    v_max3_u32 v18, v18, v187, v188
    v_max3_u32 v18, v18, v189, v190
    v_max_u32 v18, v18, v191
    s_nop 1
    v_max_u32_dpp v18, v18, v18 row_ror:8 row_mask:0xf bank_mask:0xf
    s_nop 1
    v_max_u32_dpp v18, v18, v18 row_ror:4 row_mask:0xf bank_mask:0xf
    s_nop 1
    v_max_u32_dpp v18, v18, v18 row_ror:2 row_mask:0xf bank_mask:0xf
    s_nop 1
    v_max_u32_dpp v18, v18, v18 row_ror:1 row_mask:0xf bank_mask:0xf
    v_mov_b32 v19, v18
    s_nop 1
    v_permlane16_swap_b32 v18, v19
    v_max_u32 v18, v18, v19
    v_mov_b32 v19, v18
    s_nop 1
    v_permlane32_swap_b32 v18, v19
    v_max_u32 v18, v18, v19
    s_nop 0
    v_readfirstlane_b32 s79, v18
    v_cmp_eq_u32 vcc, v18, v160
    s_nop 1
    v_cndmask_b32 v160, v160, 0, vcc
    v_cmp_eq_u32 vcc, v18, v161
    s_nop 1
    v_cndmask_b32 v161, v161, 0, vcc
    v_cmp_eq_u32 vcc, v18, v162
    s_nop 1
    v_cndmask_b32 v162, v162, 0, vcc
    v_cmp_eq_u32 vcc, v18, v163
    s_nop 1
    v_cndmask_b32 v163, v163, 0, vcc
    v_cmp_eq_u32 vcc, v18, v164
    s_nop 1
    v_cndmask_b32 v164, v164, 0, vcc
    v_cmp_eq_u32 vcc, v18, v165
    s_nop 1
    v_cndmask_b32 v165, v165, 0, vcc
    v_cmp_eq_u32 vcc, v18, v166
    s_nop 1
    v_cndmask_b32 v166, v166, 0, vcc
    v_cmp_eq_u32 vcc, v18, v167
    s_nop 1
    v_cndmask_b32 v167, v167, 0, vcc
    v_cmp_eq_u32 vcc, v18, v168
    s_nop 1
    v_cndmask_b32 v168, v168, 0, vcc
    v_cmp_eq_u32 vcc, v18, v169
    s_nop 1
    v_cndmask_b32 v169, v169, 0, vcc
    v_cmp_eq_u32 vcc, v18, v170
    s_nop 1
    v_cndmask_b32 v170, v170, 0, vcc
    v_cmp_eq_u32 vcc, v18, v171
    s_nop 1
    v_cndmask_b32 v171, v171, 0, vcc
    v_cmp_eq_u32 vcc, v18, v172
    s_nop 1
    v_cndmask_b32 v172, v172, 0, vcc
    v_cmp_eq_u32 vcc, v18, v173
    s_nop 1
    v_cndmask_b32 v173, v173, 0, vcc
    v_cmp_eq_u32 vcc, v18, v174
    s_nop 1
    v_cndmask_b32 v174, v174, 0, vcc
    v_cmp_eq_u32 vcc, v18, v175
    s_nop 1
    v_cndmask_b32 v175, v175, 0, vcc
    v_cmp_eq_u32 vcc, v18, v176
    s_nop 1
    v_cndmask_b32 v176, v176, 0, vcc
    v_cmp_eq_u32 vcc, v18, v177
    s_nop 1
    v_cndmask_b32 v177, v177, 0, vcc
    v_cmp_eq_u32 vcc, v18, v178
    s_nop 1
    v_cndmask_b32 v178, v178, 0, vcc
    v_cmp_eq_u32 vcc, v18, v179
    s_nop 1
    v_cndmask_b32 v179, v179, 0, vcc
    v_cmp_eq_u32 vcc, v18, v180
    s_nop 1
    v_cndmask_b32 v180, v180, 0, vcc
    v_cmp_eq_u32 vcc, v18, v181
    s_nop 1
    v_cndmask_b32 v181, v181, 0, vcc
    v_cmp_eq_u32 vcc, v18, v182
    s_nop 1
    v_cndmask_b32 v182, v182, 0, vcc
    v_cmp_eq_u32 vcc, v18, v183
    s_nop 1
    v_cndmask_b32 v183, v183, 0, vcc
    v_cmp_eq_u32 vcc, v18, v184
    s_nop 1
    v_cndmask_b32 v184, v184, 0, vcc
    v_cmp_eq_u32 vcc, v18, v185
    s_nop 1
    v_cndmask_b32 v185, v185, 0, vcc
    v_cmp_eq_u32 vcc, v18, v186
    s_nop 1
    v_cndmask_b32 v186, v186, 0, vcc
    v_cmp_eq_u32 vcc, v18, v187
    s_nop 1
    v_cndmask_b32 v187, v187, 0, vcc
    v_cmp_eq_u32 vcc, v18, v188
    s_nop 1
    v_cndmask_b32 v188, v188, 0, vcc
    v_cmp_eq_u32 vcc, v18, v189
    s_nop 1
    v_cndmask_b32 v189, v189, 0, vcc
    v_cmp_eq_u32 vcc, v18, v190
    s_nop 1
    v_cndmask_b32 v190, v190, 0, vcc
    v_cmp_eq_u32 vcc, v18, v191
    s_nop 1
    v_cndmask_b32 v191, v191, 0, vcc
    v_max3_u32 v18, v160, v161, v162
    v_max3_u32 v18, v18, v163, v164
    v_max3_u32 v18, v18, v165, v166
    v_max3_u32 v18, v18, v167, v168
    v_max3_u32 v18, v18, v169, v170
    v_max3_u32 v18, v18, v171, v172
    v_max3_u32 v18, v18, v173, v174
    v_max3_u32 v18, v18, v175, v176
    v_max3_u32 v18, v18, v177, v178
    v_max3_u32 v18, v18, v179, v180
    v_max3_u32 v18, v18, v181, v182
    v_max3_u32 v18, v18, v183, v184
    v_max3_u32 v18, v18, v185, v186
    v_max3_u32 v18, v18, v187, v188
    v_max3_u32 v18, v18, v189, v190
    v_max_u32 v18, v18, v191
    s_nop 1
    v_max_u32_dpp v18, v18, v18 row_ror:8 row_mask:0xf bank_mask:0xf
    s_nop 1
    v_max_u32_dpp v18, v18, v18 row_ror:4 row_mask:0xf bank_mask:0xf
    s_nop 1
    v_max_u32_dpp v18, v18, v18 row_ror:2 row_mask:0xf bank_mask:0xf
    s_nop 1
    v_max_u32_dpp v18, v18, v18 row_ror:1 row_mask:0xf bank_mask:0xf
    v_mov_b32 v19, v18
    s_nop 1
    v_permlane16_swap_b32 v18, v19
    v_max_u32 v18, v18, v19
    v_mov_b32 v19, v18
    s_nop 1
    v_permlane32_swap_b32 v18, v19
    v_max_u32 v18, v18, v19
    s_nop 0
    v_readfirstlane_b32 s80, v18
    v_cmp_eq_u32 vcc, v18, v160
    s_nop 1
    v_cndmask_b32 v160, v160, 0, vcc
    v_cmp_eq_u32 vcc, v18, v161
    s_nop 1
    v_cndmask_b32 v161, v161, 0, vcc
    v_cmp_eq_u32 vcc, v18, v162
    s_nop 1
    v_cndmask_b32 v162, v162, 0, vcc
    v_cmp_eq_u32 vcc, v18, v163
    s_nop 1
    v_cndmask_b32 v163, v163, 0, vcc
    v_cmp_eq_u32 vcc, v18, v164
    s_nop 1
    v_cndmask_b32 v164, v164, 0, vcc
    v_cmp_eq_u32 vcc, v18, v165
    s_nop 1
    v_cndmask_b32 v165, v165, 0, vcc
    v_cmp_eq_u32 vcc, v18, v166
    s_nop 1
    v_cndmask_b32 v166, v166, 0, vcc
    v_cmp_eq_u32 vcc, v18, v167
    s_nop 1
    v_cndmask_b32 v167, v167, 0, vcc
    v_cmp_eq_u32 vcc, v18, v168
    s_nop 1
    v_cndmask_b32 v168, v168, 0, vcc
    v_cmp_eq_u32 vcc, v18, v169
    s_nop 1
    v_cndmask_b32 v169, v169, 0, vcc
    v_cmp_eq_u32 vcc, v18, v170
    s_nop 1
    v_cndmask_b32 v170, v170, 0, vcc
    v_cmp_eq_u32 vcc, v18, v171
    s_nop 1
    v_cndmask_b32 v171, v171, 0, vcc
    v_cmp_eq_u32 vcc, v18, v172
    s_nop 1
    v_cndmask_b32 v172, v172, 0, vcc
    v_cmp_eq_u32 vcc, v18, v173
    s_nop 1
    v_cndmask_b32 v173, v173, 0, vcc
    v_cmp_eq_u32 vcc, v18, v174
    s_nop 1
    v_cndmask_b32 v174, v174, 0, vcc
    v_cmp_eq_u32 vcc, v18, v175
    s_nop 1
    v_cndmask_b32 v175, v175, 0, vcc
    v_cmp_eq_u32 vcc, v18, v176
    s_nop 1
    v_cndmask_b32 v176, v176, 0, vcc
    v_cmp_eq_u32 vcc, v18, v177
    s_nop 1
    v_cndmask_b32 v177, v177, 0, vcc
    v_cmp_eq_u32 vcc, v18, v178
    s_nop 1
    v_cndmask_b32 v178, v178, 0, vcc
    v_cmp_eq_u32 vcc, v18, v179
    s_nop 1
    v_cndmask_b32 v179, v179, 0, vcc
    v_cmp_eq_u32 vcc, v18, v180
    s_nop 1
    v_cndmask_b32 v180, v180, 0, vcc
    v_cmp_eq_u32 vcc, v18, v181
    s_nop 1
    v_cndmask_b32 v181, v181, 0, vcc
    v_cmp_eq_u32 vcc, v18, v182
    s_nop 1
    v_cndmask_b32 v182, v182, 0, vcc
    v_cmp_eq_u32 vcc, v18, v183
    s_nop 1
    v_cndmask_b32 v183, v183, 0, vcc
    v_cmp_eq_u32 vcc, v18, v184
    s_nop 1
    v_cndmask_b32 v184, v184, 0, vcc
    v_cmp_eq_u32 vcc, v18, v185
    s_nop 1
    v_cndmask_b32 v185, v185, 0, vcc
    v_cmp_eq_u32 vcc, v18, v186
    s_nop 1
    v_cndmask_b32 v186, v186, 0, vcc
    v_cmp_eq_u32 vcc, v18, v187
    s_nop 1
    v_cndmask_b32 v187, v187, 0, vcc
    v_cmp_eq_u32 vcc, v18, v188
    s_nop 1
    v_cndmask_b32 v188, v188, 0, vcc
    v_cmp_eq_u32 vcc, v18, v189
    s_nop 1
    v_cndmask_b32 v189, v189, 0, vcc
    v_cmp_eq_u32 vcc, v18, v190
    s_nop 1
    v_cndmask_b32 v190, v190, 0, vcc
    v_cmp_eq_u32 vcc, v18, v191
    s_nop 1
    v_cndmask_b32 v191, v191, 0, vcc
    v_max3_u32 v18, v160, v161, v162
    v_max3_u32 v18, v18, v163, v164
    v_max3_u32 v18, v18, v165, v166
    v_max3_u32 v18, v18, v167, v168
    v_max3_u32 v18, v18, v169, v170
    v_max3_u32 v18, v18, v171, v172
    v_max3_u32 v18, v18, v173, v174
    v_max3_u32 v18, v18, v175, v176
    v_max3_u32 v18, v18, v177, v178
    v_max3_u32 v18, v18, v179, v180
    v_max3_u32 v18, v18, v181, v182
    v_max3_u32 v18, v18, v183, v184
    v_max3_u32 v18, v18, v185, v186
    v_max3_u32 v18, v18, v187, v188
    v_max3_u32 v18, v18, v189, v190
    v_max_u32 v18, v18, v191
    s_nop 1
    v_max_u32_dpp v18, v18, v18 row_ror:8 row_mask:0xf bank_mask:0xf
    s_nop 1
    v_max_u32_dpp v18, v18, v18 row_ror:4 row_mask:0xf bank_mask:0xf
    s_nop 1
    v_max_u32_dpp v18, v18, v18 row_ror:2 row_mask:0xf bank_mask:0xf
    s_nop 1
    v_max_u32_dpp v18, v18, v18 row_ror:1 row_mask:0xf bank_mask:0xf
    v_mov_b32 v19, v18
    s_nop 1
    v_permlane16_swap_b32 v18, v19
    v_max_u32 v18, v18, v19
    v_mov_b32 v19, v18
    s_nop 1
    v_permlane32_swap_b32 v18, v19
    v_max_u32 v18, v18, v19
    s_nop 0
    v_readfirstlane_b32 s81, v18
    v_cmp_eq_u32 vcc, v18, v160
    s_nop 1
    v_cndmask_b32 v160, v160, 0, vcc
    v_cmp_eq_u32 vcc, v18, v161
    s_nop 1
    v_cndmask_b32 v161, v161, 0, vcc
    v_cmp_eq_u32 vcc, v18, v162
    s_nop 1
    v_cndmask_b32 v162, v162, 0, vcc
    v_cmp_eq_u32 vcc, v18, v163
    s_nop 1
    v_cndmask_b32 v163, v163, 0, vcc
    v_cmp_eq_u32 vcc, v18, v164
    s_nop 1
    v_cndmask_b32 v164, v164, 0, vcc
    v_cmp_eq_u32 vcc, v18, v165
    s_nop 1
    v_cndmask_b32 v165, v165, 0, vcc
    v_cmp_eq_u32 vcc, v18, v166
    s_nop 1
    v_cndmask_b32 v166, v166, 0, vcc
    v_cmp_eq_u32 vcc, v18, v167
    s_nop 1
    v_cndmask_b32 v167, v167, 0, vcc
    v_cmp_eq_u32 vcc, v18, v168
    s_nop 1
    v_cndmask_b32 v168, v168, 0, vcc
    v_cmp_eq_u32 vcc, v18, v169
    s_nop 1
    v_cndmask_b32 v169, v169, 0, vcc
    v_cmp_eq_u32 vcc, v18, v170
    s_nop 1
    v_cndmask_b32 v170, v170, 0, vcc
    v_cmp_eq_u32 vcc, v18, v171
    s_nop 1
    v_cndmask_b32 v171, v171, 0, vcc
    v_cmp_eq_u32 vcc, v18, v172
    s_nop 1
    v_cndmask_b32 v172, v172, 0, vcc
    v_cmp_eq_u32 vcc, v18, v173
    s_nop 1
    v_cndmask_b32 v173, v173, 0, vcc
    v_cmp_eq_u32 vcc, v18, v174
    s_nop 1
    v_cndmask_b32 v174, v174, 0, vcc
    v_cmp_eq_u32 vcc, v18, v175
    s_nop 1
    v_cndmask_b32 v175, v175, 0, vcc
    v_cmp_eq_u32 vcc, v18, v176
    s_nop 1
    v_cndmask_b32 v176, v176, 0, vcc
    v_cmp_eq_u32 vcc, v18, v177
    s_nop 1
    v_cndmask_b32 v177, v177, 0, vcc
    v_cmp_eq_u32 vcc, v18, v178
    s_nop 1
    v_cndmask_b32 v178, v178, 0, vcc
    v_cmp_eq_u32 vcc, v18, v179
    s_nop 1
    v_cndmask_b32 v179, v179, 0, vcc
    v_cmp_eq_u32 vcc, v18, v180
    s_nop 1
    v_cndmask_b32 v180, v180, 0, vcc
    v_cmp_eq_u32 vcc, v18, v181
    s_nop 1
    v_cndmask_b32 v181, v181, 0, vcc
    v_cmp_eq_u32 vcc, v18, v182
    s_nop 1
    v_cndmask_b32 v182, v182, 0, vcc
    v_cmp_eq_u32 vcc, v18, v183
    s_nop 1
    v_cndmask_b32 v183, v183, 0, vcc
    v_cmp_eq_u32 vcc, v18, v184
    s_nop 1
    v_cndmask_b32 v184, v184, 0, vcc
    v_cmp_eq_u32 vcc, v18, v185
    s_nop 1
    v_cndmask_b32 v185, v185, 0, vcc
    v_cmp_eq_u32 vcc, v18, v186
    s_nop 1
    v_cndmask_b32 v186, v186, 0, vcc
    v_cmp_eq_u32 vcc, v18, v187
    s_nop 1
    v_cndmask_b32 v187, v187, 0, vcc
    v_cmp_eq_u32 vcc, v18, v188
    s_nop 1
    v_cndmask_b32 v188, v188, 0, vcc
    v_cmp_eq_u32 vcc, v18, v189
    s_nop 1
    v_cndmask_b32 v189, v189, 0, vcc
    v_cmp_eq_u32 vcc, v18, v190
    s_nop 1
    v_cndmask_b32 v190, v190, 0, vcc
    v_cmp_eq_u32 vcc, v18, v191
    s_nop 1
    v_cndmask_b32 v191, v191, 0, vcc
    v_max3_u32 v18, v160, v161, v162
    v_max3_u32 v18, v18, v163, v164
    v_max3_u32 v18, v18, v165, v166
    v_max3_u32 v18, v18, v167, v168
    v_max3_u32 v18, v18, v169, v170
    v_max3_u32 v18, v18, v171, v172
    v_max3_u32 v18, v18, v173, v174
    v_max3_u32 v18, v18, v175, v176
    v_max3_u32 v18, v18, v177, v178
    v_max3_u32 v18, v18, v179, v180
    v_max3_u32 v18, v18, v181, v182
    v_max3_u32 v18, v18, v183, v184
    v_max3_u32 v18, v18, v185, v186
    v_max3_u32 v18, v18, v187, v188
    v_max3_u32 v18, v18, v189, v190
    v_max_u32 v18, v18, v191
    s_nop 1
    v_max_u32_dpp v18, v18, v18 row_ror:8 row_mask:0xf bank_mask:0xf
    s_nop 1
    v_max_u32_dpp v18, v18, v18 row_ror:4 row_mask:0xf bank_mask:0xf
    s_nop 1
    v_max_u32_dpp v18, v18, v18 row_ror:2 row_mask:0xf bank_mask:0xf
    s_nop 1
    v_max_u32_dpp v18, v18, v18 row_ror:1 row_mask:0xf bank_mask:0xf
    v_mov_b32 v19, v18
    s_nop 1
    v_permlane16_swap_b32 v18, v19
    v_max_u32 v18, v18, v19
    v_mov_b32 v19, v18
    s_nop 1
    v_permlane32_swap_b32 v18, v19
    v_max_u32 v18, v18, v19
    s_nop 0
    v_readfirstlane_b32 s82, v18
    v_cmp_eq_u32 vcc, v18, v160
    s_nop 1
    v_cndmask_b32 v160, v160, 0, vcc
    v_cmp_eq_u32 vcc, v18, v161
    s_nop 1
    v_cndmask_b32 v161, v161, 0, vcc
    v_cmp_eq_u32 vcc, v18, v162
    s_nop 1
    v_cndmask_b32 v162, v162, 0, vcc
    v_cmp_eq_u32 vcc, v18, v163
    s_nop 1
    v_cndmask_b32 v163, v163, 0, vcc
    v_cmp_eq_u32 vcc, v18, v164
    s_nop 1
    v_cndmask_b32 v164, v164, 0, vcc
    v_cmp_eq_u32 vcc, v18, v165
    s_nop 1
    v_cndmask_b32 v165, v165, 0, vcc
    v_cmp_eq_u32 vcc, v18, v166
    s_nop 1
    v_cndmask_b32 v166, v166, 0, vcc
    v_cmp_eq_u32 vcc, v18, v167
    s_nop 1
    v_cndmask_b32 v167, v167, 0, vcc
    v_cmp_eq_u32 vcc, v18, v168
    s_nop 1
    v_cndmask_b32 v168, v168, 0, vcc
    v_cmp_eq_u32 vcc, v18, v169
    s_nop 1
    v_cndmask_b32 v169, v169, 0, vcc
    v_cmp_eq_u32 vcc, v18, v170
    s_nop 1
    v_cndmask_b32 v170, v170, 0, vcc
    v_cmp_eq_u32 vcc, v18, v171
    s_nop 1
    v_cndmask_b32 v171, v171, 0, vcc
    v_cmp_eq_u32 vcc, v18, v172
    s_nop 1
    v_cndmask_b32 v172, v172, 0, vcc
    v_cmp_eq_u32 vcc, v18, v173
    s_nop 1
    v_cndmask_b32 v173, v173, 0, vcc
    v_cmp_eq_u32 vcc, v18, v174
    s_nop 1
    v_cndmask_b32 v174, v174, 0, vcc
    v_cmp_eq_u32 vcc, v18, v175
    s_nop 1
    v_cndmask_b32 v175, v175, 0, vcc
    v_cmp_eq_u32 vcc, v18, v176
    s_nop 1
    v_cndmask_b32 v176, v176, 0, vcc
    v_cmp_eq_u32 vcc, v18, v177
    s_nop 1
    v_cndmask_b32 v177, v177, 0, vcc
    v_cmp_eq_u32 vcc, v18, v178
    s_nop 1
    v_cndmask_b32 v178, v178, 0, vcc
    v_cmp_eq_u32 vcc, v18, v179
    s_nop 1
    v_cndmask_b32 v179, v179, 0, vcc
    v_cmp_eq_u32 vcc, v18, v180
    s_nop 1
    v_cndmask_b32 v180, v180, 0, vcc
    v_cmp_eq_u32 vcc, v18, v181
    s_nop 1
    v_cndmask_b32 v181, v181, 0, vcc
    v_cmp_eq_u32 vcc, v18, v182
    s_nop 1
    v_cndmask_b32 v182, v182, 0, vcc
    v_cmp_eq_u32 vcc, v18, v183
    s_nop 1
    v_cndmask_b32 v183, v183, 0, vcc
    v_cmp_eq_u32 vcc, v18, v184
    s_nop 1
    v_cndmask_b32 v184, v184, 0, vcc
    v_cmp_eq_u32 vcc, v18, v185
    s_nop 1
    v_cndmask_b32 v185, v185, 0, vcc
    v_cmp_eq_u32 vcc, v18, v186
    s_nop 1
    v_cndmask_b32 v186, v186, 0, vcc
    v_cmp_eq_u32 vcc, v18, v187
    s_nop 1
    v_cndmask_b32 v187, v187, 0, vcc
    v_cmp_eq_u32 vcc, v18, v188
    s_nop 1
    v_cndmask_b32 v188, v188, 0, vcc
    v_cmp_eq_u32 vcc, v18, v189
    s_nop 1
    v_cndmask_b32 v189, v189, 0, vcc
    v_cmp_eq_u32 vcc, v18, v190
    s_nop 1
    v_cndmask_b32 v190, v190, 0, vcc
    v_cmp_eq_u32 vcc, v18, v191
    s_nop 1
    v_cndmask_b32 v191, v191, 0, vcc
    v_max3_u32 v18, v160, v161, v162
    v_max3_u32 v18, v18, v163, v164
    v_max3_u32 v18, v18, v165, v166
    v_max3_u32 v18, v18, v167, v168
    v_max3_u32 v18, v18, v169, v170
    v_max3_u32 v18, v18, v171, v172
    v_max3_u32 v18, v18, v173, v174
    v_max3_u32 v18, v18, v175, v176
    v_max3_u32 v18, v18, v177, v178
    v_max3_u32 v18, v18, v179, v180
    v_max3_u32 v18, v18, v181, v182
    v_max3_u32 v18, v18, v183, v184
    v_max3_u32 v18, v18, v185, v186
    v_max3_u32 v18, v18, v187, v188
    v_max3_u32 v18, v18, v189, v190
    v_max_u32 v18, v18, v191
    s_nop 1
    v_max_u32_dpp v18, v18, v18 row_ror:8 row_mask:0xf bank_mask:0xf
    s_nop 1
    v_max_u32_dpp v18, v18, v18 row_ror:4 row_mask:0xf bank_mask:0xf
    s_nop 1
    v_max_u32_dpp v18, v18, v18 row_ror:2 row_mask:0xf bank_mask:0xf
    s_nop 1
    v_max_u32_dpp v18, v18, v18 row_ror:1 row_mask:0xf bank_mask:0xf
    v_mov_b32 v19, v18
    s_nop 1
    v_permlane16_swap_b32 v18, v19
    v_max_u32 v18, v18, v19
    v_mov_b32 v19, v18
    s_nop 1
    v_permlane32_swap_b32 v18, v19
    v_max_u32 v18, v18, v19
    s_nop 0
    v_readfirstlane_b32 s83, v18
    v_mov_b32 v20, s76
    v_and_b32 v19, 7, v1
    v_cmp_eq_u32 vcc, 1, v19
    v_mov_b32 v18, s77
    s_nop 0
    v_cndmask_b32 v20, v20, v18, vcc
    v_cmp_eq_u32 vcc, 2, v19
    v_mov_b32 v18, s78
    s_nop 0
    v_cndmask_b32 v20, v20, v18, vcc
    v_cmp_eq_u32 vcc, 3, v19
    v_mov_b32 v18, s79
    s_nop 0
    v_cndmask_b32 v20, v20, v18, vcc
    v_cmp_eq_u32 vcc, 4, v19
    v_mov_b32 v18, s80
    s_nop 0
    v_cndmask_b32 v20, v20, v18, vcc
    v_cmp_eq_u32 vcc, 5, v19
    v_mov_b32 v18, s81
    s_nop 0
    v_cndmask_b32 v20, v20, v18, vcc
    v_cmp_eq_u32 vcc, 6, v19
    v_mov_b32 v18, s82
    s_nop 0
    v_cndmask_b32 v20, v20, v18, vcc
    v_cmp_eq_u32 vcc, 7, v19
    v_mov_b32 v18, s83
    s_nop 0
    v_cndmask_b32 v20, v20, v18, vcc
    v_and_b32 v21, 0xffff, v20
    v_sub_u32 v21, 0xffff, v21
    s_or_b32 s40, s65, s13
    s_cmp_lg_u32 s40, 0
    s_cbranch_scc1 Lm1s_39
    v_and_b32 v18, s54, v20
    v_not_b32 v19, v18
    v_ashrrev_i32 v19, 31, v19
    v_or_b32 v19, 0x80000000, v19
    v_xor_b32 v18, v18, v19
    v_and_b32 v18, s54, v18
    v_mul_f32 v19, 0xbfb8aa3b, v18
    v_exp_f32 v19, v19
    s_nop 0
    v_add_f32 v19, 1.0, v19
    v_rcp_f32 v18, v19
    s_nop 0
    v_cvt_pk_bf16_f32 v18, v18, v18
    v_and_b32 v18, s54, v18
    v_lshlrev_b32 v19, 2, v1
    s_mov_b32 s40, 67674112
    s_mov_b64 exec, 0xff
    buffer_store_dword v21, v19, s[4:7], s40 offen sc1
    buffer_store_dword v18, v19, s[4:7], s40 offen offset:32 sc1
    s_mov_b64 exec, -1
Lm1s_39:
    v_lshrrev_b32 v18, 4, v21
    v_mul_u32_u24 v18, 14336, v18
    v_and_b32 v19, 15, v21
    v_lshl_add_u32 v18, v19, 4, v18
    v_lshrrev_b32 v19, 4, v1
    v_lshl_add_u32 v18, v19, 8, v18
    s_mov_b32 s40, 12845056
    buffer_load_dwordx4 v[96:99], v18, s[4:7], s40 offen offset:0
    buffer_load_dwordx4 v[100:103], v18, s[4:7], s40 offen offset:1024
    buffer_load_dwordx4 v[104:107], v18, s[4:7], s40 offen offset:2048
    buffer_load_dwordx4 v[108:111], v18, s[4:7], s40 offen offset:3072
    s_add_u32 s40, s40, 4096
    buffer_load_dwordx4 v[112:115], v18, s[4:7], s40 offen offset:0
    buffer_load_dwordx4 v[116:119], v18, s[4:7], s40 offen offset:1024
    buffer_load_dwordx4 v[120:123], v18, s[4:7], s40 offen offset:2048
    buffer_load_dwordx4 v[124:127], v18, s[4:7], s40 offen offset:3072
    s_add_u32 s40, s40, 4096
    buffer_load_dwordx4 v[128:131], v18, s[4:7], s40 offen offset:0
    buffer_load_dwordx4 v[132:135], v18, s[4:7], s40 offen offset:1024
    buffer_load_dwordx4 v[136:139], v18, s[4:7], s40 offen offset:2048
    buffer_load_dwordx4 v[140:143], v18, s[4:7], s40 offen offset:3072
    s_add_u32 s40, s40, 4096
    buffer_load_dwordx4 v[144:147], v18, s[4:7], s40 offen offset:0
    buffer_load_dwordx4 v[148:151], v18, s[4:7], s40 offen offset:1024
    s_barrier
    s_lshl_b32 s43, s65, 7
    v_lshrrev_b32 v24, 3, v0
    v_and_b32 v25, 7, v0
    s_mov_b32 s44, 3584
    v_mul_lo_u32 v26, v24, s44
    v_lshl_add_u32 v26, v25, 4, v26
    v_bfe_u32 v27, v24, 1, 1
    v_bfe_u32 v28, v24, 3, 1
    v_lshl_add_u32 v27, v28, 1, v27
    v_lshlrev_b32 v27, 1, v27
    v_xor_b32 v27, v27, v25
    v_lshlrev_b32 v27, 4, v27
    v_lshl_add_u32 v27, v24, 7, v27
    s_mov_b32 s44, s43
    buffer_load_dwordx4 v[32:35], v26, s[68:71], s44 offen
    s_add_u32 s44, s44, 114688
    buffer_load_dwordx4 v[36:39], v26, s[68:71], s44 offen
    s_add_u32 s44, s44, 114688
    buffer_load_dwordx4 v[40:43], v26, s[68:71], s44 offen
    s_add_u32 s44, s44, 114688
    buffer_load_dwordx4 v[44:47], v26, s[68:71], s44 offen
    s_add_u32 s44, s44, 114688
    buffer_load_dwordx4 v[48:51], v26, s[68:71], s44 offen
    s_add_u32 s44, s44, 114688
    buffer_load_dwordx4 v[52:55], v26, s[68:71], s44 offen
    s_add_u32 s44, s44, 114688
    buffer_load_dwordx4 v[56:59], v26, s[68:71], s44 offen
    s_add_u32 s44, s44, 114688
    buffer_load_dwordx4 v[60:63], v26, s[68:71], s44 offen
    s_add_u32 s44, s44, 114688
    buffer_load_dwordx4 v[64:67], v26, s[68:71], s44 offen
    s_add_u32 s44, s44, 114688
    buffer_load_dwordx4 v[68:71], v26, s[68:71], s44 offen
    s_add_u32 s44, s44, 114688
    buffer_load_dwordx4 v[72:75], v26, s[68:71], s44 offen
    s_add_u32 s44, s44, 114688
    buffer_load_dwordx4 v[76:79], v26, s[68:71], s44 offen
    s_add_u32 s44, s44, 114688
    buffer_load_dwordx4 v[80:83], v26, s[68:71], s44 offen
    s_add_u32 s44, s44, 114688
    buffer_load_dwordx4 v[84:87], v26, s[68:71], s44 offen
    s_add_u32 s44, s44, 114688
    s_waitcnt vmcnt(13)
    ds_write_b128 v27, v[32:35] offset:0
    s_waitcnt vmcnt(12)
    ds_write_b128 v27, v[36:39] offset:4096
    s_waitcnt vmcnt(11)
    ds_write_b128 v27, v[40:43] offset:8192
    s_waitcnt vmcnt(10)
    ds_write_b128 v27, v[44:47] offset:12288
    s_waitcnt vmcnt(9)
    ds_write_b128 v27, v[48:51] offset:16384
    s_waitcnt vmcnt(8)
    ds_write_b128 v27, v[52:55] offset:20480
    s_waitcnt vmcnt(7)
    ds_write_b128 v27, v[56:59] offset:24576
    s_waitcnt vmcnt(6)
    ds_write_b128 v27, v[60:63] offset:28672
    s_waitcnt vmcnt(5)
    ds_write_b128 v27, v[64:67] offset:32768
    s_waitcnt vmcnt(4)
    ds_write_b128 v27, v[68:71] offset:36864
    s_waitcnt vmcnt(3)
    ds_write_b128 v27, v[72:75] offset:40960
    s_waitcnt vmcnt(2)
    ds_write_b128 v27, v[76:79] offset:45056
    s_waitcnt vmcnt(1)
    ds_write_b128 v27, v[80:83] offset:49152
    s_waitcnt vmcnt(0)
    ds_write_b128 v27, v[84:87] offset:53248
    v_lshrrev_b32 v24, 3, v0
    v_and_b32 v25, 7, v0
    s_mov_b32 s44, 3584
    v_mul_lo_u32 v26, v24, s44
    v_lshl_add_u32 v26, v25, 4, v26
    v_bfe_u32 v27, v24, 1, 1
    v_bfe_u32 v28, v24, 3, 1
    v_lshl_add_u32 v27, v28, 1, v27
    v_lshlrev_b32 v27, 1, v27
    v_xor_b32 v27, v27, v25
    v_lshlrev_b32 v27, 4, v27
    v_lshl_add_u32 v27, v24, 7, v27
    v_add_u32 v27, 57344, v27
    s_mov_b32 s44, s43
    buffer_load_dwordx4 v[32:35], v26, s[72:75], s44 offen
    s_add_u32 s44, s44, 114688
    buffer_load_dwordx4 v[36:39], v26, s[72:75], s44 offen
    s_add_u32 s44, s44, 114688
    buffer_load_dwordx4 v[40:43], v26, s[72:75], s44 offen
    s_add_u32 s44, s44, 114688
    buffer_load_dwordx4 v[44:47], v26, s[72:75], s44 offen
    s_add_u32 s44, s44, 114688
    buffer_load_dwordx4 v[48:51], v26, s[72:75], s44 offen
    s_add_u32 s44, s44, 114688
    buffer_load_dwordx4 v[52:55], v26, s[72:75], s44 offen
    s_add_u32 s44, s44, 114688
    buffer_load_dwordx4 v[56:59], v26, s[72:75], s44 offen
    s_add_u32 s44, s44, 114688
    buffer_load_dwordx4 v[60:63], v26, s[72:75], s44 offen
    s_add_u32 s44, s44, 114688
    buffer_load_dwordx4 v[64:67], v26, s[72:75], s44 offen
    s_add_u32 s44, s44, 114688
    buffer_load_dwordx4 v[68:71], v26, s[72:75], s44 offen
    s_add_u32 s44, s44, 114688
    buffer_load_dwordx4 v[72:75], v26, s[72:75], s44 offen
    s_add_u32 s44, s44, 114688
    buffer_load_dwordx4 v[76:79], v26, s[72:75], s44 offen
    s_add_u32 s44, s44, 114688
    buffer_load_dwordx4 v[80:83], v26, s[72:75], s44 offen
    s_add_u32 s44, s44, 114688
    buffer_load_dwordx4 v[84:87], v26, s[72:75], s44 offen
    s_add_u32 s44, s44, 114688
    s_waitcnt vmcnt(13)
    ds_write_b128 v27, v[32:35] offset:0
    s_waitcnt vmcnt(12)
    ds_write_b128 v27, v[36:39] offset:4096
    s_waitcnt vmcnt(11)
    ds_write_b128 v27, v[40:43] offset:8192
    s_waitcnt vmcnt(10)
    ds_write_b128 v27, v[44:47] offset:12288
    s_waitcnt vmcnt(9)
    ds_write_b128 v27, v[48:51] offset:16384
    s_waitcnt vmcnt(8)
    ds_write_b128 v27, v[52:55] offset:20480
    s_waitcnt vmcnt(7)
    ds_write_b128 v27, v[56:59] offset:24576
    s_waitcnt vmcnt(6)
    ds_write_b128 v27, v[60:63] offset:28672
    s_waitcnt vmcnt(5)
    ds_write_b128 v27, v[64:67] offset:32768
    s_waitcnt vmcnt(4)
    ds_write_b128 v27, v[68:71] offset:36864
    s_waitcnt vmcnt(3)
    ds_write_b128 v27, v[72:75] offset:40960
    s_waitcnt vmcnt(2)
    ds_write_b128 v27, v[76:79] offset:45056
    s_waitcnt vmcnt(1)
    ds_write_b128 v27, v[80:83] offset:49152
    s_waitcnt vmcnt(0)
    ds_write_b128 v27, v[84:87] offset:53248
    v_bfe_u32 v16, v1, 2, 2
    v_lshrrev_b32 v17, 4, v1
    v_lshl_add_u32 v16, v17, 3, v16
    v_lshlrev_b32 v16, 7, v16
    v_and_b32 v17, 3, v1
    v_lshl_add_u32 v16, v17, 3, v16
    v_bfe_u32 v17, v1, 3, 1
    v_bfe_u32 v18, v1, 4, 1
    v_lshl_add_u32 v17, v18, 1, v17
    v_xor_b32 v17, s13, v17
    v_lshl_add_u32 v16, v17, 5, v16
    v_add_u32 v17, 57344, v16
    s_waitcnt lgkmcnt(0)
    s_barrier
    ds_read_b64_tr_b16 v[32:33], v16 offset:0
    ds_read_b64_tr_b16 v[34:35], v16 offset:512
    ds_read_b64_tr_b16 v[36:37], v16 offset:4096
    ds_read_b64_tr_b16 v[38:39], v16 offset:4608
    ds_read_b64_tr_b16 v[40:41], v16 offset:8192
    ds_read_b64_tr_b16 v[42:43], v16 offset:8704
    ds_read_b64_tr_b16 v[44:45], v16 offset:12288
    ds_read_b64_tr_b16 v[46:47], v16 offset:12800
    ds_read_b64_tr_b16 v[48:49], v16 offset:16384
    ds_read_b64_tr_b16 v[50:51], v16 offset:16896
    ds_read_b64_tr_b16 v[52:53], v16 offset:20480
    ds_read_b64_tr_b16 v[54:55], v16 offset:20992
    ds_read_b64_tr_b16 v[56:57], v16 offset:24576
    ds_read_b64_tr_b16 v[58:59], v16 offset:25088
    ds_read_b64_tr_b16 v[60:61], v16 offset:28672
    ds_read_b64_tr_b16 v[62:63], v16 offset:29184
    ds_read_b64_tr_b16 v[64:65], v16 offset:32768
    ds_read_b64_tr_b16 v[66:67], v16 offset:33280
    ds_read_b64_tr_b16 v[68:69], v16 offset:36864
    ds_read_b64_tr_b16 v[70:71], v16 offset:37376
    ds_read_b64_tr_b16 v[72:73], v16 offset:40960
    ds_read_b64_tr_b16 v[74:75], v16 offset:41472
    ds_read_b64_tr_b16 v[76:77], v16 offset:45056
    ds_read_b64_tr_b16 v[78:79], v16 offset:45568
    ds_read_b64_tr_b16 v[80:81], v16 offset:49152
    ds_read_b64_tr_b16 v[82:83], v16 offset:49664
    ds_read_b64_tr_b16 v[84:85], v16 offset:53248
    ds_read_b64_tr_b16 v[86:87], v16 offset:53760
    s_waitcnt lgkmcnt(0)
    v_mfma_f32_16x16x32_bf16 v[24:27], v[96:99], v[32:35], 0
    v_mfma_f32_16x16x32_bf16 v[24:27], v[100:103], v[36:39], v[24:27]
    v_mfma_f32_16x16x32_bf16 v[24:27], v[104:107], v[40:43], v[24:27]
    v_mfma_f32_16x16x32_bf16 v[24:27], v[108:111], v[44:47], v[24:27]
    v_mfma_f32_16x16x32_bf16 v[24:27], v[112:115], v[48:51], v[24:27]
    v_mfma_f32_16x16x32_bf16 v[24:27], v[116:119], v[52:55], v[24:27]
    v_mfma_f32_16x16x32_bf16 v[24:27], v[120:123], v[56:59], v[24:27]
    v_mfma_f32_16x16x32_bf16 v[24:27], v[124:127], v[60:63], v[24:27]
    v_mfma_f32_16x16x32_bf16 v[24:27], v[128:131], v[64:67], v[24:27]
    v_mfma_f32_16x16x32_bf16 v[24:27], v[132:135], v[68:71], v[24:27]
    v_mfma_f32_16x16x32_bf16 v[24:27], v[136:139], v[72:75], v[24:27]
    v_mfma_f32_16x16x32_bf16 v[24:27], v[140:143], v[76:79], v[24:27]
    v_mfma_f32_16x16x32_bf16 v[24:27], v[144:147], v[80:83], v[24:27]
    v_mfma_f32_16x16x32_bf16 v[24:27], v[148:151], v[84:87], v[24:27]
    ds_read_b64_tr_b16 v[160:161], v17 offset:0
    ds_read_b64_tr_b16 v[162:163], v17 offset:512
    ds_read_b64_tr_b16 v[164:165], v17 offset:4096
    ds_read_b64_tr_b16 v[166:167], v17 offset:4608
    ds_read_b64_tr_b16 v[168:169], v17 offset:8192
    ds_read_b64_tr_b16 v[170:171], v17 offset:8704
    ds_read_b64_tr_b16 v[172:173], v17 offset:12288
    ds_read_b64_tr_b16 v[174:175], v17 offset:12800
    ds_read_b64_tr_b16 v[176:177], v17 offset:16384
    ds_read_b64_tr_b16 v[178:179], v17 offset:16896
    ds_read_b64_tr_b16 v[180:181], v17 offset:20480
    ds_read_b64_tr_b16 v[182:183], v17 offset:20992
    ds_read_b64_tr_b16 v[184:185], v17 offset:24576
    ds_read_b64_tr_b16 v[186:187], v17 offset:25088
    ds_read_b64_tr_b16 v[188:189], v17 offset:28672
    ds_read_b64_tr_b16 v[190:191], v17 offset:29184
    ds_read_b64_tr_b16 v[192:193], v17 offset:32768
    ds_read_b64_tr_b16 v[194:195], v17 offset:33280
    ds_read_b64_tr_b16 v[196:197], v17 offset:36864
    ds_read_b64_tr_b16 v[198:199], v17 offset:37376
    ds_read_b64_tr_b16 v[200:201], v17 offset:40960
    ds_read_b64_tr_b16 v[202:203], v17 offset:41472
    ds_read_b64_tr_b16 v[204:205], v17 offset:45056
    ds_read_b64_tr_b16 v[206:207], v17 offset:45568
    ds_read_b64_tr_b16 v[208:209], v17 offset:49152
    ds_read_b64_tr_b16 v[210:211], v17 offset:49664
    ds_read_b64_tr_b16 v[212:213], v17 offset:53248
    ds_read_b64_tr_b16 v[214:215], v17 offset:53760
    s_waitcnt lgkmcnt(0)
    v_mfma_f32_16x16x32_bf16 v[28:31], v[96:99], v[160:163], 0
    v_mfma_f32_16x16x32_bf16 v[28:31], v[100:103], v[164:167], v[28:31]
    v_mfma_f32_16x16x32_bf16 v[28:31], v[104:107], v[168:171], v[28:31]
    v_mfma_f32_16x16x32_bf16 v[28:31], v[108:111], v[172:175], v[28:31]
    v_mfma_f32_16x16x32_bf16 v[28:31], v[112:115], v[176:179], v[28:31]
    v_mfma_f32_16x16x32_bf16 v[28:31], v[116:119], v[180:183], v[28:31]
    v_mfma_f32_16x16x32_bf16 v[28:31], v[120:123], v[184:187], v[28:31]
    v_mfma_f32_16x16x32_bf16 v[28:31], v[124:127], v[188:191], v[28:31]
    v_mfma_f32_16x16x32_bf16 v[28:31], v[128:131], v[192:195], v[28:31]
    v_mfma_f32_16x16x32_bf16 v[28:31], v[132:135], v[196:199], v[28:31]
    v_mfma_f32_16x16x32_bf16 v[28:31], v[136:139], v[200:203], v[28:31]
    v_mfma_f32_16x16x32_bf16 v[28:31], v[140:143], v[204:207], v[28:31]
    v_mfma_f32_16x16x32_bf16 v[28:31], v[144:147], v[208:211], v[28:31]
    v_mfma_f32_16x16x32_bf16 v[28:31], v[148:151], v[212:215], v[28:31]
    v_lshrrev_b32 v18, 4, v1
    v_mul_u32_u24 v18, 14336, v18
    v_and_b32 v19, 15, v1
    v_lshl_add_u32 v18, v19, 1, v18
    s_lshl_b32 s40, s13, 5
    s_add_u32 s40, s40, s43
    s_add_u32 s40, s40, 67575808
    s_nop 3
    s_mov_b32 exec_hi, 0
    v_cvt_pk_bf16_f32 v24, v24, v24
    v_and_b32 v24, s54, v24
    v_cvt_pk_bf16_f32 v28, v28, v28
    v_and_b32 v28, s54, v28
    v_mov_b32 v20, v24
    v_mul_f32 v21, 0xbfb8aa3b, v20
    v_exp_f32 v21, v21
    s_nop 0
    v_add_f32 v21, 1.0, v21
    v_rcp_f32 v20, v21
    s_nop 0
    v_mul_f32 v24, v24, v20
    v_cvt_pk_bf16_f32 v24, v24, v24
    v_and_b32 v24, s54, v24
    v_mul_f32 v24, v24, v28
    v_cvt_pk_bf16_f32 v24, v24, v24
    buffer_store_short v24, v18, s[4:7], s40 offen sc1
    s_add_u32 s40, s40, 3584
    v_cvt_pk_bf16_f32 v25, v25, v25
    v_and_b32 v25, s54, v25
    v_cvt_pk_bf16_f32 v29, v29, v29
    v_and_b32 v29, s54, v29
    v_mov_b32 v20, v25
    v_mul_f32 v21, 0xbfb8aa3b, v20
    v_exp_f32 v21, v21
    s_nop 0
    v_add_f32 v21, 1.0, v21
    v_rcp_f32 v20, v21
    s_nop 0
    v_mul_f32 v25, v25, v20
    v_cvt_pk_bf16_f32 v25, v25, v25
    v_and_b32 v25, s54, v25
    v_mul_f32 v25, v25, v29
    v_cvt_pk_bf16_f32 v25, v25, v25
    buffer_store_short v25, v18, s[4:7], s40 offen sc1
    s_add_u32 s40, s40, 3584
    v_cvt_pk_bf16_f32 v26, v26, v26
    v_and_b32 v26, s54, v26
    v_cvt_pk_bf16_f32 v30, v30, v30
    v_and_b32 v30, s54, v30
    v_mov_b32 v20, v26
    v_mul_f32 v21, 0xbfb8aa3b, v20
    v_exp_f32 v21, v21
    s_nop 0
    v_add_f32 v21, 1.0, v21
    v_rcp_f32 v20, v21
    s_nop 0
    v_mul_f32 v26, v26, v20
    v_cvt_pk_bf16_f32 v26, v26, v26
    v_and_b32 v26, s54, v26
    v_mul_f32 v26, v26, v30
    v_cvt_pk_bf16_f32 v26, v26, v26
    buffer_store_short v26, v18, s[4:7], s40 offen sc1
    s_add_u32 s40, s40, 3584
    v_cvt_pk_bf16_f32 v27, v27, v27
    v_and_b32 v27, s54, v27
    v_cvt_pk_bf16_f32 v31, v31, v31
    v_and_b32 v31, s54, v31
    v_mov_b32 v20, v27
    v_mul_f32 v21, 0xbfb8aa3b, v20
    v_exp_f32 v21, v21
    s_nop 0
    v_add_f32 v21, 1.0, v21
    v_rcp_f32 v20, v21
    s_nop 0
    v_mul_f32 v27, v27, v20
    v_cvt_pk_bf16_f32 v27, v27, v27
    v_and_b32 v27, s54, v27
    v_mul_f32 v27, v27, v31
    v_cvt_pk_bf16_f32 v27, v27, v27
    buffer_store_short v27, v18, s[4:7], s40 offen sc1
    s_add_u32 s40, s40, 3584
    s_mov_b64 exec, -1
    s_mov_b32 s40, 67690496
    s_waitcnt vmcnt(0)
    s_barrier
    s_cmp_lg_u32 s13, 0
    s_cbranch_scc1 Lsg_40
    s_mov_b64 exec, 1
    v_mov_b32 v3, 1
    buffer_atomic_add v3, off, s[4:7], s40
    s_mov_b64 exec, -1
Lsg_40:
    s_branch W_next
T_M2:
    s_load_dwordx2 s[68:69], s[0:1], 88
    s_mov_b32 s70, 1605632
    s_mov_b32 s71, 0x20000
    s_mul_hi_u32 s45, s65, 613566757
    s_mul_i32 s46, s45, 7
    s_sub_u32 s46, s65, s46
    s_mul_i32 s43, s45, 401408
    s_lshl_b32 s40, s46, 7
    s_add_u32 s43, s43, s40
    s_waitcnt lgkmcnt(0)
    s_and_b32 s69, s69, 0xffff
    s_barrier
    v_lshrrev_b32 v24, 3, v0
    v_and_b32 v25, 7, v0
    s_mov_b32 s44, 896
    v_mul_lo_u32 v26, v24, s44
    v_lshl_add_u32 v26, v25, 4, v26
    v_bfe_u32 v27, v24, 1, 1
    v_bfe_u32 v28, v24, 3, 1
    v_lshl_add_u32 v27, v28, 1, v27
    v_lshlrev_b32 v27, 1, v27
    v_xor_b32 v27, v27, v25
    v_lshlrev_b32 v27, 4, v27
    v_lshl_add_u32 v27, v24, 7, v27
    s_mov_b32 s44, s43
    buffer_load_dwordx4 v[32:35], v26, s[68:71], s44 offen
    s_add_u32 s44, s44, 28672
    buffer_load_dwordx4 v[36:39], v26, s[68:71], s44 offen
    s_add_u32 s44, s44, 28672
    buffer_load_dwordx4 v[40:43], v26, s[68:71], s44 offen
    s_add_u32 s44, s44, 28672
    buffer_load_dwordx4 v[44:47], v26, s[68:71], s44 offen
    s_add_u32 s44, s44, 28672
    buffer_load_dwordx4 v[48:51], v26, s[68:71], s44 offen
    s_add_u32 s44, s44, 28672
    buffer_load_dwordx4 v[52:55], v26, s[68:71], s44 offen
    s_add_u32 s44, s44, 28672
    buffer_load_dwordx4 v[56:59], v26, s[68:71], s44 offen
    s_add_u32 s44, s44, 28672
    buffer_load_dwordx4 v[60:63], v26, s[68:71], s44 offen
    s_add_u32 s44, s44, 28672
    buffer_load_dwordx4 v[64:67], v26, s[68:71], s44 offen
    s_add_u32 s44, s44, 28672
    buffer_load_dwordx4 v[68:71], v26, s[68:71], s44 offen
    s_add_u32 s44, s44, 28672
    buffer_load_dwordx4 v[72:75], v26, s[68:71], s44 offen
    s_add_u32 s44, s44, 28672
    buffer_load_dwordx4 v[76:79], v26, s[68:71], s44 offen
    s_add_u32 s44, s44, 28672
    buffer_load_dwordx4 v[80:83], v26, s[68:71], s44 offen
    s_add_u32 s44, s44, 28672
    buffer_load_dwordx4 v[84:87], v26, s[68:71], s44 offen
    s_add_u32 s44, s44, 28672
    s_waitcnt vmcnt(13)
    ds_write_b128 v27, v[32:35] offset:0
    s_waitcnt vmcnt(12)
    ds_write_b128 v27, v[36:39] offset:4096
    s_waitcnt vmcnt(11)
    ds_write_b128 v27, v[40:43] offset:8192
    s_waitcnt vmcnt(10)
    ds_write_b128 v27, v[44:47] offset:12288
    s_waitcnt vmcnt(9)
    ds_write_b128 v27, v[48:51] offset:16384
    s_waitcnt vmcnt(8)
    ds_write_b128 v27, v[52:55] offset:20480
    s_waitcnt vmcnt(7)
    ds_write_b128 v27, v[56:59] offset:24576
    s_waitcnt vmcnt(6)
    ds_write_b128 v27, v[60:63] offset:28672
    s_waitcnt vmcnt(5)
    ds_write_b128 v27, v[64:67] offset:32768
    s_waitcnt vmcnt(4)
    ds_write_b128 v27, v[68:71] offset:36864
    s_waitcnt vmcnt(3)
    ds_write_b128 v27, v[72:75] offset:40960
    s_waitcnt vmcnt(2)
    ds_write_b128 v27, v[76:79] offset:45056
    s_waitcnt vmcnt(1)
    ds_write_b128 v27, v[80:83] offset:49152
    s_waitcnt vmcnt(0)
    ds_write_b128 v27, v[84:87] offset:53248
    v_bfe_u32 v16, v1, 2, 2
    v_lshrrev_b32 v17, 4, v1
    v_lshl_add_u32 v16, v17, 3, v16
    v_lshlrev_b32 v16, 7, v16
    v_and_b32 v17, 3, v1
    v_lshl_add_u32 v16, v17, 3, v16
    v_bfe_u32 v17, v1, 3, 1
    v_bfe_u32 v18, v1, 4, 1
    v_lshl_add_u32 v17, v18, 1, v17
    v_xor_b32 v17, s13, v17
    v_lshl_add_u32 v16, v17, 5, v16
    s_mov_b32 s40, 67690496
    s_mov_b32 s20, 0
Lwf_41:
    buffer_load_dword v17, off, s[4:7], s40 sc1
    s_add_u32 s20, s20, 1
    s_cmp_gt_u32 s20, s23
    s_cbranch_scc1 L_fail
    s_waitcnt vmcnt(0)
    v_cmp_le_u32 vcc, 28, v17
    s_cbranch_vccnz Lwfd_42
    s_sleep 8
    s_branch Lwf_41
Lwfd_42:
    v_and_b32 v17, 7, v1
    v_mul_u32_u24 v17, 3584, v17
    v_lshrrev_b32 v18, 4, v1
    v_lshl_add_u32 v17, v18, 4, v17
    s_mul_i32 s40, s45, 896
    s_add_u32 s40, s40, 67575808
    buffer_load_dwordx4 v[96:99], v17, s[4:7], s40 offen offset:0 sc1
    buffer_load_dwordx4 v[100:103], v17, s[4:7], s40 offen offset:64 sc1
    buffer_load_dwordx4 v[104:107], v17, s[4:7], s40 offen offset:128 sc1
    buffer_load_dwordx4 v[108:111], v17, s[4:7], s40 offen offset:192 sc1
    buffer_load_dwordx4 v[112:115], v17, s[4:7], s40 offen offset:256 sc1
    buffer_load_dwordx4 v[116:119], v17, s[4:7], s40 offen offset:320 sc1
    buffer_load_dwordx4 v[120:123], v17, s[4:7], s40 offen offset:384 sc1
    buffer_load_dwordx4 v[124:127], v17, s[4:7], s40 offen offset:448 sc1
    buffer_load_dwordx4 v[128:131], v17, s[4:7], s40 offen offset:512 sc1
    buffer_load_dwordx4 v[132:135], v17, s[4:7], s40 offen offset:576 sc1
    buffer_load_dwordx4 v[136:139], v17, s[4:7], s40 offen offset:640 sc1
    buffer_load_dwordx4 v[140:143], v17, s[4:7], s40 offen offset:704 sc1
    buffer_load_dwordx4 v[144:147], v17, s[4:7], s40 offen offset:768 sc1
    buffer_load_dwordx4 v[148:151], v17, s[4:7], s40 offen offset:832 sc1
    s_waitcnt vmcnt(0) lgkmcnt(0)
    s_barrier
    ds_read_b64_tr_b16 v[32:33], v16 offset:0
    ds_read_b64_tr_b16 v[34:35], v16 offset:512
    ds_read_b64_tr_b16 v[36:37], v16 offset:4096
    ds_read_b64_tr_b16 v[38:39], v16 offset:4608
    ds_read_b64_tr_b16 v[40:41], v16 offset:8192
    ds_read_b64_tr_b16 v[42:43], v16 offset:8704
    ds_read_b64_tr_b16 v[44:45], v16 offset:12288
    ds_read_b64_tr_b16 v[46:47], v16 offset:12800
    ds_read_b64_tr_b16 v[48:49], v16 offset:16384
    ds_read_b64_tr_b16 v[50:51], v16 offset:16896
    ds_read_b64_tr_b16 v[52:53], v16 offset:20480
    ds_read_b64_tr_b16 v[54:55], v16 offset:20992
    ds_read_b64_tr_b16 v[56:57], v16 offset:24576
    ds_read_b64_tr_b16 v[58:59], v16 offset:25088
    ds_read_b64_tr_b16 v[60:61], v16 offset:28672
    ds_read_b64_tr_b16 v[62:63], v16 offset:29184
    ds_read_b64_tr_b16 v[64:65], v16 offset:32768
    ds_read_b64_tr_b16 v[66:67], v16 offset:33280
    ds_read_b64_tr_b16 v[68:69], v16 offset:36864
    ds_read_b64_tr_b16 v[70:71], v16 offset:37376
    ds_read_b64_tr_b16 v[72:73], v16 offset:40960
    ds_read_b64_tr_b16 v[74:75], v16 offset:41472
    ds_read_b64_tr_b16 v[76:77], v16 offset:45056
    ds_read_b64_tr_b16 v[78:79], v16 offset:45568
    ds_read_b64_tr_b16 v[80:81], v16 offset:49152
    ds_read_b64_tr_b16 v[82:83], v16 offset:49664
    ds_read_b64_tr_b16 v[84:85], v16 offset:53248
    ds_read_b64_tr_b16 v[86:87], v16 offset:53760
    s_waitcnt lgkmcnt(0)
    v_mfma_f32_16x16x32_bf16 v[24:27], v[96:99], v[32:35], 0
    v_mfma_f32_16x16x32_bf16 v[24:27], v[100:103], v[36:39], v[24:27]
    v_mfma_f32_16x16x32_bf16 v[24:27], v[104:107], v[40:43], v[24:27]
    v_mfma_f32_16x16x32_bf16 v[24:27], v[108:111], v[44:47], v[24:27]
    v_mfma_f32_16x16x32_bf16 v[24:27], v[112:115], v[48:51], v[24:27]
    v_mfma_f32_16x16x32_bf16 v[24:27], v[116:119], v[52:55], v[24:27]
    v_mfma_f32_16x16x32_bf16 v[24:27], v[120:123], v[56:59], v[24:27]
    v_mfma_f32_16x16x32_bf16 v[24:27], v[124:127], v[60:63], v[24:27]
    v_mfma_f32_16x16x32_bf16 v[24:27], v[128:131], v[64:67], v[24:27]
    v_mfma_f32_16x16x32_bf16 v[24:27], v[132:135], v[68:71], v[24:27]
    v_mfma_f32_16x16x32_bf16 v[24:27], v[136:139], v[72:75], v[24:27]
    v_mfma_f32_16x16x32_bf16 v[24:27], v[140:143], v[76:79], v[24:27]
    v_mfma_f32_16x16x32_bf16 v[24:27], v[144:147], v[80:83], v[24:27]
    v_mfma_f32_16x16x32_bf16 v[24:27], v[148:151], v[84:87], v[24:27]
    v_mul_u32_u24 v18, 7168, v18
    v_and_b32 v19, 15, v1
    v_lshl_add_u32 v18, v19, 2, v18
    s_mul_i32 s40, s45, 14336
    s_lshl_b32 s41, s46, 8
    s_add_u32 s40, s40, s41
    s_lshl_b32 s41, s13, 6
    s_add_u32 s40, s40, s41
    s_add_u32 s40, s40, 67608576
    s_mov_b32 exec_hi, 0
    buffer_store_dword v24, v18, s[4:7], s40 offen sc1
    s_add_u32 s40, s40, 1792
    buffer_store_dword v25, v18, s[4:7], s40 offen sc1
    s_add_u32 s40, s40, 1792
    buffer_store_dword v26, v18, s[4:7], s40 offen sc1
    s_add_u32 s40, s40, 1792
    buffer_store_dword v27, v18, s[4:7], s40 offen sc1
    s_add_u32 s40, s40, 1792
    s_mov_b64 exec, -1
    s_mov_b32 s40, 67690624
    s_waitcnt vmcnt(0)
    s_barrier
    s_cmp_lg_u32 s13, 0
    s_cbranch_scc1 Lsg_43
    s_mov_b64 exec, 1
    v_mov_b32 v3, 1
    buffer_atomic_add v3, off, s[4:7], s40
    s_mov_b64 exec, -1
Lsg_43:
    s_branch W_next
L_roleA:
    s_mov_b32 s26, s12
    v_and_b32 v1, 63, v0
    v_lshlrev_b32 v2, 4, v1
    s_lshl_b32 s21, s13, 10
    v_add_u32 v118, s21, v2
    s_add_u32 s21, s13, 4
    s_min_u32 s21, s21, 6
    s_lshl_b32 s21, s21, 10
    v_add_u32 v119, s21, v2
    v_and_b32 v114, 8, v1
    v_mov_b32 v3, 0x4444
    v_mov_b32 v115, 0xeeee
    v_cmp_ne_u32 vcc, 0, v114
    s_nop 1
    v_cndmask_b32 v3, v3, v115, vcc
    s_mov_b32 s23, 400000
    s_lshr_b32 s21, s13, 1
    s_mul_i32 s21, s21, 14
    s_and_b32 s22, s13, 1
    s_add_u32 s33, s21, 6
    s_add_u32 s33, s33, s22
    s_lshl_b32 s34, s22, 3
    s_add_u32 s32, s21, s34
    s_mul_i32 s35, s26, 401408
    s_add_u32 s35, s35, 0
    s_mul_i32 s36, s32, 14336
    s_add_u32 s36, s36, s35
    s_mul_i32 s37, s33, 14336
    s_add_u32 s37, s37, s35
    s_add_u32 s50, s13, 0
    s_sub_u32 s40, s50, 7
    s_cmp_ge_u32 s50, 7
    s_cselect_b32 s50, s40, s50
    s_lshl_b32 s50, s50, 10
    s_add_u32 s51, s13, 4
    s_sub_u32 s40, s51, 7
    s_cmp_ge_u32 s51, 7
    s_cselect_b32 s51, s40, s51
    s_lshl_b32 s51, s51, 10
    s_add_u32 s52, s13, 1
    s_sub_u32 s40, s52, 7
    s_cmp_ge_u32 s52, 7
    s_cselect_b32 s52, s40, s52
    s_lshl_b32 s52, s52, 10
    s_add_u32 s53, s13, 5
    s_sub_u32 s40, s53, 7
    s_cmp_ge_u32 s53, 7
    s_cselect_b32 s53, s40, s53
    s_lshl_b32 s53, s53, 10
    s_add_u32 s54, s13, 2
    s_sub_u32 s40, s54, 7
    s_cmp_ge_u32 s54, 7
    s_cselect_b32 s54, s40, s54
    s_lshl_b32 s54, s54, 10
    s_add_u32 s55, s13, 6
    s_sub_u32 s40, s55, 7
    s_cmp_ge_u32 s55, 7
    s_cselect_b32 s55, s40, s55
    s_lshl_b32 s55, s55, 10
    s_add_u32 s56, s13, 3
    s_sub_u32 s40, s56, 7
    s_cmp_ge_u32 s56, 7
    s_cselect_b32 s56, s40, s56
    s_lshl_b32 s56, s56, 10
    v_add_u32 v119, s51, v2
    v_lshrrev_b32 v44, 4, v1
    v_and_b32 v45, 15, v1
    s_lshr_b32 s38, s32, 1
    s_lshr_b32 s39, s33, 1
    s_lshl_b32 s40, s38, 10
    v_add_u32 v4, s40, v2
    s_lshl_b32 s40, s39, 10
    s_add_u32 s40, s40, s34
    v_add_u32 v5, s40, v2
    v_lshrrev_b32 v114, 1, v44
    v_lshlrev_b32 v114, 8, v114
    v_lshrrev_b32 v115, 2, v45
    v_lshl_add_u32 v114, v115, 5, v114
    v_and_b32 v115, 1, v45
    v_lshl_add_u32 v114, v115, 4, v114
    v_and_b32 v115, 1, v44
    v_lshlrev_b32 v115, 7, v115
    v_add_u32 v114, v114, v115
    s_lshl_b32 s40, s38, 9
    v_add_u32 v6, s40, v114
    s_lshl_b32 s40, s39, 9
    s_add_u32 s40, s40, s34
    v_add_u32 v7, s40, v114
    s_lshl_b32 s40, s13, 10
    s_add_u32 s40, s40, 23552
    v_lshrrev_b32 v114, 2, v45
    v_add_u32 v114, v114, v44
    v_and_b32 v114, 3, v114
    v_lshlrev_b32 v114, 3, v114
    v_lshlrev_b32 v115, 5, v45
    v_add3_u32 v8, v114, v115, s40
    v_lshrrev_b32 v114, 2, v1
    v_lshlrev_b32 v114, 5, v114
    v_add_u32 v115, v1, v44
    v_and_b32 v115, 3, v115
    v_lshlrev_b32 v115, 3, v115
    v_add3_u32 v9, v114, v115, s40
    s_mul_i32 s40, s13, 4096
    s_add_u32 s40, s40, 7168
    v_and_b32 v114, 7, v45
    v_lshlrev_b32 v114, 4, v114
    v_mul_u32_u24 v115, 144, v44
    v_add3_u32 v114, v114, v115, s40
    v_lshrrev_b32 v115, 3, v45
    v_mul_u32_u24 v116, 576, v115
    v_add_u32 v10, v114, v116
    v_mul_u32_u24 v116, 2304, v115
    v_add_u32 v52, v114, v116
    v_mov_b32 v48, 0xff800000
    v_mov_b32 v49, v48
    v_mov_b32 v50, v48
    v_mov_b32 v51, v48
    ds_write_b128 v114, v[48:51]
    ds_write_b128 v114, v[48:51] offset:1728
    v_mov_b32 v114, v45
    v_lshrrev_b32 v115, 5, v1
    s_lshl_b32 s40, s13, 1
    v_add_u32 v115, s40, v115
    v_and_b32 v116, 1, v44
    v_lshl_add_u32 v117, v115, 1, v116
    v_lshlrev_b32 v117, 3, v117
    v_mul_u32_u24 v11, 144, v114
    v_add_u32 v11, v11, v117
    v_add_u32 v11, 7168, v11
    s_and_b32 s42, s26, 1
    s_lshl_b32 s42, s42, 3
    v_add_u32 v115, s42, v115
    v_and_b32 v114, 3, v45
    v_lshlrev_b32 v114, 2, v114
    v_lshl_add_u32 v115, v115, 4, v114
    v_lshl_add_u32 v12, v116, 8, v115
    v_bfe_u32 v114, v45, 3, 1
    v_lshl_add_u32 v12, v114, 9, v12
    s_lshr_b32 s41, s26, 1
    s_lshl_b32 s40, s41, 10
    v_add_u32 v12, s40, v12
    v_mov_b32 v117, 0x40000000
    s_lshl_b32 s40, s41, 8
    s_add_u32 s40, s40, 8192
    v_add_u32 v114, s40, v115
    v_cmp_ne_u32 vcc, 0, v116
    s_nop 1
    v_cndmask_b32 v114, v114, v117, vcc
    v_cmp_le_u32 vcc, 4, v45
    s_nop 1
    v_cndmask_b32 v12, v114, v12, vcc
    v_cmp_le_u32 vcc, 12, v45
    s_nop 1
    v_cndmask_b32 v12, v12, v117, vcc
    v_mov_b32 v13, 1.0
    v_cmp_le_u32 vcc, v117, v12
    s_nop 1
    v_cndmask_b32 v13, v13, 0, vcc
    v_mov_b32 v13, v52
    s_mov_b32 s14, 0
    s_lshr_b32 s16, s26, 3
    s_mul_i32 s16, s16, 0
    s_add_u32 s16, s16, 62849024
    s_mov_b32 s17, 63307776
    s_mov_b32 s18, 14680064
    s_lshl_b32 s40, s26, 2
    s_add_u32 s40, s40, s13
    s_mul_i32 s40, s40, 7168
    v_min_u32 v114, 880, v2
    v_lshlrev_b32 v114, 3, v114
    v_add_u32 v114, s40, v114
    s_mov_b32 s19, 19267584
    v_lshlrev_b32 v46, 2, v44
    v_sub_u32 v46, v45, v46
    v_and_b32 v47, 1, v46
    v_lshlrev_b32 v47, 4, v47
    v_mov_b32 v1, 0x3f80
    v_lshlrev_b32 v1, v47, v1
    v_cmp_gt_u32 vcc, 4, v46
    v_cmp_lt_u32 s[48:49], 1, v46
    s_nop 0
    v_cndmask_b32 v1, 0, v1, vcc
    s_add_u32 s46, s18, 14336
    buffer_load_dwordx4 v[72:75], v4, s[4:7], s18 offen offset:0
    buffer_load_dwordx4 v[76:79], v4, s[4:7], s46 offen offset:0
    buffer_load_dwordx4 v[80:83], v4, s[4:7], s18 offen offset:1024
    buffer_load_dwordx4 v[84:87], v4, s[4:7], s46 offen offset:1024
    buffer_load_dwordx4 v[88:91], v4, s[4:7], s18 offen offset:2048
    buffer_load_dwordx4 v[92:95], v4, s[4:7], s46 offen offset:2048
    buffer_load_dwordx2 v[96:97], v5, s[4:7], s18 offen
    buffer_load_dwordx2 v[98:99], v5, s[4:7], s46 offen
    s_add_u32 s18, s18, 28672
    s_add_u32 s46, s18, 14336
    s_add_u32 s40, s50, 62849024
    buffer_load_dwordx4 v[16:19], v2, s[4:7], s40 offen
    s_add_u32 s40, s51, 62849024
    buffer_load_dwordx4 v[20:23], v2, s[4:7], s40 offen
    s_add_u32 s40, s52, 62849024
    buffer_load_dwordx4 v[24:27], v2, s[4:7], s40 offen
    s_add_u32 s40, s53, 62849024
    buffer_load_dwordx4 v[28:31], v2, s[4:7], s40 offen
    s_add_u32 s40, s54, 62849024
    buffer_load_dwordx4 v[32:35], v2, s[4:7], s40 offen
    s_add_u32 s40, s55, 62849024
    buffer_load_dwordx4 v[36:39], v2, s[4:7], s40 offen
    s_add_u32 s40, s56, 62849024
    buffer_load_dwordx4 v[40:43], v2, s[4:7], s40 offen
    buffer_load_dwordx4 v[100:103], v6, s[4:7], s16 offen offset:0
    buffer_load_dwordx4 v[104:107], v6, s[4:7], s16 offen offset:512
    buffer_load_dwordx4 v[108:111], v6, s[4:7], s16 offen offset:1024
    buffer_load_dwordx2 v[112:113], v7, s[4:7], s16 offen
    v_mov_b64 v[44:45], 0
    v_mov_b64 v[46:47], 0
    v_mov_b64 v[48:49], 0
    v_mov_b64 v[50:51], 0
    v_mov_b64 v[52:53], 0
    v_mov_b64 v[54:55], 0
    v_mov_b64 v[56:57], 0
    v_mov_b64 v[58:59], 0
    v_mov_b64 v[60:61], 0
    v_mov_b64 v[62:63], 0
    v_mov_b64 v[64:65], 0
    v_mov_b64 v[66:67], 0
    v_mov_b64 v[68:69], 0
    v_mov_b64 v[70:71], 0
    s_mov_b32 s14, -1
    s_lshl_b32 s40, s50, 1
    s_add_u32 s40, s40, s36
    buffer_load_dwordx4 a[0:3], v2, s[4:7], s40 offen offset:0
    buffer_load_dwordx4 a[4:7], v2, s[4:7], s40 offen offset:1024
    s_lshl_b32 s40, s51, 1
    s_add_u32 s40, s40, s36
    buffer_load_dwordx4 a[8:11], v2, s[4:7], s40 offen offset:0
    buffer_load_dwordx4 a[12:15], v2, s[4:7], s40 offen offset:1024
    s_lshl_b32 s40, s52, 1
    s_add_u32 s40, s40, s36
    buffer_load_dwordx4 a[16:19], v2, s[4:7], s40 offen offset:0
    buffer_load_dwordx4 a[20:23], v2, s[4:7], s40 offen offset:1024
    s_lshl_b32 s40, s53, 1
    s_add_u32 s40, s40, s36
    buffer_load_dwordx4 a[24:27], v2, s[4:7], s40 offen offset:0
    buffer_load_dwordx4 a[28:31], v2, s[4:7], s40 offen offset:1024
    s_lshl_b32 s40, s54, 1
    s_add_u32 s40, s40, s36
    buffer_load_dwordx4 a[32:35], v2, s[4:7], s40 offen offset:0
    buffer_load_dwordx4 a[36:39], v2, s[4:7], s40 offen offset:1024
    s_lshl_b32 s40, s55, 1
    s_add_u32 s40, s40, s36
    buffer_load_dwordx4 a[40:43], v2, s[4:7], s40 offen offset:0
    buffer_load_dwordx4 a[44:47], v2, s[4:7], s40 offen offset:1024
    s_lshl_b32 s40, s56, 1
    s_add_u32 s40, s40, s36
    buffer_load_dwordx4 a[48:51], v2, s[4:7], s40 offen offset:0
    buffer_load_dwordx4 a[52:55], v2, s[4:7], s40 offen offset:1024
    s_add_u32 s36, s36, 14336
    s_waitcnt vmcnt(40)
    s_lshl_b32 s40, s50, 1
    s_add_u32 s40, s40, s36
    buffer_load_dwordx4 a[56:59], v2, s[4:7], s40 offen offset:0
    buffer_load_dwordx4 a[60:63], v2, s[4:7], s40 offen offset:1024
    s_lshl_b32 s40, s51, 1
    s_add_u32 s40, s40, s36
    buffer_load_dwordx4 a[64:67], v2, s[4:7], s40 offen offset:0
    buffer_load_dwordx4 a[68:71], v2, s[4:7], s40 offen offset:1024
    s_lshl_b32 s40, s52, 1
    s_add_u32 s40, s40, s36
    buffer_load_dwordx4 a[72:75], v2, s[4:7], s40 offen offset:0
    buffer_load_dwordx4 a[76:79], v2, s[4:7], s40 offen offset:1024
    s_lshl_b32 s40, s53, 1
    s_add_u32 s40, s40, s36
    buffer_load_dwordx4 a[80:83], v2, s[4:7], s40 offen offset:0
    buffer_load_dwordx4 a[84:87], v2, s[4:7], s40 offen offset:1024
    s_lshl_b32 s40, s54, 1
    s_add_u32 s40, s40, s36
    buffer_load_dwordx4 a[88:91], v2, s[4:7], s40 offen offset:0
    buffer_load_dwordx4 a[92:95], v2, s[4:7], s40 offen offset:1024
    s_lshl_b32 s40, s55, 1
    s_add_u32 s40, s40, s36
    buffer_load_dwordx4 a[96:99], v2, s[4:7], s40 offen offset:0
    buffer_load_dwordx4 a[100:103], v2, s[4:7], s40 offen offset:1024
    s_lshl_b32 s40, s56, 1
    s_add_u32 s40, s40, s36
    buffer_load_dwordx4 a[104:107], v2, s[4:7], s40 offen offset:0
    buffer_load_dwordx4 a[108:111], v2, s[4:7], s40 offen offset:1024
    s_add_u32 s36, s36, 14336
    s_waitcnt vmcnt(40)
    s_lshl_b32 s40, s50, 1
    s_add_u32 s40, s40, s36
    buffer_load_dwordx4 a[112:115], v2, s[4:7], s40 offen offset:0
    buffer_load_dwordx4 a[116:119], v2, s[4:7], s40 offen offset:1024
    s_lshl_b32 s40, s51, 1
    s_add_u32 s40, s40, s36
    buffer_load_dwordx4 a[120:123], v2, s[4:7], s40 offen offset:0
    buffer_load_dwordx4 a[124:127], v2, s[4:7], s40 offen offset:1024
    s_lshl_b32 s40, s52, 1
    s_add_u32 s40, s40, s36
    buffer_load_dwordx4 a[128:131], v2, s[4:7], s40 offen offset:0
    buffer_load_dwordx4 a[132:135], v2, s[4:7], s40 offen offset:1024
    s_lshl_b32 s40, s53, 1
    s_add_u32 s40, s40, s36
    buffer_load_dwordx4 a[136:139], v2, s[4:7], s40 offen offset:0
    buffer_load_dwordx4 a[140:143], v2, s[4:7], s40 offen offset:1024
    s_lshl_b32 s40, s54, 1
    s_add_u32 s40, s40, s36
    buffer_load_dwordx4 a[144:147], v2, s[4:7], s40 offen offset:0
    buffer_load_dwordx4 a[148:151], v2, s[4:7], s40 offen offset:1024
    s_lshl_b32 s40, s55, 1
    s_add_u32 s40, s40, s36
    buffer_load_dwordx4 a[152:155], v2, s[4:7], s40 offen offset:0
    buffer_load_dwordx4 a[156:159], v2, s[4:7], s40 offen offset:1024
    s_lshl_b32 s40, s56, 1
    s_add_u32 s40, s40, s36
    buffer_load_dwordx4 a[160:163], v2, s[4:7], s40 offen offset:0
    buffer_load_dwordx4 a[164:167], v2, s[4:7], s40 offen offset:1024
    s_add_u32 s36, s36, 14336
    s_waitcnt vmcnt(28)
    v_smfmac_f32_16x16x64_bf16 v[44:47], v[16:19], a[0:7], v3
    v_smfmac_f32_16x16x64_bf16 v[44:47], v[20:23], a[8:15], v3
    v_smfmac_f32_16x16x64_bf16 v[44:47], v[24:27], a[16:23], v3
    v_smfmac_f32_16x16x64_bf16 v[44:47], v[28:31], a[24:31], v3
    v_smfmac_f32_16x16x64_bf16 v[44:47], v[32:35], a[32:39], v3
    v_smfmac_f32_16x16x64_bf16 v[44:47], v[36:39], a[40:47], v3
    v_smfmac_f32_16x16x64_bf16 v[44:47], v[40:43], a[48:55], v3
    s_lshl_b32 s40, s50, 1
    s_add_u32 s40, s40, s36
    buffer_load_dwordx4 a[168:171], v2, s[4:7], s40 offen offset:0
    buffer_load_dwordx4 a[172:175], v2, s[4:7], s40 offen offset:1024
    s_lshl_b32 s40, s51, 1
    s_add_u32 s40, s40, s36
    buffer_load_dwordx4 a[176:179], v2, s[4:7], s40 offen offset:0
    buffer_load_dwordx4 a[180:183], v2, s[4:7], s40 offen offset:1024
    s_lshl_b32 s40, s52, 1
    s_add_u32 s40, s40, s36
    buffer_load_dwordx4 a[184:187], v2, s[4:7], s40 offen offset:0
    buffer_load_dwordx4 a[188:191], v2, s[4:7], s40 offen offset:1024
    s_lshl_b32 s40, s53, 1
    s_add_u32 s40, s40, s36
    buffer_load_dwordx4 a[192:195], v2, s[4:7], s40 offen offset:0
    buffer_load_dwordx4 a[196:199], v2, s[4:7], s40 offen offset:1024
    s_lshl_b32 s40, s54, 1
    s_add_u32 s40, s40, s36
    buffer_load_dwordx4 a[200:203], v2, s[4:7], s40 offen offset:0
    buffer_load_dwordx4 a[204:207], v2, s[4:7], s40 offen offset:1024
    s_lshl_b32 s40, s55, 1
    s_add_u32 s40, s40, s36
    buffer_load_dwordx4 a[208:211], v2, s[4:7], s40 offen offset:0
    buffer_load_dwordx4 a[212:215], v2, s[4:7], s40 offen offset:1024
    s_lshl_b32 s40, s56, 1
    s_add_u32 s40, s40, s36
    buffer_load_dwordx4 a[216:219], v2, s[4:7], s40 offen offset:0
    buffer_load_dwordx4 a[220:223], v2, s[4:7], s40 offen offset:1024
    s_add_u32 s36, s36, 14336
    s_waitcnt vmcnt(28)
    v_smfmac_f32_16x16x64_bf16 v[48:51], v[16:19], a[56:63], v3
    v_smfmac_f32_16x16x64_bf16 v[48:51], v[20:23], a[64:71], v3
    v_smfmac_f32_16x16x64_bf16 v[48:51], v[24:27], a[72:79], v3
    v_smfmac_f32_16x16x64_bf16 v[48:51], v[28:31], a[80:87], v3
    v_cvt_pk_bf16_f32 v44, v44, v45
    v_cvt_pk_bf16_f32 v45, v46, v47
    ds_write_b64 v8, v[44:45] offset:0
    v_smfmac_f32_16x16x64_bf16 v[48:51], v[32:35], a[88:95], v3
    v_smfmac_f32_16x16x64_bf16 v[48:51], v[36:39], a[96:103], v3
    v_smfmac_f32_16x16x64_bf16 v[48:51], v[40:43], a[104:111], v3
    s_lshl_b32 s40, s50, 1
    s_add_u32 s40, s40, s36
    buffer_load_dwordx4 a[224:227], v2, s[4:7], s40 offen offset:0
    buffer_load_dwordx4 a[228:231], v2, s[4:7], s40 offen offset:1024
    s_lshl_b32 s40, s51, 1
    s_add_u32 s40, s40, s36
    buffer_load_dwordx4 a[232:235], v2, s[4:7], s40 offen offset:0
    buffer_load_dwordx4 a[236:239], v2, s[4:7], s40 offen offset:1024
    s_lshl_b32 s40, s52, 1
    s_add_u32 s40, s40, s36
    buffer_load_dwordx4 a[240:243], v2, s[4:7], s40 offen offset:0
    buffer_load_dwordx4 a[244:247], v2, s[4:7], s40 offen offset:1024
    s_lshl_b32 s40, s53, 1
    s_add_u32 s40, s40, s36
    buffer_load_dwordx4 a[248:251], v2, s[4:7], s40 offen offset:0
    buffer_load_dwordx4 a[252:255], v2, s[4:7], s40 offen offset:1024
    s_lshl_b32 s40, s54, 1
    s_add_u32 s40, s40, s36
    buffer_load_dwordx4 v[120:123], v2, s[4:7], s40 offen offset:0
    buffer_load_dwordx4 v[124:127], v2, s[4:7], s40 offen offset:1024
    s_lshl_b32 s40, s55, 1
    s_add_u32 s40, s40, s36
    buffer_load_dwordx4 v[128:131], v2, s[4:7], s40 offen offset:0
    buffer_load_dwordx4 v[132:135], v2, s[4:7], s40 offen offset:1024
    s_lshl_b32 s40, s56, 1
    s_add_u32 s40, s40, s36
    buffer_load_dwordx4 v[136:139], v2, s[4:7], s40 offen offset:0
    buffer_load_dwordx4 v[140:143], v2, s[4:7], s40 offen offset:1024
    s_add_u32 s36, s36, 14336
    s_waitcnt vmcnt(28)
    v_smfmac_f32_16x16x64_bf16 v[52:55], v[16:19], a[112:119], v3
    v_smfmac_f32_16x16x64_bf16 v[52:55], v[20:23], a[120:127], v3
    v_smfmac_f32_16x16x64_bf16 v[52:55], v[24:27], a[128:135], v3
    v_smfmac_f32_16x16x64_bf16 v[52:55], v[28:31], a[136:143], v3
    v_cvt_pk_bf16_f32 v48, v48, v49
    v_cvt_pk_bf16_f32 v49, v50, v51
    ds_write_b64 v8, v[48:49] offset:512
    v_smfmac_f32_16x16x64_bf16 v[52:55], v[32:35], a[144:151], v3
    ds_read_b64_tr_b16 v[44:45], v9 offset:0
    ds_read_b64_tr_b16 v[46:47], v9 offset:512
    v_smfmac_f32_16x16x64_bf16 v[52:55], v[36:39], a[152:159], v3
    v_smfmac_f32_16x16x64_bf16 v[52:55], v[40:43], a[160:167], v3
    v_and_b32 v15, 15, v0
    v_lshlrev_b32 v15, 2, v15
    buffer_load_dword v14, v15, s[8:11], 0 offen offset:32 sc1
    s_lshl_b32 s40, s50, 1
    s_add_u32 s40, s40, s36
    buffer_load_dwordx4 v[144:147], v2, s[4:7], s40 offen offset:0
    buffer_load_dwordx4 v[148:151], v2, s[4:7], s40 offen offset:1024
    s_lshl_b32 s40, s51, 1
    s_add_u32 s40, s40, s36
    buffer_load_dwordx4 v[152:155], v2, s[4:7], s40 offen offset:0
    buffer_load_dwordx4 v[156:159], v2, s[4:7], s40 offen offset:1024
    s_lshl_b32 s40, s52, 1
    s_add_u32 s40, s40, s36
    buffer_load_dwordx4 v[160:163], v2, s[4:7], s40 offen offset:0
    buffer_load_dwordx4 v[164:167], v2, s[4:7], s40 offen offset:1024
    s_lshl_b32 s40, s53, 1
    s_add_u32 s40, s40, s36
    buffer_load_dwordx4 v[168:171], v2, s[4:7], s40 offen offset:0
    buffer_load_dwordx4 v[172:175], v2, s[4:7], s40 offen offset:1024
    s_lshl_b32 s40, s54, 1
    s_add_u32 s40, s40, s36
    buffer_load_dwordx4 v[176:179], v2, s[4:7], s40 offen offset:0
    buffer_load_dwordx4 v[180:183], v2, s[4:7], s40 offen offset:1024
    s_lshl_b32 s40, s55, 1
    s_add_u32 s40, s40, s36
    buffer_load_dwordx4 v[184:187], v2, s[4:7], s40 offen offset:0
    buffer_load_dwordx4 v[188:191], v2, s[4:7], s40 offen offset:1024
    s_lshl_b32 s40, s56, 1
    s_add_u32 s40, s40, s36
    buffer_load_dwordx4 v[192:195], v2, s[4:7], s40 offen offset:0
    buffer_load_dwordx4 v[196:199], v2, s[4:7], s40 offen offset:1024
    s_add_u32 s36, s36, 14336
    s_waitcnt vmcnt(28)
    v_smfmac_f32_16x16x64_bf16 v[56:59], v[16:19], a[168:175], v3
    v_smfmac_f32_16x16x64_bf16 v[56:59], v[20:23], a[176:183], v3
    v_smfmac_f32_16x16x64_bf16 v[56:59], v[24:27], a[184:191], v3
    v_smfmac_f32_16x16x64_bf16 v[56:59], v[28:31], a[192:199], v3
    v_cvt_pk_bf16_f32 v52, v52, v53
    v_cvt_pk_bf16_f32 v53, v54, v55
    ds_write_b64 v8, v[52:53] offset:0
    v_smfmac_f32_16x16x64_bf16 v[56:59], v[32:35], a[200:207], v3
    v_smfmac_f32_16x16x64_bf16 v[56:59], v[36:39], a[208:215], v3
    v_smfmac_f32_16x16x64_bf16 v[56:59], v[40:43], a[216:223], v3
    s_add_u32 s21, s14, 3
    s_lshr_b32 s21, s21, 2
    s_lshl_b32 s21, s21, 7
    s_add_u32 s21, s21, 67678208
    buffer_load_dword v116, off, s[4:7], s21 sc1
Llf_44:
    s_lshl_b32 s40, s50, 1
    s_add_u32 s40, s40, s37
    buffer_load_dwordx4 v[200:203], v2, s[4:7], s40 offen offset:0
    buffer_load_dwordx4 v[204:207], v2, s[4:7], s40 offen offset:1024
    s_lshl_b32 s40, s51, 1
    s_add_u32 s40, s40, s37
    buffer_load_dwordx4 v[208:211], v2, s[4:7], s40 offen offset:0
    buffer_load_dwordx4 v[212:215], v2, s[4:7], s40 offen offset:1024
    s_lshl_b32 s40, s52, 1
    s_add_u32 s40, s40, s37
    buffer_load_dwordx4 v[216:219], v2, s[4:7], s40 offen offset:0
    buffer_load_dwordx4 v[220:223], v2, s[4:7], s40 offen offset:1024
    s_lshl_b32 s40, s53, 1
    s_add_u32 s40, s40, s37
    buffer_load_dwordx4 v[224:227], v2, s[4:7], s40 offen offset:0
    buffer_load_dwordx4 v[228:231], v2, s[4:7], s40 offen offset:1024
    s_lshl_b32 s40, s54, 1
    s_add_u32 s40, s40, s37
    buffer_load_dwordx4 v[232:235], v2, s[4:7], s40 offen offset:0
    buffer_load_dwordx4 v[236:239], v2, s[4:7], s40 offen offset:1024
    s_lshl_b32 s40, s55, 1
    s_add_u32 s40, s40, s37
    buffer_load_dwordx4 v[240:243], v2, s[4:7], s40 offen offset:0
    buffer_load_dwordx4 v[244:247], v2, s[4:7], s40 offen offset:1024
    s_lshl_b32 s40, s56, 1
    s_add_u32 s40, s40, s37
    buffer_load_dwordx4 v[248:251], v2, s[4:7], s40 offen offset:0
    buffer_load_dwordx4 v[252:255], v2, s[4:7], s40 offen offset:1024
    s_add_u32 s37, s37, 14336
    s_waitcnt vmcnt(28)
    v_smfmac_f32_16x16x64_bf16 v[60:63], v[16:19], a[224:231], v3
    v_smfmac_f32_16x16x64_bf16 v[60:63], v[20:23], a[232:239], v3
    v_smfmac_f32_16x16x64_bf16 v[60:63], v[24:27], a[240:247], v3
    v_smfmac_f32_16x16x64_bf16 v[60:63], v[28:31], a[248:255], v3
    v_cvt_pk_bf16_f32 v56, v56, v57
    v_cvt_pk_bf16_f32 v57, v58, v59
    ds_write_b64 v8, v[56:57] offset:512
    v_smfmac_f32_16x16x64_bf16 v[60:63], v[32:35], v[120:127], v3
    ds_read_b64_tr_b16 v[52:53], v9 offset:0
    ds_read_b64_tr_b16 v[54:55], v9 offset:512
    v_smfmac_f32_16x16x64_bf16 v[60:63], v[36:39], v[128:135], v3
    v_smfmac_f32_16x16x64_bf16 v[60:63], v[40:43], v[136:143], v3
    s_mov_b32 s14, 0
    s_waitcnt vmcnt(14)
    v_smfmac_f32_16x16x64_bf16 v[64:67], v[16:19], v[144:151], v3
    v_smfmac_f32_16x16x64_bf16 v[64:67], v[20:23], v[152:159], v3
    v_smfmac_f32_16x16x64_bf16 v[64:67], v[24:27], v[160:167], v3
    v_smfmac_f32_16x16x64_bf16 v[64:67], v[28:31], v[168:175], v3
    v_cvt_pk_bf16_f32 v60, v60, v61
    v_cvt_pk_bf16_f32 v61, v62, v63
    ds_write_b64 v8, v[60:61] offset:0
    v_smfmac_f32_16x16x64_bf16 v[64:67], v[32:35], v[176:183], v3
    v_smfmac_f32_16x16x64_bf16 v[64:67], v[36:39], v[184:191], v3
    v_smfmac_f32_16x16x64_bf16 v[64:67], v[40:43], v[192:199], v3
    s_mov_b32 s20, 0
    s_branch Lwm_45e
Lwm_45:
    buffer_load_dword v14, v15, s[8:11], 0 offen offset:32 sc1
    s_add_u32 s20, s20, 1
    s_cmp_gt_u32 s20, s23
    s_cbranch_scc1 L_fail
    s_waitcnt vmcnt(0)
Lwm_45e:
    v_cmp_eq_u32 vcc, 32, v14
    s_nop 1
    v_add_u32_dpp v14, v14, v14 row_ror:8 row_mask:0xf bank_mask:0xf
    s_nop 1
    v_add_u32_dpp v14, v14, v14 row_ror:4 row_mask:0xf bank_mask:0xf
    s_nop 1
    v_add_u32_dpp v14, v14, v14 row_ror:2 row_mask:0xf bank_mask:0xf
    s_nop 1
    v_add_u32_dpp v14, v14, v14 row_ror:1 row_mask:0xf bank_mask:0xf
    s_nop 0
    v_readfirstlane_b32 s15, v14
    s_nop 3
    s_cmp_lt_u32 s15, 32
    s_cbranch_scc1 Lwm_45
    s_cmp_lg_u64 vcc, 0
    s_cselect_b32 s15, 1, 2
    v_mov_b32 v117, 0x40000000
    s_add_u32 s47, s17, 10240
    s_waitcnt vmcnt(0)
    v_smfmac_f32_16x16x64_bf16 v[68:71], v[16:19], v[200:207], v3
    v_smfmac_f32_16x16x64_bf16 v[68:71], v[20:23], v[208:215], v3
    v_smfmac_f32_16x16x64_bf16 v[68:71], v[24:27], v[216:223], v3
    v_smfmac_f32_16x16x64_bf16 v[68:71], v[28:31], v[224:231], v3
    v_cvt_pk_bf16_f32 v64, v64, v65
    v_cvt_pk_bf16_f32 v65, v66, v67
    ds_write_b64 v8, v[64:65] offset:512
    v_smfmac_f32_16x16x64_bf16 v[68:71], v[32:35], v[232:239], v3
    ds_read_b64_tr_b16 v[60:61], v9 offset:0
    ds_read_b64_tr_b16 v[62:63], v9 offset:512
    v_smfmac_f32_16x16x64_bf16 v[68:71], v[36:39], v[240:247], v3
    v_smfmac_f32_16x16x64_bf16 v[68:71], v[40:43], v[248:255], v3
    v_cmp_le_u32 vcc, 32, v116
    s_nop 1
    v_cndmask_b32 v115, v117, v114, vcc
    buffer_load_dword v0, v115, s[4:7], s19 offen sc1
    s_nop 3
    v_cvt_pk_bf16_f32 v68, v68, v69
    v_cvt_pk_bf16_f32 v69, v70, v71
    ds_write_b64 v8, v[68:69] offset:0
    ds_read_b64_tr_b16 v[68:69], v9 offset:0
    s_waitcnt lgkmcnt(0)
    v_mfma_f32_16x16x32_bf16 v[20:23], v[72:75], v[44:47], 0
    v_mfma_f32_16x16x32_bf16 v[48:51], v[76:79], v[44:47], 0
    v_mfma_f32_16x16x32_bf16 v[16:19], v[100:103], v[44:47], 0
    v_mfma_f32_16x16x32_bf16 v[20:23], v[80:83], v[52:55], v[20:23]
    v_mfma_f32_16x16x32_bf16 v[48:51], v[84:87], v[52:55], v[48:51]
    v_mfma_f32_16x16x32_bf16 v[16:19], v[104:107], v[52:55], v[16:19]
    v_mfma_f32_16x16x32_bf16 v[20:23], v[88:91], v[60:63], v[20:23]
    v_mfma_f32_16x16x32_bf16 v[48:51], v[92:95], v[60:63], v[48:51]
    v_mfma_f32_16x16x32_bf16 v[16:19], v[108:111], v[60:63], v[16:19]
    v_mfma_f32_16x16x16_bf16 v[20:23], v[96:97], v[68:69], v[20:23]
    v_mfma_f32_16x16x16_bf16 v[48:51], v[98:99], v[68:69], v[48:51]
    v_mfma_f32_16x16x16_bf16 v[16:19], v[112:113], v[68:69], v[16:19]
    s_nop 7
    s_branch L_A_mid
    s_branch L_A_loop
.p2align 8
L_A_loop:
    v_mov_b64 v[44:45], 0
    v_mov_b64 v[46:47], 0
    v_mov_b64 v[48:49], 0
    v_mov_b64 v[50:51], 0
    v_mov_b64 v[52:53], 0
    v_mov_b64 v[54:55], 0
    v_mov_b64 v[56:57], 0
    v_mov_b64 v[58:59], 0
    v_mov_b64 v[60:61], 0
    v_mov_b64 v[62:63], 0
    v_mov_b64 v[64:65], 0
    v_mov_b64 v[66:67], 0
    v_mov_b64 v[68:69], 0
    v_mov_b64 v[70:71], 0
    s_add_u32 s47, s17, 10240
    v_add_u32 v108, s52, v2
    v_add_u32 v109, s53, v2
    v_add_u32 v110, s54, v2
    v_add_u32 v111, s55, v2
    v_add_u32 v112, s56, v2
    s_mov_b32 s20, 0
    buffer_load_dwordx4 v[16:19], v118, s[4:7], s16 offen sc1
    buffer_load_dwordx4 v[20:23], v119, s[4:7], s16 offen sc1
    s_sleep 2
Lgalp_46:
    buffer_load_dwordx4 v[100:103], v118, s[4:7], s16 offen sc1
    buffer_load_dwordx4 v[104:107], v119, s[4:7], s16 offen sc1
    s_add_u32 s20, s20, 1
    s_cmp_gt_u32 s20, s23
    s_cbranch_scc1 L_fail
    s_waitcnt vmcnt(3)
    v_max3_u32 v14, v16, v17, v18
    v_max_u32 v14, v14, v19
    s_waitcnt vmcnt(2)
    v_max3_u32 v14, v14, v20, v21
    v_max3_u32 v14, v14, v22, v23
    v_cmp_eq_u32 vcc, -1, v14
    s_cbranch_vccz Lgad0_47
    buffer_load_dwordx4 v[16:19], v118, s[4:7], s16 offen sc1
    buffer_load_dwordx4 v[20:23], v119, s[4:7], s16 offen sc1
    s_waitcnt vmcnt(3)
    v_max3_u32 v14, v100, v101, v102
    v_max_u32 v14, v14, v103
    s_waitcnt vmcnt(2)
    v_max3_u32 v14, v14, v104, v105
    v_max3_u32 v14, v14, v106, v107
    v_cmp_eq_u32 vcc, -1, v14
    s_cbranch_vccnz Lgalp_46x
    v_smfmac_f32_16x16x64_bf16 v[44:47], v[100:103], a[0:7], v3
    ds_write_b128 v118, v[100:103] offset:0
    v_smfmac_f32_16x16x64_bf16 v[48:51], v[100:103], a[56:63], v3
    ds_write_b128 v119, v[104:107] offset:0
    v_smfmac_f32_16x16x64_bf16 v[52:55], v[100:103], a[112:119], v3
    v_cmp_le_u32 vcc, 32, v116
    v_smfmac_f32_16x16x64_bf16 v[56:59], v[100:103], a[168:175], v3
    v_smfmac_f32_16x16x64_bf16 v[60:63], v[100:103], a[224:231], v3
    v_cndmask_b32 v115, v117, v114, vcc
    v_smfmac_f32_16x16x64_bf16 v[64:67], v[100:103], v[144:151], v3
    s_waitcnt lgkmcnt(0)
    s_barrier
    ds_read_b128 v[24:27], v108 offset:0
    v_smfmac_f32_16x16x64_bf16 v[68:71], v[100:103], v[200:207], v3
    ds_read_b128 v[28:31], v109 offset:0
    v_smfmac_f32_16x16x64_bf16 v[44:47], v[104:107], a[8:15], v3
    ds_read_b128 v[32:35], v110 offset:0
    v_smfmac_f32_16x16x64_bf16 v[48:51], v[104:107], a[64:71], v3
    ds_read_b128 v[36:39], v111 offset:0
    v_smfmac_f32_16x16x64_bf16 v[52:55], v[104:107], a[120:127], v3
    ds_read_b128 v[40:43], v112 offset:0
    v_smfmac_f32_16x16x64_bf16 v[56:59], v[104:107], a[176:183], v3
    v_smfmac_f32_16x16x64_bf16 v[60:63], v[104:107], a[232:239], v3
    v_smfmac_f32_16x16x64_bf16 v[64:67], v[104:107], v[152:159], v3
    v_smfmac_f32_16x16x64_bf16 v[68:71], v[104:107], v[208:215], v3
    s_branch Lgadn_49
Lgalp_46x:
    s_branch Lgalp_46
Lgad0_47:
    v_smfmac_f32_16x16x64_bf16 v[44:47], v[16:19], a[0:7], v3
    ds_write_b128 v118, v[16:19] offset:0
    v_smfmac_f32_16x16x64_bf16 v[48:51], v[16:19], a[56:63], v3
    ds_write_b128 v119, v[20:23] offset:0
    v_smfmac_f32_16x16x64_bf16 v[52:55], v[16:19], a[112:119], v3
    v_cmp_le_u32 vcc, 32, v116
    v_smfmac_f32_16x16x64_bf16 v[56:59], v[16:19], a[168:175], v3
    v_smfmac_f32_16x16x64_bf16 v[60:63], v[16:19], a[224:231], v3
    v_cndmask_b32 v115, v117, v114, vcc
    v_smfmac_f32_16x16x64_bf16 v[64:67], v[16:19], v[144:151], v3
    s_waitcnt lgkmcnt(0)
    s_barrier
    ds_read_b128 v[24:27], v108 offset:0
    v_smfmac_f32_16x16x64_bf16 v[68:71], v[16:19], v[200:207], v3
    ds_read_b128 v[28:31], v109 offset:0
    v_smfmac_f32_16x16x64_bf16 v[44:47], v[20:23], a[8:15], v3
    ds_read_b128 v[32:35], v110 offset:0
    v_smfmac_f32_16x16x64_bf16 v[48:51], v[20:23], a[64:71], v3
    ds_read_b128 v[36:39], v111 offset:0
    v_smfmac_f32_16x16x64_bf16 v[52:55], v[20:23], a[120:127], v3
    ds_read_b128 v[40:43], v112 offset:0
    v_smfmac_f32_16x16x64_bf16 v[56:59], v[20:23], a[176:183], v3
    v_smfmac_f32_16x16x64_bf16 v[60:63], v[20:23], a[232:239], v3
    v_smfmac_f32_16x16x64_bf16 v[64:67], v[20:23], v[152:159], v3
    v_smfmac_f32_16x16x64_bf16 v[68:71], v[20:23], v[208:215], v3
Lgadn_49:
    s_waitcnt lgkmcnt(4)
    v_smfmac_f32_16x16x64_bf16 v[44:47], v[24:27], a[16:23], v3
    s_waitcnt lgkmcnt(3)
    v_smfmac_f32_16x16x64_bf16 v[44:47], v[28:31], a[24:31], v3
    s_waitcnt lgkmcnt(2)
    v_smfmac_f32_16x16x64_bf16 v[44:47], v[32:35], a[32:39], v3
    s_waitcnt lgkmcnt(1)
    v_smfmac_f32_16x16x64_bf16 v[44:47], v[36:39], a[40:47], v3
    s_waitcnt lgkmcnt(0)
    v_smfmac_f32_16x16x64_bf16 v[44:47], v[40:43], a[48:55], v3
    s_waitcnt vmcnt(0)
    ds_read_b128 v[100:103], v6 offset:0
    v_smfmac_f32_16x16x64_bf16 v[48:51], v[24:27], a[72:79], v3
    ds_read_b128 v[104:107], v6 offset:512
    v_smfmac_f32_16x16x64_bf16 v[48:51], v[28:31], a[80:87], v3
    ds_read_b128 v[108:111], v6 offset:1024
    v_smfmac_f32_16x16x64_bf16 v[48:51], v[32:35], a[88:95], v3
    v_cvt_pk_bf16_f32 v44, v44, v45
    v_smfmac_f32_16x16x64_bf16 v[48:51], v[36:39], a[96:103], v3
    v_cvt_pk_bf16_f32 v45, v46, v47
    v_smfmac_f32_16x16x64_bf16 v[48:51], v[40:43], a[104:111], v3
    ds_write_b64 v8, v[44:45] offset:0
    v_smfmac_f32_16x16x64_bf16 v[52:55], v[24:27], a[128:135], v3
    buffer_load_dword v0, v115, s[4:7], s19 offen sc1
    v_smfmac_f32_16x16x64_bf16 v[52:55], v[28:31], a[136:143], v3
    ds_read_b64 v[112:113], v7 offset:0
    v_smfmac_f32_16x16x64_bf16 v[52:55], v[32:35], a[144:151], v3
    v_cvt_pk_bf16_f32 v48, v48, v49
    v_smfmac_f32_16x16x64_bf16 v[52:55], v[36:39], a[152:159], v3
    v_cvt_pk_bf16_f32 v49, v50, v51
    v_smfmac_f32_16x16x64_bf16 v[52:55], v[40:43], a[160:167], v3
    ds_write_b64 v8, v[48:49] offset:512
    ds_read_b64_tr_b16 v[44:45], v9 offset:0
    ds_read_b64_tr_b16 v[46:47], v9 offset:512
    v_smfmac_f32_16x16x64_bf16 v[56:59], v[24:27], a[184:191], v3
    v_cndmask_b32 v14, v1, 0, s[48:49]
    v_smfmac_f32_16x16x64_bf16 v[56:59], v[28:31], a[192:199], v3
    v_cndmask_b32 v15, 0, v1, s[48:49]
    v_smfmac_f32_16x16x64_bf16 v[56:59], v[32:35], a[200:207], v3
    v_cvt_pk_bf16_f32 v52, v52, v53
    v_smfmac_f32_16x16x64_bf16 v[56:59], v[36:39], a[208:215], v3
    v_cvt_pk_bf16_f32 v53, v54, v55
    v_smfmac_f32_16x16x64_bf16 v[56:59], v[40:43], a[216:223], v3
    ds_write_b64 v8, v[52:53] offset:0
    v_smfmac_f32_16x16x64_bf16 v[60:63], v[24:27], a[240:247], v3
    v_smfmac_f32_16x16x64_bf16 v[60:63], v[28:31], a[248:255], v3
    v_smfmac_f32_16x16x64_bf16 v[60:63], v[32:35], v[120:127], v3
    v_cvt_pk_bf16_f32 v56, v56, v57
    v_smfmac_f32_16x16x64_bf16 v[60:63], v[36:39], v[128:135], v3
    v_cvt_pk_bf16_f32 v57, v58, v59
    v_smfmac_f32_16x16x64_bf16 v[60:63], v[40:43], v[136:143], v3
    ds_write_b64 v8, v[56:57] offset:512
    ds_read_b64_tr_b16 v[52:53], v9 offset:0
    ds_read_b64_tr_b16 v[54:55], v9 offset:512
    s_waitcnt lgkmcnt(4)
    v_mfma_f32_16x16x32_bf16 v[16:19], v[100:103], v[44:47], 0
    v_mfma_f32_16x16x32_bf16 v[20:23], v[72:75], v[44:47], 0
    v_mfma_f32_16x16x32_bf16 v[48:51], v[76:79], v[44:47], 0
    v_smfmac_f32_16x16x64_bf16 v[64:67], v[24:27], v[160:167], v3
    v_smfmac_f32_16x16x64_bf16 v[64:67], v[28:31], v[168:175], v3
    v_smfmac_f32_16x16x64_bf16 v[64:67], v[32:35], v[176:183], v3
    v_cvt_pk_bf16_f32 v60, v60, v61
    v_smfmac_f32_16x16x64_bf16 v[64:67], v[36:39], v[184:191], v3
    v_cvt_pk_bf16_f32 v61, v62, v63
    v_smfmac_f32_16x16x64_bf16 v[64:67], v[40:43], v[192:199], v3
    ds_write_b64 v8, v[60:61] offset:0
    v_smfmac_f32_16x16x64_bf16 v[68:71], v[24:27], v[216:223], v3
    v_smfmac_f32_16x16x64_bf16 v[68:71], v[28:31], v[224:231], v3
    v_smfmac_f32_16x16x64_bf16 v[68:71], v[32:35], v[232:239], v3
    v_cvt_pk_bf16_f32 v64, v64, v65
    v_cvt_pk_bf16_f32 v65, v66, v67
    v_smfmac_f32_16x16x64_bf16 v[68:71], v[36:39], v[240:247], v3
    ds_write_b64 v8, v[64:65] offset:512
    v_smfmac_f32_16x16x64_bf16 v[68:71], v[40:43], v[248:255], v3
    ds_read_b64_tr_b16 v[60:61], v9 offset:0
    ds_read_b64_tr_b16 v[62:63], v9 offset:512
    s_waitcnt lgkmcnt(4)
    v_mfma_f32_16x16x32_bf16 v[16:19], v[104:107], v[52:55], v[16:19]
    v_mfma_f32_16x16x32_bf16 v[20:23], v[80:83], v[52:55], v[20:23]
    v_mfma_f32_16x16x32_bf16 v[48:51], v[84:87], v[52:55], v[48:51]
    v_cvt_pk_bf16_f32 v68, v68, v69
    v_cvt_pk_bf16_f32 v69, v70, v71
    s_waitcnt lgkmcnt(0)
    s_nop 0
    v_mfma_f32_16x16x16_bf16 v[56:59], v[68:69], v[14:15], 0
    v_mfma_f32_16x16x32_bf16 v[16:19], v[108:111], v[60:63], v[16:19]
    v_mfma_f32_16x16x32_bf16 v[20:23], v[88:91], v[60:63], v[20:23]
    v_mfma_f32_16x16x32_bf16 v[48:51], v[92:95], v[60:63], v[48:51]
    v_cvt_pk_bf16_f32 v68, v56, v57
    v_cvt_pk_bf16_f32 v69, v58, v59
    s_nop 1
    v_mfma_f32_16x16x16_bf16 v[20:23], v[96:97], v[68:69], v[20:23]
    v_mfma_f32_16x16x16_bf16 v[48:51], v[98:99], v[68:69], v[48:51]
    v_mfma_f32_16x16x16_bf16 v[16:19], v[112:113], v[68:69], v[16:19]
L_A_mid:
    s_nop 1
    v_add_f32_dpp v52, v20, v20 row_ror:8 row_mask:0xf bank_mask:0x3
    v_add_f32_dpp v53, v21, v21 row_ror:8 row_mask:0xf bank_mask:0x3
    v_add_f32_dpp v54, v22, v22 row_ror:8 row_mask:0xf bank_mask:0x3
    v_add_f32_dpp v55, v23, v23 row_ror:8 row_mask:0xf bank_mask:0x3
    v_add_f32_dpp v52, v48, v48 row_ror:8 row_mask:0xf bank_mask:0xc
    v_add_f32_dpp v53, v49, v49 row_ror:8 row_mask:0xf bank_mask:0xc
    v_add_f32_dpp v54, v50, v50 row_ror:8 row_mask:0xf bank_mask:0xc
    v_add_f32_dpp v55, v51, v51 row_ror:8 row_mask:0xf bank_mask:0xc
    ds_write_b128 v10, v[52:55] offset:576
    v_add_f32_dpp v56, v16, v16 row_ror:8 row_mask:0xf bank_mask:0xf
    v_add_f32_dpp v57, v17, v17 row_ror:8 row_mask:0xf bank_mask:0xf
    ds_write_b64 v13, v[56:57]
    s_waitcnt lgkmcnt(0)
    s_barrier
    ds_read_b64 v[60:61], v11 offset:0
    ds_read_b64 v[62:63], v11 offset:4096
    ds_read_b64 v[64:65], v11 offset:8192
    ds_read_b64 v[66:67], v11 offset:12288
    s_cmp_eq_u32 s15, 1
    s_waitcnt lgkmcnt(2)
    v_pk_add_f32 v[56:57], v[60:61], v[62:63]
    s_waitcnt lgkmcnt(1)
    v_pk_add_f32 v[56:57], v[56:57], v[64:65]
    s_waitcnt lgkmcnt(0)
    v_pk_add_f32 v[56:57], v[56:57], v[66:67]
    v_max_f32 v58, v56, v57
    s_nop 1
    v_max_f32_dpp v58, v58, v58 row_ror:8 row_mask:0xf bank_mask:0xf
    s_nop 1
    v_max_f32_dpp v58, v58, v58 row_ror:4 row_mask:0xf bank_mask:0xf
    s_nop 1
    v_max_f32_dpp v58, v58, v58 row_ror:2 row_mask:0xf bank_mask:0xf
    s_nop 1
    v_max_f32_dpp v58, v58, v58 row_ror:1 row_mask:0xf bank_mask:0xf
    v_mov_b32 v60, v58
    s_nop 1
    v_permlane16_swap_b32 v58, v60
    v_max_f32 v58, v58, v60
    v_pk_add_f32 v[56:57], v[56:57], v[58:59] op_sel_hi:[1,0] neg_lo:[0,1] neg_hi:[0,1]
    v_exp_f32 v56, v56
    v_exp_f32 v57, v57
    s_nop 0
    v_add_f32 v58, v56, v57
    s_nop 1
    v_add_f32_dpp v58, v58, v58 row_ror:8 row_mask:0xf bank_mask:0xf
    s_nop 1
    v_add_f32_dpp v58, v58, v58 row_ror:4 row_mask:0xf bank_mask:0xf
    s_nop 1
    v_add_f32_dpp v58, v58, v58 row_ror:2 row_mask:0xf bank_mask:0xf
    s_nop 1
    v_add_f32_dpp v58, v58, v58 row_ror:1 row_mask:0xf bank_mask:0xf
    v_mov_b32 v60, v58
    s_nop 1
    v_permlane16_swap_b32 v58, v60
    v_add_f32 v58, v58, v60
    v_rcp_f32 v58, v58
    s_nop 0
    v_pk_mul_f32 v[56:57], v[56:57], v[58:59] op_sel_hi:[1,0]
    v_cvt_pk_bf16_f32 v56, v56, v57
    v_min_u32 v56, -2, v56
    buffer_store_dword v56, v12, s[4:7], s17 offen
    s_cbranch_scc0 Lslow_50
Lpub_51:
    s_barrier
    s_nop 0
    s_nop 0
    s_cmp_eq_u32 s14, 62
    s_cbranch_scc1 Lae_52
    s_add_u32 s21, s14, 3
    v_cmp_gt_u32 vcc, 32, v116
    s_and_b32 s22, s21, 3
    s_cselect_b32 s22, 0, 1
    s_or_b32 s22, s22, vcc_lo
    s_cbranch_scc0 Llf_53
    s_lshr_b32 s21, s21, 2
    s_lshl_b32 s21, s21, 7
    s_add_u32 s21, s21, 67678208
    buffer_load_dword v116, off, s[4:7], s21 sc1
Llf_53:
    s_sleep 6
    buffer_load_dwordx4 v[72:75], v4, s[4:7], s18 offen offset:0
    buffer_load_dwordx4 v[76:79], v4, s[4:7], s46 offen offset:0
    buffer_load_dwordx4 v[80:83], v4, s[4:7], s18 offen offset:1024
    buffer_load_dwordx4 v[84:87], v4, s[4:7], s46 offen offset:1024
    buffer_load_dwordx4 v[88:91], v4, s[4:7], s18 offen offset:2048
    buffer_load_dwordx4 v[92:95], v4, s[4:7], s46 offen offset:2048
    buffer_load_dwordx2 v[96:97], v5, s[4:7], s18 offen
    buffer_load_dwordx2 v[98:99], v5, s[4:7], s46 offen
    s_add_u32 s18, s18, 28672
    s_add_u32 s46, s18, 14336
Lae_52:
    s_add_u32 s19, s19, 458752
    s_add_u32 s16, s16, 7168
    s_add_u32 s17, s17, 10240
    s_add_u32 s14, s14, 1
    s_cmp_lt_u32 s14, 63
    s_cbranch_scc1 L_A_loop
    s_cmp_ge_u32 s13, 2
    s_cbranch_scc1 L_exit
    s_waitcnt vmcnt(0)
    v_lshrrev_b32 v1, 4, v2
    s_mov_b32 s40, 67680256
    s_mov_b32 s20, 0
Lwf_54:
    buffer_load_dword v8, off, s[4:7], s40 sc1
    s_add_u32 s20, s20, 1
    s_cmp_gt_u32 s20, s23
    s_cbranch_scc1 L_fail
    s_waitcnt vmcnt(0)
    v_cmp_le_u32 vcc, 32, v8
    s_cbranch_vccnz Lwfd_55
    s_sleep 1
    s_branch Lwf_54
Lwfd_55:
    s_mul_i32 s40, s26, 28672
    s_mul_i32 s41, s13, 14336
    s_add_u32 s40, s40, s41
    s_add_u32 s40, s40, 47710208
    buffer_load_dwordx4 a[0:3], v2, s[4:7], s40 offen offset:0 sc1
    buffer_load_dwordx4 a[4:7], v2, s[4:7], s40 offen offset:1024 sc1
    buffer_load_dwordx4 a[8:11], v2, s[4:7], s40 offen offset:2048 sc1
    buffer_load_dwordx4 a[12:15], v2, s[4:7], s40 offen offset:3072 sc1
    s_add_u32 s40, s40, 4096
    buffer_load_dwordx4 a[16:19], v2, s[4:7], s40 offen offset:0 sc1
    buffer_load_dwordx4 a[20:23], v2, s[4:7], s40 offen offset:1024 sc1
    buffer_load_dwordx4 a[24:27], v2, s[4:7], s40 offen offset:2048 sc1
    buffer_load_dwordx4 a[28:31], v2, s[4:7], s40 offen offset:3072 sc1
    s_add_u32 s40, s40, 4096
    buffer_load_dwordx4 a[32:35], v2, s[4:7], s40 offen offset:0 sc1
    buffer_load_dwordx4 a[36:39], v2, s[4:7], s40 offen offset:1024 sc1
    buffer_load_dwordx4 a[40:43], v2, s[4:7], s40 offen offset:2048 sc1
    buffer_load_dwordx4 a[44:47], v2, s[4:7], s40 offen offset:3072 sc1
    s_add_u32 s40, s40, 4096
    buffer_load_dwordx4 a[48:51], v2, s[4:7], s40 offen offset:0 sc1
    buffer_load_dwordx4 a[52:55], v2, s[4:7], s40 offen offset:1024 sc1
    v_and_b32 v7, 0x310, v2
    v_bfe_u32 v5, v1, 1, 2
    v_lshl_add_u32 v7, v5, 6, v7
    v_bfe_u32 v5, v1, 3, 1
    v_lshl_add_u32 v7, v5, 5, v7
    s_mov_b32 s40, 16486400
    buffer_load_dwordx4 v[16:19], v7, s[4:7], s40 offen offset:0
    buffer_load_dwordx4 v[20:23], v7, s[4:7], s40 offen offset:1024
    buffer_load_dwordx4 v[24:27], v7, s[4:7], s40 offen offset:2048
    buffer_load_dwordx4 v[28:31], v7, s[4:7], s40 offen offset:3072
    s_add_u32 s40, s40, 4096
    buffer_load_dwordx4 v[32:35], v7, s[4:7], s40 offen offset:0
    buffer_load_dwordx4 v[36:39], v7, s[4:7], s40 offen offset:1024
    buffer_load_dwordx4 v[40:43], v7, s[4:7], s40 offen offset:2048
    buffer_load_dwordx4 v[44:47], v7, s[4:7], s40 offen offset:3072
    s_add_u32 s40, s40, 4096
    buffer_load_dwordx4 v[48:51], v7, s[4:7], s40 offen offset:0
    buffer_load_dwordx4 v[52:55], v7, s[4:7], s40 offen offset:1024
    buffer_load_dwordx4 v[56:59], v7, s[4:7], s40 offen offset:2048
    buffer_load_dwordx4 v[60:63], v7, s[4:7], s40 offen offset:3072
    s_add_u32 s40, s40, 4096
    buffer_load_dwordx4 v[64:67], v7, s[4:7], s40 offen offset:0
    buffer_load_dwordx4 v[68:71], v7, s[4:7], s40 offen offset:1024
    buffer_load_dwordx4 v[72:75], v7, s[4:7], s40 offen offset:2048
    buffer_load_dwordx4 v[76:79], v7, s[4:7], s40 offen offset:3072
    s_add_u32 s40, s40, 4096
    buffer_load_dwordx4 v[80:83], v7, s[4:7], s40 offen offset:0
    buffer_load_dwordx4 v[84:87], v7, s[4:7], s40 offen offset:1024
    buffer_load_dwordx4 v[88:91], v7, s[4:7], s40 offen offset:2048
    buffer_load_dwordx4 v[92:95], v7, s[4:7], s40 offen offset:3072
    s_add_u32 s40, s40, 4096
    buffer_load_dwordx4 v[96:99], v7, s[4:7], s40 offen offset:0
    buffer_load_dwordx4 v[100:103], v7, s[4:7], s40 offen offset:1024
    buffer_load_dwordx4 v[104:107], v7, s[4:7], s40 offen offset:2048
    buffer_load_dwordx4 v[108:111], v7, s[4:7], s40 offen offset:3072
    s_add_u32 s40, s40, 4096
    buffer_load_dwordx4 v[112:115], v7, s[4:7], s40 offen offset:0
    buffer_load_dwordx4 v[116:119], v7, s[4:7], s40 offen offset:1024
    buffer_load_dwordx4 v[120:123], v7, s[4:7], s40 offen offset:2048
    buffer_load_dwordx4 v[124:127], v7, s[4:7], s40 offen offset:3072
    s_add_u32 s40, s40, 4096
    v_lshrrev_b32 v4, 4, v1
    v_and_b32 v5, 15, v1
    v_lshrrev_b32 v6, 1, v4
    v_lshlrev_b32 v6, 8, v6
    v_and_b32 v8, 7, v5
    v_lshl_add_u32 v6, v8, 4, v6
    v_and_b32 v8, 1, v4
    v_lshl_add_u32 v6, v8, 7, v6
    s_lshl_b32 s41, s13, 4
    v_add_u32 v5, s41, v5
    v_lshlrev_b32 v8, 2, v4
    v_add_u32 v9, 0, v8
    v_cmp_gt_u32 s[60:61], v9, v5
    v_add_u32 v9, 1, v8
    v_cmp_gt_u32 s[62:63], v9, v5
    v_add_u32 v9, 2, v8
    v_cmp_gt_u32 s[64:65], v9, v5
    v_add_u32 v9, 3, v8
    v_cmp_gt_u32 s[66:67], v9, v5
    v_add_u32 v9, 16, v8
    v_cmp_gt_u32 s[68:69], v9, v5
    v_add_u32 v9, 17, v8
    v_cmp_gt_u32 s[70:71], v9, v5
    v_add_u32 v9, 18, v8
    v_cmp_gt_u32 s[72:73], v9, v5
    v_add_u32 v9, 19, v8
    v_cmp_gt_u32 s[74:75], v9, v5
    v_cmp_gt_u32 s[76:77], 2, v4
    s_mov_b32 s42, 67518464
    s_lshl_b32 s43, s13, 10
    s_add_u32 s42, s42, s43
    s_lshl_b32 s43, s26, 11
    s_add_u32 s43, s43, s42
    s_lshr_b32 s44, s26, 1
    s_lshl_b32 s44, s44, 11
    s_and_b32 s45, s26, 1
    s_lshl_b32 s45, s45, 2
    s_add_u32 s44, s44, s45
    s_add_u32 s44, s44, s42
    s_add_u32 s44, s44, 32768
    v_mov_b32 v10, 0xff800000
    s_waitcnt vmcnt(0)
    v_mfma_f32_16x16x32_bf16 v[188:191], v[16:19], a[0:3], 0
    v_mfma_f32_16x16x32_bf16 v[192:195], v[72:75], a[0:3], 0
    v_mfma_f32_16x16x32_bf16 v[188:191], v[20:23], a[4:7], v[188:191]
    v_mfma_f32_16x16x32_bf16 v[192:195], v[76:79], a[4:7], v[192:195]
    v_mfma_f32_16x16x32_bf16 v[188:191], v[24:27], a[8:11], v[188:191]
    v_mfma_f32_16x16x32_bf16 v[192:195], v[80:83], a[8:11], v[192:195]
    v_mfma_f32_16x16x32_bf16 v[188:191], v[28:31], a[12:15], v[188:191]
    v_mfma_f32_16x16x32_bf16 v[192:195], v[84:87], a[12:15], v[192:195]
    v_mfma_f32_16x16x32_bf16 v[188:191], v[32:35], a[16:19], v[188:191]
    v_mfma_f32_16x16x32_bf16 v[192:195], v[88:91], a[16:19], v[192:195]
    v_mfma_f32_16x16x32_bf16 v[188:191], v[36:39], a[20:23], v[188:191]
    v_mfma_f32_16x16x32_bf16 v[192:195], v[92:95], a[20:23], v[192:195]
    v_mfma_f32_16x16x32_bf16 v[188:191], v[40:43], a[24:27], v[188:191]
    v_mfma_f32_16x16x32_bf16 v[192:195], v[96:99], a[24:27], v[192:195]
    v_mfma_f32_16x16x32_bf16 v[188:191], v[44:47], a[28:31], v[188:191]
    v_mfma_f32_16x16x32_bf16 v[192:195], v[100:103], a[28:31], v[192:195]
    v_mfma_f32_16x16x32_bf16 v[188:191], v[48:51], a[32:35], v[188:191]
    v_mfma_f32_16x16x32_bf16 v[192:195], v[104:107], a[32:35], v[192:195]
    v_mfma_f32_16x16x32_bf16 v[188:191], v[52:55], a[36:39], v[188:191]
    v_mfma_f32_16x16x32_bf16 v[192:195], v[108:111], a[36:39], v[192:195]
    v_mfma_f32_16x16x32_bf16 v[188:191], v[56:59], a[40:43], v[188:191]
    v_mfma_f32_16x16x32_bf16 v[192:195], v[112:115], a[40:43], v[192:195]
    v_mfma_f32_16x16x32_bf16 v[188:191], v[60:63], a[44:47], v[188:191]
    v_mfma_f32_16x16x32_bf16 v[192:195], v[116:119], a[44:47], v[192:195]
    v_mfma_f32_16x16x32_bf16 v[188:191], v[64:67], a[48:51], v[188:191]
    v_mfma_f32_16x16x32_bf16 v[192:195], v[120:123], a[48:51], v[192:195]
    v_mfma_f32_16x16x32_bf16 v[188:191], v[68:71], a[52:55], v[188:191]
    v_mfma_f32_16x16x32_bf16 v[192:195], v[124:127], a[52:55], v[192:195]
    s_add_u32 s41, s16, 4096
    s_mov_b32 s20, 0
Ltm_56:
    buffer_load_dwordx4 v[128:131], v6, s[4:7], s16 offen offset:0 sc1
    buffer_load_dwordx4 v[132:135], v6, s[4:7], s16 offen offset:512 sc1
    buffer_load_dwordx4 v[136:139], v6, s[4:7], s16 offen offset:1024 sc1
    buffer_load_dwordx4 v[140:143], v6, s[4:7], s16 offen offset:1536 sc1
    buffer_load_dwordx4 v[144:147], v6, s[4:7], s16 offen offset:2048 sc1
    buffer_load_dwordx4 v[148:151], v6, s[4:7], s16 offen offset:2560 sc1
    buffer_load_dwordx4 v[152:155], v6, s[4:7], s16 offen offset:3072 sc1
    buffer_load_dwordx4 v[156:159], v6, s[4:7], s16 offen offset:3584 sc1
    buffer_load_dwordx4 v[160:163], v6, s[4:7], s41 offen offset:0 sc1
    buffer_load_dwordx4 v[164:167], v6, s[4:7], s41 offen offset:512 sc1
    buffer_load_dwordx4 v[168:171], v6, s[4:7], s41 offen offset:1024 sc1
    buffer_load_dwordx4 v[172:175], v6, s[4:7], s41 offen offset:1536 sc1
    buffer_load_dwordx4 v[176:179], v6, s[4:7], s41 offen offset:2048 sc1
    buffer_load_dwordx4 v[180:183], v6, s[4:7], s41 offen offset:2560 sc1
    s_add_u32 s20, s20, 1
    s_cmp_gt_u32 s20, s23
    s_cbranch_scc1 L_fail
    s_waitcnt vmcnt(13)
    v_max3_u32 v8, v128, v129, v130
    v_max_u32 v8, v8, v131
    s_waitcnt vmcnt(12)
    v_max3_u32 v8, v8, v132, v133
    v_max3_u32 v8, v8, v134, v135
    s_waitcnt vmcnt(11)
    v_max3_u32 v8, v8, v136, v137
    v_max3_u32 v8, v8, v138, v139
    s_waitcnt vmcnt(10)
    v_max3_u32 v8, v8, v140, v141
    v_max3_u32 v8, v8, v142, v143
    s_waitcnt vmcnt(9)
    v_max3_u32 v8, v8, v144, v145
    v_max3_u32 v8, v8, v146, v147
    s_waitcnt vmcnt(8)
    v_max3_u32 v8, v8, v148, v149
    v_max3_u32 v8, v8, v150, v151
    s_waitcnt vmcnt(7)
    v_max3_u32 v8, v8, v152, v153
    v_max3_u32 v8, v8, v154, v155
    s_waitcnt vmcnt(6)
    v_max3_u32 v8, v8, v156, v157
    v_max3_u32 v8, v8, v158, v159
    s_waitcnt vmcnt(5)
    v_max3_u32 v8, v8, v160, v161
    v_max3_u32 v8, v8, v162, v163
    s_waitcnt vmcnt(4)
    v_max3_u32 v8, v8, v164, v165
    v_max3_u32 v8, v8, v166, v167
    s_waitcnt vmcnt(3)
    v_max3_u32 v8, v8, v168, v169
    v_max3_u32 v8, v8, v170, v171
    s_waitcnt vmcnt(2)
    v_max3_u32 v8, v8, v172, v173
    v_max3_u32 v8, v8, v174, v175
    s_waitcnt vmcnt(1)
    v_max3_u32 v8, v8, v176, v177
    v_max3_u32 v8, v8, v178, v179
    s_waitcnt vmcnt(0)
    v_max3_u32 v8, v8, v180, v181
    v_max3_u32 v8, v8, v182, v183
    v_cmp_eq_u32 vcc, -1, v8
    s_cbranch_vccnz Ltm_56
    v_mfma_f32_16x16x32_bf16 v[184:187], v[128:131], a[0:3], 0
    v_cndmask_b32 v188, v188, v10, s[60:61]
    v_mfma_f32_16x16x32_bf16 v[184:187], v[132:135], a[4:7], v[184:187]
    v_cndmask_b32 v189, v189, v10, s[62:63]
    v_mfma_f32_16x16x32_bf16 v[184:187], v[136:139], a[8:11], v[184:187]
    v_cndmask_b32 v190, v190, v10, s[64:65]
    v_mfma_f32_16x16x32_bf16 v[184:187], v[140:143], a[12:15], v[184:187]
    v_cndmask_b32 v191, v191, v10, s[66:67]
    v_mfma_f32_16x16x32_bf16 v[184:187], v[144:147], a[16:19], v[184:187]
    v_cndmask_b32 v192, v192, v10, s[68:69]
    v_mfma_f32_16x16x32_bf16 v[184:187], v[148:151], a[20:23], v[184:187]
    v_cndmask_b32 v193, v193, v10, s[70:71]
    v_mfma_f32_16x16x32_bf16 v[184:187], v[152:155], a[24:27], v[184:187]
    v_cndmask_b32 v194, v194, v10, s[72:73]
    v_mfma_f32_16x16x32_bf16 v[184:187], v[156:159], a[28:31], v[184:187]
    v_cndmask_b32 v195, v195, v10, s[74:75]
    v_mfma_f32_16x16x32_bf16 v[184:187], v[160:163], a[32:35], v[184:187]
    v_mfma_f32_16x16x32_bf16 v[184:187], v[164:167], a[36:39], v[184:187]
    v_mfma_f32_16x16x32_bf16 v[184:187], v[168:171], a[40:43], v[184:187]
    v_mfma_f32_16x16x32_bf16 v[184:187], v[172:175], a[44:47], v[184:187]
    v_mfma_f32_16x16x32_bf16 v[184:187], v[176:179], a[48:51], v[184:187]
    v_mfma_f32_16x16x32_bf16 v[184:187], v[180:183], a[52:55], v[184:187]
    v_max3_f32 v10, v188, v189, v190
    v_max3_f32 v10, v10, v191, v192
    v_max3_f32 v10, v10, v193, v194
    v_max_f32 v10, v10, v195
    s_nop 3
    v_max3_f32 v10, v10, v184, v185
    v_max3_f32 v10, v10, v186, v187
    v_mov_b32 v12, v10
    s_nop 1
    v_permlane16_swap_b32 v10, v12
    v_max_f32 v10, v10, v12
    v_mov_b32 v12, v10
    s_nop 1
    v_permlane32_swap_b32 v10, v12
    v_max_f32 v10, v10, v12
    v_pk_add_f32 v[184:185], v[184:185], v[10:11] op_sel_hi:[1,0] neg_lo:[0,1] neg_hi:[0,1]
    v_pk_add_f32 v[186:187], v[186:187], v[10:11] op_sel_hi:[1,0] neg_lo:[0,1] neg_hi:[0,1]
    v_pk_add_f32 v[188:189], v[188:189], v[10:11] op_sel_hi:[1,0] neg_lo:[0,1] neg_hi:[0,1]
    v_pk_add_f32 v[190:191], v[190:191], v[10:11] op_sel_hi:[1,0] neg_lo:[0,1] neg_hi:[0,1]
    v_pk_add_f32 v[192:193], v[192:193], v[10:11] op_sel_hi:[1,0] neg_lo:[0,1] neg_hi:[0,1]
    v_pk_add_f32 v[194:195], v[194:195], v[10:11] op_sel_hi:[1,0] neg_lo:[0,1] neg_hi:[0,1]
    v_exp_f32 v184, v184
    v_exp_f32 v185, v185
    v_exp_f32 v186, v186
    v_exp_f32 v187, v187
    v_exp_f32 v188, v188
    v_exp_f32 v189, v189
    v_exp_f32 v190, v190
    v_exp_f32 v191, v191
    v_exp_f32 v192, v192
    v_exp_f32 v193, v193
    v_exp_f32 v194, v194
    v_exp_f32 v195, v195
    s_nop 0
    v_pk_add_f32 v[14:15], v[184:185], v[186:187]
    v_add_f32 v14, v14, v15
    v_cndmask_b32 v14, 0, v14, s[76:77]
    v_mov_b32 v15, 0
    v_pk_add_f32 v[14:15], v[14:15], v[188:189]
    v_pk_add_f32 v[14:15], v[14:15], v[190:191]
    v_pk_add_f32 v[14:15], v[14:15], v[192:193]
    v_pk_add_f32 v[14:15], v[14:15], v[194:195]
    v_add_f32 v14, v14, v15
    v_mov_b32 v12, v14
    s_nop 1
    v_permlane16_swap_b32 v14, v12
    v_add_f32 v14, v14, v12
    v_mov_b32 v12, v14
    s_nop 1
    v_permlane32_swap_b32 v14, v12
    v_add_f32 v14, v14, v12
    v_rcp_f32 v14, v14
    s_nop 0
    v_pk_mul_f32 v[184:185], v[184:185], v[14:15] op_sel_hi:[1,0]
    v_pk_mul_f32 v[186:187], v[186:187], v[14:15] op_sel_hi:[1,0]
    v_pk_mul_f32 v[188:189], v[188:189], v[14:15] op_sel_hi:[1,0]
    v_pk_mul_f32 v[190:191], v[190:191], v[14:15] op_sel_hi:[1,0]
    v_pk_mul_f32 v[192:193], v[192:193], v[14:15] op_sel_hi:[1,0]
    v_pk_mul_f32 v[194:195], v[194:195], v[14:15] op_sel_hi:[1,0]
    v_cvt_pk_bf16_f32 v196, v188, v189
    v_min_u32 v196, -2, v196
    v_cvt_pk_bf16_f32 v197, v190, v191
    v_min_u32 v197, -2, v197
    v_cvt_pk_bf16_f32 v198, v192, v193
    v_min_u32 v198, -2, v198
    v_cvt_pk_bf16_f32 v199, v194, v195
    v_min_u32 v199, -2, v199
    v_cvt_pk_bf16_f32 v200, v184, v185
    v_min_u32 v200, -2, v200
    v_cvt_pk_bf16_f32 v201, v186, v187
    v_min_u32 v201, -2, v201
    buffer_store_dwordx4 v[196:199], v2, s[4:7], s43 offen sc1
    buffer_store_dword v200, v2, s[4:7], s44 offen sc1
    buffer_store_dword v201, v2, s[4:7], s44 offen offset:8 sc1
    s_waitcnt vmcnt(0)
    s_endpgm
Lslow_50:
    buffer_store_dword v56, v12, s[4:7], s17 offen sc1
    s_branch Lpub_51
L_roleB:
    s_sub_u32 s26, s12, 16
    v_and_b32 v1, 63, v0
    v_lshlrev_b32 v2, 4, v1
    s_lshl_b32 s21, s13, 10
    v_add_u32 v3, s21, v2
    s_add_u32 s21, s13, 4
    s_min_u32 s21, s21, 6
    s_lshl_b32 s21, s21, 10
    v_add_u32 v4, s21, v2
    v_and_b32 v12, 8, v1
    v_mov_b32 v5, 0x4444
    v_mov_b32 v13, 0xeeee
    v_cmp_ne_u32 vcc, 0, v12
    s_nop 1
    v_cndmask_b32 v5, v5, v13, vcc
    s_mov_b32 s23, 400000
    s_lshl_b32 s21, s13, 2
    s_mul_i32 s21, s21, 28
    s_lshl_b32 s22, s26, 1
    s_add_u32 s21, s21, s22
    s_mul_i32 s35, s21, 14336
    s_add_u32 s35, s35, 6422528
    s_lshl_b32 s37, s13, 15
    s_add_u32 s37, s37, 16384
    v_add_u32 v6, s37, v2
    s_add_u32 s50, s13, 0
    s_sub_u32 s40, s50, 7
    s_cmp_ge_u32 s50, 7
    s_cselect_b32 s50, s40, s50
    s_lshl_b32 s50, s50, 10
    s_add_u32 s51, s13, 4
    s_sub_u32 s40, s51, 7
    s_cmp_ge_u32 s51, 7
    s_cselect_b32 s51, s40, s51
    s_lshl_b32 s51, s51, 10
    s_add_u32 s52, s13, 1
    s_sub_u32 s40, s52, 7
    s_cmp_ge_u32 s52, 7
    s_cselect_b32 s52, s40, s52
    s_lshl_b32 s52, s52, 10
    s_add_u32 s53, s13, 5
    s_sub_u32 s40, s53, 7
    s_cmp_ge_u32 s53, 7
    s_cselect_b32 s53, s40, s53
    s_lshl_b32 s53, s53, 10
    s_add_u32 s54, s13, 2
    s_sub_u32 s40, s54, 7
    s_cmp_ge_u32 s54, 7
    s_cselect_b32 s54, s40, s54
    s_lshl_b32 s54, s54, 10
    s_add_u32 s55, s13, 6
    s_sub_u32 s40, s55, 7
    s_cmp_ge_u32 s55, 7
    s_cselect_b32 s55, s40, s55
    s_lshl_b32 s55, s55, 10
    s_add_u32 s56, s13, 3
    s_sub_u32 s40, s56, 7
    s_cmp_ge_u32 s56, 7
    s_cselect_b32 s56, s40, s56
    s_lshl_b32 s56, s56, 10
    s_lshl_b32 s18, s26, 15
    s_lshl_b32 s40, s13, 13
    s_add_u32 s18, s18, s40
    s_add_u32 s18, s18, 18350080
    v_add_u32 v4, s51, v2
    s_add_u32 s40, s50, 62849024
    buffer_load_dwordx4 v[16:19], v2, s[4:7], s40 offen
    s_add_u32 s40, s51, 62849024
    buffer_load_dwordx4 v[20:23], v2, s[4:7], s40 offen
    s_add_u32 s40, s52, 62849024
    buffer_load_dwordx4 v[24:27], v2, s[4:7], s40 offen
    s_add_u32 s40, s53, 62849024
    buffer_load_dwordx4 v[28:31], v2, s[4:7], s40 offen
    s_add_u32 s40, s54, 62849024
    buffer_load_dwordx4 v[32:35], v2, s[4:7], s40 offen
    s_add_u32 s40, s55, 62849024
    buffer_load_dwordx4 v[36:39], v2, s[4:7], s40 offen
    s_add_u32 s40, s56, 62849024
    buffer_load_dwordx4 v[40:43], v2, s[4:7], s40 offen
    v_mov_b64 v[44:45], 0
    v_mov_b64 v[46:47], 0
    v_mov_b64 v[48:49], 0
    v_mov_b64 v[50:51], 0
    v_mov_b64 v[52:53], 0
    v_mov_b64 v[54:55], 0
    v_mov_b64 v[56:57], 0
    v_mov_b64 v[58:59], 0
    v_mov_b64 v[60:61], 0
    v_mov_b64 v[62:63], 0
    v_mov_b64 v[64:65], 0
    v_mov_b64 v[66:67], 0
    v_mov_b64 v[68:69], 0
    v_mov_b64 v[70:71], 0
    v_mov_b64 v[72:73], 0
    v_mov_b64 v[74:75], 0
    s_mov_b32 s58, 0
    s_add_u32 s36, s35, 0
    s_lshl_b32 s40, s50, 1
    s_add_u32 s40, s40, s36
    buffer_load_dwordx4 a[0:3], v2, s[4:7], s40 offen offset:0
    buffer_load_dwordx4 a[4:7], v2, s[4:7], s40 offen offset:1024
    s_lshl_b32 s40, s51, 1
    s_add_u32 s40, s40, s36
    buffer_load_dwordx4 a[8:11], v2, s[4:7], s40 offen offset:0
    buffer_load_dwordx4 a[12:15], v2, s[4:7], s40 offen offset:1024
    s_lshl_b32 s40, s52, 1
    s_add_u32 s40, s40, s36
    buffer_load_dwordx4 a[16:19], v2, s[4:7], s40 offen offset:0
    buffer_load_dwordx4 a[20:23], v2, s[4:7], s40 offen offset:1024
    s_lshl_b32 s40, s53, 1
    s_add_u32 s40, s40, s36
    buffer_load_dwordx4 a[24:27], v2, s[4:7], s40 offen offset:0
    buffer_load_dwordx4 a[28:31], v2, s[4:7], s40 offen offset:1024
    s_lshl_b32 s40, s54, 1
    s_add_u32 s40, s40, s36
    buffer_load_dwordx4 a[32:35], v2, s[4:7], s40 offen offset:0
    buffer_load_dwordx4 a[36:39], v2, s[4:7], s40 offen offset:1024
    s_lshl_b32 s40, s55, 1
    s_add_u32 s40, s40, s36
    s_add_u32 s38, s37, 0
    s_mov_b32 m0, s38
    s_nop 0
    buffer_load_dwordx4 v2, s[4:7], s40 offen offset:0 lds
    buffer_load_dwordx4 v2, s[4:7], s40 offen offset:1024 lds
    s_lshl_b32 s40, s56, 1
    s_add_u32 s40, s40, s36
    s_add_u32 s38, s37, 2048
    s_mov_b32 m0, s38
    s_nop 0
    buffer_load_dwordx4 v2, s[4:7], s40 offen offset:0 lds
    buffer_load_dwordx4 v2, s[4:7], s40 offen offset:1024 lds
    s_waitcnt vmcnt(40)
    s_add_u32 s36, s35, 14336
    s_lshl_b32 s40, s50, 1
    s_add_u32 s40, s40, s36
    buffer_load_dwordx4 a[40:43], v2, s[4:7], s40 offen offset:0
    buffer_load_dwordx4 a[44:47], v2, s[4:7], s40 offen offset:1024
    s_lshl_b32 s40, s51, 1
    s_add_u32 s40, s40, s36
    buffer_load_dwordx4 a[48:51], v2, s[4:7], s40 offen offset:0
    buffer_load_dwordx4 a[52:55], v2, s[4:7], s40 offen offset:1024
    s_lshl_b32 s40, s52, 1
    s_add_u32 s40, s40, s36
    buffer_load_dwordx4 a[56:59], v2, s[4:7], s40 offen offset:0
    buffer_load_dwordx4 a[60:63], v2, s[4:7], s40 offen offset:1024
    s_lshl_b32 s40, s53, 1
    s_add_u32 s40, s40, s36
    buffer_load_dwordx4 a[64:67], v2, s[4:7], s40 offen offset:0
    buffer_load_dwordx4 a[68:71], v2, s[4:7], s40 offen offset:1024
    s_lshl_b32 s40, s54, 1
    s_add_u32 s40, s40, s36
    buffer_load_dwordx4 a[72:75], v2, s[4:7], s40 offen offset:0
    buffer_load_dwordx4 a[76:79], v2, s[4:7], s40 offen offset:1024
    s_lshl_b32 s40, s55, 1
    s_add_u32 s40, s40, s36
    s_add_u32 s38, s37, 4096
    s_mov_b32 m0, s38
    s_nop 0
    buffer_load_dwordx4 v2, s[4:7], s40 offen offset:0 lds
    buffer_load_dwordx4 v2, s[4:7], s40 offen offset:1024 lds
    s_lshl_b32 s40, s56, 1
    s_add_u32 s40, s40, s36
    s_add_u32 s38, s37, 6144
    s_mov_b32 m0, s38
    s_nop 0
    buffer_load_dwordx4 v2, s[4:7], s40 offen offset:0 lds
    buffer_load_dwordx4 v2, s[4:7], s40 offen offset:1024 lds
    s_waitcnt vmcnt(40)
    s_add_u32 s36, s35, 401408
    s_lshl_b32 s40, s50, 1
    s_add_u32 s40, s40, s36
    buffer_load_dwordx4 a[80:83], v2, s[4:7], s40 offen offset:0
    buffer_load_dwordx4 a[84:87], v2, s[4:7], s40 offen offset:1024
    s_lshl_b32 s40, s51, 1
    s_add_u32 s40, s40, s36
    buffer_load_dwordx4 a[88:91], v2, s[4:7], s40 offen offset:0
    buffer_load_dwordx4 a[92:95], v2, s[4:7], s40 offen offset:1024
    s_lshl_b32 s40, s52, 1
    s_add_u32 s40, s40, s36
    buffer_load_dwordx4 a[96:99], v2, s[4:7], s40 offen offset:0
    buffer_load_dwordx4 a[100:103], v2, s[4:7], s40 offen offset:1024
    s_lshl_b32 s40, s53, 1
    s_add_u32 s40, s40, s36
    buffer_load_dwordx4 a[104:107], v2, s[4:7], s40 offen offset:0
    buffer_load_dwordx4 a[108:111], v2, s[4:7], s40 offen offset:1024
    s_lshl_b32 s40, s54, 1
    s_add_u32 s40, s40, s36
    buffer_load_dwordx4 a[112:115], v2, s[4:7], s40 offen offset:0
    buffer_load_dwordx4 a[116:119], v2, s[4:7], s40 offen offset:1024
    s_lshl_b32 s40, s55, 1
    s_add_u32 s40, s40, s36
    s_add_u32 s38, s37, 8192
    s_mov_b32 m0, s38
    s_nop 0
    buffer_load_dwordx4 v2, s[4:7], s40 offen offset:0 lds
    buffer_load_dwordx4 v2, s[4:7], s40 offen offset:1024 lds
    s_lshl_b32 s40, s56, 1
    s_add_u32 s40, s40, s36
    s_add_u32 s38, s37, 10240
    s_mov_b32 m0, s38
    s_nop 0
    buffer_load_dwordx4 v2, s[4:7], s40 offen offset:0 lds
    buffer_load_dwordx4 v2, s[4:7], s40 offen offset:1024 lds
    s_waitcnt vmcnt(28)
    ds_read_b128 v[108:111], v6 offset:0
    ds_read_b128 v[112:115], v6 offset:1024
    ds_read_b128 v[116:119], v6 offset:2048
    ds_read_b128 v[120:123], v6 offset:3072
    v_smfmac_f32_16x16x64_bf16 v[44:47], v[16:19], a[0:7], v5
    v_smfmac_f32_16x16x64_bf16 v[44:47], v[20:23], a[8:15], v5
    v_smfmac_f32_16x16x64_bf16 v[44:47], v[24:27], a[16:23], v5
    v_smfmac_f32_16x16x64_bf16 v[44:47], v[28:31], a[24:31], v5
    v_smfmac_f32_16x16x64_bf16 v[44:47], v[32:35], a[32:39], v5
    s_waitcnt lgkmcnt(0)
    v_smfmac_f32_16x16x64_bf16 v[44:47], v[36:39], v[108:115], v5
    v_smfmac_f32_16x16x64_bf16 v[44:47], v[40:43], v[116:123], v5
    s_add_u32 s36, s35, 415744
    s_lshl_b32 s40, s50, 1
    s_add_u32 s40, s40, s36
    buffer_load_dwordx4 a[120:123], v2, s[4:7], s40 offen offset:0
    buffer_load_dwordx4 a[124:127], v2, s[4:7], s40 offen offset:1024
    s_lshl_b32 s40, s51, 1
    s_add_u32 s40, s40, s36
    buffer_load_dwordx4 a[128:131], v2, s[4:7], s40 offen offset:0
    buffer_load_dwordx4 a[132:135], v2, s[4:7], s40 offen offset:1024
    s_lshl_b32 s40, s52, 1
    s_add_u32 s40, s40, s36
    buffer_load_dwordx4 a[136:139], v2, s[4:7], s40 offen offset:0
    buffer_load_dwordx4 a[140:143], v2, s[4:7], s40 offen offset:1024
    s_lshl_b32 s40, s53, 1
    s_add_u32 s40, s40, s36
    buffer_load_dwordx4 a[144:147], v2, s[4:7], s40 offen offset:0
    buffer_load_dwordx4 a[148:151], v2, s[4:7], s40 offen offset:1024
    s_lshl_b32 s40, s54, 1
    s_add_u32 s40, s40, s36
    buffer_load_dwordx4 a[152:155], v2, s[4:7], s40 offen offset:0
    buffer_load_dwordx4 a[156:159], v2, s[4:7], s40 offen offset:1024
    s_lshl_b32 s40, s55, 1
    s_add_u32 s40, s40, s36
    s_add_u32 s38, s37, 12288
    s_mov_b32 m0, s38
    s_nop 0
    buffer_load_dwordx4 v2, s[4:7], s40 offen offset:0 lds
    buffer_load_dwordx4 v2, s[4:7], s40 offen offset:1024 lds
    s_lshl_b32 s40, s56, 1
    s_add_u32 s40, s40, s36
    s_add_u32 s38, s37, 14336
    s_mov_b32 m0, s38
    s_nop 0
    buffer_load_dwordx4 v2, s[4:7], s40 offen offset:0 lds
    buffer_load_dwordx4 v2, s[4:7], s40 offen offset:1024 lds
    s_waitcnt vmcnt(28)
    ds_read_b128 v[124:127], v6 offset:4096
    ds_read_b128 v[128:131], v6 offset:5120
    ds_read_b128 v[132:135], v6 offset:6144
    ds_read_b128 v[136:139], v6 offset:7168
    v_smfmac_f32_16x16x64_bf16 v[48:51], v[16:19], a[40:47], v5
    v_smfmac_f32_16x16x64_bf16 v[48:51], v[20:23], a[48:55], v5
    v_smfmac_f32_16x16x64_bf16 v[48:51], v[24:27], a[56:63], v5
    v_smfmac_f32_16x16x64_bf16 v[48:51], v[28:31], a[64:71], v5
    v_smfmac_f32_16x16x64_bf16 v[48:51], v[32:35], a[72:79], v5
    v_cvt_pk_bf16_f32 v172, v44, v45
    v_cvt_pk_bf16_f32 v174, v46, v47
    s_waitcnt lgkmcnt(0)
    v_smfmac_f32_16x16x64_bf16 v[48:51], v[36:39], v[124:131], v5
    v_smfmac_f32_16x16x64_bf16 v[48:51], v[40:43], v[132:139], v5
    s_add_u32 s36, s35, 802816
    s_lshl_b32 s40, s50, 1
    s_add_u32 s40, s40, s36
    buffer_load_dwordx4 a[160:163], v2, s[4:7], s40 offen offset:0
    buffer_load_dwordx4 a[164:167], v2, s[4:7], s40 offen offset:1024
    s_lshl_b32 s40, s51, 1
    s_add_u32 s40, s40, s36
    buffer_load_dwordx4 a[168:171], v2, s[4:7], s40 offen offset:0
    buffer_load_dwordx4 a[172:175], v2, s[4:7], s40 offen offset:1024
    s_lshl_b32 s40, s52, 1
    s_add_u32 s40, s40, s36
    buffer_load_dwordx4 a[176:179], v2, s[4:7], s40 offen offset:0
    buffer_load_dwordx4 a[180:183], v2, s[4:7], s40 offen offset:1024
    s_lshl_b32 s40, s53, 1
    s_add_u32 s40, s40, s36
    buffer_load_dwordx4 a[184:187], v2, s[4:7], s40 offen offset:0
    buffer_load_dwordx4 a[188:191], v2, s[4:7], s40 offen offset:1024
    s_lshl_b32 s40, s54, 1
    s_add_u32 s40, s40, s36
    buffer_load_dwordx4 a[192:195], v2, s[4:7], s40 offen offset:0
    buffer_load_dwordx4 a[196:199], v2, s[4:7], s40 offen offset:1024
    s_lshl_b32 s40, s55, 1
    s_add_u32 s40, s40, s36
    s_add_u32 s38, s37, 16384
    s_mov_b32 m0, s38
    s_nop 0
    buffer_load_dwordx4 v2, s[4:7], s40 offen offset:0 lds
    buffer_load_dwordx4 v2, s[4:7], s40 offen offset:1024 lds
    s_lshl_b32 s40, s56, 1
    s_add_u32 s40, s40, s36
    s_add_u32 s38, s37, 18432
    s_mov_b32 m0, s38
    s_nop 0
    buffer_load_dwordx4 v2, s[4:7], s40 offen offset:0 lds
    buffer_load_dwordx4 v2, s[4:7], s40 offen offset:1024 lds
    s_waitcnt vmcnt(28)
    ds_read_b128 v[108:111], v6 offset:8192
    ds_read_b128 v[112:115], v6 offset:9216
    ds_read_b128 v[116:119], v6 offset:10240
    ds_read_b128 v[120:123], v6 offset:11264
    v_smfmac_f32_16x16x64_bf16 v[52:55], v[16:19], a[80:87], v5
    v_smfmac_f32_16x16x64_bf16 v[52:55], v[20:23], a[88:95], v5
    v_smfmac_f32_16x16x64_bf16 v[52:55], v[24:27], a[96:103], v5
    v_smfmac_f32_16x16x64_bf16 v[52:55], v[28:31], a[104:111], v5
    v_smfmac_f32_16x16x64_bf16 v[52:55], v[32:35], a[112:119], v5
    v_cvt_pk_bf16_f32 v180, v48, v49
    v_cvt_pk_bf16_f32 v182, v50, v51
    s_waitcnt lgkmcnt(0)
    v_smfmac_f32_16x16x64_bf16 v[52:55], v[36:39], v[108:115], v5
    v_smfmac_f32_16x16x64_bf16 v[52:55], v[40:43], v[116:123], v5
    v_and_b32 v189, 15, v0
    v_lshlrev_b32 v189, 2, v189
    buffer_load_dword v188, v189, s[8:11], 0 offen offset:32 sc1
    s_mov_b32 s40, 67690752
    buffer_load_dword v15, off, s[4:7], s40 sc1
    s_add_u32 s36, s35, 817152
    s_lshl_b32 s40, s50, 1
    s_add_u32 s40, s40, s36
    buffer_load_dwordx4 a[200:203], v2, s[4:7], s40 offen offset:0
    buffer_load_dwordx4 a[204:207], v2, s[4:7], s40 offen offset:1024
    s_lshl_b32 s40, s51, 1
    s_add_u32 s40, s40, s36
    buffer_load_dwordx4 a[208:211], v2, s[4:7], s40 offen offset:0
    buffer_load_dwordx4 a[212:215], v2, s[4:7], s40 offen offset:1024
    s_lshl_b32 s40, s52, 1
    s_add_u32 s40, s40, s36
    buffer_load_dwordx4 a[216:219], v2, s[4:7], s40 offen offset:0
    buffer_load_dwordx4 a[220:223], v2, s[4:7], s40 offen offset:1024
    s_lshl_b32 s40, s53, 1
    s_add_u32 s40, s40, s36
    buffer_load_dwordx4 a[224:227], v2, s[4:7], s40 offen offset:0
    buffer_load_dwordx4 a[228:231], v2, s[4:7], s40 offen offset:1024
    s_lshl_b32 s40, s54, 1
    s_add_u32 s40, s40, s36
    buffer_load_dwordx4 a[232:235], v2, s[4:7], s40 offen offset:0
    buffer_load_dwordx4 a[236:239], v2, s[4:7], s40 offen offset:1024
    s_lshl_b32 s40, s55, 1
    s_add_u32 s40, s40, s36
    s_add_u32 s38, s37, 20480
    s_mov_b32 m0, s38
    s_nop 0
    buffer_load_dwordx4 v2, s[4:7], s40 offen offset:0 lds
    buffer_load_dwordx4 v2, s[4:7], s40 offen offset:1024 lds
    s_lshl_b32 s40, s56, 1
    s_add_u32 s40, s40, s36
    s_add_u32 s38, s37, 22528
    s_mov_b32 m0, s38
    s_nop 0
    buffer_load_dwordx4 v2, s[4:7], s40 offen offset:0 lds
    buffer_load_dwordx4 v2, s[4:7], s40 offen offset:1024 lds
    s_waitcnt vmcnt(28)
    ds_read_b128 v[124:127], v6 offset:12288
    ds_read_b128 v[128:131], v6 offset:13312
    ds_read_b128 v[132:135], v6 offset:14336
    ds_read_b128 v[136:139], v6 offset:15360
    v_smfmac_f32_16x16x64_bf16 v[56:59], v[16:19], a[120:127], v5
    v_smfmac_f32_16x16x64_bf16 v[56:59], v[20:23], a[128:135], v5
    v_smfmac_f32_16x16x64_bf16 v[56:59], v[24:27], a[136:143], v5
    v_smfmac_f32_16x16x64_bf16 v[56:59], v[28:31], a[144:151], v5
    v_smfmac_f32_16x16x64_bf16 v[56:59], v[32:35], a[152:159], v5
    v_cvt_pk_bf16_f32 v173, v52, v53
    v_cvt_pk_bf16_f32 v175, v54, v55
    s_waitcnt lgkmcnt(0)
    v_smfmac_f32_16x16x64_bf16 v[56:59], v[36:39], v[124:131], v5
    v_smfmac_f32_16x16x64_bf16 v[56:59], v[40:43], v[132:139], v5
    s_add_u32 s36, s35, 1204224
    s_lshl_b32 s40, s50, 1
    s_add_u32 s40, s40, s36
    buffer_load_dwordx4 a[240:243], v2, s[4:7], s40 offen offset:0
    buffer_load_dwordx4 a[244:247], v2, s[4:7], s40 offen offset:1024
    s_lshl_b32 s40, s51, 1
    s_add_u32 s40, s40, s36
    buffer_load_dwordx4 a[248:251], v2, s[4:7], s40 offen offset:0
    buffer_load_dwordx4 a[252:255], v2, s[4:7], s40 offen offset:1024
    s_lshl_b32 s40, s52, 1
    s_add_u32 s40, s40, s36
    buffer_load_dwordx4 v[192:195], v2, s[4:7], s40 offen offset:0
    buffer_load_dwordx4 v[196:199], v2, s[4:7], s40 offen offset:1024
    s_lshl_b32 s40, s53, 1
    s_add_u32 s40, s40, s36
    buffer_load_dwordx4 v[200:203], v2, s[4:7], s40 offen offset:0
    buffer_load_dwordx4 v[204:207], v2, s[4:7], s40 offen offset:1024
    s_lshl_b32 s40, s54, 1
    s_add_u32 s40, s40, s36
    buffer_load_dwordx4 v[208:211], v2, s[4:7], s40 offen offset:0
    buffer_load_dwordx4 v[212:215], v2, s[4:7], s40 offen offset:1024
    s_lshl_b32 s40, s55, 1
    s_add_u32 s40, s40, s36
    s_add_u32 s38, s37, 24576
    s_mov_b32 m0, s38
    s_nop 0
    buffer_load_dwordx4 v2, s[4:7], s40 offen offset:0 lds
    buffer_load_dwordx4 v2, s[4:7], s40 offen offset:1024 lds
    s_lshl_b32 s40, s56, 1
    s_add_u32 s40, s40, s36
    s_add_u32 s38, s37, 26624
    s_mov_b32 m0, s38
    s_nop 0
    buffer_load_dwordx4 v2, s[4:7], s40 offen offset:0 lds
    buffer_load_dwordx4 v2, s[4:7], s40 offen offset:1024 lds
    s_waitcnt vmcnt(28)
    ds_read_b128 v[108:111], v6 offset:16384
    ds_read_b128 v[112:115], v6 offset:17408
    ds_read_b128 v[116:119], v6 offset:18432
    ds_read_b128 v[120:123], v6 offset:19456
    v_smfmac_f32_16x16x64_bf16 v[60:63], v[16:19], a[160:167], v5
    v_smfmac_f32_16x16x64_bf16 v[60:63], v[20:23], a[168:175], v5
    v_smfmac_f32_16x16x64_bf16 v[60:63], v[24:27], a[176:183], v5
    v_smfmac_f32_16x16x64_bf16 v[60:63], v[28:31], a[184:191], v5
    v_smfmac_f32_16x16x64_bf16 v[60:63], v[32:35], a[192:199], v5
    v_cvt_pk_bf16_f32 v181, v56, v57
    v_cvt_pk_bf16_f32 v183, v58, v59
    s_waitcnt lgkmcnt(0)
    v_smfmac_f32_16x16x64_bf16 v[60:63], v[36:39], v[108:115], v5
    v_smfmac_f32_16x16x64_bf16 v[60:63], v[40:43], v[116:123], v5
    s_waitcnt vmcnt(28)
    v_cmp_le_u32 vcc, 64, v15
    s_cbranch_vccz Lue_57
    s_add_u32 s21, s18, 4096
    buffer_load_dwordx4 v[76:79], v2, s[4:7], s18 offen offset:0 sc1
    buffer_load_dwordx4 v[84:87], v2, s[4:7], s18 offen offset:1024 sc1
    buffer_load_dwordx4 v[80:83], v2, s[4:7], s18 offen offset:2048 sc1
    buffer_load_dwordx4 v[88:91], v2, s[4:7], s18 offen offset:3072 sc1
    buffer_load_dwordx4 v[92:95], v2, s[4:7], s21 offen offset:0 sc1
    buffer_load_dwordx4 v[100:103], v2, s[4:7], s21 offen offset:1024 sc1
    buffer_load_dwordx4 v[96:99], v2, s[4:7], s21 offen offset:2048 sc1
    buffer_load_dwordx4 v[104:107], v2, s[4:7], s21 offen offset:3072 sc1
    s_add_u32 s18, s18, 458752
    s_mov_b32 s58, 1
Lue_57:
    s_add_u32 s36, s35, 1218560
    s_lshl_b32 s40, s50, 1
    s_add_u32 s40, s40, s36
    buffer_load_dwordx4 v[216:219], v2, s[4:7], s40 offen offset:0
    buffer_load_dwordx4 v[220:223], v2, s[4:7], s40 offen offset:1024
    s_lshl_b32 s40, s51, 1
    s_add_u32 s40, s40, s36
    buffer_load_dwordx4 v[224:227], v2, s[4:7], s40 offen offset:0
    buffer_load_dwordx4 v[228:231], v2, s[4:7], s40 offen offset:1024
    s_lshl_b32 s40, s52, 1
    s_add_u32 s40, s40, s36
    buffer_load_dwordx4 v[232:235], v2, s[4:7], s40 offen offset:0
    buffer_load_dwordx4 v[236:239], v2, s[4:7], s40 offen offset:1024
    s_lshl_b32 s40, s53, 1
    s_add_u32 s40, s40, s36
    buffer_load_dwordx4 v[240:243], v2, s[4:7], s40 offen offset:0
    buffer_load_dwordx4 v[244:247], v2, s[4:7], s40 offen offset:1024
    s_lshl_b32 s40, s54, 1
    s_add_u32 s40, s40, s36
    buffer_load_dwordx4 v[248:251], v2, s[4:7], s40 offen offset:0
    buffer_load_dwordx4 v[252:255], v2, s[4:7], s40 offen offset:1024
    s_lshl_b32 s40, s55, 1
    s_add_u32 s40, s40, s36
    s_add_u32 s38, s37, 28672
    s_mov_b32 m0, s38
    s_nop 0
    buffer_load_dwordx4 v2, s[4:7], s40 offen offset:0 lds
    buffer_load_dwordx4 v2, s[4:7], s40 offen offset:1024 lds
    s_lshl_b32 s40, s56, 1
    s_add_u32 s40, s40, s36
    s_add_u32 s38, s37, 30720
    s_mov_b32 m0, s38
    s_nop 0
    buffer_load_dwordx4 v2, s[4:7], s40 offen offset:0 lds
    buffer_load_dwordx4 v2, s[4:7], s40 offen offset:1024 lds
    s_waitcnt vmcnt(28)
    ds_read_b128 v[124:127], v6 offset:20480
    ds_read_b128 v[128:131], v6 offset:21504
    ds_read_b128 v[132:135], v6 offset:22528
    ds_read_b128 v[136:139], v6 offset:23552
    v_smfmac_f32_16x16x64_bf16 v[64:67], v[16:19], a[200:207], v5
    v_smfmac_f32_16x16x64_bf16 v[64:67], v[20:23], a[208:215], v5
    v_smfmac_f32_16x16x64_bf16 v[64:67], v[24:27], a[216:223], v5
    v_smfmac_f32_16x16x64_bf16 v[64:67], v[28:31], a[224:231], v5
    v_smfmac_f32_16x16x64_bf16 v[64:67], v[32:35], a[232:239], v5
    v_cvt_pk_bf16_f32 v176, v60, v61
    v_cvt_pk_bf16_f32 v178, v62, v63
    s_waitcnt lgkmcnt(0)
    v_smfmac_f32_16x16x64_bf16 v[64:67], v[36:39], v[124:131], v5
    v_smfmac_f32_16x16x64_bf16 v[64:67], v[40:43], v[132:139], v5
    v_lshrrev_b32 v108, 4, v1
    v_and_b32 v109, 15, v1
    s_lshl_b32 s40, s13, 11
    v_add_u32 v7, s40, v2
    v_lshrrev_b32 v12, 1, v108
    v_lshlrev_b32 v12, 8, v12
    v_lshl_add_u32 v12, v109, 4, v12
    s_lshl_b32 s40, s13, 9
    s_add_u32 s40, s40, 8192
    v_add_u32 v8, s40, v12
    s_mul_i32 s40, s13, 1152
    s_add_u32 s40, s40, 7168
    v_mul_u32_u24 v12, 288, v108
    v_lshl_add_u32 v12, v109, 4, v12
    v_lshrrev_b32 v13, 3, v109
    v_lshl_add_u32 v12, v13, 4, v12
    v_add_u32 v9, s40, v12
    v_and_b32 v12, 3, v1
    v_lshlrev_b32 v12, 6, v12
    v_bfe_u32 v13, v1, 1, 1
    v_lshl_add_u32 v12, v13, 4, v12
    v_lshrrev_b32 v13, 5, v1
    v_lshl_add_u32 v12, v13, 5, v12
    v_lshrrev_b32 v13, 2, v1
    v_and_b32 v14, 3, v13
    v_lshl_add_u32 v12, v14, 2, v12
    v_bfe_u32 v14, v1, 4, 1
    v_mul_u32_u24 v14, 288, v14
    v_add_u32 v12, v12, v14
    s_and_b32 s40, s13, 1
    s_mul_i32 s40, s40, 576
    s_add_u32 s40, s40, 7168
    v_add_u32 v10, s40, v12
    s_lshl_b32 s40, s26, 1
    s_and_b32 s41, s13, 1
    s_add_u32 s40, s40, s41
    s_lshl_b32 s40, s40, 8
    v_lshlrev_b32 v11, 2, v1
    v_add_u32 v11, s40, v11
    s_mov_b32 s14, 0
    s_lshr_b32 s16, s13, 1
    s_mul_i32 s16, s16, 14336
    s_add_u32 s16, s16, 62849024
    s_mov_b32 s47, 63955968
    s_mov_b32 s49, 62849024
    s_and_b32 s17, s26, 1
    s_mul_i32 s17, s17, 0
    s_add_u32 s17, s17, 63307776
    s_mul_i32 s19, s13, 57344
    s_lshl_b32 s40, s26, 11
    s_add_u32 s19, s19, s40
    s_add_u32 s19, s19, 48168960
    s_mov_b32 s43, s19
    s_mov_b32 s14, 0
    s_waitcnt vmcnt(14)
    ds_read_b128 v[108:111], v6 offset:24576
    ds_read_b128 v[112:115], v6 offset:25600
    ds_read_b128 v[116:119], v6 offset:26624
    ds_read_b128 v[120:123], v6 offset:27648
    v_smfmac_f32_16x16x64_bf16 v[68:71], v[16:19], a[240:247], v5
    v_smfmac_f32_16x16x64_bf16 v[68:71], v[20:23], a[248:255], v5
    v_smfmac_f32_16x16x64_bf16 v[68:71], v[24:27], v[192:199], v5
    v_smfmac_f32_16x16x64_bf16 v[68:71], v[28:31], v[200:207], v5
    v_smfmac_f32_16x16x64_bf16 v[68:71], v[32:35], v[208:215], v5
    v_cvt_pk_bf16_f32 v184, v64, v65
    v_cvt_pk_bf16_f32 v186, v66, v67
    s_waitcnt lgkmcnt(0)
    v_smfmac_f32_16x16x64_bf16 v[68:71], v[36:39], v[108:115], v5
    v_smfmac_f32_16x16x64_bf16 v[68:71], v[40:43], v[116:123], v5
    s_waitcnt vmcnt(0)
    ds_read_b128 v[124:127], v6 offset:28672
    ds_read_b128 v[128:131], v6 offset:29696
    ds_read_b128 v[132:135], v6 offset:30720
    ds_read_b128 v[136:139], v6 offset:31744
    v_smfmac_f32_16x16x64_bf16 v[72:75], v[16:19], v[216:223], v5
    v_smfmac_f32_16x16x64_bf16 v[72:75], v[20:23], v[224:231], v5
    v_smfmac_f32_16x16x64_bf16 v[72:75], v[24:27], v[232:239], v5
    v_smfmac_f32_16x16x64_bf16 v[72:75], v[28:31], v[240:247], v5
    v_smfmac_f32_16x16x64_bf16 v[72:75], v[32:35], v[248:255], v5
    v_cvt_pk_bf16_f32 v177, v68, v69
    v_cvt_pk_bf16_f32 v179, v70, v71
    s_waitcnt lgkmcnt(0)
    v_smfmac_f32_16x16x64_bf16 v[72:75], v[36:39], v[124:131], v5
    v_smfmac_f32_16x16x64_bf16 v[72:75], v[40:43], v[132:139], v5
    s_cmp_eq_u32 s58, 1
    s_cbranch_scc1 Luf_58
    s_mov_b32 s21, 67690752
    s_mov_b32 s20, 0
Lwf_59:
    buffer_load_dword v12, off, s[4:7], s21 sc1
    s_add_u32 s20, s20, 1
    s_cmp_gt_u32 s20, s23
    s_cbranch_scc1 L_fail
    s_waitcnt vmcnt(0)
    v_cmp_le_u32 vcc, 64, v12
    s_cbranch_vccnz Lwfd_60
    s_sleep 1
    s_branch Lwf_59
Lwfd_60:
    s_add_u32 s21, s18, 4096
    buffer_load_dwordx4 v[76:79], v2, s[4:7], s18 offen offset:0 sc1
    buffer_load_dwordx4 v[84:87], v2, s[4:7], s18 offen offset:1024 sc1
    buffer_load_dwordx4 v[80:83], v2, s[4:7], s18 offen offset:2048 sc1
    buffer_load_dwordx4 v[88:91], v2, s[4:7], s18 offen offset:3072 sc1
    buffer_load_dwordx4 v[92:95], v2, s[4:7], s21 offen offset:0 sc1
    buffer_load_dwordx4 v[100:103], v2, s[4:7], s21 offen offset:1024 sc1
    buffer_load_dwordx4 v[96:99], v2, s[4:7], s21 offen offset:2048 sc1
    buffer_load_dwordx4 v[104:107], v2, s[4:7], s21 offen offset:3072 sc1
    s_add_u32 s18, s18, 458752
Luf_58:
    s_waitcnt vmcnt(0)
    s_mov_b32 s20, 0
    s_branch Lwm_61e
Lwm_61:
    buffer_load_dword v188, v189, s[8:11], 0 offen offset:32 sc1
    s_add_u32 s20, s20, 1
    s_cmp_gt_u32 s20, s23
    s_cbranch_scc1 L_fail
    s_waitcnt vmcnt(0)
Lwm_61e:
    v_cmp_eq_u32 vcc, 32, v188
    s_nop 1
    v_add_u32_dpp v188, v188, v188 row_ror:8 row_mask:0xf bank_mask:0xf
    s_nop 1
    v_add_u32_dpp v188, v188, v188 row_ror:4 row_mask:0xf bank_mask:0xf
    s_nop 1
    v_add_u32_dpp v188, v188, v188 row_ror:2 row_mask:0xf bank_mask:0xf
    s_nop 1
    v_add_u32_dpp v188, v188, v188 row_ror:1 row_mask:0xf bank_mask:0xf
    s_nop 0
    v_readfirstlane_b32 s15, v188
    s_nop 3
    s_cmp_lt_u32 s15, 32
    s_cbranch_scc1 Lwm_61
    s_cmp_lg_u64 vcc, 0
    s_cselect_b32 s15, 1, 2
    v_add_u32 v188, 1152, v10
    v_add_u32 v189, 2304, v10
    v_add_u32 v190, 3456, v10
    v_pk_mov_b32 v[140:141], v[76:77], v[80:81] op_sel:[0,0]
    v_pk_mov_b32 v[142:143], v[76:77], v[80:81] op_sel:[1,1]
    v_pk_mov_b32 v[144:145], v[78:79], v[82:83] op_sel:[0,0]
    v_pk_mov_b32 v[146:147], v[78:79], v[82:83] op_sel:[1,1]
    v_pk_mov_b32 v[148:149], v[84:85], v[88:89] op_sel:[0,0]
    v_pk_mov_b32 v[150:151], v[84:85], v[88:89] op_sel:[1,1]
    v_pk_mov_b32 v[152:153], v[86:87], v[90:91] op_sel:[0,0]
    v_pk_mov_b32 v[154:155], v[86:87], v[90:91] op_sel:[1,1]
    v_mov_b32 v15, 0
    s_add_u32 s21, s18, 4096
    buffer_load_dwordx4 v[76:79], v2, s[4:7], s18 offen offset:0 sc1
    buffer_load_dwordx4 v[84:87], v2, s[4:7], s18 offen offset:1024 sc1
    buffer_load_dwordx4 v[80:83], v2, s[4:7], s18 offen offset:2048 sc1
    buffer_load_dwordx4 v[88:91], v2, s[4:7], s18 offen offset:3072 sc1
    s_add_u32 s18, s18, 458752
    s_branch L_B_mid
    s_branch L_B_loop
.p2align 8
L_B_loop:
    s_waitcnt vmcnt(1)
    s_add_u32 s21, s18, -454656
    s_sub_u32 s22, s18, 458752
    buffer_load_dwordx4 v[92:95], v2, s[4:7], s21 offen offset:0 sc1
    buffer_load_dwordx4 v[100:103], v2, s[4:7], s21 offen offset:1024 sc1
    buffer_load_dwordx4 v[96:99], v2, s[4:7], s21 offen offset:2048 sc1
    buffer_load_dwordx4 v[104:107], v2, s[4:7], s21 offen offset:3072 sc1
    buffer_load_dwordx4 v[16:19], v3, s[4:7], s49 offen sc1
    buffer_load_dwordx4 v[20:23], v4, s[4:7], s49 offen sc1
    v_pk_mov_b32 v[140:141], v[76:77], v[80:81] op_sel:[0,0]
    v_pk_mov_b32 v[142:143], v[76:77], v[80:81] op_sel:[1,1]
    v_pk_mov_b32 v[144:145], v[78:79], v[82:83] op_sel:[0,0]
    v_pk_mov_b32 v[146:147], v[78:79], v[82:83] op_sel:[1,1]
    v_pk_mov_b32 v[148:149], v[84:85], v[88:89] op_sel:[0,0]
    v_pk_mov_b32 v[150:151], v[84:85], v[88:89] op_sel:[1,1]
    v_pk_mov_b32 v[152:153], v[86:87], v[90:91] op_sel:[0,0]
    v_pk_mov_b32 v[154:155], v[86:87], v[90:91] op_sel:[1,1]
    v_mov_b64 v[44:45], 0
    v_mov_b64 v[46:47], 0
    v_mov_b64 v[48:49], 0
    v_mov_b64 v[50:51], 0
    v_mov_b64 v[52:53], 0
    v_mov_b64 v[54:55], 0
    v_mov_b64 v[56:57], 0
    v_mov_b64 v[58:59], 0
    v_mov_b64 v[60:61], 0
    v_mov_b64 v[62:63], 0
    v_mov_b64 v[64:65], 0
    v_mov_b64 v[66:67], 0
    v_mov_b64 v[68:69], 0
    v_mov_b64 v[70:71], 0
    v_mov_b64 v[72:73], 0
    v_mov_b64 v[74:75], 0
    v_add_u32 v126, s52, v2
    v_add_u32 v127, s53, v2
    v_add_u32 v128, s54, v2
    v_add_u32 v129, s55, v2
    v_add_u32 v130, s56, v2
    s_add_u32 s45, s14, 1
    s_lshr_b32 s45, s45, 2
    s_lshl_b32 s45, s45, 7
    s_add_u32 s45, s45, 67678208
    s_cmp_eq_u32 s14, 0
    s_cselect_b32 s45, 67690752, s45
    s_add_u32 s44, s43, 28672
    ds_read_b128 v[108:111], v6 offset:0
    ds_read_b128 v[112:115], v6 offset:1024
    ds_read_b128 v[116:119], v6 offset:2048
    ds_read_b128 v[120:123], v6 offset:3072
    s_mov_b32 s20, 0
    s_branch Lgm_62w
Lgm_62:
    buffer_load_dwordx4 v[16:19], v3, s[4:7], s49 offen sc1
    buffer_load_dwordx4 v[20:23], v4, s[4:7], s49 offen sc1
    s_add_u32 s20, s20, 1
    s_cmp_gt_u32 s20, s23
    s_cbranch_scc1 L_fail
Lgm_62w:
    s_waitcnt vmcnt(1)
    v_max3_u32 v12, v16, v17, v18
    s_waitcnt vmcnt(0)
    v_max3_u32 v13, v20, v21, v22
    v_max3_u32 v12, v12, v19, v23
    v_max_u32 v12, v12, v13
    v_cmp_eq_u32 vcc, -1, v12
    s_cbranch_vccnz Lgm_62
    ds_write_b128 v3, v[16:19] offset:0
    ds_write_b128 v4, v[20:23] offset:0
    s_cmp_eq_u32 s14, 0
    s_cbranch_scc1 Lbt_64
    s_cmp_ge_u32 s13, 2
    s_cbranch_scc1 Lbs_63
    buffer_store_dword v191, v11, s[4:7], s47 offen sc1
    s_branch Lbt_64
Lbs_63:
    s_cmp_eq_u32 s13, 2
    s_cselect_b32 s21, s14, 0
    s_cmp_le_u32 s21, 61
    s_cbranch_scc1 Lbt_64
    s_cmp_eq_u32 s14, 63
    s_cbranch_scc1 Lbt_64
    s_lshl_b32 s21, s14, 7
    s_add_u32 s21, s21, 67682048
    s_mov_b64 exec, 1
    v_mov_b32 v12, 1
    buffer_atomic_add v12, off, s[4:7], s21
    s_mov_b64 exec, -1
Lbt_64:
    s_cmp_lt_u32 s14, 61
    s_cbranch_scc1 Lum_65
    v_min_u32 v172, -2, v172
    v_min_u32 v173, -2, v173
    v_min_u32 v174, -2, v174
    v_min_u32 v175, -2, v175
    v_min_u32 v176, -2, v176
    v_min_u32 v177, -2, v177
    v_min_u32 v178, -2, v178
    v_min_u32 v179, -2, v179
    v_min_u32 v180, -2, v180
    v_min_u32 v181, -2, v181
    v_min_u32 v182, -2, v182
    v_min_u32 v183, -2, v183
    v_min_u32 v184, -2, v184
    v_min_u32 v185, -2, v185
    v_min_u32 v186, -2, v186
    v_min_u32 v187, -2, v187
    buffer_store_dwordx4 v[172:175], v2, s[4:7], s43 offen offset:0 sc1
    buffer_store_dwordx4 v[180:183], v2, s[4:7], s43 offen offset:1024 sc1
    buffer_store_dwordx4 v[176:179], v2, s[4:7], s44 offen offset:0 sc1
    buffer_store_dwordx4 v[184:187], v2, s[4:7], s44 offen offset:1024 sc1
Lum_65:
    s_cmp_ge_u32 s14, 62
    s_cbranch_scc1 Lsk_66
    v_cmp_le_u32 vcc, 32, v15
    s_cbranch_vccnz Lnu_67
    s_mov_b32 s20, 0
Lwf_68:
    buffer_load_dword v12, off, s[4:7], s45 sc1
    s_add_u32 s20, s20, 1
    s_cmp_gt_u32 s20, s23
    s_cbranch_scc1 L_fail
    s_waitcnt vmcnt(0)
    v_cmp_le_u32 vcc, 32, v12
    s_cbranch_vccnz Lwfd_69
    s_sleep 8
    s_branch Lwf_68
Lwfd_69:
Lnu_67:
    s_add_u32 s21, s18, 4096
    buffer_load_dwordx4 v[76:79], v2, s[4:7], s18 offen offset:0 sc1
    buffer_load_dwordx4 v[84:87], v2, s[4:7], s18 offen offset:1024 sc1
    buffer_load_dwordx4 v[80:83], v2, s[4:7], s18 offen offset:2048 sc1
    buffer_load_dwordx4 v[88:91], v2, s[4:7], s18 offen offset:3072 sc1
Lsk_66:
    s_add_u32 s18, s18, 458752
    v_mov_b32 v15, 32
    s_add_u32 s45, s14, 2
    s_and_b32 s21, s45, 3
    s_cbranch_scc1 Llf_70
    s_lshl_b32 s45, s45, 5
    s_add_u32 s45, s45, 67678208
    buffer_load_dword v15, off, s[4:7], s45 sc1
Llf_70:
    v_smfmac_f32_16x16x64_bf16 v[44:47], v[16:19], a[0:7], v5
    v_smfmac_f32_16x16x64_bf16 v[48:51], v[16:19], a[40:47], v5
    v_smfmac_f32_16x16x64_bf16 v[52:55], v[16:19], a[80:87], v5
    v_smfmac_f32_16x16x64_bf16 v[56:59], v[16:19], a[120:127], v5
    v_smfmac_f32_16x16x64_bf16 v[60:63], v[16:19], a[160:167], v5
    v_smfmac_f32_16x16x64_bf16 v[64:67], v[16:19], a[200:207], v5
    s_waitcnt lgkmcnt(0)
    s_barrier
    ds_read_b128 v[24:27], v126 offset:0
    v_smfmac_f32_16x16x64_bf16 v[68:71], v[16:19], a[240:247], v5
    ds_read_b128 v[28:31], v127 offset:0
    v_smfmac_f32_16x16x64_bf16 v[72:75], v[16:19], v[216:223], v5
    ds_read_b128 v[32:35], v128 offset:0
    v_smfmac_f32_16x16x64_bf16 v[44:47], v[20:23], a[8:15], v5
    ds_read_b128 v[36:39], v129 offset:0
    v_smfmac_f32_16x16x64_bf16 v[48:51], v[20:23], a[48:55], v5
    ds_read_b128 v[40:43], v130 offset:0
    v_smfmac_f32_16x16x64_bf16 v[52:55], v[20:23], a[88:95], v5
    v_smfmac_f32_16x16x64_bf16 v[56:59], v[20:23], a[128:135], v5
    v_smfmac_f32_16x16x64_bf16 v[60:63], v[20:23], a[168:175], v5
    v_smfmac_f32_16x16x64_bf16 v[64:67], v[20:23], a[208:215], v5
    v_smfmac_f32_16x16x64_bf16 v[68:71], v[20:23], a[248:255], v5
    v_smfmac_f32_16x16x64_bf16 v[72:75], v[20:23], v[224:231], v5
    s_waitcnt lgkmcnt(4)
    v_smfmac_f32_16x16x64_bf16 v[44:47], v[24:27], a[16:23], v5
    ds_read_b128 v[124:127], v6 offset:4096
    s_waitcnt lgkmcnt(4)
    v_smfmac_f32_16x16x64_bf16 v[44:47], v[28:31], a[24:31], v5
    ds_read_b128 v[128:131], v6 offset:5120
    s_waitcnt lgkmcnt(4)
    v_smfmac_f32_16x16x64_bf16 v[44:47], v[32:35], a[32:39], v5
    s_waitcnt lgkmcnt(3)
    v_smfmac_f32_16x16x64_bf16 v[44:47], v[36:39], v[108:115], v5
    ds_read_b128 v[132:135], v6 offset:6144
    s_waitcnt lgkmcnt(3)
    v_smfmac_f32_16x16x64_bf16 v[44:47], v[40:43], v[116:123], v5
    ds_read_b128 v[136:139], v6 offset:7168
    v_smfmac_f32_16x16x64_bf16 v[48:51], v[24:27], a[56:63], v5
    ds_read_b128 v[108:111], v6 offset:8192
    v_smfmac_f32_16x16x64_bf16 v[48:51], v[28:31], a[64:71], v5
    ds_read_b128 v[112:115], v6 offset:9216
    v_smfmac_f32_16x16x64_bf16 v[48:51], v[32:35], a[72:79], v5
    v_cvt_pk_bf16_f32 v172, v44, v45
    v_cvt_pk_bf16_f32 v174, v46, v47
    s_waitcnt lgkmcnt(2)
    v_smfmac_f32_16x16x64_bf16 v[48:51], v[36:39], v[124:131], v5
    ds_read_b128 v[116:119], v6 offset:10240
    v_smfmac_f32_16x16x64_bf16 v[48:51], v[40:43], v[132:139], v5
    ds_read_b128 v[120:123], v6 offset:11264
    v_smfmac_f32_16x16x64_bf16 v[52:55], v[24:27], a[96:103], v5
    ds_read_b128 v[124:127], v6 offset:12288
    v_smfmac_f32_16x16x64_bf16 v[52:55], v[28:31], a[104:111], v5
    ds_read_b128 v[128:131], v6 offset:13312
    v_smfmac_f32_16x16x64_bf16 v[52:55], v[32:35], a[112:119], v5
    v_cvt_pk_bf16_f32 v180, v48, v49
    v_cvt_pk_bf16_f32 v182, v50, v51
    s_waitcnt lgkmcnt(2)
    v_smfmac_f32_16x16x64_bf16 v[52:55], v[36:39], v[108:115], v5
    ds_read_b128 v[132:135], v6 offset:14336
    v_smfmac_f32_16x16x64_bf16 v[52:55], v[40:43], v[116:123], v5
    ds_read_b128 v[136:139], v6 offset:15360
    v_smfmac_f32_16x16x64_bf16 v[56:59], v[24:27], a[136:143], v5
    ds_read_b128 v[108:111], v6 offset:16384
    v_smfmac_f32_16x16x64_bf16 v[56:59], v[28:31], a[144:151], v5
    ds_read_b128 v[112:115], v6 offset:17408
    v_smfmac_f32_16x16x64_bf16 v[56:59], v[32:35], a[152:159], v5
    v_cvt_pk_bf16_f32 v173, v52, v53
    v_cvt_pk_bf16_f32 v175, v54, v55
    s_waitcnt lgkmcnt(2)
    v_smfmac_f32_16x16x64_bf16 v[56:59], v[36:39], v[124:131], v5
    ds_read_b128 v[116:119], v6 offset:18432
    v_smfmac_f32_16x16x64_bf16 v[56:59], v[40:43], v[132:139], v5
    ds_read_b128 v[120:123], v6 offset:19456
    v_smfmac_f32_16x16x64_bf16 v[60:63], v[24:27], a[176:183], v5
    ds_read_b128 v[124:127], v6 offset:20480
    v_smfmac_f32_16x16x64_bf16 v[60:63], v[28:31], a[184:191], v5
    ds_read_b128 v[128:131], v6 offset:21504
    v_smfmac_f32_16x16x64_bf16 v[60:63], v[32:35], a[192:199], v5
    v_cvt_pk_bf16_f32 v181, v56, v57
    v_cvt_pk_bf16_f32 v183, v58, v59
    s_waitcnt lgkmcnt(2)
    v_smfmac_f32_16x16x64_bf16 v[60:63], v[36:39], v[108:115], v5
    ds_read_b128 v[132:135], v6 offset:22528
    v_smfmac_f32_16x16x64_bf16 v[60:63], v[40:43], v[116:123], v5
    ds_read_b128 v[136:139], v6 offset:23552
    v_smfmac_f32_16x16x64_bf16 v[64:67], v[24:27], a[216:223], v5
    ds_read_b128 v[108:111], v6 offset:24576
    v_smfmac_f32_16x16x64_bf16 v[64:67], v[28:31], a[224:231], v5
    ds_read_b128 v[112:115], v6 offset:25600
    v_smfmac_f32_16x16x64_bf16 v[64:67], v[32:35], a[232:239], v5
    v_cvt_pk_bf16_f32 v176, v60, v61
    v_cvt_pk_bf16_f32 v178, v62, v63
    s_waitcnt lgkmcnt(2)
    v_smfmac_f32_16x16x64_bf16 v[64:67], v[36:39], v[124:131], v5
    ds_read_b128 v[116:119], v6 offset:26624
    v_smfmac_f32_16x16x64_bf16 v[64:67], v[40:43], v[132:139], v5
    ds_read_b128 v[120:123], v6 offset:27648
    v_smfmac_f32_16x16x64_bf16 v[68:71], v[24:27], v[192:199], v5
    ds_read_b128 v[124:127], v6 offset:28672
    v_smfmac_f32_16x16x64_bf16 v[68:71], v[28:31], v[200:207], v5
    ds_read_b128 v[128:131], v6 offset:29696
    v_smfmac_f32_16x16x64_bf16 v[68:71], v[32:35], v[208:215], v5
    v_cvt_pk_bf16_f32 v184, v64, v65
    v_cvt_pk_bf16_f32 v186, v66, v67
    s_waitcnt lgkmcnt(2)
    v_smfmac_f32_16x16x64_bf16 v[68:71], v[36:39], v[108:115], v5
    ds_read_b128 v[132:135], v6 offset:30720
    v_smfmac_f32_16x16x64_bf16 v[68:71], v[40:43], v[116:123], v5
    ds_read_b128 v[136:139], v6 offset:31744
    v_smfmac_f32_16x16x64_bf16 v[72:75], v[24:27], v[232:239], v5
    v_smfmac_f32_16x16x64_bf16 v[72:75], v[28:31], v[240:247], v5
    v_smfmac_f32_16x16x64_bf16 v[72:75], v[32:35], v[248:255], v5
    v_cvt_pk_bf16_f32 v177, v68, v69
    v_cvt_pk_bf16_f32 v179, v70, v71
    s_waitcnt lgkmcnt(0)
    v_smfmac_f32_16x16x64_bf16 v[72:75], v[36:39], v[124:131], v5
    v_smfmac_f32_16x16x64_bf16 v[72:75], v[40:43], v[132:139], v5
L_B_mid:
    s_mov_b32 s43, s19
    s_add_u32 s19, s19, 229376
    v_pk_mov_b32 v[156:157], v[92:93], v[96:97] op_sel:[0,0]
    v_pk_mov_b32 v[158:159], v[92:93], v[96:97] op_sel:[1,1]
    v_pk_mov_b32 v[160:161], v[94:95], v[98:99] op_sel:[0,0]
    v_pk_mov_b32 v[162:163], v[94:95], v[98:99] op_sel:[1,1]
    v_pk_mov_b32 v[164:165], v[100:101], v[104:105] op_sel:[0,0]
    v_pk_mov_b32 v[166:167], v[100:101], v[104:105] op_sel:[1,1]
    v_pk_mov_b32 v[168:169], v[102:103], v[106:107] op_sel:[0,0]
    v_pk_mov_b32 v[170:171], v[102:103], v[106:107] op_sel:[1,1]
    v_cvt_pk_bf16_f32 v185, v72, v73
    v_cvt_pk_bf16_f32 v187, v74, v75
    v_mov_b64 v[108:109], 0
    v_mov_b64 v[110:111], 0
    v_mov_b64 v[112:113], 0
    v_mov_b64 v[114:115], 0
    s_cmp_ge_u32 s14, 63
    s_cbranch_scc1 L_B_end
    s_mov_b32 s20, 0
    buffer_load_dwordx4 v[24:27], v8, s[4:7], s17 offen sc1
    buffer_load_dwordx4 v[16:19], v7, s[4:7], s17 offen sc1
    buffer_load_dwordx4 v[20:23], v7, s[4:7], s17 offen offset:1024 sc1
    s_sleep 0
Lsp_71:
    buffer_load_dwordx4 v[52:55], v8, s[4:7], s17 offen sc1
    buffer_load_dwordx4 v[44:47], v7, s[4:7], s17 offen sc1
    buffer_load_dwordx4 v[48:51], v7, s[4:7], s17 offen offset:1024 sc1
    s_add_u32 s20, s20, 1
    s_cmp_gt_u32 s20, s23
    s_cbranch_scc1 L_fail
    v_mov_b64 v[108:109], 0
    v_mov_b64 v[110:111], 0
    v_mov_b64 v[112:113], 0
    v_mov_b64 v[114:115], 0
    s_waitcnt vmcnt(5)
    v_smfmac_f32_16x16x64_bf16 v[108:111], v[24:27], v[172:179], v5
    v_max3_u32 v12, v24, v25, v26
    v_smfmac_f32_16x16x64_bf16 v[112:115], v[24:27], v[180:187], v5
    v_max_u32 v12, v12, v27
    s_waitcnt vmcnt(4)
    v_smfmac_f32_16x16x64_bf16 v[108:111], v[16:19], v[140:147], v5
    v_max3_u32 v12, v12, v16, v17
    v_smfmac_f32_16x16x64_bf16 v[112:115], v[16:19], v[148:155], v5
    v_max3_u32 v12, v12, v18, v19
    s_waitcnt vmcnt(3)
    v_smfmac_f32_16x16x64_bf16 v[108:111], v[20:23], v[156:163], v5
    v_max3_u32 v12, v12, v20, v21
    v_smfmac_f32_16x16x64_bf16 v[112:115], v[20:23], v[164:171], v5
    v_max3_u32 v12, v12, v22, v23
    v_cmp_eq_u32 vcc, -1, v12
    s_cbranch_vccz Lsd_720
    buffer_load_dwordx4 v[24:27], v8, s[4:7], s17 offen sc1
    buffer_load_dwordx4 v[16:19], v7, s[4:7], s17 offen sc1
    buffer_load_dwordx4 v[20:23], v7, s[4:7], s17 offen offset:1024 sc1
    v_mov_b64 v[116:117], 0
    v_mov_b64 v[118:119], 0
    v_mov_b64 v[120:121], 0
    v_mov_b64 v[122:123], 0
    s_waitcnt vmcnt(5)
    v_smfmac_f32_16x16x64_bf16 v[116:119], v[52:55], v[172:179], v5
    v_max3_u32 v12, v52, v53, v54
    v_smfmac_f32_16x16x64_bf16 v[120:123], v[52:55], v[180:187], v5
    v_max_u32 v12, v12, v55
    s_waitcnt vmcnt(4)
    v_smfmac_f32_16x16x64_bf16 v[116:119], v[44:47], v[140:147], v5
    v_max3_u32 v12, v12, v44, v45
    v_smfmac_f32_16x16x64_bf16 v[120:123], v[44:47], v[148:155], v5
    v_max3_u32 v12, v12, v46, v47
    s_waitcnt vmcnt(3)
    v_smfmac_f32_16x16x64_bf16 v[116:119], v[48:51], v[156:163], v5
    v_max3_u32 v12, v12, v48, v49
    v_smfmac_f32_16x16x64_bf16 v[120:123], v[48:51], v[164:171], v5
    v_max3_u32 v12, v12, v50, v51
    v_cmp_eq_u32 vcc, -1, v12
    s_cbranch_vccnz Lsp_71
    s_nop 4
    v_permlane32_swap_b32 v116, v120
    v_permlane32_swap_b32 v117, v121
    v_permlane32_swap_b32 v118, v122
    v_permlane32_swap_b32 v119, v123
    v_pk_add_f32 v[108:109], v[116:117], v[120:121]
    v_pk_add_f32 v[110:111], v[118:119], v[122:123]
    ds_write_b128 v9, v[108:111]
    s_branch Lsd_72
Lsd_720:
    s_nop 4
    v_permlane32_swap_b32 v108, v112
    v_permlane32_swap_b32 v109, v113
    v_permlane32_swap_b32 v110, v114
    v_permlane32_swap_b32 v111, v115
    v_pk_add_f32 v[108:109], v[108:109], v[112:113]
    v_pk_add_f32 v[110:111], v[110:111], v[114:115]
    ds_write_b128 v9, v[108:111]
Lsd_72:
    s_add_u32 s16, s16, 7168
    s_add_u32 s47, s47, 7168
    s_add_u32 s48, s16, 7168
    s_add_u32 s49, s49, 7168
    s_add_u32 s17, s17, 10240
    s_cmp_ge_u32 s13, 2
    s_cbranch_scc1 L_B_skip
    s_cmp_eq_u32 s15, 1
    s_waitcnt lgkmcnt(0)
    s_barrier
    ds_read2_b32 v[124:125], v10 offset0:0 offset1:4
    ds_read2_b32 v[126:127], v188 offset0:0 offset1:4
    ds_read2_b32 v[128:129], v189 offset0:0 offset1:4
    ds_read2_b32 v[130:131], v190 offset0:0 offset1:4
    s_waitcnt lgkmcnt(2)
    v_pk_add_f32 v[124:125], v[124:125], v[126:127]
    s_waitcnt lgkmcnt(1)
    v_pk_add_f32 v[124:125], v[124:125], v[128:129]
    s_waitcnt lgkmcnt(0)
    v_pk_add_f32 v[124:125], v[124:125], v[130:131]
    v_cvt_pk_bf16_f32 v124, v124, v125
    v_min_u32 v124, -2, v124
    buffer_store_dword v124, v11, s[4:7], s16 offen
    s_cbranch_scc0 Lslow_73
Lpub_74:
    v_mov_b32 v191, v124
    s_cmp_lg_u32 s14, 62
    s_cbranch_scc1 L_B_skip2
    buffer_store_dword v124, v11, s[4:7], s47 offen sc1
    s_branch L_B_skip2
L_B_skip:
    s_waitcnt lgkmcnt(0)
    s_barrier
    s_waitcnt vmcnt(0)
L_B_skip2:
    s_barrier
    s_add_u32 s14, s14, 1
    s_branch L_B_loop
L_B_end:
    v_min_u32 v172, -2, v172
    v_min_u32 v173, -2, v173
    v_min_u32 v174, -2, v174
    v_min_u32 v175, -2, v175
    v_min_u32 v176, -2, v176
    v_min_u32 v177, -2, v177
    v_min_u32 v178, -2, v178
    v_min_u32 v179, -2, v179
    v_min_u32 v180, -2, v180
    v_min_u32 v181, -2, v181
    v_min_u32 v182, -2, v182
    v_min_u32 v183, -2, v183
    v_min_u32 v184, -2, v184
    v_min_u32 v185, -2, v185
    v_min_u32 v186, -2, v186
    v_min_u32 v187, -2, v187
    s_add_u32 s44, s43, 28672
    buffer_store_dwordx4 v[172:175], v2, s[4:7], s43 offen offset:0 sc1
    buffer_store_dwordx4 v[180:183], v2, s[4:7], s43 offen offset:1024 sc1
    buffer_store_dwordx4 v[176:179], v2, s[4:7], s44 offen offset:0 sc1
    buffer_store_dwordx4 v[184:187], v2, s[4:7], s44 offen offset:1024 sc1
    s_endpgm
Lslow_73:
    buffer_store_dword v124, v11, s[4:7], s16 offen sc1
    s_branch Lpub_74
L_roleP:
    s_mov_b32 s23, 400000
    s_sub_u32 s26, s12, 30
    s_lshl_b32 s26, s26, 2
    s_add_u32 s26, s26, s13
    v_and_b32 v1, 63, v0
    v_lshlrev_b32 v2, 7, v1
    s_mul_i32 s40, s26, 57344
    v_add_u32 v2, s40, v2
    v_min_u32 v3, 55, v1
    s_mul_i32 s40, s26, 56
    v_add_lshl_u32 v3, v3, s40, 6
    v_min_u32 v4, 19, v1
    s_mul_i32 s40, s26, 20
    v_add_lshl_u32 v4, v4, s40, 6
    v_min_u32 v5, 13, v1
    s_mul_i32 s40, s26, 14
    v_add_lshl_u32 v5, v5, s40, 6
    s_mov_b32 s14, 0
    s_mov_b32 s18, 18350080
    s_mov_b32 s19, 14680064
    s_mov_b32 s17, 63307776
    s_mov_b32 s16, 62856192
    s_mov_b32 s41, 62834688
L_P_loop:
    s_cmp_le_u32 s14, 2
    s_cbranch_scc1 L_P_go
    s_mov_b32 s20, 0
L_P_wait:
    buffer_load_dword v8, off, s[4:7], s41 sc1
    s_add_u32 s20, s20, 1
    s_cmp_gt_u32 s20, s23
    s_cbranch_scc1 L_fail
    s_waitcnt vmcnt(0)
    v_cmp_eq_u32 vcc, -1, v8
    s_cbranch_vccz L_P_go
    s_sleep 2
    s_branch L_P_wait
L_P_go:
    buffer_load_dword v9, v4, s[4:7], s17 offen sc1
    buffer_load_dword v10, v5, s[4:7], s16 offen sc1
    buffer_load_dword v11, v3, s[4:7], s19 offen sc1
    s_mov_b32 s21, s18
    s_add_u32 s18, s18, 458752
    s_add_u32 s19, s19, 28672
    s_add_u32 s17, s17, 10240
    s_add_u32 s16, s16, 7168
    s_add_u32 s41, s41, 7168
    s_add_u32 s14, s14, 1
    s_cmp_lt_u32 s14, 64
    s_cbranch_scc1 L_P_loop
    s_waitcnt vmcnt(0)
    s_endpgm
L_fail:
    s_mov_b64 exec, 1
    v_mov_b32 v2, s14
    v_mov_b32 v3, s12
    v_lshl_add_u32 v2, v3, 8, v2
    v_or_b32 v2, 0x10000, v2
    buffer_store_dword v2, off, s[8:11], 0 offset:8
    v_mov_b32 v3, 163832
    ds_write_b32 v3, v2
    s_waitcnt lgkmcnt(0)
    s_waitcnt vmcnt(0)
L_exit:
    s_endpgm
.section .rodata,"a"
.p2align 6
.amdhsa_kernel main_kernel
  .amdhsa_next_free_vgpr 512
  .amdhsa_next_free_sgpr 96
  .amdhsa_accum_offset 256
  .amdhsa_group_segment_fixed_size 0
  .amdhsa_kernarg_size 120
  .amdhsa_user_sgpr_count 2
  .amdhsa_user_sgpr_kernarg_segment_ptr 1
  .amdhsa_system_sgpr_workgroup_id_x 1
.end_amdhsa_kernel
.text
```
